```python
import torch

def _softmax(x, axis=-1):
    return torch.softmax(x, dim=axis)
def _gelu(x):
    return torch.nn.functional.gelu(x, approximate="tanh")
def _silu(x):
    return torch.nn.functional.silu(x)
def _sigmoid(x):
    return torch.sigmoid(x)
def _layernorm(x, axis=-1, eps=1e-5):
    m = x.mean(dim=axis, keepdim=True)
    v = x.var(dim=axis, keepdim=True, unbiased=False)
    return (x - m) / torch.sqrt(v + eps)
def _scatter_add(tgt, idx, src, axis=0):
    return tgt.clone().index_add_(axis, idx, src)
def _segment_sum(src, seg, n):
    out = torch.zeros((n,) + src.shape[1:], dtype=src.dtype)
    return out.index_add_(0, seg, src)
def _pad(x, pw):
    flat = tuple(v for pair in reversed(pw) for v in pair)
    return torch.nn.functional.pad(x, flat)

kernel_name = 'gated_mix__compressed_kv_cla__dense_activation_silu__prompt'

def setup_inputs():

    _w = (lambda a: (lambda t: t.to(torch.bfloat16) if t.is_floating_point() else t)(torch.as_tensor(a)))
    def _A_setup():
        B, H, Sq, Sk, D, M = 1, 32, 2048, 2048, 128, 576
        Dc = 4 * D
        return {
            "x": _w((lambda *s: torch.randn(*s, dtype=torch.bfloat16) * 0.1)(B, Sq, M)),
            "c_kv": _w((lambda *s: torch.randn(*s, dtype=torch.bfloat16) * 0.8)(B, Sk, Dc)),
            "w_q": _w((lambda *s: torch.randn(*s, dtype=torch.bfloat16) * 6.4)(M, H, D) * (M ** -0.5)),
            "w_uk": _w((lambda *s: torch.randn(*s, dtype=torch.bfloat16) * 6.4)(Dc, H, D) * (Dc ** -0.5)),
            "w_uv": _w((lambda *s: torch.randn(*s, dtype=torch.bfloat16) * 0.8)(Dc, H, D) * (Dc ** -0.5)),
            "w_o": _w((lambda *s: torch.randn(*s, dtype=torch.bfloat16) * 0.8)(H, D, M) * ((H * D) ** -0.5)),
        }
    _A_in = _A_setup()

    def _B_setup():
        B, S, D, F = 1, 2048, 576, 4608
        return {
            "x": _w((lambda *s: torch.randn(*s, dtype=torch.bfloat16) * 0.1)(B, S, D)),
            "w1": _w((lambda *s: torch.randn(*s, dtype=torch.bfloat16) * 3.2)(D, F) * (D ** -0.5)),
            "w2": _w((lambda *s: torch.randn(*s, dtype=torch.bfloat16) * 3.2)(F, D) * (F ** -0.5)),
        }
    _B_in = _B_setup()

    return {
        "A_x": _A_in["x"],
        "A_c_kv": _A_in["c_kv"],
        "A_w_q": _A_in["w_q"],
        "A_w_uk": _A_in["w_uk"],
        "A_w_uv": _A_in["w_uv"],
        "A_w_o": _A_in["w_o"],
        "B_x": _B_in["x"],
        "B_w1": _B_in["w1"],
        "B_w2": _B_in["w2"],
        "gate_w": _w((lambda *s: torch.randn(*s, dtype=torch.bfloat16) * 0.1)(576) * 16.0),
    }

def reference(A_x, A_c_kv, A_w_q, A_w_uk, A_w_uv, A_w_o, B_x, B_w1, B_w2, gate_w):
    def _A_ref(x, c_kv, w_q, w_uk, w_uv, w_o):
        B, Sq, M = x.shape[0], x.shape[1], x.shape[2]
        Sk = c_kv.shape[1]
        H, D = w_q.shape[1], w_q.shape[2]
        q = torch.einsum("bqm,mhd->bhqd", x, w_q)
        k = torch.einsum("bkc,chd->bhkd", c_kv, w_uk)
        v = torch.einsum("bkc,chd->bhkd", c_kv, w_uv)
        scores = torch.einsum("bhqd,bhkd->bhqk", q, k) * (D ** -0.5)
        off = Sk - Sq
        qi = torch.arange(Sq)[:, None]
        kj = torch.arange(Sk)[None, :]
        cmask = kj <= (qi + off)
        scores = torch.where(cmask[None, None], scores, -1e9)
        p = _softmax(scores, axis=-1)
        ctx = torch.einsum("bhqk,bhkd->bhqd", p, v)
        return torch.einsum("bhqd,hdm->bqm", ctx, w_o)

    def _B_ref(x, w1, w2):
        h = torch.einsum("bsd,df->bsf", x, w1)
        h = _silu(h)
        out = torch.einsum("bsf,fd->bsd", h, w2)
        return out

    x = A_x
    g = _sigmoid((x * gate_w).sum(-1, keepdims=True))
    a = _A_ref(x, A_c_kv, A_w_q, A_w_uk, A_w_uv, A_w_o)
    b = _B_ref(x, B_w1, B_w2)
    return g * a + (1 - g) * b
```

```asm
; @launch kernel=gated_mix__compressed_kv_cla__dense_activation_silu__prompt_kernel grid=(256,1,1) block=(256,1,1) lds=163840
.amdgcn_target "amdgcn-amd-amdhsa--gfx950"
.text
.macro Mvvv d,a,b
 v_mfma_f32_16x16x32_bf16 v[\d:\d+3], v[\a:\a+3], v[\b:\b+3], v[\d:\d+3]
.endm
.macro Zvvv d,a,b
 v_mfma_f32_16x16x32_bf16 v[\d:\d+3], v[\a:\a+3], v[\b:\b+3], 0
.endm
.macro Cvvv d,a,b,c
 v_mfma_f32_16x16x32_bf16 v[\d:\d+3], v[\a:\a+3], v[\b:\b+3], v[\c:\c+3]
.endm
.macro Mvva d,a,b
 v_mfma_f32_16x16x32_bf16 v[\d:\d+3], v[\a:\a+3], a[\b:\b+3], v[\d:\d+3]
.endm
.macro Zvva d,a,b
 v_mfma_f32_16x16x32_bf16 v[\d:\d+3], v[\a:\a+3], a[\b:\b+3], 0
.endm
.macro Cvva d,a,b,c
 v_mfma_f32_16x16x32_bf16 v[\d:\d+3], v[\a:\a+3], a[\b:\b+3], v[\c:\c+3]
.endm
.macro Mvav d,a,b
 v_mfma_f32_16x16x32_bf16 v[\d:\d+3], a[\a:\a+3], v[\b:\b+3], v[\d:\d+3]
.endm
.macro Zvav d,a,b
 v_mfma_f32_16x16x32_bf16 v[\d:\d+3], a[\a:\a+3], v[\b:\b+3], 0
.endm
.macro Cvav d,a,b,c
 v_mfma_f32_16x16x32_bf16 v[\d:\d+3], a[\a:\a+3], v[\b:\b+3], v[\c:\c+3]
.endm
.macro Mvaa d,a,b
 v_mfma_f32_16x16x32_bf16 v[\d:\d+3], a[\a:\a+3], a[\b:\b+3], v[\d:\d+3]
.endm
.macro Zvaa d,a,b
 v_mfma_f32_16x16x32_bf16 v[\d:\d+3], a[\a:\a+3], a[\b:\b+3], 0
.endm
.macro Cvaa d,a,b,c
 v_mfma_f32_16x16x32_bf16 v[\d:\d+3], a[\a:\a+3], a[\b:\b+3], v[\c:\c+3]
.endm
.macro Mavv d,a,b
 v_mfma_f32_16x16x32_bf16 a[\d:\d+3], v[\a:\a+3], v[\b:\b+3], a[\d:\d+3]
.endm
.macro Zavv d,a,b
 v_mfma_f32_16x16x32_bf16 a[\d:\d+3], v[\a:\a+3], v[\b:\b+3], 0
.endm
.macro Cavv d,a,b,c
 v_mfma_f32_16x16x32_bf16 a[\d:\d+3], v[\a:\a+3], v[\b:\b+3], a[\c:\c+3]
.endm
.macro Mava d,a,b
 v_mfma_f32_16x16x32_bf16 a[\d:\d+3], v[\a:\a+3], a[\b:\b+3], a[\d:\d+3]
.endm
.macro Zava d,a,b
 v_mfma_f32_16x16x32_bf16 a[\d:\d+3], v[\a:\a+3], a[\b:\b+3], 0
.endm
.macro Cava d,a,b,c
 v_mfma_f32_16x16x32_bf16 a[\d:\d+3], v[\a:\a+3], a[\b:\b+3], a[\c:\c+3]
.endm
.macro Maav d,a,b
 v_mfma_f32_16x16x32_bf16 a[\d:\d+3], a[\a:\a+3], v[\b:\b+3], a[\d:\d+3]
.endm
.macro Zaav d,a,b
 v_mfma_f32_16x16x32_bf16 a[\d:\d+3], a[\a:\a+3], v[\b:\b+3], 0
.endm
.macro Caav d,a,b,c
 v_mfma_f32_16x16x32_bf16 a[\d:\d+3], a[\a:\a+3], v[\b:\b+3], a[\c:\c+3]
.endm
.macro Maaa d,a,b
 v_mfma_f32_16x16x32_bf16 a[\d:\d+3], a[\a:\a+3], a[\b:\b+3], a[\d:\d+3]
.endm
.macro Zaaa d,a,b
 v_mfma_f32_16x16x32_bf16 a[\d:\d+3], a[\a:\a+3], a[\b:\b+3], 0
.endm
.macro Caaa d,a,b,c
 v_mfma_f32_16x16x32_bf16 a[\d:\d+3], a[\a:\a+3], a[\b:\b+3], a[\c:\c+3]
.endm
.macro Tv d,p,o
 ds_read_b64_tr_b16 v[\d:\d+1], v\p offset:\o
.endm
.macro Lv d,p,o
 ds_read_b128 v[\d:\d+3], v\p offset:\o
.endm
.macro Ta d,p,o
 ds_read_b64_tr_b16 a[\d:\d+1], v\p offset:\o
.endm
.macro La d,p,o
 ds_read_b128 a[\d:\d+3], v\p offset:\o
.endm
.macro PK d,a,b
 v_cvt_pk_bf16_f32 v\d, v\a, v\b
.endm
.globl gated_mix__compressed_kv_cla__dense_activation_silu__prompt_kernel
.p2align 12
.type gated_mix__compressed_kv_cla__dense_activation_silu__prompt_kernel,@function
gated_mix__compressed_kv_cla__dense_activation_silu__prompt_kernel:
s_cmp_lt_u32 s2, 0x100
s_cbranch_scc1 M_in
s_endpgm
M_in:
v_lshrrev_b32 v232, 6, v0
v_and_b32 v15, 63, v0
s_mov_b32 s50, 0
s_mov_b32 s88, 0
v_readfirstlane_b32 s24, v232
M_start:
s_load_dwordx2 s[56:57], s[0:1], 8
s_load_dwordx2 s[60:61], s[0:1], 24
s_load_dwordx2 s[16:17], s[0:1], 96
s_load_dwordx2 s[64:65], s[0:1], 32
s_load_dwordx2 s[12:13], s[0:1], 0
s_load_dwordx2 s[8:9], s[0:1], 16
s_load_dwordx2 s[4:5], s[0:1], 56
s_load_dwordx2 s[68:69], s[0:1], 72
s_load_dwordx2 s[20:21], s[0:1], 88
s_load_dwordx2 s[96:97], s[0:1], 64
s_load_dwordx2 s[98:99], s[0:1], 40
s_load_dwordx2 s[100:101], s[0:1], 80
s_lshr_b32 s26, s2, 5
s_and_b32 s39, s24, 1
s_lshr_b32 s40, s24, 1
s_mul_i32 s38, s24, 0xa000
s_bfe_u32 s35, s2, 0x20003
s_and_b32 s25, s2, 7
s_lshl_b32 s25, s25, 2
s_add_u32 s25, s25, s35
s_lshl_b32 s35, s35, 1
s_add_u32 s35, s35, s26
s_and_b32 s37, s2, 1
s_add_u32 s35, s35, s37
s_and_b32 s33, s35, 7
s_lshl_b32 s37, s24, 15
s_lshl_b32 s73, s26, 17
s_add_u32 s29, s37, s73
s_add_u32 s30, s29, 0x4000
s_sub_u32 s73, 0x1e0000, s73
s_add_u32 s27, s37, s73
s_add_u32 s28, s27, 0x4000
v_lshrrev_b32 v232, 3, v15
s_movk_i32 s36, 0x400
v_mul_u32_u24 v11, s36, v232
v_lshrrev_b32 v233, 1, v232
v_and_b32 v234, 7, v15
v_xor_b32 v233, v233, v234
v_lshlrev_b32 v233, 4, v233
v_xor_b32 v234, 64, v233
v_add_u32 v12, v11, v234
v_add_u32 v12, 0x1c00, v12
v_add_u32 v11, v11, v233
v_and_b32 v233, 2, v232
s_lshl_b32 s37, s39, 2
v_or_b32 v233, s37, v233
v_and_b32 v234, 7, v15
v_xor_b32 v233, v233, v234
v_lshlrev_b32 v233, 4, v233
s_lshl_b32 s37, s24, 3
v_add_u32 v232, s37, v232
s_lshl_b32 s37, s25, 8
v_lshlrev_b32 v0, 13, v232
v_add3_u32 v0, v0, v233, s37
v_add_u32 v2, 0x3fc00, v0
s_mov_b32 s58, 0x200000
s_mov_b32 s59, 0x20000
s_mov_b32 s62, 0x400000
s_mov_b32 s63, 0x20000
s_mov_b32 s18, 0x10000000
s_mov_b32 s19, 0x20000
s_mov_b32 s66, 0x400000
s_mov_b32 s67, 0x20000
s_mov_b32 s14, 0x240000
s_mov_b32 s15, 0x20000
s_mov_b32 s10, 0x480000
s_mov_b32 s11, 0x20000
s_mov_b32 s6, 0x510000
s_mov_b32 s7, 0x20000
s_mov_b32 s70, 0x480
s_mov_b32 s71, 0x20000
s_mov_b32 s22, 0x100
s_mov_b32 s23, 0x20000
s_getpc_b64 s[74:75]
M_pc:
s_lshr_b32 s76, s2, 3
s_lshl_b32 s76, s76, 2
s_add_u32 s76, s76, s24
s_mul_i32 s76, s76, 11
v_min_u32 v216, 10, v15
v_add_u32 v216, s76, v216
v_lshlrev_b32 v216, 7, v216
v_min_u32 v216, M_end-M_pc-4, v216
v_mov_b32 v217, s75
v_add_co_u32 v216, vcc, s74, v216
s_nop 1
v_addc_co_u32 v217, vcc, 0, v217, vcc
global_load_dword v218, v[216:217], off
s_waitcnt lgkmcnt(0)
s_lshl_b32 s34, s33, 7
s_add_u32 m0, s38, 0x2000
s_add_u32 s36, s27, s34
buffer_load_dwordx4 v11, s[56:59], s36 offen lds
buffer_load_dwordx4 v12, s[56:59], s36 offen offset:1024 lds
s_add_u32 m0, s38, 0x2800
s_add_u32 s36, s28, s34
buffer_load_dwordx4 v11, s[56:59], s36 offen lds
buffer_load_dwordx4 v12, s[56:59], s36 offen offset:1024 lds
s_add_u32 m0, s38, 0x3000
s_add_u32 s36, s29, s34
buffer_load_dwordx4 v11, s[56:59], s36 offen lds
buffer_load_dwordx4 v12, s[56:59], s36 offen offset:1024 lds
s_add_u32 m0, s38, 0x3800
s_add_u32 s36, s30, s34
buffer_load_dwordx4 v11, s[56:59], s36 offen lds
buffer_load_dwordx4 v12, s[56:59], s36 offen offset:1024 lds
s_add_u32 m0, s38, 0
s_mul_i32 s36, s33, 0x80000
buffer_load_dwordx4 v0, s[60:63], s36 offen lds
buffer_load_dwordx4 v2, s[60:63], s36 offen offset:1024 lds
s_add_u32 m0, s38, 0x800
s_mul_i32 s36, s33, 0x80000
s_add_u32 s36, s36, 0x80
buffer_load_dwordx4 v0, s[60:63], s36 offen lds
buffer_load_dwordx4 v2, s[60:63], s36 offen offset:1024 lds
s_add_u32 s33, s33, 1
s_and_b32 s33, s33, 7
s_lshl_b32 s37, s26, 2
s_add_u32 s37, s37, s24
s_lshl_b32 s49, s37, 13
s_mul_i32 s53, s37, 0x2400
s_lshl_b32 s37, s25, 8
s_add_u32 s49, s49, s37
s_lshl_b32 s51, s2, 2
s_add_u32 s51, s51, s24
s_mul_i32 s51, s51, 0x900
s_lshl_b32 s73, s24, 28
s_add_u32 s73, s73, 0x6100000
s_lshl_b32 s37, s2, 8
s_add_u32 s37, s37, s73
s_add_u32 s77, s37, 0x10000
s_lshl_b32 s72, s25, 3
s_add_u32 s72, s72, s26
s_lshl_b32 s72, s72, 7
s_add_u32 s72, s72, s73
s_add_u32 s72, s72, 0x20000
s_lshl_b32 s37, s25, 7
s_add_u32 s73, s73, s37
s_lshl_b32 s37, s26, 12
s_add_u32 s79, s73, s37
s_sub_u32 s37, 0xf000, s37
s_add_u32 s78, s73, s37
s_lshl_b32 s37, s2, 2
s_add_u32 s37, s37, s24
s_lshl_b32 s37, s37, 11
s_add_u32 s37, s37, 0x6100000
s_or_b32 s73, s26, s50
s_cmp_eq_u32 s73, 0
s_cselect_b32 s37, s37, 0x10000000
v_min_u32 v235, 15, v15
v_lshlrev_b32 v235, 7, v235
v_add_u32 v235, s37, v235
v_mov_b32 v234, 0
buffer_store_dword v234, v235, s[16:19], 0 offen sc0 sc1
s_lshr_b32 s73, s25, 2
s_lshl_b32 s37, s25, 1
s_add_u32 s37, s37, s73
s_lshl_b32 s37, s37, 7
s_movk_i32 s36, 0x2400
v_mul_u32_u24 v3, s36, v232
v_add3_u32 v3, v3, v233, s37
v_add_u32 v4, 0x47c00, v3
v_mul_u32_u24 v219, 0x120000, v15
v_add_u32 v219, s53, v219
s_add_u32 s53, s53, s37
v_bfe_u32 v232, v15, 1, 3
s_lshl_b32 s37, s39, 2
v_xor_b32 v232, s37, v232
s_lshl_b32 s37, s24, 3
v_and_b32 v233, 16, v15
v_lshlrev_b32 v233, 1, v233
v_add3_u32 v232, v232, v233, s37
v_mul_u32_u24 v5, s36, v232
v_and_b32 v233, 1, v15
v_lshlrev_b32 v233, 4, v233
v_and_b32 v236, 32, v15
v_lshlrev_b32 v236, 23, v236
v_add3_u32 v5, v5, v233, v236
s_mul_i32 s37, s73, 0x480
s_and_b32 s36, s25, 3
s_lshl_b32 s36, s36, 5
s_add_u32 s37, s37, s36
s_add_u32 s37, s37, 0x400
v_add_u32 v5, s37, v5
s_mul_i32 s36, s36, 0x2400
s_add_u32 s37, s37, s36
v_add_u32 v219, s37, v219
v_lshrrev_b32 v232, 4, v15
s_mov_b32 s37, 0xa000
v_mul_u32_u24 v237, s37, v232
v_and_b32 v233, 1, v232
v_lshlrev_b32 v233, 6, v233
v_add_u32 v248, v237, v233
v_add_u32 v6, v248, v233
v_and_b32 v233, 15, v15
v_lshlrev_b32 v233, 3, v233
v_add_u32 v6, v6, v233
v_xor_b32 v7, 0x80, v6
v_bfe_u32 v233, v15, 2, 2
v_lshlrev_b32 v236, 7, v233
v_add_u32 v248, v248, v236
v_lshrrev_b32 v233, 1, v233
v_lshlrev_b32 v233, 5, v233
v_and_b32 v236, 3, v15
v_lshlrev_b32 v236, 3, v236
v_add3_u32 v248, v248, v233, v236
v_xor_b32 v249, 32, v248
v_xor_b32 v250, 64, v248
v_xor_b32 v251, 0x60, v248
s_mul_i32 s37, s40, 0x14000
s_add_u32 s37, s37, 0x6000
v_lshlrev_b32 v233, 4, v232
v_add_u32 v8, s37, v233
v_and_b32 v236, 15, v15
v_lshrrev_b32 v233, 1, v236
v_xor_b32 v233, v233, v232
v_lshlrev_b32 v233, 4, v233
v_lshlrev_b32 v236, 7, v236
v_add3_u32 v13, v236, v233, s38
v_xor_b32 v14, 64, v13
v_lshlrev_b32 v1, 4, v15
v_add_u32 v10, s38, v1
s_xor_b32 s36, s24, 2
s_mul_i32 s36, s36, 0xa000
v_add_u32 v9, s36, v1
s_sub_u32 s37, s35, 9
s_min_u32 s35, s35, s37
s_mul_i32 s37, s39, 36
s_lshl_b32 s36, s35, 3
s_add_u32 s37, s37, s36
v_min_u32 v232, 35, v15
v_add_u32 v232, s37, v232
v_subrev_u32 v233, 0x48, v232
v_min_u32 v232, v232, v233
v_lshlrev_b32 v255, 4, v232
s_mov_b32 s3, 0x3e0293ee
s_mov_b32 s89, 0xbfb8aa3b
s_mul_i32 s55, s25, 0x80000
s_lshl_b32 s54, s26, 13
s_sub_u32 s52, 0x1e000, s54
s_add_u32 s54, s54, s55
s_add_u32 s52, s52, s55
s_lshl_b32 s37, s40, 1
s_xor_b32 s37, s37, 0
s_add_u32 s36, s37, s39
s_and_b32 s36, s36, 1
s_lshl_b32 s37, s37, 1
s_add_u32 s37, s37, s36
s_lshl_b32 s37, s37, 10
s_add_u32 s41, s37, s52
s_add_u32 s45, s37, s54
s_lshl_b32 s37, s40, 1
s_xor_b32 s37, s37, 1
s_add_u32 s36, s37, s39
s_and_b32 s36, s36, 1
s_lshl_b32 s37, s37, 1
s_add_u32 s37, s37, s36
s_lshl_b32 s37, s37, 10
s_add_u32 s42, s37, s52
s_add_u32 s46, s37, s54
s_lshl_b32 s37, s40, 1
s_xor_b32 s37, s37, 2
s_add_u32 s36, s37, s39
s_and_b32 s36, s36, 1
s_lshl_b32 s37, s37, 1
s_add_u32 s37, s37, s36
s_lshl_b32 s37, s37, 10
s_add_u32 s43, s37, s52
s_add_u32 s47, s37, s54
s_lshl_b32 s37, s40, 1
s_xor_b32 s37, s37, 3
s_add_u32 s36, s37, s39
s_and_b32 s36, s36, 1
s_lshl_b32 s37, s37, 1
s_add_u32 s37, s37, s36
s_lshl_b32 s37, s37, 10
s_add_u32 s44, s37, s52
s_add_u32 s48, s37, s54
s_lshl_b32 s37, s24, 11
s_add_u32 s37, s37, 0x1000000
s_add_u32 s31, s37, s52
s_add_u32 s32, s37, s54
s_mul_i32 s73, s73, 0x40000
s_add_u32 s73, s73, 0x4000000
s_add_u32 s84, s41, s73
s_add_u32 s85, s42, s73
s_add_u32 s86, s45, s73
s_add_u32 s87, s46, s73
s_and_b32 s36, s25, 3
s_lshr_b32 s37, s36, 1
s_lshl_b32 s36, s36, 2
s_sub_u32 s37, s37, s36
s_add_u32 s37, s37, 16
s_mul_i32 s37, s37, 0x20000
s_add_u32 s73, s73, s37
s_and_b32 s36, s25, 1
s_lshl_b32 s36, s36, 10
s_add_u32 s73, s73, s36
s_sub_u32 s73, s73, 0x1000000
s_add_u32 s94, s31, s73
s_add_u32 s95, s32, s73
s_mov_b64 exec, 0
s_cmp_eq_u32 s24, 0
s_cbranch_scc1 M_w0
s_cmp_eq_u32 s24, 1
s_cbranch_scc1 M_w4
s_cmp_eq_u32 s24, 2
s_cbranch_scc1 M_w8
s_branch M_w10
.p2align 12
M_wd:
s_mov_b64 exec, -1
s_lshl_b32 s34, s33, 7
s_add_u32 m0, s38, 0x5800
s_add_u32 s36, s27, s34
buffer_load_dwordx4 v11, s[56:59], s36 offen lds
buffer_load_dwordx4 v12, s[56:59], s36 offen offset:1024 lds
s_add_u32 m0, s38, 0x8000
s_add_u32 s36, s28, s34
buffer_load_dwordx4 v11, s[56:59], s36 offen lds
buffer_load_dwordx4 v12, s[56:59], s36 offen offset:1024 lds
s_add_u32 m0, s38, 0x8800
s_add_u32 s36, s29, s34
buffer_load_dwordx4 v11, s[56:59], s36 offen lds
buffer_load_dwordx4 v12, s[56:59], s36 offen offset:1024 lds
s_add_u32 m0, s38, 0x9000
s_add_u32 s36, s30, s34
buffer_load_dwordx4 v11, s[56:59], s36 offen lds
buffer_load_dwordx4 v12, s[56:59], s36 offen offset:1024 lds
s_add_u32 m0, s38, 0x5000
s_mul_i32 s36, s33, 0x80000
buffer_load_dwordx4 v0, s[60:63], s36 offen lds
buffer_load_dwordx4 v2, s[60:63], s36 offen offset:1024 lds
s_add_u32 m0, s38, 0x7000
s_mul_i32 s36, s33, 0x80000
s_add_u32 s36, s36, 0x80
buffer_load_dwordx4 v0, s[60:63], s36 offen lds
buffer_load_dwordx4 v2, s[60:63], s36 offen offset:1024 lds
s_add_u32 s33, s33, 1
s_and_b32 s33, s33, 7
s_waitcnt vmcnt(17)
La 0,13,8192
La 16,14,8192
La 4,13,10240
La 20,14,10240
La 8,13,12288
La 24,14,12288
La 12,13,14336
La 28,14,14336
s_waitcnt vmcnt(13)
s_barrier
Tv 48,248,0
Tv 50,248,512
Tv 52,248,1024
Tv 54,248,1536
Tv 56,249,0
Tv 58,249,512
Tv 60,249,1024
Tv 62,249,1536
s_waitcnt vmcnt(63) lgkmcnt(4)
Zvva 144,48,0
s_lshl_b32 s34, s33, 7
s_add_u32 m0, s38, 0x1000
s_add_u32 s36, s27, s34
Mvva 144,52,16
buffer_load_dwordx4 v11, s[56:59], s36 offen lds
Zvva 148,48,4
Tv 64,250,0
Mvva 148,52,20
Tv 66,250,512
Zvva 152,48,8
buffer_load_dwordx4 v12, s[56:59], s36 offen offset:1024 lds
Mvva 152,52,24
s_add_u32 m0, s38, 0x1800
s_add_u32 s36, s28, s34
Tv 68,250,1024
Zvva 156,48,12
Tv 70,250,1536
Mvva 156,52,28
s_waitcnt lgkmcnt(4)
buffer_load_dwordx4 v11, s[56:59], s36 offen lds
Zvva 160,56,0
Tv 72,251,0
Mvva 160,60,16
Tv 74,251,512
Zvva 164,56,4
buffer_load_dwordx4 v12, s[56:59], s36 offen offset:1024 lds
Mvva 164,60,20
s_add_u32 m0, s38, 0x4000
s_add_u32 s36, s29, s34
Tv 76,251,1024
Zvva 168,56,8
Tv 78,251,1536
Mvva 168,60,24
buffer_load_dwordx4 v11, s[56:59], s36 offen lds
Zvva 172,56,12
Tv 212,248,2048
Mvva 172,60,28
s_waitcnt lgkmcnt(5)
Tv 214,248,2560
Zvva 176,64,0
buffer_load_dwordx4 v12, s[56:59], s36 offen offset:1024 lds
Mvva 176,68,16
s_add_u32 m0, s38, 0x4800
s_add_u32 s36, s30, s34
Tv 232,248,3072
Zvva 180,64,4
Tv 234,248,3584
Mvva 180,68,20
buffer_load_dwordx4 v11, s[56:59], s36 offen lds
Zvva 184,64,8
Tv 236,249,2048
Mvva 184,68,24
Tv 238,249,2560
Zvva 188,64,12
buffer_load_dwordx4 v12, s[56:59], s36 offen offset:1024 lds
Mvva 188,68,28
s_waitcnt lgkmcnt(6)
s_add_u32 m0, s38, 0x9800
s_mul_i32 s36, s33, 0x80000
Zvva 192,72,0
Tv 240,249,3072
Mvva 192,76,16
buffer_load_dwordx4 v0, s[60:63], s36 offen lds
Zvva 196,72,4
Tv 242,249,3584
Mvva 196,76,20
Tv 48,250,2048
Zvva 200,72,8
buffer_load_dwordx4 v2, s[60:63], s36 offen offset:1024 lds
Mvva 200,76,24
s_add_u32 m0, s38, 0x6000
s_mul_i32 s36, s33, 0x80000
s_add_u32 s36, s36, 0x80
Zvva 204,72,12
Tv 50,250,2560
Mvva 204,76,28
s_waitcnt vmcnt(63) lgkmcnt(6)
buffer_load_dwordx4 v0, s[60:63], s36 offen lds
Zvva 80,212,0
Tv 52,250,3072
Mvva 80,232,16
Tv 54,250,3584
Zvva 84,212,4
Tv 56,251,2048
Mvva 84,232,20
buffer_load_dwordx4 v2, s[60:63], s36 offen offset:1024 lds
Zvva 88,212,8
s_add_u32 s33, s33, 1
s_and_b32 s33, s33, 7
s_lshl_b32 s34, s33, 7
Mvva 88,232,24
s_waitcnt vmcnt(16)
s_add_u32 m0, s38, 0x2000
s_add_u32 s36, s27, s34
Zvva 92,212,12
Tv 58,251,2560
Mvva 92,232,28
s_waitcnt lgkmcnt(6)
buffer_load_dwordx4 v11, s[56:59], s36 offen lds
Zvva 96,236,0
Tv 60,251,3072
Mvva 96,240,16
Tv 62,251,3584
Zvva 100,236,4
La 32,13,22528
Mvva 100,240,20
buffer_load_dwordx4 v12, s[56:59], s36 offen offset:1024 lds
Zvva 104,236,8
s_add_u32 m0, s38, 0x2800
s_add_u32 s36, s28, s34
La 48,14,22528
Mvva 104,240,24
La 36,13,32768
Zvva 108,236,12
La 52,14,32768
Mvva 108,240,28
s_waitcnt lgkmcnt(4)
buffer_load_dwordx4 v11, s[56:59], s36 offen lds
Zvva 112,48,0
s_waitcnt vmcnt(15)
s_barrier
Mvva 112,52,16
Tv 64,248,20480
Zvva 116,48,4
La 40,13,34816
Mvva 116,52,20
buffer_load_dwordx4 v12, s[56:59], s36 offen offset:1024 lds
Zvva 120,48,8
s_add_u32 m0, s38, 0x3000
s_add_u32 s36, s29, s34
Tv 66,248,20992
Mvva 120,52,24
La 56,14,34816
Zvva 124,48,12
Tv 68,248,21504
Mvva 124,52,28
buffer_load_dwordx4 v11, s[56:59], s36 offen lds
Zvva 128,56,0
La 44,13,36864
Mvva 128,60,16
Tv 70,248,22016
Zvva 132,56,4
La 60,14,36864
Mvva 132,60,20
buffer_load_dwordx4 v12, s[56:59], s36 offen offset:1024 lds
Zvva 136,56,8
s_add_u32 m0, s38, 0x3800
s_add_u32 s36, s30, s34
Tv 72,249,20480
Mvva 136,60,24
Tv 74,249,20992
Zvva 140,56,12
Tv 76,249,21504
Mvva 140,60,28
s_waitcnt vmcnt(63) lgkmcnt(3)
buffer_load_dwordx4 v11, s[56:59], s36 offen lds
Mvva 144,64,32
Tv 78,249,22016
Mvva 144,68,48
Tv 212,250,20480
Mvva 148,64,36
Tv 214,250,20992
Mvva 148,68,52
buffer_load_dwordx4 v12, s[56:59], s36 offen offset:1024 lds
Mvva 152,64,40
Tv 232,250,21504
Mvva 152,68,56
s_add_u32 m0, s38, 0x6800
s_mul_i32 s36, s33, 0x80000
Tv 234,250,22016
Mvva 156,64,44
Tv 236,251,20480
v_mov_b32 v216, 1
Mvva 156,68,60
s_waitcnt lgkmcnt(5)
Tv 238,251,20992
v_mov_b32 v217, 0x10000000
Mvva 160,72,32
buffer_load_dwordx4 v0, s[60:63], s36 offen lds
Mvva 160,76,48
s_lshl_b32 s37, s24, 5
s_add_u32 s37, s37, s2
s_lshl_b32 s37, s37, 3
Mvva 164,72,36
Tv 240,251,21504
v_writelane_b32 v217, s37, 0
Mvva 164,76,52
Tv 242,251,22016
Mvva 168,72,40
buffer_load_dwordx4 v2, s[60:63], s36 offen offset:1024 lds
Mvva 168,76,56
s_add_u32 m0, s38, 0x7800
s_mul_i32 s36, s33, 0x80000
s_add_u32 s36, s36, 0x80
Mvva 172,72,44
Tv 48,248,28672
Mvva 172,76,60
s_waitcnt vmcnt(63) lgkmcnt(5)
Tv 50,248,29184
Mvva 176,212,32
buffer_load_dwordx4 v0, s[60:63], s36 offen lds
Mvva 176,232,48
Tv 52,248,29696
Mvva 180,212,36
Tv 54,248,30208
Mvva 180,232,52
Tv 56,249,28672
Mvva 184,212,40
buffer_load_dwordx4 v2, s[60:63], s36 offen offset:1024 lds
Mvva 184,232,56
s_add_u32 s33, s33, 1
s_and_b32 s33, s33, 7
s_lshl_b32 s34, s33, 7
Mvva 188,212,44
s_add_u32 m0, s38, 0x5800
s_add_u32 s36, s27, s34
Tv 58,249,29184
Mvva 188,232,60
s_waitcnt lgkmcnt(6)
Tv 60,249,29696
Mvva 192,236,32
buffer_load_dwordx4 v11, s[56:59], s36 offen lds
Mvva 192,240,48
Tv 62,249,30208
Mvva 196,236,36
Tv 64,250,28672
Mvva 196,240,52
Tv 66,250,29184
Mvva 200,236,40
buffer_load_dwordx4 v12, s[56:59], s36 offen offset:1024 lds
Mvva 200,240,56
s_add_u32 m0, s38, 0x8000
s_add_u32 s36, s28, s34
Tv 68,250,29696
Mvva 204,236,44
Tv 70,250,30208
Mvva 204,240,60
s_waitcnt lgkmcnt(8)
Tv 72,251,28672
Mvva 80,48,32
buffer_load_dwordx4 v11, s[56:59], s36 offen lds
Mvva 80,52,48
Tv 74,251,29184
Mvva 84,48,36
Tv 76,251,29696
Mvva 84,52,52
Tv 78,251,30208
Mvva 88,48,40
buffer_load_dwordx4 v12, s[56:59], s36 offen offset:1024 lds
Mvva 88,52,56
s_waitcnt vmcnt(20)
s_add_u32 m0, s38, 0x8800
s_add_u32 s36, s29, s34
Mvva 92,48,44
La 64,13,4096
Mvva 92,52,60
s_waitcnt lgkmcnt(9)
La 80,14,4096
Mvva 96,56,32
buffer_load_dwordx4 v11, s[56:59], s36 offen lds
Mvva 96,60,48
La 68,13,6144
Mvva 100,56,36
La 84,14,6144
Mvva 100,60,52
La 72,13,16384
Mvva 104,56,40
buffer_load_dwordx4 v12, s[56:59], s36 offen offset:1024 lds
Mvva 104,60,56
La 88,14,16384
Mvva 108,56,44
s_add_u32 m0, s38, 0x9000
s_add_u32 s36, s30, s34
La 76,13,18432
Mvva 108,60,60
s_waitcnt lgkmcnt(7)
La 92,14,18432
Mvva 112,64,32
s_waitcnt vmcnt(18)
s_barrier
Mvva 112,68,48
buffer_load_dwordx4 v11, s[56:59], s36 offen lds
Mvva 116,64,36
Tv 212,248,38912
Mvva 116,68,52
Tv 214,248,39424
Mvva 120,64,40
Tv 232,248,39936
Mvva 120,68,56
buffer_load_dwordx4 v12, s[56:59], s36 offen offset:1024 lds
Mvva 124,64,44
s_add_u32 m0, s38, 0
s_mul_i32 s36, s33, 0x80000
Tv 234,248,40448
Mvva 124,68,60
Tv 236,249,38912
Mvva 128,72,32
Tv 238,249,39424
Mvva 128,76,48
buffer_load_dwordx4 v0, s[60:63], s36 offen lds
Mvva 132,72,36
Tv 240,249,39936
Mvva 132,76,52
Tv 242,249,40448
Mvva 136,72,40
Tv 48,250,38912
Mvva 136,76,56
buffer_load_dwordx4 v2, s[60:63], s36 offen offset:1024 lds
Mvva 140,72,44
s_add_u32 m0, s38, 0x800
s_mul_i32 s36, s33, 0x80000
s_add_u32 s36, s36, 0x80
Mvva 140,76,60
s_waitcnt vmcnt(63) lgkmcnt(5)
Tv 50,250,39424
Mvva 144,212,64
Tv 52,250,39936
Mvva 144,232,80
buffer_load_dwordx4 v0, s[60:63], s36 offen lds
Mvva 148,212,68
Tv 54,250,40448
Mvva 148,232,84
Tv 56,251,38912
Mvva 152,212,72
Tv 58,251,39424
Mvva 152,232,88
buffer_load_dwordx4 v2, s[60:63], s36 offen offset:1024 lds
Mvva 156,212,76
s_add_u32 s33, s33, 1
s_and_b32 s33, s33, 7
s_lshl_b32 s34, s33, 7
Mvva 156,232,92
s_waitcnt lgkmcnt(6)
s_add_u32 m0, s38, 0x1000
s_add_u32 s36, s27, s34
Mvva 160,236,64
Tv 60,251,39936
Mvva 160,240,80
buffer_load_dwordx4 v11, s[56:59], s36 offen lds
Mvva 164,236,68
Tv 62,251,40448
Mvva 164,240,84
Tv 64,248,24576
Mvva 168,236,72
Tv 66,248,25088
Mvva 168,240,88
buffer_load_dwordx4 v12, s[56:59], s36 offen offset:1024 lds
Mvva 172,236,76
s_add_u32 m0, s38, 0x1800
s_add_u32 s36, s28, s34
Tv 68,248,25600
Mvva 172,240,92
s_waitcnt lgkmcnt(7)
Tv 70,248,26112
Mvva 176,48,64
Tv 72,249,24576
Mvva 176,52,80
buffer_load_dwordx4 v11, s[56:59], s36 offen lds
Mvva 180,48,68
Tv 74,249,25088
Mvva 180,52,84
Tv 76,249,25600
Mvva 184,48,72
Tv 78,249,26112
Mvva 184,52,88
buffer_load_dwordx4 v12, s[56:59], s36 offen offset:1024 lds
Mvva 188,48,76
Tv 212,250,24576
Mvva 188,52,92
s_waitcnt lgkmcnt(9)
s_add_u32 m0, s38, 0x4000
s_add_u32 s36, s29, s34
Mvva 192,56,64
Tv 214,250,25088
Mvva 192,60,80
Tv 232,250,25600
Mvva 196,56,68
buffer_load_dwordx4 v11, s[56:59], s36 offen lds
Mvva 196,60,84
Tv 234,250,26112
Mvva 200,56,72
Tv 236,251,24576
Mvva 200,60,88
Tv 238,251,25088
Mvva 204,56,76
buffer_load_dwordx4 v12, s[56:59], s36 offen offset:1024 lds
Mvva 204,60,92
s_waitcnt lgkmcnt(10)
s_add_u32 m0, s38, 0x4800
s_add_u32 s36, s30, s34
Mvva 80,64,64
Tv 240,251,25600
Mvva 80,68,80
Tv 242,251,26112
Mvva 84,64,68
buffer_load_dwordx4 v11, s[56:59], s36 offen lds
Mvva 84,68,84
Mvva 88,64,72
Mvva 88,68,88
s_waitcnt vmcnt(23)
La 96,13,8192
Mvva 92,64,76
buffer_load_dwordx4 v12, s[56:59], s36 offen offset:1024 lds
Mvva 92,68,92
s_waitcnt lgkmcnt(9)
s_add_u32 m0, s38, 0x5000
s_mul_i32 s36, s33, 0x80000
Mvva 96,72,64
La 112,14,8192
Mvva 96,76,80
La 100,13,10240
Mvva 100,72,68
buffer_load_dwordx4 v0, s[60:63], s36 offen lds
Mvva 100,76,84
La 116,14,10240
Mvva 104,72,72
La 104,13,12288
Mvva 104,76,88
La 120,14,12288
Mvva 108,72,76
buffer_load_dwordx4 v2, s[60:63], s36 offen offset:1024 lds
Mvva 108,76,92
s_waitcnt vmcnt(63) lgkmcnt(6)
s_add_u32 m0, s38, 0x7000
s_mul_i32 s36, s33, 0x80000
Mvva 112,212,64
s_waitcnt vmcnt(22)
s_barrier
Mvva 112,232,80
s_add_u32 s36, s36, 0x80
Tv 48,248,26624
Mvva 116,212,68
buffer_load_dwordx4 v0, s[60:63], s36 offen lds
Mvva 116,232,84
Tv 50,248,27136
Mvva 120,212,72
Tv 52,248,27648
Mvva 120,232,88
La 108,13,14336
Mvva 124,212,76
buffer_load_dwordx4 v2, s[60:63], s36 offen offset:1024 lds
Mvva 124,232,92
s_add_u32 s33, s33, 1
s_and_b32 s33, s33, 7
Tv 54,248,28160
Mvva 128,236,64
La 124,14,14336
Mvva 128,240,80
Tv 56,249,26624
Mvva 132,236,68
Tv 58,249,27136
Mvva 132,240,84
Tv 60,249,27648
Mvva 136,236,72
Tv 62,249,28160
Mvva 136,240,88
Tv 64,250,26624
Mvva 140,236,76
Tv 66,250,27136
Mvva 140,240,92
s_waitcnt lgkmcnt(6)
Tv 68,250,27648
Mvva 144,48,96
s_lshl_b32 s34, s33, 7
s_add_u32 m0, s38, 0x2000
s_add_u32 s36, s27, s34
Mvva 144,52,112
buffer_load_dwordx4 v11, s[56:59], s36 offen lds
Mvva 148,48,100
Tv 70,250,28160
Mvva 148,52,116
Tv 72,251,26624
Mvva 152,48,104
buffer_load_dwordx4 v12, s[56:59], s36 offen offset:1024 lds
Mvva 152,52,120
s_add_u32 m0, s38, 0x2800
s_add_u32 s36, s28, s34
Tv 74,251,27136
Mvva 156,48,108
Tv 76,251,27648
Mvva 156,52,124
s_waitcnt lgkmcnt(7)
buffer_load_dwordx4 v11, s[56:59], s36 offen lds
Mvva 160,56,96
Tv 78,251,28160
Mvva 160,60,112
Tv 212,248,30720
Mvva 164,56,100
buffer_load_dwordx4 v12, s[56:59], s36 offen offset:1024 lds
Mvva 164,60,116
s_add_u32 m0, s38, 0x3000
s_add_u32 s36, s29, s34
Tv 214,248,31232
Mvva 168,56,104
Tv 232,248,31744
Mvva 168,60,120
buffer_load_dwordx4 v11, s[56:59], s36 offen lds
Mvva 172,56,108
Tv 234,248,32256
Mvva 172,60,124
s_waitcnt lgkmcnt(8)
Tv 236,249,30720
Mvva 176,64,96
M_w0:
s_cbranch_execz M_w1
buffer_load_dwordx4 v12, s[56:59], s36 offen offset:1024 lds
Mvva 176,68,112
s_add_u32 m0, s38, 0x3800
s_add_u32 s36, s30, s34
Tv 238,249,31232
Mvva 180,64,100
Tv 240,249,31744
Mvva 180,68,116
buffer_load_dwordx4 v11, s[56:59], s36 offen lds
Mvva 184,64,104
Tv 242,249,32256
Mvva 184,68,120
Tv 48,250,30720
Mvva 188,64,108
Tv 50,250,31232
Mvva 188,68,124
s_waitcnt lgkmcnt(10)
buffer_load_dwordx4 v12, s[56:59], s36 offen offset:1024 lds
Mvva 192,72,96
s_add_u32 m0, s38, 0x9800
s_mul_i32 s36, s33, 0x80000
Tv 52,250,31744
Mvva 192,76,112
Tv 54,250,32256
Mvva 196,72,100
Tv 56,251,30720
Mvva 196,76,116
buffer_load_dwordx4 v0, s[60:63], s36 offen lds
Mvva 200,72,104
Tv 58,251,31232
Mvva 200,76,120
Tv 60,251,31744
Mvva 204,72,108
Tv 62,251,32256
Mvva 204,76,124
s_waitcnt vmcnt(63) lgkmcnt(12)
buffer_load_dwordx4 v2, s[60:63], s36 offen offset:1024 lds
Mvva 80,212,96
s_add_u32 m0, s38, 0x6000
s_mul_i32 s36, s33, 0x80000
s_add_u32 s36, s36, 0x80
Mvva 80,232,112
Mvva 84,212,100
Mvva 84,232,116
buffer_load_dwordx4 v0, s[60:63], s36 offen lds
Mvva 88,212,104
Mvva 88,232,120
s_waitcnt vmcnt(27)
La 128,13,22528
Mvva 92,212,108
La 144,14,22528
Mvva 92,232,124
s_waitcnt lgkmcnt(10)
buffer_load_dwordx4 v2, s[60:63], s36 offen offset:1024 lds
Mvva 96,236,96
s_add_u32 s33, s33, 1
s_and_b32 s33, s33, 7
La 132,13,32768
Mvva 96,240,112
La 148,14,32768
Mvva 100,236,100
La 136,13,34816
Mvva 100,240,116
La 152,14,34816
Mvva 104,236,104
La 140,13,36864
Mvva 104,240,120
La 156,14,36864
Mvva 108,236,108
Mvva 108,240,124
s_waitcnt lgkmcnt(8)
Mvva 112,48,96
s_waitcnt vmcnt(24)
s_barrier
Mvva 112,52,112
Tv 64,248,0
Mvva 116,48,100
Tv 66,248,512
Mvva 116,52,116
Tv 68,248,1024
Mvva 120,48,104
Tv 70,248,1536
Mvva 120,52,120
Tv 72,249,0
Mvva 124,48,108
Tv 74,249,512
Mvva 124,52,124
Tv 76,249,1024
Mvva 128,56,96
Tv 78,249,1536
Mvva 128,60,112
Tv 212,250,0
Mvva 132,56,100
Tv 214,250,512
Mvva 132,60,116
Tv 232,250,1024
Mvva 136,56,104
Tv 234,250,1536
Mvva 136,60,120
Tv 236,251,0
Mvva 140,56,108
Tv 238,251,512
Mvva 140,60,124
s_waitcnt lgkmcnt(10)
Tv 240,251,1024
Mvva 144,64,128
s_lshl_b32 s34, s33, 7
s_add_u32 m0, s38, 0x5800
s_add_u32 s36, s27, s34
Mvva 144,68,144
buffer_load_dwordx4 v11, s[56:59], s36 offen lds
Mvva 148,64,132
Tv 242,251,1536
Mvva 148,68,148
Tv 48,248,2048
Mvva 152,64,136
buffer_load_dwordx4 v12, s[56:59], s36 offen offset:1024 lds
Mvva 152,68,152
s_add_u32 m0, s38, 0x8000
s_add_u32 s36, s28, s34
Tv 50,248,2560
Mvva 156,64,140
Tv 52,248,3072
Mvva 156,68,156
s_waitcnt lgkmcnt(11)
buffer_load_dwordx4 v11, s[56:59], s36 offen lds
Mvva 160,72,128
Tv 54,248,3584
Mvva 160,76,144
Tv 56,249,2048
Mvva 164,72,132
buffer_load_dwordx4 v12, s[56:59], s36 offen offset:1024 lds
Mvva 164,76,148
s_add_u32 m0, s38, 0x8800
s_add_u32 s36, s29, s34
Tv 58,249,2560
Mvva 168,72,136
Tv 60,249,3072
Mvva 168,76,152
buffer_load_dwordx4 v11, s[56:59], s36 offen lds
Mvva 172,72,140
Tv 62,249,3584
Mvva 172,76,156
s_waitcnt vmcnt(63) lgkmcnt(12)
Tv 64,250,2048
Mvva 176,212,128
buffer_load_dwordx4 v12, s[56:59], s36 offen offset:1024 lds
Mvva 176,232,144
s_add_u32 m0, s38, 0x9000
s_add_u32 s36, s30, s34
Tv 66,250,2560
Mvva 180,212,132
Tv 68,250,3072
Mvva 180,232,148
buffer_load_dwordx4 v11, s[56:59], s36 offen lds
Mvva 184,212,136
Tv 70,250,3584
Mvva 184,232,152
Tv 72,251,2048
Mvva 188,212,140
buffer_load_dwordx4 v12, s[56:59], s36 offen offset:1024 lds
Mvva 188,232,156
s_waitcnt lgkmcnt(13)
s_add_u32 m0, s38, 0x6800
s_mul_i32 s36, s33, 0x80000
Mvva 192,236,128
Tv 74,251,2560
Mvva 192,240,144
buffer_load_dwordx4 v0, s[60:63], s36 offen lds
Mvva 196,236,132
Tv 76,251,3072
Mvva 196,240,148
Tv 78,251,3584
Mvva 200,236,136
buffer_load_dwordx4 v2, s[60:63], s36 offen offset:1024 lds
Mvva 200,240,152
s_add_u32 m0, s38, 0x7800
s_mul_i32 s36, s33, 0x80000
s_add_u32 s36, s36, 0x80
Mvva 204,236,140
Mvva 204,240,156
s_waitcnt lgkmcnt(12)
buffer_load_dwordx4 v0, s[60:63], s36 offen lds
Mvva 80,48,128
Mvva 80,52,144
Mvva 84,48,132
Mvva 84,52,148
buffer_load_dwordx4 v2, s[60:63], s36 offen offset:1024 lds
Mvva 88,48,136
s_add_u32 s33, s33, 1
s_and_b32 s33, s33, 7
Mvva 88,52,152
s_waitcnt vmcnt(28)
La 160,13,4096
Mvva 92,48,140
La 176,14,4096
Mvva 92,52,156
s_waitcnt lgkmcnt(10)
La 164,13,6144
Mvva 96,56,128
La 180,14,6144
Mvva 96,60,144
La 168,13,16384
Mvva 100,56,132
La 184,14,16384
Mvva 100,60,148
La 172,13,18432
Mvva 104,56,136
La 188,14,18432
Mvva 104,60,152
Mvva 108,56,140
Mvva 108,60,156
s_waitcnt lgkmcnt(8)
Mvva 112,64,128
s_waitcnt vmcnt(24)
s_barrier
Mvva 112,68,144
s_add_u32 m0, s38, 0
s_mul_i32 s36, s33, 0x80000
Tv 212,248,20480
Mvva 116,64,132
buffer_load_dwordx4 v0, s[64:67], s36 offen lds
Mvva 116,68,148
Tv 214,248,20992
Mvva 120,64,136
Tv 232,248,21504
Mvva 120,68,152
buffer_load_dwordx4 v2, s[64:67], s36 offen offset:1024 lds
Mvva 124,64,140
s_add_u32 s33, s33, 1
s_and_b32 s33, s33, 7
s_add_u32 m0, s38, 0x800
Mvva 124,68,156
s_mul_i32 s36, s33, 0x80000
Tv 234,248,22016
Mvva 128,72,128
buffer_load_dwordx4 v0, s[64:67], s36 offen lds
Mvva 128,76,144
Tv 236,249,20480
Mvva 132,72,132
Tv 238,249,20992
Mvva 132,76,148
buffer_load_dwordx4 v2, s[64:67], s36 offen offset:1024 lds
Mvva 136,72,136
s_add_u32 s33, s33, 1
s_and_b32 s33, s33, 7
Tv 240,249,21504
Mvva 136,76,152
Tv 242,249,22016
Mvva 140,72,140
Tv 48,250,20480
Mvva 140,76,156
s_waitcnt vmcnt(63) lgkmcnt(5)
Tv 50,250,20992
Mvva 144,212,160
s_add_u32 m0, s38, 0x1000
s_mul_i32 s36, s33, 0x80000
Tv 52,250,21504
Mvva 144,232,176
buffer_load_dwordx4 v0, s[64:67], s36 offen lds
Mvva 148,212,164
Tv 54,250,22016
Mvva 148,232,180
Tv 56,251,20480
Mvva 152,212,168
buffer_load_dwordx4 v2, s[64:67], s36 offen offset:1024 lds
Mvva 152,232,184
s_add_u32 s33, s33, 1
s_and_b32 s33, s33, 7
s_add_u32 m0, s38, 0x1800
Mvva 156,212,172
s_mul_i32 s36, s33, 0x80000
Tv 58,251,20992
Mvva 156,232,188
s_waitcnt lgkmcnt(6)
buffer_load_dwordx4 v0, s[64:67], s36 offen lds
Mvva 160,236,160
Tv 60,251,21504
Mvva 160,240,176
Tv 62,251,22016
Mvva 164,236,164
buffer_load_dwordx4 v2, s[64:67], s36 offen offset:1024 lds
Mvva 164,240,180
s_add_u32 s33, s33, 1
s_and_b32 s33, s33, 7
s_add_u32 m0, s38, 0x4000
Mvva 168,236,168
s_mul_i32 s36, s33, 0x80000
Tv 64,248,28672
Mvva 168,240,184
buffer_load_dwordx4 v0, s[64:67], s36 offen lds
Mvva 172,236,172
Tv 66,248,29184
Mvva 172,240,188
s_waitcnt lgkmcnt(6)
Tv 68,248,29696
Mvva 176,48,160
buffer_load_dwordx4 v2, s[64:67], s36 offen offset:1024 lds
Mvva 176,52,176
s_add_u32 s33, s33, 1
s_and_b32 s33, s33, 7
Tv 70,248,30208
Mvva 180,48,164
Tv 72,249,28672
Mvva 180,52,180
Tv 74,249,29184
Mvva 184,48,168
Tv 76,249,29696
Mvva 184,52,184
Tv 78,249,30208
Mvva 188,48,172
Tv 212,250,28672
Mvva 188,52,188
s_waitcnt lgkmcnt(9)
Tv 214,250,29184
Mvva 192,56,160
Tv 232,250,29696
Mvva 192,60,176
Tv 234,250,30208
Mvva 196,56,164
Tv 236,251,28672
Mvva 196,60,180
Tv 238,251,29184
Mvva 200,56,168
Tv 240,251,29696
Mvva 200,60,184
Tv 242,251,30208
Mvva 204,56,172
Mvva 204,60,188
s_waitcnt lgkmcnt(12)
Mvva 80,64,160
Mvva 80,68,176
Mvva 84,64,164
Mvva 84,68,180
Mvva 88,64,168
Mvva 88,68,184
s_waitcnt vmcnt(26)
La 192,13,8192
Mvva 92,64,172
La 208,14,8192
Mvva 92,68,188
s_waitcnt lgkmcnt(10)
La 196,13,10240
Mvva 96,72,160
La 212,14,10240
Mvva 96,76,176
La 200,13,12288
Mvva 100,72,164
La 216,14,12288
Mvva 100,76,180
La 204,13,14336
Mvva 104,72,168
La 220,14,14336
Mvva 104,76,184
Mvva 108,72,172
Mvva 108,76,188
s_waitcnt vmcnt(63) lgkmcnt(8)
Mvva 112,212,160
s_waitcnt vmcnt(22)
s_barrier
Mvva 112,232,176
Tv 48,248,38912
Mvva 116,212,164
Tv 50,248,39424
Mvva 116,232,180
Tv 52,248,39936
Mvva 120,212,168
Tv 54,248,40448
Mvva 120,232,184
Tv 56,249,38912
Mvva 124,212,172
s_add_u32 m0, s38, 0x4800
s_mul_i32 s36, s33, 0x80000
Tv 58,249,39424
Mvva 124,232,188
Tv 60,249,39936
Mvva 128,236,160
Tv 62,249,40448
Mvva 128,240,176
buffer_load_dwordx4 v0, s[64:67], s36 offen lds
Mvva 132,236,164
Tv 64,250,38912
Mvva 132,240,180
Tv 66,250,39424
Mvva 136,236,168
Tv 68,250,39936
Mvva 136,240,184
Tv 70,250,40448
Mvva 140,236,172
Tv 72,251,38912
Mvva 140,240,188
s_waitcnt lgkmcnt(9)
Tv 74,251,39424
Mvva 144,48,192
Tv 76,251,39936
Mvva 144,52,208
Tv 78,251,40448
Mvva 148,48,196
Tv 212,248,24576
Mvva 148,52,212
Tv 214,248,25088
Mvva 152,48,200
Tv 232,248,25600
Mvva 152,52,216
Tv 234,248,26112
Mvva 156,48,204
Tv 236,249,24576
Mvva 156,52,220
s_waitcnt lgkmcnt(13)
Tv 238,249,25088
Mvva 160,56,192
Tv 240,249,25600
Mvva 160,60,208
Tv 242,249,26112
Mvva 164,56,196
Tv 48,250,24576
Mvva 164,60,212
Tv 50,250,25088
Mvva 168,56,200
buffer_load_dwordx4 v2, s[64:67], s36 offen offset:1024 lds
Mvva 168,60,216
s_add_u32 s33, s33, 1
s_and_b32 s33, s33, 7
Tv 52,250,25600
Mvva 172,56,204
s_add_u32 m0, s38, 0x5000
s_mul_i32 s36, s33, 0x80000
Tv 54,250,26112
Mvva 172,60,220
s_waitcnt lgkmcnt(15)
Tv 56,251,24576
Mvva 176,64,192
Tv 58,251,25088
Mvva 176,68,208
buffer_load_dwordx4 v0, s[64:67], s36 offen lds
Mvva 180,64,196
Tv 60,251,25600
Mvva 180,68,212
Tv 62,251,26112
Mvva 184,64,200
Mvva 184,68,216
buffer_load_dwordx4 v2, s[64:67], s36 offen offset:1024 lds
Mvva 188,64,204
s_add_u32 s33, s33, 1
s_and_b32 s33, s33, 7
s_add_u32 m0, s38, 0x7000
Mvva 188,68,220
s_waitcnt lgkmcnt(15)
s_mul_i32 s36, s33, 0x80000
Mvva 192,72,192
Mvva 192,76,208
buffer_load_dwordx4 v0, s[64:67], s36 offen lds
Mvva 196,72,196
Mvva 196,76,212
Mvva 200,72,200
Mvva 200,76,216
buffer_load_dwordx4 v2, s[64:67], s36 offen offset:1024 lds
Mvva 204,72,204
s_add_u32 s33, s33, 1
s_and_b32 s33, s33, 7
Mvva 204,76,220
s_waitcnt vmcnt(63) lgkmcnt(12)
Mvva 80,212,192
Mvva 80,232,208
Mvva 84,212,196
Mvva 84,232,212
v_min_u32 v220, 17, v15
v_lshlrev_b32 v220, 7, v220
Mvva 88,212,200
buffer_load_dword v220, v220, s[12:15], s51 offen
Mvva 88,232,216
s_waitcnt vmcnt(21)
La 224,13,22528
Mvva 92,212,204
La 240,14,22528
Mvva 92,232,220
s_waitcnt lgkmcnt(10)
La 228,13,32768
Mvva 96,236,192
La 244,14,32768
Mvva 96,240,208
La 232,13,34816
Mvva 100,236,196
La 248,14,34816
Mvva 100,240,212
La 236,13,36864
Mvva 104,236,200
La 252,14,36864
Mvva 104,240,216
Mvva 108,236,204
Mvva 108,240,220
s_waitcnt lgkmcnt(8)
Mvva 112,48,192
s_waitcnt vmcnt(17)
s_barrier
Mvva 112,52,208
Tv 64,248,26624
Mvva 116,48,196
Tv 66,248,27136
Mvva 116,52,212
Tv 68,248,27648
Mvva 120,48,200
Tv 70,248,28160
Mvva 120,52,216
Tv 72,249,26624
Mvva 124,48,204
Tv 74,249,27136
Mvva 124,52,220
Tv 76,249,27648
Mvva 128,56,192
Tv 78,249,28160
Mvva 128,60,208
Tv 212,250,26624
Mvva 132,56,196
Tv 214,250,27136
Mvva 132,60,212
Tv 232,250,27648
Mvva 136,56,200
Tv 234,250,28160
Mvva 136,60,216
Tv 236,251,26624
Mvva 140,56,204
Tv 238,251,27136
Mvva 140,60,220
s_waitcnt lgkmcnt(10)
Tv 240,251,27648
Mvva 144,64,224
s_add_u32 m0, s38, 0x8000
s_mul_i32 s36, s33, 0x80000
s_add_u32 s36, s36, 0x80
Mvva 144,68,240
buffer_load_dwordx4 v0, s[64:67], s36 offen lds
Mvva 148,64,228
Tv 242,251,28160
Mvva 148,68,244
Tv 48,248,30720
Mvva 152,64,232
buffer_load_dwordx4 v2, s[64:67], s36 offen offset:1024 lds
Mvva 152,68,248
s_add_u32 s33, s33, 1
s_and_b32 s33, s33, 7
s_add_u32 m0, s38, 0x8800
Mvva 156,64,236
s_mul_i32 s36, s33, 0x80000
s_add_u32 s36, s36, 0x80
Tv 50,248,31232
Mvva 156,68,252
M_w1:
s_cbranch_execz M_w2
s_waitcnt lgkmcnt(10)
buffer_load_dwordx4 v0, s[64:67], s36 offen lds
Mvva 160,72,224
Tv 52,248,31744
v_mul_f32 v144, s3, v144
Mvva 160,76,240
Tv 54,248,32256
v_mul_f32 v145, s3, v145
Mvva 164,72,228
buffer_load_dwordx4 v2, s[64:67], s36 offen offset:1024 lds
Mvva 164,76,244
s_add_u32 s33, s33, 1
s_and_b32 s33, s33, 7
s_add_u32 m0, s38, 0x9000
Mvva 168,72,232
s_mul_i32 s36, s33, 0x80000
s_add_u32 s36, s36, 0x80
Tv 56,249,30720
Mvva 168,76,248
buffer_load_dwordx4 v0, s[64:67], s36 offen lds
Mvva 172,72,236
Tv 58,249,31232
v_mul_f32 v146, s3, v146
Mvva 172,76,252
s_waitcnt vmcnt(63) lgkmcnt(10)
Tv 60,249,31744
v_mul_f32 v147, s3, v147
Mvva 176,212,224
buffer_load_dwordx4 v2, s[64:67], s36 offen offset:1024 lds
Mvva 176,232,240
s_add_u32 s33, s33, 1
s_and_b32 s33, s33, 7
s_add_u32 m0, s38, 0x9800
Mvva 180,212,228
s_mul_i32 s36, s33, 0x80000
s_add_u32 s36, s36, 0x80
Tv 62,249,32256
Mvva 180,232,244
buffer_load_dwordx4 v0, s[64:67], s36 offen lds
Mvva 184,212,232
Tv 64,250,30720
PK 144,144,145
Mvva 184,232,248
Tv 66,250,31232
PK 145,146,147
Mvva 188,212,236
buffer_load_dwordx4 v2, s[64:67], s36 offen offset:1024 lds
Mvva 188,232,252
s_waitcnt lgkmcnt(10)
s_add_u32 s33, s33, 1
s_and_b32 s33, s33, 7
Mvva 192,236,224
s_add_u32 m0, s38, 0x2000
s_mul_i32 s36, s33, 0x80000
s_add_u32 s36, s36, 0x80
Mvva 192,240,240
buffer_load_dwordx4 v0, s[64:67], s36 offen lds
Mvva 196,236,228
Tv 68,250,31744
v_mul_f32 v160, s3, v160
Mvva 196,240,244
Tv 70,250,32256
v_mul_f32 v161, s3, v161
Mvva 200,236,232
Tv 72,251,30720
v_mul_f32 v162, s3, v162
Mvva 200,240,248
Tv 74,251,31232
v_mul_f32 v163, s3, v163
Mvva 204,236,236
Tv 76,251,31744
PK 146,160,161
Mvva 204,240,252
s_waitcnt lgkmcnt(11)
Tv 78,251,32256
PK 147,162,163
Mvva 80,48,224
v_mul_f32 v148, s3, v148
v_mul_f32 v149, s3, v149
Mvva 80,52,240
v_mul_f32 v150, s3, v150
v_mul_f32 v151, s3, v151
Mvva 84,48,228
PK 148,148,149
PK 149,150,151
Mvva 84,52,244
v_mul_f32 v164, s3, v164
v_mul_f32 v165, s3, v165
Mvva 88,48,232
v_mul_f32 v166, s3, v166
v_mul_f32 v167, s3, v167
Mvva 88,52,248
PK 150,164,165
PK 151,166,167
Mvva 92,48,236
v_mul_f32 v152, s3, v152
v_mul_f32 v153, s3, v153
Mvva 92,52,252
s_waitcnt lgkmcnt(8)
v_mul_f32 v154, s3, v154
v_mul_f32 v155, s3, v155
Mvva 96,56,224
PK 152,152,153
PK 153,154,155
Mvva 96,60,240
v_mul_f32 v168, s3, v168
v_mul_f32 v169, s3, v169
Mvva 100,56,228
v_mul_f32 v170, s3, v170
v_mul_f32 v171, s3, v171
Mvva 100,60,244
PK 154,168,169
PK 155,170,171
Mvva 104,56,232
v_mul_f32 v156, s3, v156
v_mul_f32 v157, s3, v157
Mvva 104,60,248
v_mul_f32 v158, s3, v158
v_mul_f32 v159, s3, v159
Mvva 108,56,236
PK 156,156,157
PK 157,158,159
Mvva 108,60,252
s_waitcnt lgkmcnt(0)
v_mul_f32 v172, s3, v172
v_mul_f32 v173, s3, v173
Mvva 112,64,224
s_waitcnt vmcnt(10)
s_barrier
Mvva 112,68,240
buffer_store_dword v216, v217, s[20:23], 0 offen sc0 sc1
Mvva 116,64,228
Tv 212,248,0
v_mul_f32 v174, s3, v174
Mvva 116,68,244
Tv 214,248,512
v_mul_f32 v175, s3, v175
Mvva 120,64,232
Tv 232,248,1024
PK 158,172,173
Mvva 120,68,248
Tv 234,248,1536
PK 159,174,175
Mvva 124,64,236
Tv 236,248,2048
v_mul_f32 v176, s3, v176
Mvva 124,68,252
Tv 238,248,2560
v_mul_f32 v177, s3, v177
Mvva 128,72,224
Tv 240,248,3072
v_mul_f32 v178, s3, v178
Mvva 128,76,240
Tv 242,248,3584
v_mul_f32 v179, s3, v179
Mvva 132,72,228
Tv 48,249,0
PK 176,176,177
Mvva 132,76,244
Tv 50,249,512
PK 177,178,179
Mvva 136,72,232
Tv 52,249,1024
v_mul_f32 v192, s3, v192
Mvva 136,76,248
Tv 54,249,1536
v_mul_f32 v193, s3, v193
Mvva 140,72,236
Tv 56,249,2048
v_mul_f32 v194, s3, v194
Mvva 140,76,252
s_waitcnt vmcnt(63) lgkmcnt(5)
Tv 58,249,2560
v_mul_f32 v195, s3, v195
Zvav 16,0,212
s_add_u32 s55, s31, 0
Tv 60,249,3072
PK 178,192,193
Mvav 16,16,232
Tv 62,249,3584
PK 179,194,195
Mvav 16,32,236
Tv 64,248,4096
v_mul_f32 v180, s3, v180
Mvav 16,48,240
buffer_store_dwordx4 v[144:147], v1, s[16:19], s55 offen sc0 sc1
Tv 66,248,4608
Tv 68,248,5120
Zvav 20,4,212
Tv 70,248,5632
v_mul_f32 v181, s3, v181
Mvav 20,20,232
Tv 72,248,6144
v_mul_f32 v182, s3, v182
Mvav 20,36,236
Tv 74,248,6656
v_mul_f32 v183, s3, v183
Mvav 20,52,240
Tv 76,248,7168
PK 180,180,181
Zvav 24,8,212
Tv 78,248,7680
PK 181,182,183
Mvav 24,24,232
v_mul_f32 v196, s3, v196
v_mul_f32 v197, s3, v197
Mvav 24,40,236
v_mul_f32 v198, s3, v198
v_mul_f32 v199, s3, v199
Mvav 24,56,240
PK 182,196,197
PK 183,198,199
Zvav 28,12,212
v_mul_u32_u24 v221, 0x48000, v15
v_mul_f32 v184, s3, v184
Mvav 28,28,232
v_mul_f32 v185, s3, v185
v_mul_f32 v186, s3, v186
Mvav 28,44,236
v_mul_f32 v187, s3, v187
PK 184,184,185
Mvav 28,60,240
s_waitcnt lgkmcnt(8)
buffer_load_dword v221, v221, s[4:7], s53 offen
Zvav 32,0,48
Tv 212,249,4096
PK 185,186,187
Mvav 32,16,52
Tv 214,249,4608
v_mul_f32 v200, s3, v200
Mvav 32,32,56
Tv 232,249,5120
v_mul_f32 v201, s3, v201
Mvav 32,48,60
Tv 234,249,5632
v_mul_f32 v202, s3, v202
Zvav 36,4,48
Tv 236,249,6144
v_mul_f32 v203, s3, v203
Mvav 36,20,52
Tv 238,249,6656
PK 186,200,201
Mvav 36,36,56
Tv 240,249,7168
PK 187,202,203
Mvav 36,52,60
Tv 242,249,7680
v_mul_f32 v188, s3, v188
Zvav 40,8,48
v_mul_f32 v189, s3, v189
v_mul_f32 v190, s3, v190
Mvav 40,24,52
v_mul_f32 v191, s3, v191
PK 188,188,189
Mvav 40,40,56
PK 189,190,191
v_mul_f32 v204, s3, v204
Mvav 40,56,60
v_mul_f32 v205, s3, v205
v_mul_f32 v206, s3, v206
Zvav 44,12,48
v_mul_f32 v207, s3, v207
PK 190,204,205
Mvav 44,28,52
PK 191,206,207
v_mul_f32 v80, s3, v80
Mvav 44,44,56
v_mul_f32 v81, s3, v81
v_mul_f32 v82, s3, v82
Mvav 44,60,60
s_waitcnt lgkmcnt(8)
Tv 48,248,16384
v_mul_f32 v83, s3, v83
Mvav 16,64,64
Tv 50,248,16896
PK 80,80,81
Mvav 16,80,68
Tv 52,248,17408
PK 81,82,83
Mvav 16,96,72
Tv 54,248,17920
v_mul_f32 v96, s3, v96
Mvav 16,112,76
Tv 56,248,18432
v_mul_f32 v97, s3, v97
Mvav 20,68,64
Tv 58,248,18944
v_mul_f32 v98, s3, v98
Mvav 20,84,68
Tv 60,248,19456
v_mul_f32 v99, s3, v99
Mvav 20,100,72
Tv 62,248,19968
PK 82,96,97
Mvav 20,116,76
PK 83,98,99
v_mul_f32 v84, s3, v84
Mvav 24,72,64
v_mul_f32 v85, s3, v85
v_mul_f32 v86, s3, v86
Mvav 24,88,68
v_mul_f32 v87, s3, v87
PK 84,84,85
Mvav 24,104,72
PK 85,86,87
v_mul_f32 v100, s3, v100
Mvav 24,120,76
v_mul_f32 v101, s3, v101
v_mul_f32 v102, s3, v102
Mvav 28,76,64
s_add_u32 s55, s31, 0
v_mul_f32 v103, s3, v103
PK 86,100,101
Mvav 28,92,68
PK 87,102,103
v_mul_f32 v88, s3, v88
Mvav 28,108,72
v_mul_f32 v89, s3, v89
v_mul_f32 v90, s3, v90
Mvav 28,124,76
s_waitcnt vmcnt(63) lgkmcnt(8)
buffer_store_dwordx4 v[148:151], v1, s[16:19], s55 offen offset:1024 sc0 sc1
Tv 64,249,16384
Tv 66,249,16896
Mvav 32,64,212
Tv 68,249,17408
v_mul_f32 v91, s3, v91
Mvav 32,80,232
Tv 70,249,17920
PK 88,88,89
Mvav 32,96,236
Tv 72,249,18432
PK 89,90,91
Mvav 32,112,240
Tv 74,249,18944
v_mul_f32 v104, s3, v104
Mvav 36,68,212
s_add_u32 s55, s32, 0
Tv 76,249,19456
v_mul_f32 v105, s3, v105
Mvav 36,84,232
Tv 78,249,19968
v_mul_f32 v106, s3, v106
Mvav 36,100,236
v_mul_f32 v107, s3, v107
PK 90,104,105
Mvav 36,116,240
buffer_store_dwordx4 v[152:155], v1, s[16:19], s55 offen sc0 sc1
PK 91,106,107
v_mul_f32 v92, s3, v92
v_mul_f32 v93, s3, v93
Mvav 40,72,212
v_mul_f32 v94, s3, v94
v_mul_f32 v95, s3, v95
Mvav 40,88,232
PK 92,92,93
PK 93,94,95
Mvav 40,104,236
v_mul_f32 v108, s3, v108
v_mul_f32 v109, s3, v109
Mvav 40,120,240
v_mul_f32 v110, s3, v110
v_mul_f32 v111, s3, v111
Mvav 44,76,212
PK 94,108,109
PK 95,110,111
Mvav 44,92,232
s_add_u32 s55, s32, 0
v_mul_f32 v112, s3, v112
v_mul_f32 v113, s3, v113
Mvav 44,108,236
v_mul_f32 v114, s3, v114
v_mul_f32 v115, s3, v115
Mvav 44,124,240
s_waitcnt lgkmcnt(8)
Tv 212,248,20480
PK 112,112,113
Mvav 16,128,48
buffer_store_dwordx4 v[156:159], v1, s[16:19], s55 offen offset:1024 sc0 sc1
Tv 214,248,20992
Tv 232,248,21504
Mvav 16,144,52
Tv 234,248,22016
PK 113,114,115
Mvav 16,160,56
Tv 236,248,28672
v_mul_f32 v128, s3, v128
Mvav 16,176,60
Tv 238,248,29184
v_mul_f32 v129, s3, v129
Mvav 20,132,48
Tv 240,248,29696
v_mul_f32 v130, s3, v130
Mvav 20,148,52
Tv 242,248,30208
v_mul_f32 v131, s3, v131
Mvav 20,164,56
PK 114,128,129
PK 115,130,131
Mvav 20,180,60
v_mul_f32 v116, s3, v116
v_mul_f32 v117, s3, v117
Mvav 24,136,48
buffer_load_dword v222, v219, s[4:7], 0 offen
Mvav 24,152,52
v_mul_f32 v118, s3, v118
v_mul_f32 v119, s3, v119
Mvav 24,168,56
PK 116,116,117
PK 117,118,119
Mvav 24,184,60
v_mul_f32 v132, s3, v132
v_mul_f32 v133, s3, v133
Mvav 28,140,48
v_mul_f32 v134, s3, v134
v_mul_f32 v135, s3, v135
Mvav 28,156,52
PK 118,132,133
PK 119,134,135
Mvav 28,172,56
v_mul_f32 v120, s3, v120
v_mul_f32 v121, s3, v121
Mvav 28,188,60
s_waitcnt lgkmcnt(8)
Tv 48,249,20480
v_mul_f32 v122, s3, v122
Mvav 32,128,64
Tv 50,249,20992
v_mul_f32 v123, s3, v123
Mvav 32,144,68
Tv 52,249,21504
PK 120,120,121
Mvav 32,160,72
Tv 54,249,22016
PK 121,122,123
Mvav 32,176,76
Tv 56,249,28672
v_mul_f32 v136, s3, v136
Mvav 36,132,64
Tv 58,249,29184
v_mul_f32 v137, s3, v137
Mvav 36,148,68
Tv 60,249,29696
v_mul_f32 v138, s3, v138
Mvav 36,164,72
Tv 62,249,30208
v_mul_f32 v139, s3, v139
Mvav 36,180,76
v_lshlrev_b32 v223, 18, v15
PK 122,136,137
Mvav 40,136,64
buffer_load_dword v223, v223, s[8:11], s49 offen
Mvav 40,152,68
PK 123,138,139
v_mul_f32 v124, s3, v124
Mvav 40,168,72
v_mul_f32 v125, s3, v125
v_mul_f32 v126, s3, v126
Mvav 40,184,76
buffer_load_dwordx4 v2, s[64:67], s36 offen offset:1024 lds
Mvav 44,140,64
s_add_u32 s33, s33, 1
s_and_b32 s33, s33, 7
v_mul_f32 v127, s3, v127
Mvav 44,156,68
PK 124,124,125
PK 125,126,127
Mvav 44,172,72
v_mul_f32 v140, s3, v140
v_mul_f32 v141, s3, v141
Mvav 44,188,76
s_waitcnt vmcnt(63) lgkmcnt(8)
Tv 64,250,0
v_mul_f32 v142, s3, v142
Mvav 16,192,212
Tv 66,250,512
v_mul_f32 v143, s3, v143
Mvav 16,208,232
Tv 68,250,1024
PK 126,140,141
Mvav 16,224,236
Tv 70,250,1536
PK 127,142,143
Mvav 16,240,240
Tv 72,250,2048
Mvav 20,196,212
Tv 74,250,2560
Mvav 20,212,232
Tv 76,250,3072
Mvav 20,228,236
Tv 78,250,3584
Mvav 20,244,240
Mvav 24,200,212
Mvav 24,216,232
Mvav 24,232,236
Mvav 24,248,240
Mvav 28,204,212
Mvav 28,220,232
Mvav 28,236,236
Mvav 28,252,240
s_waitcnt lgkmcnt(8)
Tv 212,251,0
Mvav 32,192,48
Tv 214,251,512
Mvav 32,208,52
Tv 232,251,1024
Mvav 32,224,56
Tv 234,251,1536
Mvav 32,240,60
Tv 236,251,2048
Mvav 36,196,48
Tv 238,251,2560
Mvav 36,212,52
Tv 240,251,3072
Mvav 36,228,56
Tv 242,251,3584
Mvav 36,244,60
s_add_u32 m0, s38, 0x2800
s_mul_i32 s36, s33, 0x80000
s_add_u32 s36, s36, 0x80
Mvav 40,200,48
Mvav 40,216,52
Mvav 40,232,56
buffer_load_dwordx4 v0, s[64:67], s36 offen lds
Mvav 40,248,60
Mvav 44,204,48
Mvav 44,220,52
Mvav 44,236,56
Mvav 44,252,60
s_waitcnt lgkmcnt(8)
Tv 48,250,4096
Zvav 144,0,64
Tv 50,250,4608
Mvav 144,16,68
Tv 52,250,5120
Mvav 144,32,72
Tv 54,250,5632
Mvav 144,48,76
Tv 56,250,6144
Zvav 148,4,64
Tv 58,250,6656
Mvav 148,20,68
Tv 60,250,7168
Mvav 148,36,72
Tv 62,250,7680
Mvav 148,52,76
Zvav 152,8,64
Mvav 152,24,68
buffer_load_dwordx4 v2, s[64:67], s36 offen offset:1024 lds
Mvav 152,40,72
s_add_u32 s33, s33, 1
s_and_b32 s33, s33, 7
s_add_u32 m0, s38, 0x3000
Mvav 152,56,76
s_mul_i32 s36, s33, 0x80000
s_add_u32 s36, s36, 0x80
Zvav 156,12,64
buffer_load_dwordx4 v0, s[64:67], s36 offen lds
Mvav 156,28,68
Mvav 156,44,72
Mvav 156,60,76
s_waitcnt vmcnt(63) lgkmcnt(8)
Tv 64,251,4096
Zvav 160,0,212
Tv 66,251,4608
Mvav 160,16,232
Tv 68,251,5120
Mvav 160,32,236
Tv 70,251,5632
Mvav 160,48,240
Tv 72,251,6144
Zvav 164,4,212
Tv 74,251,6656
Mvav 164,20,232
Tv 76,251,7168
Mvav 164,36,236
Tv 78,251,7680
Mvav 164,52,240
Zvav 168,8,212
Mvav 168,24,232
buffer_load_dwordx4 v2, s[64:67], s36 offen offset:1024 lds
Mvav 168,40,236
s_add_u32 s33, s33, 1
s_and_b32 s33, s33, 7
s_add_u32 m0, s38, 0x3800
Mvav 168,56,240
s_mul_i32 s36, s33, 0x80000
s_add_u32 s36, s36, 0x80
Zvav 172,12,212
buffer_load_dwordx4 v0, s[64:67], s36 offen lds
Mvav 172,28,232
Mvav 172,44,236
M_w2:
s_cbranch_execz M_w3
Mvav 172,60,240
s_waitcnt lgkmcnt(8)
Tv 212,250,16384
Mvav 144,64,48
Tv 214,250,16896
Mvav 144,80,52
Tv 232,250,17408
Mvav 144,96,56
Tv 234,250,17920
Mvav 144,112,60
Tv 236,250,18432
Mvav 148,68,48
Tv 238,250,18944
Mvav 148,84,52
Tv 240,250,19456
Mvav 148,100,56
Tv 242,250,19968
Mvav 148,116,60
Mvav 152,72,48
buffer_load_dwordx4 v2, s[64:67], s36 offen offset:1024 lds
Mvav 152,88,52
s_add_u32 s33, s33, 1
s_and_b32 s33, s33, 7
s_add_u32 s55, s31, 0x20000
Mvav 152,104,56
Mvav 152,120,60
buffer_store_dwordx4 v[176:179], v1, s[16:19], s55 offen sc0 sc1
Mvav 156,76,48
Mvav 156,92,52
Mvav 156,108,56
Mvav 156,124,60
s_waitcnt lgkmcnt(8)
Tv 48,251,16384
Mvav 160,64,64
Tv 50,251,16896
Mvav 160,80,68
Tv 52,251,17408
Mvav 160,96,72
Tv 54,251,17920
Mvav 160,112,76
Tv 56,251,18432
Mvav 164,68,64
Tv 58,251,18944
Mvav 164,84,68
Tv 60,251,19456
Mvav 164,100,72
Tv 62,251,19968
Mvav 164,116,76
Mvav 168,72,64
Mvav 168,88,68
Mvav 168,104,72
Mvav 168,120,76
Mvav 172,76,64
Mvav 172,92,68
Mvav 172,108,72
Mvav 172,124,76
s_waitcnt lgkmcnt(8)
Tv 64,250,20480
Mvav 144,128,212
Tv 66,250,20992
Mvav 144,144,232
Tv 68,250,21504
Mvav 144,160,236
Tv 70,250,22016
Mvav 144,176,240
Tv 72,250,28672
Mvav 148,132,212
Tv 74,250,29184
Mvav 148,148,232
Tv 76,250,29696
Mvav 148,164,236
Tv 78,250,30208
Mvav 148,180,240
Mvav 152,136,212
Mvav 152,152,232
Mvav 152,168,236
Mvav 152,184,240
Mvav 156,140,212
Mvav 156,156,232
Mvav 156,172,236
Mvav 156,188,240
s_waitcnt lgkmcnt(8)
Tv 212,251,20480
Mvav 160,128,48
Tv 214,251,20992
Mvav 160,144,52
Tv 232,251,21504
Mvav 160,160,56
Tv 234,251,22016
Mvav 160,176,60
Tv 236,251,28672
Mvav 164,132,48
s_add_u32 s55, s31, 0x20000
Tv 238,251,29184
Mvav 164,148,52
Tv 240,251,29696
Mvav 164,164,56
Tv 242,251,30208
Mvav 164,180,60
buffer_store_dwordx4 v[180:183], v1, s[16:19], s55 offen offset:1024 sc0 sc1
Mvav 168,136,48
Mvav 168,152,52
Mvav 168,168,56
Mvav 168,184,60
Mvav 172,140,48
Mvav 172,156,52
Mvav 172,172,56
Mvav 172,188,60
s_waitcnt lgkmcnt(8)
Mvav 144,192,64
Mvav 144,208,68
Mvav 144,224,72
Mvav 144,240,76
Mvav 148,196,64
s_add_u32 s55, s32, 0x20000
Mvav 148,212,68
Mvav 148,228,72
Mvav 148,244,76
buffer_store_dwordx4 v[184:187], v1, s[16:19], s55 offen sc0 sc1
Mvav 152,200,64
Mvav 152,216,68
PK 144,144,145
PK 145,146,147
Mvav 152,232,72
Mvav 152,248,76
Mvav 156,204,64
Mvav 156,220,68
PK 146,148,149
PK 147,150,151
Mvav 156,236,72
Mvav 156,252,76
s_waitcnt lgkmcnt(0)
Mvav 160,192,212
s_waitcnt vmcnt(3)
s_barrier
Mvav 160,208,232
Tv 48,248,32768
PK 152,152,153
Mvav 160,224,236
s_add_u32 s55, s32, 0x20000
Tv 50,248,33280
PK 153,154,155
Mvav 160,240,240
Tv 52,248,33792
Mvav 164,196,212
Tv 54,248,34304
Mvav 164,212,232
buffer_store_dwordx4 v[188:191], v1, s[16:19], s55 offen offset:1024 sc0 sc1
Tv 56,248,34816
Tv 58,248,35328
Mvav 164,228,236
Tv 60,248,35840
PK 154,156,157
Mvav 164,244,240
Tv 62,248,36352
PK 155,158,159
Mvav 168,200,212
Tv 64,249,32768
Mvav 168,216,232
Tv 66,249,33280
PK 160,160,161
Mvav 168,232,236
Tv 68,249,33792
PK 161,162,163
Mvav 168,248,240
Tv 70,249,34304
Mvav 172,204,212
Tv 72,249,34816
Mvav 172,220,232
Tv 74,249,35328
PK 162,164,165
Mvav 172,236,236
Tv 76,249,35840
PK 163,166,167
Mvav 172,252,240
s_waitcnt lgkmcnt(7)
Tv 78,249,36352
Zvav 176,0,48
Tv 212,248,36864
Mvav 176,16,52
Tv 214,248,37376
PK 168,168,169
Mvav 176,32,56
s_add_u32 s55, s31, 0x40000
Tv 232,248,37888
PK 169,170,171
Mvav 176,48,60
Tv 234,248,38400
Zvav 180,4,48
Tv 236,248,38912
Mvav 180,20,52
buffer_store_dwordx4 v[80:83], v1, s[16:19], s55 offen sc0 sc1
Tv 238,248,39424
Tv 240,248,39936
Mvav 180,36,56
Tv 242,248,40448
PK 170,172,173
Mvav 180,52,60
PK 171,174,175
Zvav 184,8,48
Mvav 184,24,52
Mvav 184,40,56
Mvav 184,56,60
Zvav 188,12,48
Mvav 188,28,52
Mvav 188,44,56
Mvav 188,60,60
s_waitcnt lgkmcnt(8)
Tv 48,249,36864
Zvav 192,0,64
Tv 50,249,37376
Mvav 192,16,68
s_add_u32 s55, s31, 0x40000
Tv 52,249,37888
Mvav 192,32,72
Tv 54,249,38400
Mvav 192,48,76
Tv 56,249,38912
Zvav 196,4,64
buffer_store_dwordx4 v[84:87], v1, s[16:19], s55 offen offset:1024 sc0 sc1
Tv 58,249,39424
Tv 60,249,39936
Mvav 196,20,68
Tv 62,249,40448
Mvav 196,36,72
Mvav 196,52,76
Zvav 200,8,64
Mvav 200,24,68
Mvav 200,40,72
Mvav 200,56,76
Zvav 204,12,64
Mvav 204,28,68
Mvav 204,44,72
Mvav 204,60,76
s_waitcnt lgkmcnt(8)
Tv 64,248,8192
Mvav 176,64,212
s_add_u32 s55, s32, 0x40000
Tv 66,248,8704
Mvav 176,80,232
Tv 68,248,9216
Mvav 176,96,236
Tv 70,248,9728
Mvav 176,112,240
buffer_store_dwordx4 v[88:91], v1, s[16:19], s55 offen sc0 sc1
Tv 72,248,10240
Tv 74,248,10752
Mvav 180,68,212
Tv 76,248,11264
Mvav 180,84,232
Tv 78,248,11776
Mvav 180,100,236
Mvav 180,116,240
Mvav 184,72,212
Mvav 184,88,232
Mvav 184,104,236
Mvav 184,120,240
Mvav 188,76,212
Mvav 188,92,232
Mvav 188,108,236
Mvav 188,124,240
s_waitcnt lgkmcnt(8)
Tv 212,249,8192
Mvav 192,64,48
s_add_u32 s55, s32, 0x40000
Tv 214,249,8704
Mvav 192,80,52
Tv 232,249,9216
Mvav 192,96,56
Tv 234,249,9728
Mvav 192,112,60
buffer_store_dwordx4 v[92:95], v1, s[16:19], s55 offen offset:1024 sc0 sc1
Tv 236,249,10240
Tv 238,249,10752
Mvav 196,68,48
Tv 240,249,11264
Mvav 196,84,52
Tv 242,249,11776
Mvav 196,100,56
Mvav 196,116,60
Mvav 200,72,48
Mvav 200,88,52
Mvav 200,104,56
Mvav 200,120,60
Mvav 204,76,48
Mvav 204,92,52
Mvav 204,108,56
Mvav 204,124,60
s_waitcnt lgkmcnt(8)
s_mov_b32 s33, s35
Tv 48,248,12288
Mvav 176,128,64
Tv 50,248,12800
v_lshrrev_b32 v252, 3, v15
Mvav 176,144,68
s_movk_i32 s36, 0x480
Tv 52,248,13312
v_mul_u32_u24 v11, s36, v252
Mvav 176,160,72
Tv 54,248,13824
v_lshrrev_b32 v253, 1, v252
Mvav 176,176,76
Tv 56,248,14336
v_and_b32 v254, 7, v15
Mvav 180,132,64
Tv 58,248,14848
v_xor_b32 v253, v253, v254
Mvav 180,148,68
Tv 60,248,15360
v_lshlrev_b32 v253, 4, v253
Mvav 180,164,72
Tv 62,248,15872
v_xor_b32 v254, 64, v253
Mvav 180,180,76
v_add_u32 v12, v11, v254
v_add_u32 v12, 0x2000, v12
Mvav 184,136,64
v_add_u32 v11, v11, v253
s_bfe_u32 s27, s41, 0x7000a
Mvav 184,152,68
s_mul_i32 s27, s27, 0x4800
s_bfe_u32 s28, s42, 0x7000a
s_mul_i32 s28, s28, 0x4800
Mvav 184,168,72
s_bfe_u32 s29, s45, 0x7000a
s_mul_i32 s29, s29, 0x4800
s_bfe_u32 s30, s46, 0x7000a
Mvav 184,184,76
s_mul_i32 s30, s30, 0x4800
s_add_u32 m0, s38, 0x6000
Mvav 188,140,64
buffer_load_dwordx4 v255, s[68:71], 0 offen lds
Mvav 188,156,68
s_lshl_b32 s34, s33, 7
s_add_u32 m0, s38, 0
s_add_u32 s36, s27, s34
Mvav 188,172,72
Mvav 188,188,76
s_waitcnt lgkmcnt(8)
Tv 64,249,12288
Mvav 192,128,212
buffer_load_dwordx4 v11, s[12:15], s36 offen lds
Mvav 192,144,232
Tv 66,249,12800
Mvav 192,160,236
Tv 68,249,13312
Mvav 192,176,240
buffer_load_dwordx4 v12, s[12:15], s36 offen offset:1024 lds
Mvav 196,132,212
s_add_u32 m0, s38, 0x800
s_add_u32 s36, s28, s34
Tv 70,249,13824
Mvav 196,148,232
Tv 72,249,14336
Mvav 196,164,236
buffer_load_dwordx4 v11, s[12:15], s36 offen lds
Mvav 196,180,240
Tv 74,249,14848
Mvav 200,136,212
Tv 76,249,15360
Mvav 200,152,232
buffer_load_dwordx4 v12, s[12:15], s36 offen offset:1024 lds
Mvav 200,168,236
Tv 78,249,15872
Mvav 200,184,240
Mvav 204,140,212
Mvav 204,156,232
Mvav 204,172,236
Mvav 204,188,240
s_waitcnt lgkmcnt(8)
s_add_u32 m0, s38, 0x1000
s_add_u32 s36, s29, s34
Mvav 176,192,48
Tv 212,250,32768
Mvav 176,208,52
Tv 214,250,33280
Mvav 176,224,56
buffer_load_dwordx4 v11, s[12:15], s36 offen lds
Mvav 176,240,60
Tv 232,250,33792
Mvav 180,196,48
Tv 234,250,34304
Mvav 180,212,52
Tv 236,250,34816
Mvav 180,228,56
Tv 238,250,35328
Mvav 180,244,60
Tv 240,250,35840
Mvav 184,200,48
Tv 242,250,36352
Mvav 184,216,52
PK 216,176,177
PK 217,178,179
Mvav 184,232,56
Mvav 184,248,60
Mvav 188,204,48
buffer_load_dwordx4 v12, s[12:15], s36 offen offset:1024 lds
Mvav 188,220,52
PK 218,180,181
PK 219,182,183
Mvav 188,236,56
Mvav 188,252,60
s_waitcnt lgkmcnt(8)
Tv 48,251,32768
Mvav 192,192,64
Tv 50,251,33280
Mvav 192,208,68
Tv 52,251,33792
PK 224,184,185
Mvav 192,224,72
s_add_u32 m0, s38, 0x1800
s_add_u32 s36, s30, s34
Tv 54,251,34304
Mvav 192,240,76
Tv 56,251,34816
PK 225,186,187
Mvav 196,196,64
Tv 58,251,35328
Mvav 196,212,68
buffer_load_dwordx4 v11, s[12:15], s36 offen lds
Mvav 196,228,72
Tv 60,251,35840
PK 226,188,189
Mvav 196,244,76
Tv 62,251,36352
PK 227,190,191
Mvav 200,200,64
Mvav 200,216,68
PK 220,192,193
PK 221,194,195
Mvav 200,232,72
Mvav 200,248,76
Mvav 204,204,64
Mvav 204,220,68
PK 222,196,197
PK 223,198,199
Mvav 204,236,72
Mvav 204,252,76
s_waitcnt lgkmcnt(8)
buffer_load_dwordx4 v12, s[12:15], s36 offen offset:1024 lds
Zvav 80,0,212
Tv 64,250,36864
Mvav 80,16,232
Tv 66,250,37376
PK 228,200,201
Mvav 80,32,236
Tv 68,250,37888
PK 229,202,203
Mvav 80,48,240
Tv 70,250,38400
Zvav 84,4,212
Tv 72,250,38912
Mvav 84,20,232
Tv 74,250,39424
PK 230,204,205
Mvav 84,36,236
Tv 76,250,39936
PK 231,206,207
Mvav 84,52,240
Tv 78,250,40448
PK 16,16,17
Zvav 88,8,212
PK 17,18,19
PK 18,20,21
Mvav 88,24,232
PK 19,22,23
PK 32,32,33
Mvav 88,40,236
PK 33,34,35
PK 34,36,37
Mvav 88,56,240
PK 35,38,39
PK 24,24,25
Zvav 92,12,212
PK 25,26,27
PK 26,28,29
Mvav 92,28,232
PK 27,30,31
PK 40,40,41
Mvav 92,44,236
PK 41,42,43
PK 42,44,45
Mvav 92,60,240
s_waitcnt lgkmcnt(8)
Tv 212,251,36864
PK 43,46,47
Zvav 96,0,48
Tv 214,251,37376
Mvav 96,16,52
Tv 232,251,37888
Mvav 96,32,56
Tv 234,251,38400
Mvav 96,48,60
Tv 236,251,38912
Zvav 100,4,48
Tv 238,251,39424
Mvav 100,20,52
Tv 240,251,39936
Mvav 100,36,56
Tv 242,251,40448
Mvav 100,52,60
Zvav 104,8,48
Mvav 104,24,52
Mvav 104,40,56
Mvav 104,56,60
Zvav 108,12,48
Mvav 108,28,52
Mvav 108,44,56
s_add_u32 m0, s38, 0x7800
s_mul_i32 s36, s33, 0x90000
Mvav 108,60,60
s_waitcnt lgkmcnt(8)
Mvav 80,64,64
Mvav 80,80,68
buffer_load_dwordx4 v3, s[4:7], s36 offen lds
Mvav 80,96,72
Mvav 80,112,76
Mvav 84,68,64
Mvav 84,84,68
buffer_load_dwordx4 v4, s[4:7], s36 offen offset:1024 lds
Mvav 84,100,72
s_add_u32 m0, s38, 0x6400
Mvav 84,116,76
Mvav 88,72,64
Mvav 88,88,68
buffer_load_dwordx4 v5, s[4:7], s36 offen lds
Mvav 88,104,72
s_add_u32 s33, s33, 1
s_sub_u32 s36, s33, 9
s_min_u32 s33, s33, s36
Mvav 88,120,76
s_lshl_b32 s34, s33, 7
s_add_u32 m0, s38, 0x4000
s_add_u32 s36, s27, s34
Mvav 92,76,64
M_w3:
s_cbranch_execz M_wd
buffer_load_dwordx4 v11, s[12:15], s36 offen lds
Mvav 92,92,68
Mvav 92,108,72
Mvav 92,124,76
s_waitcnt lgkmcnt(0)
buffer_load_dwordx4 v12, s[12:15], s36 offen offset:1024 lds
Mvav 96,64,212
s_barrier
s_add_u32 m0, s38, 0x4800
Mvav 96,80,232
s_add_u32 s36, s28, s34
Tv 48,250,8192
Mvav 96,96,236
buffer_load_dwordx4 v11, s[12:15], s36 offen lds
Mvav 96,112,240
Tv 50,250,8704
Mvav 100,68,212
Tv 52,250,9216
Mvav 100,84,232
Tv 54,250,9728
Mvav 100,100,236
Tv 56,250,10240
Mvav 100,116,240
Tv 58,250,10752
Mvav 104,72,212
Tv 60,250,11264
Mvav 104,88,232
Tv 62,250,11776
Mvav 104,104,236
buffer_load_dwordx4 v12, s[12:15], s36 offen offset:1024 lds
Mvav 104,120,240
Tv 64,251,8192
Mvav 108,76,212
s_add_u32 m0, s38, 0x5000
s_add_u32 s36, s29, s34
Tv 66,251,8704
Mvav 108,92,232
Tv 68,251,9216
Mvav 108,108,236
Tv 70,251,9728
Mvav 108,124,240
s_waitcnt lgkmcnt(4)
buffer_load_dwordx4 v11, s[12:15], s36 offen lds
Mvav 80,128,48
Tv 72,251,10240
Mvav 80,144,52
Tv 74,251,10752
Mvav 80,160,56
Tv 76,251,11264
Mvav 80,176,60
Tv 78,251,11776
Mvav 84,132,48
Mvav 84,148,52
Mvav 84,164,56
Mvav 84,180,60
Mvav 88,136,48
Mvav 88,152,52
buffer_load_dwordx4 v12, s[12:15], s36 offen offset:1024 lds
Mvav 88,168,56
Mvav 88,184,60
Mvav 92,140,48
Mvav 92,156,52
Mvav 92,172,56
Tv 212,250,12288
Mvav 92,188,60
s_waitcnt lgkmcnt(1)
Tv 214,250,12800
Mvav 96,128,64
s_add_u32 m0, s38, 0x7000
s_add_u32 s36, s30, s34
Tv 48,250,13312
Mvav 96,144,68
Tv 50,250,13824
Mvav 96,160,72
Tv 52,250,14336
Mvav 96,176,76
buffer_load_dwordx4 v11, s[12:15], s36 offen lds
Mvav 100,132,64
Tv 54,250,14848
Mvav 100,148,68
Tv 56,250,15360
Mvav 100,164,72
Tv 58,250,15872
Mvav 100,180,76
Mvav 104,136,64
Mvav 104,152,68
Mvav 104,168,72
Mvav 104,184,76
Mvav 108,140,64
buffer_load_dwordx4 v12, s[12:15], s36 offen offset:1024 lds
Mvav 108,156,68
Mvav 108,172,72
Tv 60,251,12288
Mvav 108,188,76
s_waitcnt lgkmcnt(1)
Tv 62,251,12800
Mvav 80,192,212
Tv 64,251,13312
Mvav 80,208,48
Tv 66,251,13824
Mvav 80,224,52
Tv 68,251,14336
Mvav 80,240,56
Tv 70,251,14848
Mvav 84,196,212
Tv 72,251,15360
Mvav 84,212,48
s_waitcnt vmcnt(11)
Tv 74,251,15872
Mvav 84,228,52
La 0,13,0
Mvav 84,244,56
La 16,14,0
Mvav 88,200,212
La 4,13,2048
Mvav 88,216,48
La 20,14,2048
Mvav 88,232,52
La 8,13,4096
Mvav 88,248,56
La 24,14,4096
Mvav 92,204,212
La 12,13,6144
Mvav 92,220,48
La 28,14,6144
Mvav 92,236,52
Mvav 92,252,56
s_waitcnt lgkmcnt(8)
Mvav 96,192,60
s_waitcnt vmcnt(8)
s_barrier
Mvav 96,208,64
Lv 76,8,0
Mvav 96,224,68
Lv 212,8,64
Mvav 96,240,72
Tv 48,6,25600
Mvav 100,196,60
s_add_u32 s55, s31, 0x60000
Tv 50,7,25600
Mvav 100,212,64
Tv 52,6,25856
Mvav 100,228,68
Tv 54,7,25856
Mvav 100,244,72
buffer_store_dwordx4 v[112:115], v1, s[16:19], s55 offen sc0 sc1
s_add_u32 s55, s31, 0x60000
Mvav 104,200,60
Mvav 104,216,64
Mvav 104,232,68
buffer_store_dwordx4 v[116:119], v1, s[16:19], s55 offen offset:1024 sc0 sc1
s_add_u32 s55, s32, 0x60000
Mvav 104,248,72
Mvav 108,204,60
Tv 56,248,30720
Mvav 108,220,64
buffer_store_dwordx4 v[120:123], v1, s[16:19], s55 offen sc0 sc1
s_add_u32 s55, s32, 0x60000
Tv 58,248,31232
Mvav 108,236,68
Tv 60,248,31744
Mvav 108,252,72
s_waitcnt lgkmcnt(7)
Tv 62,248,32256
Zvva 112,76,0
buffer_store_dwordx4 v[124:127], v1, s[16:19], s55 offen offset:1024 sc0 sc1
s_add_u32 m0, s38, 0x5800
s_mul_i32 s36, s33, 0x90000
Tv 64,249,30720
Mvva 112,212,16
Tv 66,249,31232
Zvva 116,76,4
Tv 68,249,31744
Mvva 116,212,20
buffer_load_dwordx4 v3, s[4:7], s36 offen lds
Zvva 120,76,8
Tv 70,249,32256
Mvva 120,212,24
Zvva 124,76,12
buffer_load_dwordx4 v4, s[4:7], s36 offen offset:1024 lds
Mvva 124,212,28
s_waitcnt lgkmcnt(8)
s_add_u32 s55, s31, 0x1020000
Tv 72,250,30720
Zvva 128,48,0
Tv 74,250,31232
Mvva 128,52,16
buffer_store_dwordx4 v[144:147], v1, s[16:19], s55 offen sc0 sc1
s_add_u32 s55, s32, 0x1020000
Tv 76,250,31744
Zvva 132,48,4
Tv 78,250,32256
Mvva 132,52,20
Zvva 136,48,8
buffer_store_dwordx4 v[152:155], v1, s[16:19], s55 offen sc0 sc1
s_add_u32 s55, s31, 0x1020000
Mvva 136,52,24
Zvva 140,48,12
Tv 212,251,30720
Mvva 140,52,28
s_waitcnt lgkmcnt(9)
buffer_store_dwordx4 v[160:163], v1, s[16:19], s55 offen offset:1024 sc0 sc1
s_add_u32 m0, s38, 0x6800
Tv 214,251,31232
Zvva 144,56,0
Tv 48,251,31744
Mvva 144,60,16
Tv 50,251,32256
Zvva 148,56,4
buffer_load_dwordx4 v5, s[4:7], s36 offen lds
Mvva 148,60,20
s_add_u32 s33, s33, 1
s_sub_u32 s36, s33, 9
s_min_u32 s33, s33, s36
Zvva 152,56,8
s_add_u32 s55, s32, 0x1020000
Mvva 152,60,24
s_waitcnt vmcnt(10)
La 32,13,16384
Zvva 156,56,12
buffer_store_dwordx4 v[168:171], v1, s[16:19], s55 offen offset:1024 sc0 sc1
s_lshl_b32 s34, s33, 7
s_add_u32 m0, s38, 0x8000
s_add_u32 s36, s27, s34
Mvva 156,60,28
s_waitcnt lgkmcnt(9)
La 48,14,16384
Zvva 160,64,0
La 36,13,18432
Mvva 160,68,16
buffer_load_dwordx4 v11, s[12:15], s36 offen lds
Zvva 164,64,4
La 52,14,18432
Mvva 164,68,20
La 40,13,20480
Zvva 168,64,8
buffer_load_dwordx4 v12, s[12:15], s36 offen offset:1024 lds
Mvva 168,68,24
s_add_u32 m0, s38, 0x8800
s_add_u32 s36, s28, s34
La 56,14,20480
Zvva 172,64,12
La 44,13,28672
Mvva 172,68,28
s_waitcnt lgkmcnt(7)
buffer_load_dwordx4 v11, s[12:15], s36 offen lds
Zvva 176,72,0
s_waitcnt vmcnt(4)
s_barrier
Mvva 176,76,16
Lv 52,8,128
Zvva 180,72,4
buffer_load_dwordx4 v12, s[12:15], s36 offen offset:1024 lds
Mvva 180,76,20
s_add_u32 m0, s38, 0x9000
s_add_u32 s36, s29, s34
Lv 56,8,192
Zvva 184,72,8
La 60,14,28672
Mvva 184,76,24
buffer_load_dwordx4 v11, s[12:15], s36 offen lds
Zvva 188,72,12
Tv 60,6,26624
Mvva 188,76,28
Tv 62,7,26624
Zvva 192,212,0
buffer_load_dwordx4 v12, s[12:15], s36 offen offset:1024 lds
Mvva 192,48,16
s_add_u32 m0, s38, 0x9800
s_add_u32 s36, s30, s34
Tv 64,6,26880
Zvva 196,212,4
Tv 66,7,26880
Mvva 196,48,20
buffer_load_dwordx4 v11, s[12:15], s36 offen lds
Zvva 200,212,8
Tv 68,248,22528
Mvva 200,48,24
Tv 70,248,23040
Zvva 204,212,12
buffer_load_dwordx4 v12, s[12:15], s36 offen offset:1024 lds
Mvva 204,48,28
s_waitcnt lgkmcnt(6)
s_add_u32 m0, s38, 0x2000
s_mul_i32 s36, s33, 0x90000
Mvva 112,52,32
Tv 72,248,23552
Mvva 112,56,48
buffer_load_dwordx4 v3, s[4:7], s36 offen lds
Mvva 116,52,36
Tv 74,248,24064
Mvva 116,56,52
Tv 76,249,22528
Mvva 120,52,40
buffer_load_dwordx4 v4, s[4:7], s36 offen offset:1024 lds
Mvva 120,56,56
s_add_u32 m0, s38, 0x6c00
Tv 78,249,23040
Mvva 124,52,44
Tv 212,249,23552
Mvva 124,56,60
s_waitcnt lgkmcnt(7)
buffer_load_dwordx4 v5, s[4:7], s36 offen lds
Mvva 128,60,32
s_add_u32 s33, s33, 1
s_sub_u32 s36, s33, 9
s_min_u32 s33, s33, s36
Mvva 128,64,48
s_lshl_b32 s34, s33, 7
s_add_u32 m0, s38, 0
s_add_u32 s36, s27, s34
Mvva 132,60,36
buffer_load_dwordx4 v11, s[12:15], s36 offen lds
Mvva 132,64,52
Tv 214,249,24064
Mvva 136,60,40
Tv 48,250,22528
Mvva 136,64,56
buffer_load_dwordx4 v12, s[12:15], s36 offen offset:1024 lds
Mvva 140,60,44
s_add_u32 m0, s38, 0x800
s_add_u32 s36, s28, s34
Tv 50,250,23040
Mvva 140,64,60
s_waitcnt lgkmcnt(6)
Tv 52,250,23552
Mvva 144,68,32
Tv 54,250,24064
Mvva 144,72,48
buffer_load_dwordx4 v11, s[12:15], s36 offen lds
Mvva 148,68,36
Tv 56,251,22528
Mvva 148,72,52
Tv 58,251,23040
Mvva 152,68,40
Tv 60,251,23552
Mvva 152,72,56
s_waitcnt vmcnt(6)
buffer_load_dwordx4 v12, s[12:15], s36 offen offset:1024 lds
Mvva 156,68,44
s_add_u32 m0, s38, 0x1000
s_add_u32 s36, s29, s34
Tv 62,251,24064
Mvva 156,72,60
s_waitcnt lgkmcnt(8)
La 64,13,32768
Mvva 160,76,32
buffer_load_dwordx4 v11, s[12:15], s36 offen lds
Mvva 160,212,48
La 80,14,32768
Mvva 164,76,36
La 68,13,34816
Mvva 164,212,52
buffer_load_dwordx4 v12, s[12:15], s36 offen offset:1024 lds
Mvva 168,76,40
s_add_u32 m0, s38, 0x1800
s_add_u32 s36, s30, s34
La 84,14,34816
Mvva 168,212,56
La 72,13,36864
Mvva 172,76,44
buffer_load_dwordx4 v11, s[12:15], s36 offen lds
Mvva 172,212,60
s_waitcnt lgkmcnt(5)
La 88,14,36864
Mvva 176,48,32
s_waitcnt vmcnt(7)
s_barrier
Mvva 176,52,48
buffer_load_dwordx4 v12, s[12:15], s36 offen offset:1024 lds
Mvva 180,48,36
s_add_u32 m0, s38, 0x2800
s_mul_i32 s36, s33, 0x90000
Lv 64,8,256
Mvva 180,52,52
La 76,13,38912
Mvva 184,48,40
buffer_load_dwordx4 v3, s[4:7], s36 offen lds
Mvva 184,52,56
Lv 68,8,320
Mvva 188,48,44
La 92,14,38912
Mvva 188,52,60
buffer_load_dwordx4 v4, s[4:7], s36 offen offset:1024 lds
Mvva 192,56,32
s_add_u32 m0, s38, 0x6400
Tv 72,6,27648
Mvva 192,60,48
Tv 74,7,27648
Mvva 196,56,36
buffer_load_dwordx4 v5, s[4:7], s36 offen lds
Mvva 196,60,52
s_add_u32 s33, s33, 1
s_sub_u32 s36, s33, 9
s_min_u32 s33, s33, s36
Mvva 200,56,40
s_lshl_b32 s34, s33, 7
s_add_u32 m0, s38, 0x4000
s_add_u32 s36, s27, s34
Mvva 200,60,56
buffer_load_dwordx4 v11, s[12:15], s36 offen lds
Mvva 204,56,44
Tv 76,6,27904
Mvva 204,60,60
s_waitcnt lgkmcnt(3)
Tv 78,7,27904
Mvva 112,64,64
buffer_load_dwordx4 v12, s[12:15], s36 offen offset:1024 lds
Mvva 112,68,80
s_add_u32 m0, s38, 0x4800
s_add_u32 s36, s28, s34
Tv 212,248,8192
Mvva 116,64,68
Tv 214,248,8704
Mvva 116,68,84
buffer_load_dwordx4 v11, s[12:15], s36 offen lds
Mvva 120,64,72
Tv 48,248,9216
Mvva 120,68,88
Tv 50,248,9728
Mvva 124,64,76
buffer_load_dwordx4 v12, s[12:15], s36 offen offset:1024 lds
Mvva 124,68,92
s_waitcnt lgkmcnt(4)
s_add_u32 m0, s38, 0x5000
s_add_u32 s36, s29, s34
Mvva 128,72,64
Tv 52,249,8192
Mvva 128,76,80
buffer_load_dwordx4 v11, s[12:15], s36 offen lds
Mvva 132,72,68
Tv 54,249,8704
Mvva 132,76,84
Tv 56,249,9216
Mvva 136,72,72
Tv 58,249,9728
Mvva 136,76,88
buffer_load_dwordx4 v12, s[12:15], s36 offen offset:1024 lds
Mvva 140,72,76
s_add_u32 m0, s38, 0x7000
s_add_u32 s36, s30, s34
Tv 60,250,8192
Mvva 140,76,92
s_waitcnt lgkmcnt(5)
Tv 62,250,8704
Mvva 144,212,64
Tv 64,250,9216
Mvva 144,48,80
buffer_load_dwordx4 v11, s[12:15], s36 offen lds
Mvva 148,212,68
Tv 66,250,9728
Mvva 148,48,84
Tv 68,251,8192
Mvva 152,212,72
Tv 70,251,8704
Mvva 152,48,88
s_waitcnt vmcnt(10)
buffer_load_dwordx4 v12, s[12:15], s36 offen offset:1024 lds
Mvva 156,212,76
s_add_u32 m0, s38, 0x3000
s_mul_i32 s36, s33, 0x90000
Tv 72,251,9216
Mvva 156,48,92
s_waitcnt lgkmcnt(7)
Tv 74,251,9728
Mvva 160,52,64
La 96,13,0
Mvva 160,56,80
buffer_load_dwordx4 v3, s[4:7], s36 offen lds
Mvva 164,52,68
La 112,14,0
Mvva 164,56,84
La 100,13,2048
Mvva 168,52,72
La 116,14,2048
Mvva 168,56,88
La 104,13,4096
Mvva 172,52,76
La 120,14,4096
Mvva 172,56,92
s_waitcnt lgkmcnt(6)
La 108,13,6144
Mvva 176,60,64
s_waitcnt vmcnt(9)
s_barrier
Mvva 176,64,80
buffer_load_dwordx4 v4, s[4:7], s36 offen offset:1024 lds
Mvva 180,60,68
s_add_u32 m0, s38, 0x6800
Lv 76,8,384
Mvva 180,64,84
Lv 212,8,448
Mvva 184,60,72
La 124,14,6144
Mvva 184,64,88
buffer_load_dwordx4 v5, s[4:7], s36 offen lds
Mvva 188,60,76
s_add_u32 s33, s33, 1
s_sub_u32 s36, s33, 9
s_min_u32 s33, s33, s36
Mvva 188,64,92
s_lshl_b32 s34, s33, 7
s_add_u32 m0, s38, 0x8000
s_add_u32 s36, s27, s34
Mvva 192,68,64
Tv 48,6,25600
Mvva 192,72,80
buffer_load_dwordx4 v11, s[12:15], s36 offen lds
Mvva 196,68,68
Tv 50,7,25600
Mvva 196,72,84
Tv 52,6,25856
Mvva 200,68,72
Tv 54,7,25856
Mvva 200,72,88
buffer_load_dwordx4 v12, s[12:15], s36 offen offset:1024 lds
Mvva 204,68,76
s_add_u32 m0, s38, 0x8800
s_add_u32 s36, s28, s34
Tv 56,248,10240
Mvva 204,72,92
s_waitcnt lgkmcnt(5)
Tv 58,248,10752
Mvva 112,76,96
Tv 60,248,11264
Mvva 112,212,112
buffer_load_dwordx4 v11, s[12:15], s36 offen lds
Mvva 116,76,100
Tv 62,248,11776
Mvva 116,212,116
Tv 64,249,10240
Mvva 120,76,104
Tv 66,249,10752
Mvva 120,212,120
buffer_load_dwordx4 v12, s[12:15], s36 offen offset:1024 lds
Mvva 124,76,108
s_add_u32 m0, s38, 0x9000
s_add_u32 s36, s29, s34
Tv 68,249,11264
Mvva 124,212,124
s_waitcnt lgkmcnt(7)
Tv 70,249,11776
Mvva 128,48,96
Tv 72,250,10240
Mvva 128,52,112
M_w4:
s_cbranch_execz M_w5
buffer_load_dwordx4 v11, s[12:15], s36 offen lds
Mvva 132,48,100
Tv 74,250,10752
Mvva 132,52,116
Tv 76,250,11264
Mvva 136,48,104
Tv 78,250,11776
Mvva 136,52,120
buffer_load_dwordx4 v12, s[12:15], s36 offen offset:1024 lds
Mvva 140,48,108
s_add_u32 m0, s38, 0x9800
s_add_u32 s36, s30, s34
Tv 212,251,10240
Mvva 140,52,124
s_waitcnt lgkmcnt(9)
Tv 214,251,10752
Mvva 144,56,96
Tv 48,251,11264
Mvva 144,60,112
buffer_load_dwordx4 v11, s[12:15], s36 offen lds
Mvva 148,56,100
s_add_u32 s55, s31, 0x1000000
Tv 50,251,11776
Mvva 148,60,116
Mvva 152,56,104
Mvva 152,60,120
s_waitcnt vmcnt(10)
buffer_store_dwordx4 v[16:19], v1, s[16:19], s55 offen sc0 sc1
La 128,13,16384
La 144,14,16384
Mvva 156,56,108
La 132,13,18432
Mvva 156,60,124
s_waitcnt lgkmcnt(11)
La 148,14,18432
Mvva 160,64,96
La 136,13,20480
Mvva 160,68,112
La 152,14,20480
Mvva 164,64,100
La 140,13,28672
Mvva 164,68,116
La 156,14,28672
Mvva 168,64,104
Mvva 168,68,120
Mvva 172,64,108
Mvva 172,68,124
s_waitcnt lgkmcnt(8)
Mvva 176,72,96
s_waitcnt vmcnt(8)
s_barrier
Mvva 176,76,112
Lv 52,8,512
Mvva 180,72,100
Lv 56,8,40960
Mvva 180,76,116
buffer_load_dwordx4 v12, s[12:15], s36 offen offset:1024 lds
Mvva 184,72,104
s_add_u32 m0, s38, 0x3800
s_mul_i32 s36, s33, 0x90000
Tv 60,6,26624
Mvva 184,76,120
Tv 62,7,26624
Mvva 188,72,108
Tv 64,6,26880
Mvva 188,76,124
buffer_load_dwordx4 v3, s[4:7], s36 offen lds
Mvva 192,212,96
Tv 66,7,26880
Mvva 192,48,112
Tv 68,248,12288
Mvva 196,212,100
Tv 70,248,12800
Mvva 196,48,116
buffer_load_dwordx4 v4, s[4:7], s36 offen offset:1024 lds
Mvva 200,212,104
s_add_u32 m0, s38, 0x6c00
Tv 72,248,13312
Mvva 200,48,120
Tv 74,248,13824
Mvva 204,212,108
Tv 76,249,12288
Mvva 204,48,124
s_waitcnt lgkmcnt(9)
buffer_load_dwordx4 v5, s[4:7], s36 offen lds
Mvva 112,52,128
s_add_u32 s33, s33, 1
s_sub_u32 s36, s33, 9
s_min_u32 s33, s33, s36
Mvva 112,56,144
Tv 78,249,12800
Mvva 116,52,132
Tv 212,249,13312
Mvva 116,56,148
Tv 214,249,13824
Mvva 120,52,136
Mvva 120,56,152
s_lshl_b32 s34, s33, 7
s_add_u32 m0, s38, 0
s_add_u32 s36, s27, s34
Mvva 124,52,140
Tv 48,250,12288
Mvva 124,56,156
s_waitcnt lgkmcnt(9)
Tv 50,250,12800
Mvva 128,60,128
buffer_load_dwordx4 v11, s[12:15], s36 offen lds
Mvva 128,64,144
Tv 52,250,13312
Mvva 132,60,132
Tv 54,250,13824
Mvva 132,64,148
Mvva 136,60,136
buffer_load_dwordx4 v12, s[12:15], s36 offen offset:1024 lds
Mvva 136,64,152
s_add_u32 m0, s38, 0x800
s_add_u32 s36, s28, s34
Mvva 140,60,140
Tv 56,251,12288
Mvva 140,64,156
s_waitcnt lgkmcnt(9)
Tv 58,251,12800
Mvva 144,68,128
buffer_load_dwordx4 v11, s[12:15], s36 offen lds
Mvva 144,72,144
Tv 60,251,13312
Mvva 148,68,132
Tv 62,251,13824
Mvva 148,72,148
Mvva 152,68,136
buffer_load_dwordx4 v12, s[12:15], s36 offen offset:1024 lds
Mvva 152,72,152
s_waitcnt vmcnt(7)
s_add_u32 m0, s38, 0x1000
s_add_u32 s36, s29, s34
Mvva 156,68,140
La 160,13,32768
Mvva 156,72,156
s_waitcnt lgkmcnt(9)
buffer_load_dwordx4 v11, s[12:15], s36 offen lds
Mvva 160,76,128
La 176,14,32768
Mvva 160,212,144
La 164,13,34816
Mvva 164,76,132
buffer_load_dwordx4 v12, s[12:15], s36 offen offset:1024 lds
Mvva 164,212,148
s_add_u32 m0, s38, 0x1800
s_add_u32 s36, s30, s34
La 180,14,34816
Mvva 168,76,136
La 168,13,36864
Mvva 168,212,152
buffer_load_dwordx4 v11, s[12:15], s36 offen lds
Mvva 172,76,140
La 184,14,36864
Mvva 172,212,156
s_waitcnt lgkmcnt(6)
La 172,13,38912
Mvva 176,48,128
s_waitcnt vmcnt(7)
s_barrier
Mvva 176,52,144
buffer_load_dwordx4 v12, s[12:15], s36 offen offset:1024 lds
Mvva 180,48,132
s_add_u32 s55, s31, 0x1000000
Lv 64,8,41024
Mvva 180,52,148
Lv 68,8,41088
Mvva 184,48,136
buffer_store_dwordx4 v[32:35], v1, s[16:19], s55 offen offset:1024 sc0 sc1
La 188,14,38912
s_add_u32 m0, s38, 0x5800
s_mul_i32 s36, s33, 0x90000
Mvva 184,52,152
Tv 72,6,27648
Mvva 188,48,140
Tv 74,7,27648
Mvva 188,52,156
buffer_load_dwordx4 v3, s[4:7], s36 offen lds
Mvva 192,56,128
Tv 76,6,27904
Mvva 192,60,144
Tv 78,7,27904
Mvva 196,56,132
Tv 212,248,14336
Mvva 196,60,148
buffer_load_dwordx4 v4, s[4:7], s36 offen offset:1024 lds
Mvva 200,56,136
s_add_u32 m0, s38, 0x6400
Tv 214,248,14848
Mvva 200,60,152
Tv 48,248,15360
Mvva 204,56,140
Tv 50,248,15872
Mvva 204,60,156
s_waitcnt lgkmcnt(8)
buffer_load_dwordx4 v5, s[4:7], s36 offen lds
Mvva 112,64,160
s_add_u32 s33, s33, 1
s_sub_u32 s36, s33, 9
s_min_u32 s33, s33, s36
Mvva 112,68,176
Tv 52,249,14336
Mvva 116,64,164
Tv 54,249,14848
Mvva 116,68,180
Tv 56,249,15360
Mvva 120,64,168
Tv 58,249,15872
Mvva 120,68,184
s_lshl_b32 s34, s33, 7
s_add_u32 m0, s38, 0x4000
s_add_u32 s36, s27, s34
Mvva 124,64,172
Tv 60,250,14336
Mvva 124,68,188
s_waitcnt lgkmcnt(9)
Tv 62,250,14848
Mvva 128,72,160
buffer_load_dwordx4 v11, s[12:15], s36 offen lds
Mvva 128,76,176
Tv 64,250,15360
Mvva 132,72,164
Tv 66,250,15872
Mvva 132,76,180
Mvva 136,72,168
buffer_load_dwordx4 v12, s[12:15], s36 offen offset:1024 lds
Mvva 136,76,184
s_add_u32 m0, s38, 0x4800
s_add_u32 s36, s28, s34
Mvva 140,72,172
Tv 68,251,14336
Mvva 140,76,188
s_waitcnt lgkmcnt(9)
Tv 70,251,14848
Mvva 144,212,160
buffer_load_dwordx4 v11, s[12:15], s36 offen lds
Mvva 144,48,176
Tv 72,251,15360
Mvva 148,212,164
Tv 74,251,15872
Mvva 148,48,180
Mvva 152,212,168
buffer_load_dwordx4 v12, s[12:15], s36 offen offset:1024 lds
Mvva 152,48,184
s_waitcnt vmcnt(8)
s_add_u32 m0, s38, 0x5000
s_add_u32 s36, s29, s34
Mvva 156,212,172
La 192,13,0
Mvva 156,48,188
s_waitcnt lgkmcnt(9)
La 208,14,0
Mvva 160,52,160
buffer_load_dwordx4 v11, s[12:15], s36 offen lds
Mvva 160,56,176
La 196,13,2048
Mvva 164,52,164
La 212,14,2048
Mvva 164,56,180
La 200,13,4096
Mvva 168,52,168
La 216,14,4096
Mvva 168,56,184
La 204,13,6144
Mvva 172,52,172
La 220,14,6144
Mvva 172,56,188
s_waitcnt lgkmcnt(8)
Mvva 176,60,160
s_waitcnt vmcnt(5)
s_barrier
Mvva 176,64,176
buffer_load_dwordx4 v12, s[12:15], s36 offen offset:1024 lds
Mvva 180,60,164
s_add_u32 m0, s38, 0x7000
s_add_u32 s36, s30, s34
Lv 76,8,41152
Mvva 180,64,180
Lv 212,8,41216
Mvva 184,60,168
buffer_load_dwordx4 v11, s[12:15], s36 offen lds
Mvva 184,64,184
Tv 48,6,25600
Mvva 188,60,172
Tv 50,7,25600
Mvva 188,64,188
buffer_load_dwordx4 v12, s[12:15], s36 offen offset:1024 lds
Mvva 192,68,160
s_add_u32 m0, s38, 0x7800
s_mul_i32 s36, s33, 0x90000
Tv 52,6,25856
Mvva 192,72,176
Tv 54,7,25856
Mvva 196,68,164
buffer_load_dwordx4 v3, s[4:7], s36 offen lds
Mvva 196,72,180
Tv 56,248,22528
Mvva 200,68,168
Tv 58,248,23040
Mvva 200,72,184
buffer_load_dwordx4 v4, s[4:7], s36 offen offset:1024 lds
Mvva 204,68,172
s_add_u32 s55, s32, 0x1000000
Tv 60,248,23552
Mvva 204,72,188
s_waitcnt lgkmcnt(7)
Tv 62,248,24064
Mvva 112,76,192
buffer_store_dwordx4 v[24:27], v1, s[16:19], s55 offen sc0 sc1
Tv 64,249,22528
Tv 66,249,23040
Mvva 112,212,208
Tv 68,249,23552
Mvva 116,76,196
s_add_u32 m0, s38, 0x6800
Tv 70,249,24064
Mvva 116,212,212
Mvva 120,76,200
Mvva 120,212,216
buffer_load_dwordx4 v5, s[4:7], s36 offen lds
Mvva 124,76,204
s_add_u32 s33, s33, 1
s_sub_u32 s36, s33, 9
s_min_u32 s33, s33, s36
Mvva 124,212,220
s_waitcnt lgkmcnt(8)
Tv 72,250,22528
Mvva 128,48,192
Tv 74,250,23040
Mvva 128,52,208
Tv 76,250,23552
Mvva 132,48,196
s_lshl_b32 s34, s33, 7
s_add_u32 m0, s38, 0x8000
s_add_u32 s36, s27, s34
Mvva 132,52,212
Tv 78,250,24064
Mvva 136,48,200
Mvva 136,52,216
buffer_load_dwordx4 v11, s[12:15], s36 offen lds
Mvva 140,48,204
Tv 212,251,22528
Mvva 140,52,220
s_waitcnt lgkmcnt(9)
Tv 214,251,23040
Mvva 144,56,192
Tv 48,251,23552
Mvva 144,60,208
buffer_load_dwordx4 v12, s[12:15], s36 offen offset:1024 lds
Mvva 148,56,196
s_add_u32 m0, s38, 0x8800
s_add_u32 s36, s28, s34
Tv 50,251,24064
Mvva 148,60,212
Mvva 152,56,200
Mvva 152,60,216
s_waitcnt vmcnt(6)
buffer_load_dwordx4 v11, s[12:15], s36 offen lds
Mvva 156,56,204
La 224,13,16384
Mvva 156,60,220
s_waitcnt lgkmcnt(9)
La 240,14,16384
Mvva 160,64,192
buffer_load_dwordx4 v12, s[12:15], s36 offen offset:1024 lds
Mvva 160,68,208
s_add_u32 m0, s38, 0x9000
s_add_u32 s36, s29, s34
La 228,13,18432
Mvva 164,64,196
La 244,14,18432
Mvva 164,68,212
La 232,13,20480
Mvva 168,64,200
buffer_load_dwordx4 v11, s[12:15], s36 offen lds
Mvva 168,68,216
La 248,14,20480
Mvva 172,64,204
La 236,13,28672
Mvva 172,68,220
s_waitcnt lgkmcnt(7)
La 252,14,28672
Mvva 176,72,192
s_waitcnt vmcnt(5)
s_barrier
Mvva 176,76,208
buffer_load_dwordx4 v12, s[12:15], s36 offen offset:1024 lds
Mvva 180,72,196
s_add_u32 m0, s38, 0x9800
s_add_u32 s36, s30, s34
Lv 52,8,41280
Mvva 180,76,212
Lv 56,8,41344
Mvva 184,72,200
buffer_load_dwordx4 v11, s[12:15], s36 offen lds
Mvva 184,76,216
Tv 60,6,26624
Mvva 188,72,204
Tv 62,7,26624
Mvva 188,76,220
buffer_load_dwordx4 v12, s[12:15], s36 offen offset:1024 lds
Mvva 192,212,192
s_add_u32 m0, s38, 0
s_mul_i32 s36, s33, 0x90000
Tv 64,6,26880
Mvva 192,48,208
Tv 66,7,26880
Mvva 196,212,196
buffer_load_dwordx4 v3, s[4:7], s36 offen lds
Mvva 196,48,212
Tv 68,248,30720
Mvva 200,212,200
Tv 70,248,31232
Mvva 200,48,216
buffer_load_dwordx4 v4, s[4:7], s36 offen offset:1024 lds
Mvva 204,212,204
s_add_u32 m0, s38, 0x6c00
Tv 72,248,31744
Mvva 204,48,220
s_waitcnt lgkmcnt(7)
Tv 74,248,32256
Mvva 112,52,224
buffer_load_dwordx4 v5, s[4:7], s36 offen lds
Mvva 112,56,240
s_add_u32 s33, s33, 1
s_sub_u32 s36, s33, 9
s_min_u32 s33, s33, s36
Mvva 116,52,228
s_add_u32 s55, s32, 0x1000000
Tv 76,249,30720
Mvva 116,56,244
buffer_store_dwordx4 v[40:43], v1, s[16:19], s55 offen offset:1024 sc0 sc1
Tv 78,249,31232
Tv 212,249,31744
Mvva 120,52,232
Tv 214,249,32256
Mvva 120,56,248
Mvva 124,52,236
Tv 48,250,30720
Mvva 124,56,252
s_waitcnt lgkmcnt(9)
Tv 50,250,31232
Mvva 128,60,224
Tv 52,250,31744
Mvva 128,64,240
Tv 54,250,32256
Mvva 132,60,228
s_add_u32 m0, s38, 0x2000
s_mul_i32 s36, s33, 0x80000
Mvva 132,64,244
Mvva 136,60,232
Mvva 136,64,248
buffer_load_dwordx4 v0, s[8:11], s36 offen lds
Mvva 140,60,236
Tv 56,251,30720
Mvva 140,64,252
s_waitcnt lgkmcnt(9)
Tv 58,251,31232
Mvva 144,68,224
Tv 60,251,31744
Mvva 144,72,240
buffer_load_dwordx4 v2, s[8:11], s36 offen offset:1024 lds
Mvva 148,68,228
s_add_u32 s33, s33, 1
s_sub_u32 s36, s33, 9
s_min_u32 s33, s33, s36
Mvva 148,72,244
s_add_u32 m0, s38, 0x2800
s_mul_i32 s36, s33, 0x80000
Tv 62,251,32256
Mvva 152,68,232
Mvva 152,72,248
s_waitcnt vmcnt(6)
buffer_load_dwordx4 v0, s[8:11], s36 offen lds
Mvva 156,68,236
Lv 16,13,32768
Mvva 156,72,252
s_waitcnt lgkmcnt(9)
Lv 32,14,32768
Mvva 160,76,224
buffer_load_dwordx4 v2, s[8:11], s36 offen offset:1024 lds
Mvva 160,212,240
s_add_u32 s33, s33, 1
s_sub_u32 s36, s33, 9
s_min_u32 s33, s33, s36
Mvva 164,76,228
s_add_u32 m0, s38, 0x3000
s_mul_i32 s36, s33, 0x80000
Lv 20,13,34816
Mvva 164,212,244
Lv 36,14,34816
Mvva 168,76,232
buffer_load_dwordx4 v0, s[8:11], s36 offen lds
Mvva 168,212,248
Lv 24,13,36864
Mvva 172,76,236
Lv 40,14,36864
Mvva 172,212,252
s_waitcnt lgkmcnt(6)
Lv 28,13,38912
Mvva 176,48,224
s_waitcnt vmcnt(6)
s_barrier
Mvva 176,52,240
buffer_load_dwordx4 v2, s[8:11], s36 offen offset:1024 lds
Mvva 180,48,228
s_add_u32 s33, s33, 1
s_sub_u32 s36, s33, 9
s_min_u32 s33, s33, s36
Mvva 180,52,244
s_add_u32 m0, s38, 0x3800
s_mul_i32 s36, s33, 0x80000
Lv 64,8,41408
Mvva 184,48,232
buffer_load_dwordx4 v0, s[8:11], s36 offen lds
Mvva 184,52,248
Lv 68,8,41472
Mvva 188,48,236
Lv 44,14,38912
Mvva 188,52,252
buffer_load_dwordx4 v2, s[8:11], s36 offen offset:1024 lds
Mvva 192,56,224
s_add_u32 s33, s33, 1
s_sub_u32 s36, s33, 9
s_min_u32 s33, s33, s36
Mvva 192,60,240
Tv 72,6,27648
Mvva 196,56,228
Tv 74,7,27648
Mvva 196,60,244
Tv 76,6,27904
Mvva 200,56,232
Tv 78,7,27904
Mvva 200,60,248
s_add_u32 m0, s38, 0x5800
s_mul_i32 s36, s33, 0x80000
Tv 212,248,0
Mvva 204,56,236
Tv 214,248,512
Mvva 204,60,252
s_waitcnt lgkmcnt(6)
Tv 48,248,1024
Mvvv 112,64,16
buffer_load_dwordx4 v0, s[8:11], s36 offen lds
Mvvv 112,68,32
Tv 50,248,1536
Mvvv 116,64,20
Tv 52,249,0
Mvvv 116,68,36
M_w5:
s_cbranch_execz M_w6
buffer_load_dwordx4 v2, s[8:11], s36 offen offset:1024 lds
Mvvv 120,64,24
s_add_u32 s33, s33, 1
s_sub_u32 s36, s33, 9
s_min_u32 s33, s33, s36
Mvvv 120,68,40
s_add_u32 m0, s38, 0x8000
s_mul_i32 s36, s33, 0x80000
Tv 54,249,512
Mvvv 124,64,28
buffer_load_dwordx4 v0, s[8:11], s36 offen lds
Mvvv 124,68,44
s_waitcnt lgkmcnt(6)
Tv 56,249,1024
Mvvv 128,72,16
Tv 58,249,1536
Mvvv 128,76,32
buffer_load_dwordx4 v2, s[8:11], s36 offen offset:1024 lds
Mvvv 132,72,20
s_add_u32 s33, s33, 1
s_sub_u32 s36, s33, 9
s_min_u32 s33, s33, s36
Mvvv 132,76,36
s_add_u32 m0, s38, 0x8800
s_mul_i32 s36, s33, 0x80000
Tv 60,250,0
Mvvv 136,72,24
buffer_load_dwordx4 v0, s[8:11], s36 offen lds
Mvvv 136,76,40
Tv 62,250,512
v_mul_f32 v112, s89, v112
Mvvv 140,72,28
Tv 64,250,1024
v_mul_f32 v116, s89, v116
Mvvv 140,76,44
s_waitcnt lgkmcnt(7)
Tv 66,250,1536
v_mul_f32 v120, s89, v120
Mvvv 144,212,16
buffer_load_dwordx4 v2, s[8:11], s36 offen offset:1024 lds
Mvvv 144,48,32
s_add_u32 s33, s33, 1
s_sub_u32 s36, s33, 9
s_min_u32 s33, s33, s36
Mvvv 148,212,20
s_add_u32 m0, s38, 0x9000
Tv 68,251,0
v_mul_f32 v124, s89, v124
Mvvv 148,48,36
s_mul_i32 s36, s33, 0x80000
v_exp_f32 v112, -v112
Mvvv 152,212,24
v_exp_f32 v116, -v116
Mvvv 152,48,40
v_exp_f32 v120, -v120
Mvvv 156,212,28
v_exp_f32 v124, -v124
Mvvv 156,48,44
s_waitcnt lgkmcnt(5)
v_min_f32 v112, 0x5d800000, v112
v_min_f32 v116, 0x5d800000, v116
Mvvv 160,52,16
buffer_load_dwordx4 v0, s[8:11], s36 offen lds
Mvvv 160,56,32
Tv 70,251,512
v_min_f32 v120, 0x5d800000, v120
Mvvv 164,52,20
Tv 72,251,1024
Tv 74,251,1536
Mvvv 164,56,36
v_min_f32 v124, 0x5d800000, v124
v_add_f32 v252, 1.0, v112
Mvvv 168,52,24
buffer_load_dwordx4 v2, s[8:11], s36 offen offset:1024 lds
s_add_u32 s33, s33, 1
s_sub_u32 s36, s33, 9
s_min_u32 s33, s33, s36
Mvvv 168,56,40
s_add_u32 m0, s38, 0x9800
v_add_f32 v253, 1.0, v116
v_add_f32 v254, 1.0, v120
Mvvv 172,52,28
s_mul_i32 s36, s33, 0x80000
v_add_f32 v255, 1.0, v124
Mvvv 172,56,44
s_waitcnt lgkmcnt(0)
v_rcp_f32 v113, v252
Mvvv 176,60,16
s_waitcnt vmcnt(6)
s_barrier
Mvvv 176,64,32
buffer_load_dwordx4 v0, s[8:11], s36 offen lds
Mvvv 180,60,20
v_rcp_f32 v117, v253
v_rcp_f32 v121, v254
v_rcp_f32 v125, v255
v_mul_f32 v11, v112, v113
v_mul_f32 v12, v116, v117
v_mul_f32 v13, v120, v121
v_mul_f32 v14, v124, v125
PK 80,80,81
PK 81,82,83
PK 82,84,85
PK 83,86,87
Mvvv 180,64,36
Tv 76,248,8192
PK 88,88,89
Mvvv 184,60,24
buffer_load_dwordx4 v2, s[8:11], s36 offen offset:1024 lds
s_add_u32 s33, s33, 1
s_sub_u32 s36, s33, 9
s_min_u32 s33, s33, s36
Mvvv 184,64,40
s_add_u32 s55, s31, 0x1060000
Tv 78,248,8704
PK 89,90,91
Mvvv 188,60,28
Tv 212,248,9216
PK 90,92,93
Mvvv 188,64,44
buffer_store_dwordx4 v[80:83], v1, s[16:19], s55 offen sc0 sc1
Tv 214,248,9728
Tv 48,248,10240
Mvvv 192,68,16
Tv 50,248,10752
PK 91,94,95
Mvvv 192,72,32
Tv 52,249,8192
v_mul_u32_u24 v5, 0x48000, v15
Mvvv 196,68,20
buffer_load_dword v5, v5, s[4:7], s53 offen offset:128
Mvvv 196,72,36
s_add_u32 s55, s32, 0x1060000
Tv 54,249,8704
PK 96,96,97
Mvvv 200,68,24
Tv 56,249,9216
PK 97,98,99
Mvvv 200,72,40
buffer_store_dwordx4 v[88:91], v1, s[16:19], s55 offen sc0 sc1
Tv 58,249,9728
PK 98,100,101
PK 99,102,103
Mvvv 204,68,28
s_add_u32 s55, s31, 0x1060000
Tv 60,249,10240
PK 104,104,105
Mvvv 204,72,44
s_waitcnt lgkmcnt(5)
Tv 62,249,10752
PK 105,106,107
Zvva 80,76,0
Tv 64,248,11264
PK 106,108,109
Mvva 80,212,16
buffer_store_dwordx4 v[96:99], v1, s[16:19], s55 offen offset:1024 sc0 sc1
Tv 66,248,11776
PK 107,110,111
v_mul_f32 v232, s89, v128
Mvva 80,48,32
Tv 68,248,12288
v_mul_f32 v233, s89, v129
Zvva 84,76,4
Tv 70,248,12800
v_mul_f32 v234, s89, v130
Mvva 84,212,20
Tv 72,248,13312
v_mul_f32 v235, s89, v131
Mvva 84,48,36
Tv 74,248,13824
v_mul_f32 v240, s89, v136
Zvva 88,76,8
s_add_u32 s55, s32, 0x1060000
v_exp_f32 v232, v232
Mvva 88,212,24
v_exp_f32 v233, v233
Mvva 88,48,40
v_exp_f32 v234, v234
Zvva 92,76,12
buffer_store_dwordx4 v[104:107], v1, s[16:19], s55 offen offset:1024 sc0 sc1
v_exp_f32 v235, v235
v_fma_f32 v232, v232, v252, v252
Mvva 92,212,28
v_fma_f32 v233, v233, v252, v252
v_fma_f32 v234, v234, v252, v252
Mvva 92,48,44
s_waitcnt lgkmcnt(6)
Tv 76,249,11264
v_fma_f32 v235, v235, v252, v252
Zvva 96,52,0
Tv 78,249,11776
v_mul_f32 v241, s89, v137
Mvva 96,56,16
Tv 212,249,12288
v_mul_f32 v242, s89, v138
Mvva 96,60,32
s_add_u32 m0, s38, 0x800
s_mul_i32 s36, s33, 0x90000
s_add_u32 s36, s36, 0x80
Zvva 100,52,4
Tv 214,249,12800
v_mul_f32 v243, s89, v139
Mvva 100,56,20
Tv 48,249,13312
v_mul_f32 v236, s89, v148
Mvva 100,60,36
buffer_load_dwordx4 v3, s[4:7], s36 offen lds
Zvva 104,52,8
Tv 50,249,13824
v_mul_f32 v237, s89, v149
Mvva 104,56,24
v_rcp_f32 v232, v232
Mvva 104,60,40
v_rcp_f32 v233, v233
Zvva 108,52,12
v_rcp_f32 v234, v234
Mvva 108,56,28
v_rcp_f32 v235, v235
Mvva 108,60,44
s_waitcnt lgkmcnt(6)
Tv 52,248,14336
v_mul_f32 v128, v232, v128
Mvva 80,64,48
Tv 54,248,14848
v_mul_f32 v129, v233, v129
Mvva 80,68,64
Tv 56,248,15360
v_mul_f32 v130, v234, v130
Mvva 80,72,80
Tv 58,248,15872
v_mul_f32 v131, v235, v131
Mvva 84,64,52
Tv 60,248,22528
PK 128,128,129
Mvva 84,68,68
Tv 62,248,23040
PK 129,130,131
Mvva 84,72,84
v_exp_f32 v240, v240
Mvva 88,64,56
v_exp_f32 v241, v241
Mvva 88,68,72
v_exp_f32 v242, v242
Mvva 88,72,88
v_exp_f32 v243, v243
Mvva 92,64,60
buffer_load_dwordx4 v4, s[4:7], s36 offen offset:1024 lds
Mvva 92,68,76
s_add_u32 s33, s33, 1
s_sub_u32 s36, s33, 9
s_min_u32 s33, s33, s36
Mvva 92,72,92
s_waitcnt lgkmcnt(6)
s_add_u32 m0, s38, 0x1000
s_mul_i32 s36, s33, 0x90000
Mvva 96,76,48
s_add_u32 s36, s36, 0x80
Tv 64,249,14336
v_mul_f32 v232, s89, v132
Mvva 96,212,64
buffer_load_dwordx4 v3, s[4:7], s36 offen lds
Mvva 96,48,80
Tv 66,249,14848
v_mul_f32 v233, s89, v133
Mvva 100,76,52
Tv 68,249,15360
v_mul_f32 v234, s89, v134
Mvva 100,212,68
Tv 70,249,15872
v_mul_f32 v235, s89, v135
Mvva 100,48,84
Tv 72,249,22528
v_fma_f32 v240, v240, v254, v254
Mvva 104,76,56
Tv 74,249,23040
v_fma_f32 v241, v241, v254, v254
Mvva 104,212,72
v_exp_f32 v232, v232
Mvva 104,48,88
v_exp_f32 v233, v233
Mvva 108,76,60
v_exp_f32 v234, v234
Mvva 108,212,76
v_exp_f32 v235, v235
Mvva 108,48,92
s_waitcnt lgkmcnt(6)
v_fma_f32 v232, v232, v253, v253
v_fma_f32 v233, v233, v253, v253
Mvva 80,52,96
v_fma_f32 v234, v234, v253, v253
v_fma_f32 v235, v235, v253, v253
Mvva 80,56,112
v_rcp_f32 v232, v232
Mvva 80,60,128
v_rcp_f32 v233, v233
Mvva 84,52,100
v_rcp_f32 v234, v234
Mvva 84,56,116
v_rcp_f32 v235, v235
Mvva 84,60,132
v_mul_f32 v132, v232, v132
v_mul_f32 v133, v233, v133
Mvva 88,52,104
v_mul_f32 v134, v234, v134
v_mul_f32 v135, v235, v135
Mvva 88,56,120
PK 130,132,133
PK 131,134,135
Mvva 88,60,136
buffer_store_dwordx4 v[128:131], v1, s[16:19], s94 offen sc0 sc1
v_fma_f32 v242, v242, v254, v254
v_fma_f32 v243, v243, v254, v254
v_mul_f32 v232, s89, v144
Mvva 92,52,108
v_rcp_f32 v240, v240
Mvva 92,56,124
v_rcp_f32 v241, v241
Mvva 92,60,140
s_waitcnt lgkmcnt(0)
v_rcp_f32 v242, v242
Mvva 96,64,96
s_waitcnt vmcnt(9)
s_barrier
Mvva 96,68,112
Tv 76,248,23552
v_mul_f32 v233, s89, v145
Mvva 96,72,128
Tv 78,248,24064
v_mul_f32 v234, s89, v146
Mvva 100,64,100
Tv 212,248,32768
v_mul_f32 v235, s89, v147
Mvva 100,68,116
Tv 214,248,33280
v_mul_f32 v238, s89, v150
Mvva 100,72,132
Tv 48,248,33792
v_mul_f32 v239, s89, v151
Mvva 104,64,104
Tv 50,248,34304
v_mul_f32 v244, s89, v156
Mvva 104,68,120
Tv 52,249,23552
v_mul_f32 v245, s89, v157
Mvva 104,72,136
Tv 54,249,24064
v_mul_f32 v246, s89, v158
Mvva 108,64,108
Tv 56,249,32768
v_mul_f32 v247, s89, v159
Mvva 108,68,124
v_rcp_f32 v243, v243
Mvva 108,72,140
s_waitcnt lgkmcnt(3)
Tv 58,249,33280
v_mul_f32 v136, v240, v136
Mvva 80,76,144
Tv 60,249,33792
v_mul_f32 v137, v241, v137
Mvva 80,212,160
Tv 62,249,34304
v_mul_f32 v138, v242, v138
Mvva 80,48,176
Tv 64,248,34816
v_mul_f32 v139, v243, v139
Mvva 84,76,148
Tv 66,248,35328
PK 136,136,137
Mvva 84,212,164
Tv 68,248,35840
PK 137,138,139
Mvva 84,48,180
Tv 70,248,36352
v_mul_f32 v240, s89, v140
Mvva 88,76,152
Tv 72,248,36864
v_mul_f32 v241, s89, v141
Mvva 88,212,168
Tv 74,248,37376
v_mul_f32 v242, s89, v142
Mvva 88,48,184
v_exp_f32 v232, v232
Mvva 92,76,156
v_exp_f32 v233, v233
Mvva 92,212,172
v_exp_f32 v234, v234
Mvva 92,48,188
s_waitcnt lgkmcnt(6)
Tv 76,249,34816
v_mul_f32 v243, s89, v143
Mvva 96,52,144
v_exp_f32 v240, v240
Mvva 96,56,160
v_exp_f32 v241, v241
Mvva 96,60,176
v_exp_f32 v242, v242
Mvva 100,52,148
v_exp_f32 v243, v243
Mvva 100,56,164
Tv 78,249,35328
v_fma_f32 v240, v240, v255, v255
Mvva 100,60,180
Tv 212,249,35840
v_fma_f32 v241, v241, v255, v255
Mvva 104,52,152
Tv 214,249,36352
v_fma_f32 v242, v242, v255, v255
Mvva 104,56,168
Tv 48,249,36864
v_fma_f32 v243, v243, v255, v255
Mvva 104,60,184
v_rcp_f32 v240, v240
Mvva 108,52,156
v_rcp_f32 v241, v241
Mvva 108,56,172
v_rcp_f32 v242, v242
Mvva 108,60,188
s_waitcnt lgkmcnt(5)
v_rcp_f32 v243, v243
Mvva 80,64,192
Tv 50,249,37376
v_mul_f32 v140, v240, v140
Mvva 80,68,208
Tv 52,248,37888
v_mul_f32 v141, v241, v141
Mvva 80,72,224
Tv 54,248,38400
v_mul_f32 v142, v242, v142
Mvva 84,64,196
Tv 56,248,38912
v_mul_f32 v143, v243, v143
Mvva 84,68,212
Tv 58,248,39424
PK 138,140,141
Mvva 84,72,228
Tv 60,248,39936
PK 139,142,143
Mvva 88,64,200
buffer_store_dwordx4 v[136:139], v1, s[16:19], s95 offen sc0 sc1
Tv 62,248,40448
v_exp_f32 v235, v235
Mvva 88,68,216
v_exp_f32 v236, v236
Mvva 88,72,232
v_exp_f32 v237, v237
Mvva 92,64,204
v_exp_f32 v238, v238
Mvva 92,68,220
v_exp_f32 v239, v239
Mvva 92,72,236
s_waitcnt lgkmcnt(6)
Tv 64,249,37888
v_fma_f32 v232, v232, v252, v252
Mvva 96,76,192
Tv 66,249,38400
v_fma_f32 v233, v233, v252, v252
Mvva 96,212,208
Tv 68,249,38912
v_fma_f32 v234, v234, v252, v252
Mvva 96,48,224
Tv 70,249,39424
v_fma_f32 v235, v235, v252, v252
Mvva 100,76,196
Tv 72,249,39936
v_fma_f32 v236, v236, v253, v253
Mvva 100,212,212
Tv 74,249,40448
v_fma_f32 v237, v237, v253, v253
Mvva 100,48,228
v_rcp_f32 v232, v232
Mvva 104,76,200
v_rcp_f32 v233, v233
Mvva 104,212,216
v_rcp_f32 v234, v234
Mvva 104,48,232
v_rcp_f32 v235, v235
Mvva 108,76,204
v_exp_f32 v244, v244
Mvva 108,212,220
v_exp_f32 v245, v245
Mvva 108,48,236
s_waitcnt lgkmcnt(6)
Tv 76,250,8192
v_mul_f32 v144, v232, v144
Mvva 80,52,240
Tv 78,250,8704
v_mul_f32 v145, v233, v145
Mvvv 80,56,16
Tv 212,250,9216
v_mul_f32 v146, v234, v146
Mvvv 80,60,32
Tv 214,250,9728
v_mul_f32 v147, v235, v147
Mvva 84,52,244
Tv 48,250,10240
PK 144,144,145
Mvvv 84,56,20
Tv 50,250,10752
PK 145,146,147
Mvvv 84,60,36
v_exp_f32 v246, v246
Mvva 88,52,248
v_exp_f32 v247, v247
Mvvv 88,56,24
v_mul_f32 v232, s89, v160
v_mul_f32 v233, s89, v161
Mvvv 88,60,40
v_mul_f32 v234, s89, v162
v_mul_f32 v235, s89, v163
Mvva 92,52,252
v_exp_f32 v232, v232
Mvvv 92,56,28
v_exp_f32 v233, v233
Mvvv 92,60,44
s_waitcnt lgkmcnt(6)
Tv 52,251,8192
v_fma_f32 v238, v238, v253, v253
Mvva 96,64,240
Tv 54,251,8704
v_fma_f32 v239, v239, v253, v253
Mvvv 96,68,16
Tv 56,251,9216
v_mul_f32 v240, s89, v152
Mvvv 96,72,32
Tv 58,251,9728
v_mul_f32 v241, s89, v153
Mvva 100,64,244
buffer_load_dwordx4 v4, s[4:7], s36 offen offset:1024 lds
Mvvv 100,68,20
s_add_u32 s33, s33, 1
s_sub_u32 s36, s33, 9
s_min_u32 s33, s33, s36
Mvvv 100,72,36
s_add_u32 m0, s38, 0x1800
s_mul_i32 s36, s33, 0x90000
s_add_u32 s36, s36, 0x80
Mvva 104,64,248
Tv 60,251,10240
v_mul_f32 v242, s89, v154
Mvvv 104,68,24
buffer_load_dwordx4 v3, s[4:7], s36 offen lds
Mvvv 104,72,40
Tv 62,251,10752
v_mul_f32 v243, s89, v155
Mvva 108,64,252
v_exp_f32 v234, v234
Mvvv 108,68,28
v_exp_f32 v235, v235
Mvvv 108,72,44
s_waitcnt lgkmcnt(6)
buffer_load_dwordx4 v4, s[4:7], s36 offen offset:1024 lds
Zvva 112,76,0
s_add_u32 s33, s33, 1
v_fma_f32 v232, v232, v252, v252
v_fma_f32 v233, v233, v252, v252
Mvva 112,212,16
s_sub_u32 s36, s33, 9
v_fma_f32 v234, v234, v252, v252
v_fma_f32 v235, v235, v252, v252
Mvva 112,48,32
s_min_u32 s33, s33, s36
v_rcp_f32 v232, v232
Zvva 116,76,4
s_add_u32 m0, s38, 0x4000
v_rcp_f32 v233, v233
Mvva 116,212,20
s_mul_i32 s36, s33, 0x90000
v_rcp_f32 v234, v234
Mvva 116,48,36
s_add_u32 s36, s36, 0x80
v_rcp_f32 v235, v235
Zvva 120,76,8
v_mul_f32 v160, v232, v160
v_mul_f32 v161, v233, v161
Mvva 120,212,24
buffer_load_dwordx4 v3, s[4:7], s36 offen lds
Mvva 120,48,40
v_mul_f32 v162, v234, v162
v_mul_f32 v163, v235, v163
Zvva 124,76,12
PK 146,160,161
PK 147,162,163
Mvva 124,212,28
buffer_store_dwordx4 v[144:147], v1, s[16:19], s84 offen sc0 sc1
s_add_u32 s84, s84, 0x20000
Tv 64,250,11264
PK 88,88,89
Mvva 124,48,44
s_waitcnt lgkmcnt(1)
Tv 66,250,11776
PK 89,90,91
Zvva 128,52,0
buffer_load_dwordx4 v4, s[4:7], s36 offen offset:1024 lds
s_add_u32 s33, s33, 1
s_sub_u32 s36, s33, 9
s_min_u32 s33, s33, s36
Mvva 128,56,16
Tv 68,250,12288
PK 90,104,105
Mvva 128,60,32
Tv 70,250,12800
PK 91,106,107
Zvva 132,52,4
M_w6:
s_cbranch_execz M_w7
Tv 72,250,13312
PK 92,92,93
Mvva 132,56,20
Tv 74,250,13824
PK 93,94,95
Mvva 132,60,36
Tv 76,251,11264
PK 94,108,109
Zvva 136,52,8
Tv 78,251,11776
v_fma_f32 v244, v244, v255, v255
Mvva 136,56,24
Tv 212,251,12288
PK 95,110,111
Mvva 136,60,40
Tv 214,251,12800
v_fma_f32 v245, v245, v255, v255
Zvva 140,52,12
Tv 48,251,13312
v_fma_f32 v246, v246, v255, v255
Mvva 140,56,28
Tv 50,251,13824
v_fma_f32 v247, v247, v255, v255
Mvva 140,60,44
s_waitcnt lgkmcnt(6)
Tv 52,250,14336
PK 80,80,81
Mvva 112,64,48
s_add_u32 m0, s38, 0x4800
s_mul_i32 s36, s33, 0x90000
s_add_u32 s36, s36, 0x80
Mvva 112,68,64
Tv 54,250,14848
PK 81,82,83
Mvva 112,72,80
Tv 56,250,15360
PK 82,96,97
Mvva 116,64,52
buffer_load_dwordx4 v3, s[4:7], s36 offen lds
Mvva 116,68,68
Tv 58,250,15872
PK 83,98,99
Mvva 116,72,84
Tv 60,250,22528
v_mul_f32 v232, s89, v176
Mvva 120,64,56
Tv 62,250,23040
v_mul_f32 v233, s89, v177
Mvva 120,68,72
v_rcp_f32 v236, v236
Mvva 120,72,88
v_rcp_f32 v237, v237
Mvva 124,64,60
buffer_load_dwordx4 v4, s[4:7], s36 offen offset:1024 lds
Mvva 124,68,76
s_add_u32 s33, s33, 1
s_sub_u32 s36, s33, 9
s_min_u32 s33, s33, s36
Mvva 124,72,92
s_waitcnt lgkmcnt(6)
s_add_u32 m0, s38, 0x5000
s_mul_i32 s36, s33, 0x90000
Mvva 128,76,48
s_add_u32 s36, s36, 0x80
v_rcp_f32 v238, v238
Mvva 128,212,64
v_rcp_f32 v239, v239
Mvva 128,48,80
v_mul_f32 v148, v236, v148
v_mul_f32 v149, v237, v149
Mvva 132,76,52
buffer_load_dwordx4 v3, s[4:7], s36 offen lds
Mvva 132,212,68
v_mul_f32 v150, v238, v150
v_mul_f32 v151, v239, v151
Mvva 132,48,84
PK 148,148,149
PK 149,150,151
Mvva 136,76,56
buffer_load_dwordx4 v4, s[4:7], s36 offen offset:1024 lds
Mvva 136,212,72
s_add_u32 s33, s33, 1
s_sub_u32 s36, s33, 9
s_min_u32 s33, s33, s36
Mvva 136,48,88
s_add_u32 m0, s38, 0x7000
v_mul_f32 v236, s89, v164
v_mul_f32 v237, s89, v165
Mvva 140,76,60
s_mul_i32 s36, s33, 0x90000
v_mul_f32 v238, s89, v166
v_mul_f32 v239, s89, v167
Mvva 140,212,76
s_add_u32 s36, s36, 0x80
v_exp_f32 v236, v236
Mvva 140,48,92
s_waitcnt lgkmcnt(0)
v_exp_f32 v237, v237
Mvva 112,52,96
buffer_load_dwordx4 v3, s[4:7], s36 offen lds
Mvva 112,56,112
v_exp_f32 v238, v238
Mvva 112,60,128
v_exp_f32 v239, v239
Mvva 116,52,100
v_fma_f32 v236, v236, v253, v253
v_fma_f32 v237, v237, v253, v253
Mvva 116,56,116
buffer_load_dwordx4 v4, s[4:7], s36 offen offset:1024 lds
s_add_u32 s33, s33, 1
s_sub_u32 s36, s33, 9
s_min_u32 s33, s33, s36
Mvva 116,60,132
s_add_u32 m0, s38, 0x7800
Tv 64,251,14336
v_fma_f32 v238, v238, v253, v253
Mvva 120,52,104
s_mul_i32 s36, s33, 0x90000
Tv 66,251,14848
Tv 68,251,15360
Tv 70,251,15872
Tv 72,251,22528
Tv 74,251,23040
Mvva 120,56,120
s_add_u32 s36, s36, 0x80
Tv 76,250,23552
v_fma_f32 v239, v239, v253, v253
Mvva 120,60,136
buffer_load_dwordx4 v3, s[4:7], s36 offen lds
Mvva 124,52,108
v_rcp_f32 v236, v236
v_rcp_f32 v237, v237
v_rcp_f32 v238, v238
v_rcp_f32 v239, v239
v_mul_f32 v164, v236, v164
v_mul_f32 v165, v237, v165
v_mul_f32 v166, v238, v166
v_mul_f32 v167, v239, v167
PK 150,164,165
PK 151,166,167
buffer_store_dwordx4 v[148:151], v1, s[16:19], s85 offen sc0 sc1
s_add_u32 s85, s85, 0x20000
Tv 78,250,24064
v_mul_f32 v234, s89, v178
Mvva 124,56,124
Tv 212,250,32768
v_mul_f32 v235, s89, v179
Mvva 124,60,140
s_waitcnt lgkmcnt(3)
Tv 214,250,33280
v_mul_f32 v236, s89, v180
Mvva 128,64,96
buffer_load_dwordx4 v4, s[4:7], s36 offen offset:1024 lds
s_add_u32 s33, s33, 1
s_sub_u32 s36, s33, 9
s_min_u32 s33, s33, s36
Mvva 128,68,112
Tv 48,250,33792
v_mul_f32 v237, s89, v181
Mvva 128,72,128
Tv 50,250,34304
v_mul_f32 v238, s89, v182
Mvva 132,64,100
Tv 52,251,23552
v_mul_f32 v239, s89, v183
Mvva 132,68,116
v_exp_f32 v240, v240
Mvva 132,72,132
v_exp_f32 v241, v241
Mvva 136,64,104
v_exp_f32 v242, v242
Mvva 136,68,120
v_exp_f32 v243, v243
Mvva 136,72,136
Tv 54,251,24064
v_fma_f32 v240, v240, v254, v254
Mvva 140,64,108
Tv 56,251,32768
v_fma_f32 v241, v241, v254, v254
Mvva 140,68,124
Tv 58,251,33280
v_fma_f32 v242, v242, v254, v254
Mvva 140,72,140
s_waitcnt lgkmcnt(4)
Tv 60,251,33792
v_fma_f32 v243, v243, v254, v254
Mvva 112,76,144
s_add_u32 m0, s38, 0
s_mul_i32 s36, s33, 0x90000
s_add_u32 s36, s36, 0x80
Mvva 112,212,160
v_rcp_f32 v240, v240
Mvva 112,48,176
v_rcp_f32 v241, v241
Mvva 116,76,148
buffer_load_dwordx4 v3, s[4:7], s36 offen lds
Mvva 116,212,164
v_rcp_f32 v242, v242
Mvva 116,48,180
Tv 62,251,34304
Mvva 120,76,152
v_rcp_f32 v243, v243
Mvva 120,212,168
buffer_load_dwordx4 v4, s[4:7], s36 offen offset:1024 lds
Mvva 120,48,184
s_add_u32 s33, s33, 1
s_sub_u32 s36, s33, 9
s_min_u32 s33, s33, s36
Mvva 124,76,156
s_add_u32 s55, s31, 0x1040000
Tv 64,250,34816
v_mul_f32 v152, v240, v152
Mvva 124,212,172
Tv 66,250,35328
v_mul_f32 v153, v241, v153
Mvva 124,48,188
s_waitcnt lgkmcnt(2)
Tv 68,250,35840
v_mul_f32 v154, v242, v154
Mvva 128,52,144
buffer_store_dwordx4 v[216:219], v1, s[16:19], s55 offen sc0 sc1
Tv 70,250,36352
v_mul_f32 v155, v243, v155
PK 152,152,153
Mvva 128,56,160
Tv 72,250,36864
PK 153,154,155
Mvva 128,60,176
Tv 74,250,37376
v_mul_f32 v240, s89, v168
Mvva 132,52,148
Tv 76,251,34816
v_mul_f32 v241, s89, v169
Mvva 132,56,164
Tv 78,251,35328
v_mul_f32 v242, s89, v170
Mvva 132,60,180
Tv 212,251,35840
v_mul_f32 v243, s89, v171
Mvva 136,52,152
v_exp_f32 v240, v240
Mvva 136,56,168
v_exp_f32 v241, v241
Mvva 136,60,184
v_exp_f32 v242, v242
Mvva 140,52,156
v_exp_f32 v243, v243
Mvva 140,56,172
v_fma_f32 v240, v240, v254, v254
v_fma_f32 v241, v241, v254, v254
Mvva 140,60,188
s_waitcnt lgkmcnt(3)
v_fma_f32 v242, v242, v254, v254
v_fma_f32 v243, v243, v254, v254
Mvva 112,64,192
s_add_u32 s55, s45, 0
v_rcp_f32 v240, v240
Mvva 112,68,208
v_rcp_f32 v241, v241
Mvva 112,72,224
v_rcp_f32 v242, v242
Mvva 116,64,196
Tv 214,251,36352
Mvva 116,68,212
v_rcp_f32 v243, v243
Mvva 116,72,228
Tv 48,251,36864
v_mul_f32 v168, v240, v168
Mvva 120,64,200
Tv 50,251,37376
v_mul_f32 v169, v241, v169
Mvva 120,68,216
buffer_store_dwordx4 v[88:91], v1, s[16:19], s55 offen
v_mul_f32 v170, v242, v170
v_mul_f32 v171, v243, v171
PK 154,168,169
Mvva 120,72,232
PK 155,170,171
buffer_store_dwordx4 v[152:155], v1, s[16:19], s86 offen sc0 sc1
s_add_u32 s86, s86, 0x20000
Tv 52,250,37888
v_mul_f32 v240, s89, v184
Mvva 124,64,204
Tv 54,250,38400
v_mul_f32 v241, s89, v185
Mvva 124,68,220
Tv 56,250,38912
v_mul_f32 v242, s89, v186
Mvva 124,72,236
s_waitcnt lgkmcnt(3)
Tv 58,250,39424
v_mul_f32 v243, s89, v187
Mvva 128,76,192
v_rcp_f32 v244, v244
Mvva 128,212,208
v_rcp_f32 v245, v245
Mvva 128,48,224
v_rcp_f32 v246, v246
Mvva 132,76,196
v_rcp_f32 v247, v247
Mvva 132,212,212
Tv 60,250,39936
v_mul_f32 v156, v244, v156
Mvva 132,48,228
Tv 62,250,40448
v_mul_f32 v157, v245, v157
Mvva 136,76,200
Tv 64,251,37888
v_mul_f32 v158, v246, v158
Mvva 136,212,216
Tv 66,251,38400
v_mul_f32 v159, v247, v159
Mvva 136,48,232
Tv 68,251,38912
PK 156,156,157
Mvva 140,76,204
Tv 70,251,39424
PK 157,158,159
Mvva 140,212,220
Tv 72,251,39936
v_mul_f32 v244, s89, v172
Mvva 140,48,236
s_waitcnt lgkmcnt(5)
Tv 74,251,40448
v_mul_f32 v245, s89, v173
Mvva 112,52,240
v_exp_f32 v232, v232
Mvvv 112,56,16
v_exp_f32 v233, v233
Mvvv 112,60,32
v_exp_f32 v234, v234
Mvva 116,52,244
v_exp_f32 v235, v235
Mvvv 116,56,20
v_exp_f32 v236, v236
Mvvv 116,60,36
v_exp_f32 v237, v237
Mvva 120,52,248
v_exp_f32 v238, v238
Mvvv 120,56,24
v_exp_f32 v239, v239
Mvvv 120,60,40
v_lshlrev_b32 v8, 18, v15
v_mul_f32 v246, s89, v174
Mvva 124,52,252
buffer_load_dword v8, v8, s[8:11], s49 offen offset:128
Mvvv 124,56,28
s_add_u32 s55, s46, 0
v_exp_f32 v240, v240
Mvvv 124,60,44
s_waitcnt lgkmcnt(0)
v_exp_f32 v241, v241
Mvva 128,64,240
s_waitcnt vmcnt(4)
s_barrier
buffer_store_dwordx4 v[92:95], v1, s[16:19], s55 offen
s_add_u32 s55, s31, 0x1040000
v_mul_f32 v247, s89, v175
v_fma_f32 v232, v232, v252, v252
Mvvv 128,68,16
Tv 76,248,2048
v_fma_f32 v233, v233, v252, v252
Mvvv 128,72,32
Tv 78,248,2560
v_and_b32 v7, 31, v15
Mvva 132,64,244
buffer_store_dwordx4 v[220:223], v1, s[16:19], s55 offen offset:1024 sc0 sc1
Tv 212,248,3072
Tv 214,248,3584
Mvvv 132,68,20
Tv 48,248,4096
v_fma_f32 v234, v234, v252, v252
Mvvv 132,72,36
Tv 50,248,4608
v_lshlrev_b32 v7, 3, v7
Mvva 136,64,248
s_add_u32 s55, s32, 0x1040000
v_exp_f32 v244, v244
Mvvv 136,68,24
v_exp_f32 v245, v245
Mvvv 136,72,40
v_exp_f32 v246, v246
Mvva 140,64,252
v_exp_f32 v247, v247
Mvvv 140,68,28
ds_write_b128 v10, v[80:83] offset:24576
Mvvv 140,72,44
s_waitcnt lgkmcnt(1)
v_fma_f32 v244, v244, v255, v255
v_fma_f32 v245, v245, v255, v255
Zvva 80,76,0
PK 84,84,85
v_fma_f32 v246, v246, v255, v255
Mvva 80,212,16
buffer_store_dwordx4 v[224:227], v1, s[16:19], s55 offen sc0 sc1
PK 85,86,87
PK 86,100,101
PK 87,102,103
ds_write_b128 v10, v[84:87] offset:25600
Mvva 80,48,32
Tv 52,249,2048
v_fma_f32 v247, v247, v255, v255
Zvva 84,76,4
v_rcp_f32 v244, v244
Mvva 84,212,20
v_rcp_f32 v245, v245
Mvva 84,48,36
Tv 54,249,2560
v_fma_f32 v235, v235, v252, v252
Zvva 88,76,8
Tv 56,249,3072
Tv 58,249,3584
Tv 60,249,4096
Tv 62,249,4608
Mvva 88,212,24
v_rcp_f32 v246, v246
v_rcp_f32 v247, v247
v_mul_f32 v172, v244, v172
v_mul_f32 v173, v245, v173
v_mul_f32 v174, v246, v174
v_mul_f32 v175, v247, v175
PK 158,172,173
PK 159,174,175
buffer_store_dwordx4 v[156:159], v1, s[16:19], s87 offen sc0 sc1
s_add_u32 s87, s87, 0x20000
Tv 64,248,5120
v_fma_f32 v236, v236, v253, v253
Mvva 88,48,40
Tv 66,248,5632
v_fma_f32 v237, v237, v253, v253
Zvva 92,76,12
Tv 68,248,6144
v_fma_f32 v238, v238, v253, v253
Mvva 92,212,28
buffer_load_dword v6, v7, s[20:23], 0 offen sc1
Mvva 92,48,44
s_waitcnt lgkmcnt(3)
Tv 70,248,6656
v_fma_f32 v239, v239, v253, v253
Zvva 96,52,0
Tv 72,248,7168
v_mul_f32 v244, s89, v188
Mvva 96,56,16
Tv 74,248,7680
v_mul_f32 v245, s89, v189
Mvva 96,60,32
Tv 76,249,5120
v_mul_f32 v246, s89, v190
Zvva 100,52,4
Tv 78,249,5632
v_mul_f32 v247, s89, v191
Mvva 100,56,20
Tv 212,249,6144
PK 120,120,121
Mvva 100,60,36
Tv 214,249,6656
PK 121,122,123
Zvva 104,52,8
Tv 48,249,7168
PK 122,136,137
Mvva 104,56,24
s_add_u32 s55, s32, 0x1040000
Tv 50,249,7680
PK 123,138,139
Mvva 104,60,40
v_rcp_f32 v232, v232
Zvva 108,52,12
v_rcp_f32 v233, v233
Mvva 108,56,28
buffer_store_dwordx4 v[228:231], v1, s[16:19], s55 offen offset:1024 sc0 sc1
v_rcp_f32 v234, v234
PK 124,124,125
Mvva 108,60,44
s_waitcnt lgkmcnt(6)
Tv 52,248,16384
PK 125,126,127
Mvva 80,64,48
Tv 54,248,16896
PK 126,140,141
Mvva 80,68,64
Tv 56,248,17408
PK 127,142,143
Mvva 80,72,80
Tv 58,248,17920
PK 112,112,113
Mvva 84,64,52
Tv 60,248,18432
PK 113,114,115
Mvva 84,68,68
Tv 62,248,18944
PK 114,128,129
Mvva 84,72,84
v_rcp_f32 v235, v235
Mvva 88,64,56
v_rcp_f32 v236, v236
Mvva 88,68,72
v_rcp_f32 v237, v237
Mvva 88,72,88
v_rcp_f32 v238, v238
Mvva 92,64,60
v_rcp_f32 v239, v239
Mvva 92,68,76
v_exp_f32 v242, v242
Mvva 92,72,92
s_waitcnt lgkmcnt(6)
v_mul_f32 v176, v232, v176
v_mul_f32 v177, v233, v177
Mvva 96,76,48
v_mul_f32 v178, v234, v178
v_mul_f32 v179, v235, v179
Mvva 96,212,64
PK 176,176,177
PK 177,178,179
Mvva 96,48,80
v_mul_f32 v232, s89, v192
v_mul_f32 v233, s89, v193
Mvva 100,76,52
v_mul_f32 v234, s89, v194
v_mul_f32 v235, s89, v195
Mvva 100,212,68
v_exp_f32 v232, v232
Mvva 100,48,84
v_exp_f32 v233, v233
Mvva 104,76,56
v_exp_f32 v234, v234
Mvva 104,212,72
v_exp_f32 v235, v235
Mvva 104,48,88
v_fma_f32 v232, v232, v252, v252
v_fma_f32 v233, v233, v252, v252
Mvva 108,76,60
v_fma_f32 v234, v234, v252, v252
v_fma_f32 v235, v235, v252, v252
Mvva 108,212,76
v_rcp_f32 v232, v232
Mvva 108,48,92
s_waitcnt lgkmcnt(0)
v_rcp_f32 v233, v233
Mvva 80,52,96
Tv 64,249,16384
v_mul_f32 v180, v236, v180
Mvva 80,56,112
v_rcp_f32 v234, v234
Mvva 80,60,128
Tv 66,249,16896
v_mul_f32 v181, v237, v181
Mvva 84,52,100
v_rcp_f32 v235, v235
Mvva 84,56,116
Tv 68,249,17408
v_mul_f32 v192, v232, v192
Mvva 84,60,132
Tv 70,249,17920
v_mul_f32 v193, v233, v193
Mvva 88,52,104
Tv 72,249,18432
Tv 74,249,18944
v_mul_f32 v194, v234, v194
v_mul_f32 v195, v235, v195
PK 178,192,193
PK 179,194,195
buffer_store_dwordx4 v[176:179], v1, s[16:19], s84 offen sc0 sc1
s_add_u32 s84, s84, 0x20000
Tv 76,248,19456
Mvva 88,56,120
Tv 78,248,19968
v_mul_f32 v182, v238, v182
Mvva 88,60,136
Tv 212,248,20480
v_mul_f32 v183, v239, v183
Mvva 92,52,108
Tv 214,248,20992
PK 180,180,181
Mvva 92,56,124
Tv 48,248,21504
PK 181,182,183
Mvva 92,60,140
s_waitcnt lgkmcnt(5)
Tv 50,248,22016
v_mul_f32 v236, s89, v196
Mvva 96,64,96
Tv 52,249,19456
v_mul_f32 v237, s89, v197
Mvva 96,68,112
Tv 54,249,19968
v_mul_f32 v238, s89, v198
Mvva 96,72,128
Tv 56,249,20480
v_mul_f32 v239, s89, v199
Mvva 100,64,100
Tv 58,249,20992
PK 115,130,131
Mvva 100,68,116
v_exp_f32 v236, v236
Mvva 100,72,132
v_exp_f32 v237, v237
Mvva 104,64,104
v_exp_f32 v238, v238
Mvva 104,68,120
v_exp_f32 v239, v239
Mvva 104,72,136
Tv 60,249,21504
v_fma_f32 v236, v236, v253, v253
Mvva 108,64,108
M_w7:
s_cbranch_execz M_wd
Tv 62,249,22016
v_fma_f32 v237, v237, v253, v253
Mvva 108,68,124
v_exp_f32 v243, v243
Mvva 108,72,140
s_waitcnt lgkmcnt(6)
Tv 64,248,28672
v_fma_f32 v238, v238, v253, v253
Mvva 80,76,144
Tv 66,248,29184
v_fma_f32 v239, v239, v253, v253
Mvva 80,212,160
Tv 68,248,29696
v_fma_f32 v240, v240, v254, v254
Mvva 80,48,176
Tv 70,248,30208
v_fma_f32 v241, v241, v254, v254
Mvva 84,76,148
Tv 72,248,30720
v_fma_f32 v242, v242, v254, v254
Mvva 84,212,164
Tv 74,248,31232
v_fma_f32 v243, v243, v254, v254
Mvva 84,48,180
v_rcp_f32 v236, v236
Mvva 88,76,152
v_rcp_f32 v237, v237
Mvva 88,212,168
v_rcp_f32 v238, v238
Mvva 88,48,184
v_rcp_f32 v239, v239
Mvva 92,76,156
v_rcp_f32 v240, v240
Mvva 92,212,172
v_rcp_f32 v241, v241
Mvva 92,48,188
s_waitcnt lgkmcnt(6)
Tv 76,249,28672
v_mul_f32 v196, v236, v196
Mvva 96,52,144
Tv 78,249,29184
v_mul_f32 v197, v237, v197
Mvva 96,56,160
Tv 212,249,29696
v_mul_f32 v198, v238, v198
Mvva 96,60,176
Tv 214,249,30208
v_mul_f32 v199, v239, v199
Mvva 100,52,148
Tv 48,249,30720
PK 182,196,197
Mvva 100,56,164
Tv 50,249,31232
PK 183,198,199
Mvva 100,60,180
buffer_store_dwordx4 v[180:183], v1, s[16:19], s85 offen sc0 sc1
s_add_u32 s85, s85, 0x20000
v_rcp_f32 v242, v242
Mvva 104,52,152
v_rcp_f32 v243, v243
Mvva 104,56,168
v_exp_f32 v244, v244
Mvva 104,60,184
v_exp_f32 v245, v245
Mvva 108,52,156
v_exp_f32 v246, v246
Mvva 108,56,172
v_exp_f32 v247, v247
Mvva 108,60,188
s_waitcnt lgkmcnt(6)
Tv 52,248,31744
v_mul_f32 v184, v240, v184
Mvva 80,64,192
Tv 54,248,32256
v_mul_f32 v185, v241, v185
Mvva 80,68,208
Tv 56,248,0
v_mul_f32 v186, v242, v186
Mvva 80,72,224
Tv 58,248,512
v_mul_f32 v187, v243, v187
Mvva 84,64,196
Tv 60,248,1024
PK 184,184,185
Mvva 84,68,212
Tv 62,248,1536
PK 185,186,187
Mvva 84,72,228
v_mul_f32 v240, s89, v200
v_mul_f32 v241, s89, v201
Mvva 88,64,200
v_mul_f32 v242, s89, v202
v_mul_f32 v243, s89, v203
Mvva 88,68,216
v_exp_f32 v240, v240
Mvva 88,72,232
v_exp_f32 v241, v241
Mvva 92,64,204
v_exp_f32 v242, v242
Mvva 92,68,220
v_exp_f32 v243, v243
Mvva 92,72,236
s_waitcnt lgkmcnt(6)
Tv 64,249,31744
v_fma_f32 v240, v240, v254, v254
Mvva 96,76,192
Tv 66,249,32256
v_fma_f32 v241, v241, v254, v254
Mvva 96,212,208
Tv 68,249,0
v_fma_f32 v242, v242, v254, v254
Mvva 96,48,224
Tv 70,249,512
v_fma_f32 v243, v243, v254, v254
Mvva 100,76,196
Tv 72,249,1024
v_fma_f32 v244, v244, v255, v255
Mvva 100,212,212
Tv 74,249,1536
v_fma_f32 v245, v245, v255, v255
Mvva 100,48,228
v_rcp_f32 v240, v240
Mvva 104,76,200
v_rcp_f32 v241, v241
Mvva 104,212,216
v_rcp_f32 v242, v242
Mvva 104,48,232
v_rcp_f32 v243, v243
Mvva 108,76,204
v_mul_f32 v200, v240, v200
v_mul_f32 v201, v241, v201
Mvva 108,212,220
v_mul_f32 v202, v242, v202
v_mul_f32 v203, v243, v203
Mvva 108,48,236
s_waitcnt lgkmcnt(6)
PK 186,200,201
PK 187,202,203
Mvva 80,52,240
buffer_store_dwordx4 v[184:187], v1, s[16:19], s86 offen sc0 sc1
s_add_u32 s86, s86, 0x20000
v_fma_f32 v246, v246, v255, v255
v_fma_f32 v247, v247, v255, v255
Mvvv 80,56,16
v_rcp_f32 v244, v244
Mvvv 80,60,32
v_rcp_f32 v245, v245
Mvva 84,52,244
v_rcp_f32 v246, v246
Mvvv 84,56,20
v_rcp_f32 v247, v247
Mvvv 84,60,36
v_mul_f32 v188, v244, v188
v_mul_f32 v189, v245, v189
Mvva 88,52,248
v_mul_f32 v190, v246, v190
v_mul_f32 v191, v247, v191
Mvvv 88,56,24
PK 188,188,189
PK 189,190,191
Mvvv 88,60,40
v_mul_f32 v244, s89, v204
v_mul_f32 v245, s89, v205
Mvva 92,52,252
v_mul_f32 v246, s89, v206
v_mul_f32 v247, s89, v207
Mvvv 92,56,28
s_waitcnt vmcnt(4)
v_cmp_ne_u32 vcc, 1, v6
s_nop 0
s_cbranch_vccnz M_sZ
M_rZ:
Mvvv 92,60,44
s_waitcnt lgkmcnt(0)
v_exp_f32 v244, v244
Mvva 96,64,240
s_waitcnt vmcnt(3)
s_barrier
Mvvv 96,68,16
Tv 76,250,2048
v_mov_b32 v216, 1
Mvvv 96,72,32
Tv 78,250,2560
v_mov_b32 v217, 0x10000000
Mvva 100,64,244
Tv 212,250,3072
v_writelane_b32 v217, s72, 0
Mvvv 100,68,20
Tv 214,250,3584
v_mul_f32 v232, s89, v80
Mvvv 100,72,36
Tv 48,250,4096
v_mul_f32 v233, s89, v81
Mvva 104,64,248
Tv 50,250,4608
v_mul_f32 v234, s89, v82
Mvvv 104,68,24
buffer_store_dword v216, v217, s[16:19], 0 offen sc0 sc1
Mvvv 104,72,40
Tv 52,251,2048
v_mul_f32 v235, s89, v83
Mvva 108,64,252
Tv 54,251,2560
v_mul_f32 v236, s89, v84
Mvvv 108,68,28
Tv 56,251,3072
v_mul_f32 v237, s89, v85
Mvvv 108,72,44
s_waitcnt lgkmcnt(3)
Tv 58,251,3584
v_mul_f32 v238, s89, v86
Zvva 144,76,0
Tv 60,251,4096
v_mul_f32 v239, s89, v87
Mvva 144,212,16
Tv 62,251,4608
v_and_b32 v221, 7, v15
Mvva 144,48,32
Tv 64,250,5120
v_lshlrev_b32 v221, 7, v221
Zvva 148,76,4
s_lshl_b32 s72, s25, 10
s_add_u32 s72, s72, 0x6120000
s_and_b32 s74, s2, 7
Mvva 148,212,20
s_bfe_u32 s75, s2, 0x10003
s_lshr_b32 s76, s2, 4
s_lshl_b32 s37, s74, 5
Mvva 148,48,36
s_lshr_b32 s73, s2, 3
s_add_u32 s37, s37, s73
s_lshl_b32 s37, s37, 2
Zvva 152,76,8
s_add_u32 s37, s37, s24
s_mul_i32 s56, s37, 0x1200
s_mul_i32 s57, s37, 0x1440
Mvva 152,212,24
s_add_u32 m0, s38, 0x2000
s_mul_i32 s36, s33, 0x80000
s_add_u32 s36, s36, 0x80
Mvva 152,48,40
s_lshl_b32 s37, s76, 13
s_lshl_b32 s73, s24, 11
s_add_u32 s37, s37, s73
Zvva 156,76,12
s_mul_i32 s58, s74, 0x240000
s_add_u32 s58, s58, s37
s_add_u32 s58, s58, 0x4000000
Mvva 156,212,28
buffer_load_dwordx4 v0, s[8:11], s36 offen lds
Mvva 156,48,44
s_waitcnt lgkmcnt(1)
s_mul_i32 s59, s74, 0x200000
s_add_u32 s59, s59, s37
Zvva 160,52,0
s_add_u32 s59, s59, 0x3000000
s_and_b32 s73, s74, 1
s_mul_i32 s60, s73, 0x40000
Mvva 160,56,16
s_add_u32 s58, s58, s60
s_mul_i32 s73, s73, 0x12000
Tv 66,250,5632
Mvva 160,60,32
s_mul_i32 s60, s74, 0xa2000
s_add_u32 s60, s60, s73
Tv 68,250,6144
Zvva 164,52,4
s_mul_i32 s62, s74, 0x90000
s_mul_i32 s37, s24, 0x4800
Tv 70,250,6656
Mvva 164,56,20
buffer_load_dwordx4 v2, s[8:11], s36 offen offset:1024 lds
Mvva 164,60,36
s_add_u32 s33, s33, 1
s_sub_u32 s36, s33, 9
Tv 72,250,7168
Zvva 168,52,8
s_min_u32 s33, s33, s36
s_add_u32 m0, s38, 0x2800
Tv 74,250,7680
Mvva 168,56,24
s_mul_i32 s36, s33, 0x80000
s_add_u32 s36, s36, 0x80
s_lshl_b32 s73, s75, 6
Mvva 168,60,40
buffer_load_dwordx4 v0, s[8:11], s36 offen lds
Zvva 172,52,12
s_add_u32 s37, s37, s73
s_add_u32 s37, s37, 0x200
s_add_u32 s61, s60, s37
Mvva 172,56,28
s_add_u32 s63, s62, s37
s_mul_i32 s37, s75, 0x280
s_add_u32 s60, s60, s37
Mvva 172,60,44
s_waitcnt lgkmcnt(0)
buffer_load_dwordx4 v2, s[8:11], s36 offen offset:1024 lds
Mvva 144,64,48
s_add_u32 s33, s33, 1
s_sub_u32 s36, s33, 9
Tv 76,251,5120
Mvva 144,68,64
s_min_u32 s33, s33, s36
s_add_u32 m0, s38, 0x3000
Tv 78,251,5632
Mvva 144,72,80
s_mul_i32 s36, s33, 0x80000
s_add_u32 s36, s36, 0x80
Tv 212,251,6144
Mvva 148,64,52
s_add_u32 s62, s62, s37
s_mul_i32 s73, s39, 0x9000
Tv 214,251,6656
Mvva 148,68,68
s_add_u32 s62, s62, s73
s_andn2_b32 s66, 6, s2
Tv 48,251,7168
Mvva 148,72,84
s_lshr_b32 s66, s66, 1
s_xor_b32 s73, s66, s24
Tv 50,251,7680
Mvva 152,64,56
buffer_load_dwordx4 v0, s[8:11], s36 offen lds
Mvva 152,68,72
s_lshl_b32 s73, s73, 7
s_add_u32 s60, s60, s73
s_xor_b32 s73, s66, s40
Mvva 152,72,88
s_lshl_b32 s73, s73, 7
s_xor_b32 s66, s73, 0x100
s_add_u32 s66, s66, s62
Mvva 156,64,60
buffer_load_dwordx4 v2, s[8:11], s36 offen offset:1024 lds
Mvva 156,68,76
s_add_u32 s33, s33, 1
s_sub_u32 s36, s33, 9
s_min_u32 s33, s33, s36
Mvva 156,72,92
s_waitcnt lgkmcnt(0)
s_add_u32 m0, s38, 0x3800
s_mul_i32 s36, s33, 0x80000
Mvva 160,76,48
s_add_u32 s36, s36, 0x80
s_add_u32 s62, s62, s73
Tv 52,250,16384
Mvva 160,212,64
s_and_b32 s73, s74, 6
s_add_u32 s73, s73, s40
Tv 54,250,16896
Mvva 160,48,80
s_lshl_b32 s73, s73, 6
s_add_u32 s68, s37, s73
Tv 56,250,17408
Mvva 164,76,52
s_lshl_b32 s73, s76, 1
v_exp_f32 v245, v245
Mvva 164,212,68
buffer_load_dwordx4 v0, s[8:11], s36 offen lds
Mvva 164,48,84
s_add_u32 s73, s73, s39
s_lshl_b32 s73, s73, 1
Tv 58,250,17920
Mvva 168,76,56
s_and_b32 s37, s74, 1
Tv 60,250,18432
Tv 62,250,18944
Mvva 168,212,72
buffer_load_dwordx4 v2, s[8:11], s36 offen offset:1024 lds
s_add_u32 s33, s33, 1
s_sub_u32 s36, s33, 9
s_min_u32 s33, s33, s36
Mvva 168,48,88
s_add_u32 s73, s73, s37
v_exp_f32 v246, v246
Mvva 172,76,60
s_mul_i32 s73, s73, 0x9000
v_exp_f32 v247, v247
Mvva 172,212,76
s_add_u32 s68, s68, s73
v_fma_f32 v244, v244, v255, v255
v_fma_f32 v245, v245, v255, v255
Mvva 172,48,92
s_waitcnt lgkmcnt(0)
v_fma_f32 v246, v246, v255, v255
v_fma_f32 v247, v247, v255, v255
Mvva 144,52,96
s_lshl_b32 s37, s76, 3
v_rcp_f32 v244, v244
Mvva 144,56,112
s_add_u32 s37, s37, s74
v_rcp_f32 v245, v245
Mvva 144,60,128
s_mul_i32 s37, s37, 0x4800
v_rcp_f32 v246, v246
Mvva 148,52,100
v_rcp_f32 v247, v247
v_mul_f32 v204, v244, v204
v_mul_f32 v205, v245, v205
v_mul_f32 v206, v246, v206
v_mul_f32 v207, v247, v207
PK 190,204,205
PK 191,206,207
buffer_store_dwordx4 v[188:191], v1, s[16:19], s87 offen sc0 sc1
Tv 64,251,16384
Tv 66,251,16896
Mvva 148,56,116
s_add_u32 s87, s87, 0x20000
s_lshl_b32 s73, s75, 1
Tv 68,251,17408
Mvva 148,60,132
s_add_u32 s73, s73, s39
s_lshl_b32 s73, s73, 5
Tv 70,251,17920
Mvva 152,52,104
s_add_u32 s69, s37, s73
Tv 72,251,18432
Tv 74,251,18944
Mvva 152,56,120
s_add_u32 m0, s38, 0x5800
s_mul_i32 s36, s33, 0x80000
s_add_u32 s36, s36, 0x80
Mvva 152,60,136
s_add_u32 s69, s69, 0x200
s_mul_i32 s64, s2, 0x12000
s_add_u32 s64, s64, 0x6400000
Mvva 156,52,108
s_lshl_b32 s73, s39, 2
s_add_u32 s73, s73, s40
s_lshl_b32 s73, s73, 10
Mvva 156,56,124
buffer_load_dwordx4 v0, s[8:11], s36 offen lds
Mvva 156,60,140
s_waitcnt lgkmcnt(0)
s_add_u32 s65, s64, s73
s_add_u32 s65, s65, 0x10000
Mvva 160,64,96
s_andn2_b32 s73, 1, s2
s_lshl_b32 s73, s73, 11
Tv 76,250,19456
Mvva 160,68,112
s_add_u32 s65, s65, s73
s_lshl_b32 s73, s24, 11
Tv 78,250,19968
Mvva 160,72,128
s_add_u32 s64, s64, s73
s_sub_u32 s37, 3, s24
Tv 212,250,20480
Mvva 164,64,100
s_lshl_b32 s37, s37, 11
s_and_b32 s73, s74, 6
Tv 214,250,20992
Mvva 164,68,116
buffer_load_dwordx4 v2, s[8:11], s36 offen offset:1024 lds
Mvva 164,72,132
s_add_u32 s33, s33, 1
s_sub_u32 s36, s33, 9
Tv 48,250,21504
Mvva 168,64,104
s_min_u32 s33, s33, s36
s_add_u32 m0, s38, 0x8000
Tv 50,250,22016
Mvva 168,68,120
s_mul_i32 s36, s33, 0x80000
s_add_u32 s36, s36, 0x80
s_add_u32 s73, s73, s39
Mvva 168,72,136
buffer_load_dwordx4 v0, s[8:11], s36 offen lds
Mvva 172,64,108
s_lshl_b32 s73, s73, 10
v_exp_f32 v232, v232
Mvva 172,68,124
s_add_u32 s67, s37, s73
v_exp_f32 v233, v233
Mvva 172,72,140
s_waitcnt lgkmcnt(0)
v_exp_f32 v234, v234
Mvva 144,76,144
s_and_b32 s73, s74, 1
s_lshl_b32 s73, s73, 3
Tv 52,251,19456
Mvva 144,212,160
s_add_u32 s67, s67, s73
v_exp_f32 v235, v235
Mvva 144,48,176
buffer_load_dwordx4 v2, s[8:11], s36 offen offset:1024 lds
Mvva 148,76,148
s_add_u32 s33, s33, 1
s_sub_u32 s36, s33, 9
s_min_u32 s33, s33, s36
Mvva 148,212,164
s_add_u32 m0, s38, 0x8800
Tv 54,251,19968
v_fma_f32 v232, v232, v252, v252
Mvva 148,48,180
s_mul_i32 s36, s33, 0x80000
Tv 56,251,20480
v_fma_f32 v233, v233, v252, v252
Mvva 152,76,152
s_add_u32 s36, s36, 0x80
Tv 58,251,20992
Tv 60,251,21504
Tv 62,251,22016
Mvva 152,212,168
buffer_load_dwordx4 v0, s[8:11], s36 offen lds
Mvva 152,48,184
s_lshl_b32 s73, s40, 28
v_fma_f32 v234, v234, v252, v252
v_fma_f32 v235, v235, v252, v252
Mvva 156,76,156
s_add_u32 s67, s67, s73
v_rcp_f32 v232, v232
Mvva 156,212,172
s_add_u32 s69, s69, s73
v_rcp_f32 v233, v233
Mvva 156,48,188
s_waitcnt lgkmcnt(0)
buffer_load_dwordx4 v2, s[8:11], s36 offen offset:1024 lds
s_add_u32 s33, s33, 1
s_sub_u32 s36, s33, 9
s_min_u32 s33, s33, s36
Mvva 160,52,144
s_add_u32 m0, s38, 0x9000
v_rcp_f32 v234, v234
Mvva 160,56,160
s_mul_i32 s36, s33, 0x80000
v_rcp_f32 v235, v235
Mvva 160,60,176
s_add_u32 s36, s36, 0x80
v_mul_f32 v80, v232, v80
v_mul_f32 v81, v233, v81
Mvva 164,52,148
buffer_load_dwordx4 v0, s[8:11], s36 offen lds
Mvva 164,56,164
s_lshl_b32 s70, s76, 12
v_mul_f32 v82, v234, v82
v_mul_f32 v83, v235, v83
Mvva 164,60,180
s_lshl_b32 s73, s74, 9
PK 80,80,81
PK 81,82,83
Mvva 168,52,152
s_add_u32 s70, s70, s73
Tv 64,250,28672
Tv 66,250,29184
Tv 68,250,29696
Tv 70,250,30208
Tv 72,250,30720
Tv 74,250,31232
Mvva 168,56,168
buffer_load_dwordx4 v2, s[8:11], s36 offen offset:1024 lds
s_add_u32 s33, s33, 1
s_sub_u32 s36, s33, 9
s_min_u32 s33, s33, s36
Mvva 168,60,184
s_add_u32 s70, s70, 0x6100000
v_mul_f32 v232, s89, v96
v_mul_f32 v233, s89, v97
Mvva 172,52,156
s_lshr_b32 s71, s2, 3
v_mul_f32 v234, s89, v98
v_mul_f32 v235, s89, v99
Mvva 172,56,172
s_lshl_b32 s71, s71, 11
v_exp_f32 v232, v232
Mvva 172,60,188
s_waitcnt lgkmcnt(0)
v_exp_f32 v233, v233
Mvva 144,64,192
s_add_u32 s71, s71, 0x6110000
v_exp_f32 v234, v234
Mvva 144,68,208
v_exp_f32 v235, v235
Mvva 144,72,224
v_fma_f32 v232, v232, v252, v252
v_fma_f32 v233, v233, v252, v252
v_fma_f32 v234, v234, v252, v252
v_fma_f32 v235, v235, v252, v252
v_rcp_f32 v232, v232
v_rcp_f32 v233, v233
v_rcp_f32 v234, v234
v_rcp_f32 v235, v235
v_mul_f32 v96, v232, v96
v_mul_f32 v97, v233, v97
v_mul_f32 v98, v234, v98
v_mul_f32 v99, v235, v99
PK 82,96,97
PK 83,98,99
buffer_store_dwordx4 v[80:83], v1, s[16:19], s84 offen sc0 sc1
Tv 76,251,28672
Tv 78,251,29184
Mvva 148,64,196
s_add_u32 s84, s84, 0x20000
Tv 212,251,29696
v_mul_f32 v240, s89, v88
Mvva 148,68,212
Tv 214,251,30208
v_mul_f32 v241, s89, v89
Mvva 148,72,228
Tv 48,251,30720
v_mul_f32 v242, s89, v90
Mvva 152,64,200
s_add_u32 m0, s38, 0x9800
s_mul_i32 s36, s33, 0x80000
Tv 50,251,31232
Mvva 152,68,216
s_add_u32 s36, s36, 0x80
Tv 52,250,31744
v_mul_f32 v243, s89, v91
Mvva 152,72,232
Tv 54,250,32256
v_mul_f32 v244, s89, v92
Mvva 156,64,204
buffer_load_dwordx4 v0, s[8:11], s36 offen lds
Mvva 156,68,220
Tv 56,250,0
v_mul_f32 v245, s89, v93
Mvva 156,72,236
s_waitcnt lgkmcnt(3)
Tv 58,250,512
v_mul_f32 v246, s89, v94
Mvva 160,76,192
buffer_load_dwordx4 v2, s[8:11], s36 offen offset:1024 lds
Mvva 160,212,208
s_add_u32 s33, s33, 1
s_sub_u32 s36, s33, 9
s_min_u32 s33, s33, s36
Mvva 160,48,224
M_w8:
s_cbranch_execz M_w9
Tv 60,250,1024
v_mul_f32 v247, s89, v95
Mvva 164,76,196
v_exp_f32 v236, v236
Mvva 164,212,212
s_add_u32 s55, s45, 0x20000
v_exp_f32 v237, v237
Mvva 164,48,228
Tv 62,250,1536
Mvva 168,76,200
v_exp_f32 v238, v238
Mvva 168,212,216
buffer_store_dwordx4 v[120:123], v1, s[16:19], s55 offen
Tv 64,251,31744
v_exp_f32 v239, v239
Mvva 168,48,232
Tv 66,251,32256
v_fma_f32 v236, v236, v253, v253
Mvva 172,76,204
Tv 68,251,0
v_fma_f32 v237, v237, v253, v253
Mvva 172,212,220
Tv 70,251,512
v_fma_f32 v238, v238, v253, v253
Mvva 172,48,236
s_waitcnt lgkmcnt(4)
Tv 72,251,1024
v_fma_f32 v239, v239, v253, v253
Mvva 144,52,240
v_rcp_f32 v236, v236
Mvvv 144,56,16
v_rcp_f32 v237, v237
Mvvv 144,60,32
s_add_u32 s55, s46, 0x20000
v_rcp_f32 v238, v238
Mvva 148,52,244
v_rcp_f32 v239, v239
Mvvv 148,56,20
Tv 74,251,1536
v_mul_f32 v84, v236, v84
Mvvv 148,60,36
buffer_store_dwordx4 v[124:127], v1, s[16:19], s55 offen
v_mul_f32 v85, v237, v85
v_mul_f32 v86, v238, v86
v_mul_f32 v87, v239, v87
Mvva 152,52,248
v_exp_f32 v240, v240
Mvvv 152,56,24
v_exp_f32 v241, v241
Mvvv 152,60,40
PK 84,84,85
PK 85,86,87
Mvva 156,52,252
v_mul_f32 v236, s89, v100
v_mul_f32 v237, s89, v101
Mvvv 156,56,28
v_mul_f32 v238, s89, v102
v_mul_f32 v239, s89, v103
Mvvv 156,60,44
s_waitcnt lgkmcnt(0)
v_exp_f32 v236, v236
Mvva 160,64,240
s_waitcnt vmcnt(2)
s_barrier
Mvvv 160,68,16
Tv 76,248,8192
v_mul_f32 v232, s89, v144
Mvvv 160,72,32
v_exp_f32 v237, v237
Mvva 164,64,244
Tv 78,248,8704
v_mul_f32 v233, s89, v145
Mvvv 164,68,20
v_exp_f32 v238, v238
Mvvv 164,72,36
Tv 212,248,9216
v_mul_f32 v234, s89, v146
Mvva 168,64,248
Tv 214,248,9728
Tv 48,248,10240
Tv 50,248,10752
Mvvv 168,68,24
v_exp_f32 v239, v239
Mvvv 168,72,40
v_fma_f32 v236, v236, v253, v253
v_fma_f32 v237, v237, v253, v253
Mvva 172,64,252
v_fma_f32 v238, v238, v253, v253
v_fma_f32 v239, v239, v253, v253
Mvvv 172,68,28
ds_write_b128 v10, v[112:115] offset:26624
Mvvv 172,72,44
s_waitcnt lgkmcnt(1)
buffer_load_dword v220, v221, s[16:19], s72 offen sc1
Zvva 112,76,0
v_rcp_f32 v236, v236
Mvva 112,212,16
v_rcp_f32 v237, v237
v_rcp_f32 v238, v238
v_rcp_f32 v239, v239
v_mul_f32 v100, v236, v100
v_mul_f32 v101, v237, v101
PK 116,116,117
v_mul_f32 v102, v238, v102
PK 117,118,119
v_mul_f32 v103, v239, v103
PK 118,132,133
PK 86,100,101
PK 119,134,135
PK 87,102,103
ds_write_b128 v10, v[116:119] offset:27648
buffer_store_dwordx4 v[84:87], v1, s[16:19], s85 offen sc0 sc1
Tv 52,249,8192
s_add_u32 s85, s85, 0x20000
Mvva 112,48,32
Tv 54,249,8704
v_mul_f32 v235, s89, v147
Zvva 116,76,4
Tv 56,249,9216
v_mul_f32 v236, s89, v148
Mvva 116,212,20
Tv 58,249,9728
v_mul_f32 v237, s89, v149
Mvva 116,48,36
Tv 60,249,10240
v_mul_f32 v238, s89, v150
Zvva 120,76,8
Tv 62,249,10752
v_mul_f32 v239, s89, v151
Mvva 120,212,24
v_exp_f32 v242, v242
Mvva 120,48,40
v_exp_f32 v243, v243
Zvva 124,76,12
Tv 64,248,11264
v_fma_f32 v240, v240, v254, v254
Mvva 124,212,28
Tv 66,248,11776
v_fma_f32 v241, v241, v254, v254
Mvva 124,48,44
s_waitcnt lgkmcnt(2)
Tv 68,248,12288
v_fma_f32 v242, v242, v254, v254
Zvva 128,52,0
Tv 70,248,12800
v_fma_f32 v243, v243, v254, v254
Mvva 128,56,16
v_rcp_f32 v240, v240
Mvva 128,60,32
v_rcp_f32 v241, v241
Zvva 132,52,4
v_rcp_f32 v242, v242
Mvva 132,56,20
Tv 72,248,13312
Mvva 132,60,36
Tv 74,248,13824
Zvva 136,52,8
v_rcp_f32 v243, v243
Mvva 136,56,24
Tv 76,249,11264
v_mul_f32 v88, v240, v88
Mvva 136,60,40
Tv 78,249,11776
v_mul_f32 v89, v241, v89
Zvva 140,52,12
Tv 212,249,12288
v_mul_f32 v90, v242, v90
Mvva 140,56,28
Tv 214,249,12800
v_mul_f32 v91, v243, v91
Mvva 140,60,44
s_waitcnt lgkmcnt(4)
Tv 48,249,13312
PK 88,88,89
Mvva 112,64,48
Tv 50,249,13824
PK 89,90,91
Mvva 112,68,64
Tv 52,248,14336
v_mul_f32 v240, s89, v104
Mvva 112,72,80
Tv 54,248,14848
v_mul_f32 v241, s89, v105
Mvva 116,64,52
Tv 56,248,15360
v_mul_f32 v242, s89, v106
Mvva 116,68,68
Tv 58,248,15872
v_mul_f32 v243, s89, v107
Mvva 116,72,84
v_exp_f32 v240, v240
Mvva 120,64,56
v_exp_f32 v241, v241
Mvva 120,68,72
v_exp_f32 v242, v242
Mvva 120,72,88
v_exp_f32 v243, v243
Mvva 124,64,60
Tv 60,248,22528
v_fma_f32 v240, v240, v254, v254
Mvva 124,68,76
Tv 62,248,23040
v_fma_f32 v241, v241, v254, v254
Mvva 124,72,92
s_waitcnt lgkmcnt(6)
Tv 64,249,14336
v_fma_f32 v242, v242, v254, v254
Mvva 128,76,48
Tv 66,249,14848
v_fma_f32 v243, v243, v254, v254
Mvva 128,212,64
v_rcp_f32 v240, v240
Mvva 128,48,80
v_rcp_f32 v241, v241
Mvva 132,76,52
s_waitcnt vmcnt(1)
v_cmp_ne_u32 vcc, 1, v220
s_nop 0
s_cbranch_vccnz M_sK
M_rK:
Mvva 132,212,68
s_lshl_b32 s36, s25, 2
s_add_u32 s36, s36, s24
s_mul_i32 s36, s36, 0x20000
Mvva 132,48,84
s_add_u32 s28, s36, 0x1000000
s_add_u32 s29, s36, 0x2000000
Tv 68,249,15360
Mvva 136,76,56
v_rcp_f32 v242, v242
Mvva 136,212,72
v_rcp_f32 v243, v243
Mvva 136,48,88
v_mul_f32 v104, v240, v104
v_mul_f32 v105, v241, v105
Mvva 140,76,60
v_mul_f32 v106, v242, v106
v_mul_f32 v107, v243, v107
Mvva 140,212,76
PK 90,104,105
PK 91,106,107
Mvva 140,48,92
s_waitcnt lgkmcnt(3)
buffer_store_dwordx4 v[88:91], v1, s[16:19], s86 offen sc0 sc1
s_add_u32 s86, s86, 0x20000
Tv 70,249,15872
v_add_u32 v2, 0x1000, v1
Mvva 112,52,96
s_lshl_b32 s54, s26, 13
s_sub_u32 s52, 0x1e000, s54
s_add_u32 s53, s29, s52
Mvva 112,56,112
s_add_u32 s52, s28, s52
s_add_u32 s30, s28, s54
s_add_u32 s54, s29, s54
Mvva 112,60,128
s_mov_b32 s34, s52
s_mov_b32 s35, s53
s_mov_b32 s32, s30
Mvva 116,52,100
s_mov_b32 s33, s54
s_sub_u32 s27, 8, s26
s_mov_b32 s31, s28
Mvva 116,56,116
s_mov_b32 s51, 0
s_mov_b32 s49, 0
Tv 72,249,22528
Mvva 116,60,132
s_mov_b64 s[4:5], s[96:97]
s_mov_b32 s6, 0x510000
Tv 74,249,23040
Mvva 120,52,104
s_mov_b64 s[8:9], s[98:99]
s_mov_b32 s10, 0x480000
s_mov_b64 s[12:13], s[100:101]
Mvva 120,56,120
s_mov_b32 s14, 0x240000
s_add_u32 m0, s38, 0
Tv 76,248,23552
Mvva 120,60,136
buffer_load_dwordx4 v1, s[16:19], s32 offen sc1 lds
Mvva 124,52,108
Tv 78,248,24064
v_mov_b32 v216, 0
Mvva 124,56,124
Tv 212,248,32768
v_mov_b32 v217, 0
Mvva 124,60,140
s_waitcnt lgkmcnt(3)
buffer_load_dwordx4 v1, s[16:19], s32 offen offset:1024 sc1 lds
Mvva 128,64,96
Tv 214,248,33280
v_mov_b32 v218, 0
Mvva 128,68,112
Tv 48,248,33792
v_mov_b32 v219, 0
Mvva 128,72,128
buffer_load_dwordx4 v1, s[16:19], s32 offen offset:2048 sc1 lds
Mvva 132,64,100
Tv 50,248,34304
v_mov_b32 v220, 0
Mvva 132,68,116
Tv 52,249,23552
v_mov_b32 v221, 0
Mvva 132,72,132
buffer_load_dwordx4 v1, s[16:19], s32 offen offset:3072 sc1 lds
Mvva 136,64,104
s_add_u32 m0, s38, 0x1000
v_exp_f32 v244, v244
Mvva 136,68,120
v_exp_f32 v245, v245
Mvva 136,72,136
v_exp_f32 v246, v246
Mvva 140,64,108
buffer_load_dwordx4 v2, s[16:19], s32 offen sc1 lds
Mvva 140,68,124
v_exp_f32 v247, v247
Mvva 140,72,140
s_waitcnt lgkmcnt(1)
v_fma_f32 v244, v244, v255, v255
v_fma_f32 v245, v245, v255, v255
Mvva 112,76,144
v_fma_f32 v246, v246, v255, v255
v_fma_f32 v247, v247, v255, v255
Mvva 112,212,160
buffer_load_dwordx4 v2, s[16:19], s32 offen offset:1024 sc1 lds
Mvva 112,48,176
v_rcp_f32 v244, v244
Mvva 116,76,148
Tv 54,249,24064
v_mov_b32 v222, 0
Mvva 116,212,164
buffer_load_dwordx4 v2, s[16:19], s32 offen offset:2048 sc1 lds
Mvva 116,48,180
v_rcp_f32 v245, v245
Mvva 120,76,152
Tv 56,249,32768
Tv 58,249,33280
Tv 60,249,33792
Tv 62,249,34304
Mvva 120,212,168
buffer_load_dwordx4 v2, s[16:19], s32 offen offset:3072 sc1 lds
s_add_u32 s32, s32, 0x2000
s_cmp_eq_u32 s32, s34
s_cselect_b32 s32, s28, s32
Mvva 120,48,184
v_rcp_f32 v246, v246
Mvva 124,76,156
v_rcp_f32 v247, v247
Mvva 124,212,172
v_mul_f32 v92, v244, v92
v_mul_f32 v93, v245, v93
Mvva 124,48,188
s_waitcnt lgkmcnt(0)
v_mul_f32 v94, v246, v94
v_mul_f32 v95, v247, v95
Mvva 128,52,144
PK 92,92,93
PK 93,94,95
Mvva 128,56,160
v_mul_f32 v244, s89, v108
v_mul_f32 v245, s89, v109
Mvva 128,60,176
v_mul_f32 v246, s89, v110
v_mul_f32 v247, s89, v111
Mvva 132,52,148
v_exp_f32 v244, v244
Mvva 132,56,164
v_exp_f32 v245, v245
Mvva 132,60,180
v_exp_f32 v246, v246
Mvva 136,52,152
Tv 64,248,34816
Tv 66,248,35328
Tv 68,248,35840
Tv 70,248,36352
Tv 72,248,36864
Tv 74,248,37376
Mvva 136,56,168
v_exp_f32 v247, v247
Mvva 136,60,184
v_fma_f32 v244, v244, v255, v255
v_fma_f32 v245, v245, v255, v255
Mvva 140,52,156
v_fma_f32 v246, v246, v255, v255
v_fma_f32 v247, v247, v255, v255
Mvva 140,56,172
v_rcp_f32 v244, v244
Mvva 140,60,188
s_waitcnt lgkmcnt(0)
v_rcp_f32 v245, v245
v_rcp_f32 v246, v246
v_rcp_f32 v247, v247
v_mul_f32 v108, v244, v108
v_mul_f32 v109, v245, v109
v_mul_f32 v110, v246, v110
v_mul_f32 v111, v247, v111
PK 94,108,109
PK 95,110,111
buffer_store_dwordx4 v[92:95], v1, s[16:19], s87 offen sc0 sc1
s_add_u32 s87, s87, 0x20000
Tv 76,249,34816
v_mov_b32 v223, 0
Mvva 112,64,192
Tv 78,249,35328
v_mov_b32 v224, 0
Mvva 112,68,208
Tv 212,249,35840
v_mov_b32 v225, 0
Mvva 112,72,224
Tv 214,249,36352
v_mov_b32 v226, 0
Mvva 116,64,196
Tv 48,249,36864
v_mov_b32 v227, 0
Mvva 116,68,212
Tv 50,249,37376
v_mov_b32 v228, 0
Mvva 116,72,228
Tv 52,248,37888
v_mov_b32 v229, 0
Mvva 120,64,200
Tv 54,248,38400
v_mov_b32 v230, 0
Mvva 120,68,216
Tv 56,248,38912
v_mov_b32 v231, 0
Mvva 120,72,232
s_mov_b32 s37, s40
s_lshl_b32 s37, s37, 11
Tv 58,248,39424
Mvva 124,64,204
Tv 60,248,39936
v_add_u32 v3, s37, v1
Mvva 124,68,220
Tv 62,248,40448
v_add_u32 v4, 0x10000, v3
Mvva 124,72,236
s_waitcnt lgkmcnt(6)
Tv 64,249,37888
v_add_u32 v5, 0x20000, v3
Mvva 128,76,192
s_sub_u32 s37, 3, s40
s_lshl_b32 s37, s37, 11
Tv 66,249,38400
Mvva 128,212,208
Tv 68,249,38912
v_add_u32 v6, s37, v1
Mvva 128,48,224
Tv 70,249,39424
v_add_u32 v7, 0x10000, v6
Mvva 132,76,196
Tv 72,249,39936
v_add_u32 v8, 0x20000, v6
Mvva 132,212,212
Tv 74,249,40448
v_mul_f32 v240, s89, v152
Mvva 132,48,228
v_exp_f32 v232, v232
Mvva 136,76,200
v_exp_f32 v233, v233
Mvva 136,212,216
v_exp_f32 v234, v234
Mvva 136,48,232
v_exp_f32 v235, v235
Mvva 140,76,204
v_fma_f32 v232, v232, v252, v252
v_fma_f32 v233, v233, v252, v252
Mvva 140,212,220
v_fma_f32 v234, v234, v252, v252
v_fma_f32 v235, v235, v252, v252
Mvva 140,48,236
s_waitcnt lgkmcnt(6)
v_rcp_f32 v232, v232
Mvva 112,52,240
v_rcp_f32 v233, v233
Mvvv 112,56,16
v_rcp_f32 v234, v234
Mvvv 112,60,32
v_rcp_f32 v235, v235
Mvva 116,52,244
v_mul_f32 v144, v232, v144
v_mul_f32 v145, v233, v145
Mvvv 116,56,20
v_mul_f32 v146, v234, v146
v_mul_f32 v147, v235, v147
Mvvv 116,60,36
PK 144,144,145
PK 145,146,147
Mvva 120,52,248
v_mul_f32 v232, s89, v160
v_mul_f32 v233, s89, v161
Mvvv 120,56,24
v_mul_f32 v234, s89, v162
v_mul_f32 v235, s89, v163
Mvvv 120,60,40
v_exp_f32 v232, v232
Mvva 124,52,252
v_exp_f32 v233, v233
Mvvv 124,56,28
v_exp_f32 v234, v234
Mvvv 124,60,44
s_waitcnt lgkmcnt(0)
v_exp_f32 v235, v235
Mvva 128,64,240
Tv 76,250,8192
v_fma_f32 v232, v232, v252, v252
Mvvv 128,68,16
Tv 78,250,8704
v_fma_f32 v233, v233, v252, v252
Mvvv 128,72,32
v_fma_f32 v234, v234, v252, v252
v_fma_f32 v235, v235, v252, v252
Mvva 132,64,244
Tv 212,250,9216
PK 120,120,121
Mvvv 132,68,20
v_rcp_f32 v232, v232
Mvvv 132,72,36
Tv 214,250,9728
PK 121,122,123
Mvva 136,64,248
Tv 48,250,10240
Tv 50,250,10752
Mvvv 136,68,24
v_rcp_f32 v233, v233
Mvvv 136,72,40
v_rcp_f32 v234, v234
Mvva 140,64,252
v_rcp_f32 v235, v235
Mvvv 140,68,28
v_mul_f32 v160, v232, v160
v_mul_f32 v161, v233, v161
v_mul_f32 v162, v234, v162
v_mul_f32 v163, v235, v163
PK 146,160,161
PK 147,162,163
buffer_store_dwordx4 v[144:147], v1, s[16:19], s84 offen sc0 sc1
s_add_u32 s84, s84, 0x20000
Tv 52,251,8192
v_mul_f32 v241, s89, v153
Mvvv 140,72,44
s_waitcnt lgkmcnt(1)
Tv 54,251,8704
v_mul_f32 v242, s89, v154
Zvva 176,76,0
Tv 56,251,9216
v_mul_f32 v243, s89, v155
Mvva 176,212,16
Tv 58,251,9728
v_mul_f32 v244, s89, v156
Mvva 176,48,32
Tv 60,251,10240
PK 122,136,137
Zvva 180,76,4
Tv 62,251,10752
PK 123,138,139
Mvva 180,212,20
Tv 64,250,11264
PK 124,124,125
Mvva 180,48,36
Tv 66,250,11776
PK 125,126,127
Zvva 184,76,8
Tv 68,250,12288
PK 126,140,141
Mvva 184,212,24
Tv 70,250,12800
PK 127,142,143
Mvva 184,48,40
Tv 72,250,13312
PK 112,112,113
Zvva 188,76,12
Tv 74,250,13824
PK 113,114,115
Mvva 188,212,28
v_exp_f32 v236, v236
Mvva 188,48,44
s_waitcnt lgkmcnt(6)
s_add_u32 s55, s45, 0x40000
Tv 76,251,11264
Zvva 192,52,0
buffer_store_dwordx4 v[120:123], v1, s[16:19], s55 offen
Tv 78,251,11776
v_exp_f32 v237, v237
Mvva 192,56,16
Tv 212,251,12288
PK 114,128,129
Mvva 192,60,32
Tv 214,251,12800
PK 115,130,131
Zvva 196,52,4
Tv 48,251,13312
v_mul_f32 v245, s89, v157
Mvva 196,56,20
s_add_u32 s55, s46, 0x40000
Tv 50,251,13824
v_mul_f32 v246, s89, v158
Mvva 196,60,36
buffer_store_dwordx4 v[124:127], v1, s[16:19], s55 offen
v_exp_f32 v238, v238
v_mul_f32 v247, s89, v159
Zvva 200,52,8
v_exp_f32 v239, v239
Mvva 200,56,24
v_exp_f32 v240, v240
Mvva 200,60,40
v_fma_f32 v236, v236, v253, v253
v_fma_f32 v237, v237, v253, v253
Zvva 204,52,12
M_w9:
s_cbranch_execz M_w16
v_fma_f32 v238, v238, v253, v253
v_fma_f32 v239, v239, v253, v253
Mvva 204,56,28
v_rcp_f32 v236, v236
Mvva 204,60,44
s_waitcnt lgkmcnt(6)
v_rcp_f32 v237, v237
Mvva 176,64,48
v_rcp_f32 v238, v238
Mvva 176,68,64
v_rcp_f32 v239, v239
Mvva 176,72,80
v_mul_f32 v148, v236, v148
v_mul_f32 v149, v237, v149
Mvva 180,64,52
v_mul_f32 v150, v238, v150
v_mul_f32 v151, v239, v151
Mvva 180,68,68
PK 148,148,149
PK 149,150,151
Mvva 180,72,84
v_mul_f32 v236, s89, v164
v_mul_f32 v237, s89, v165
Mvva 184,64,56
v_mul_f32 v238, s89, v166
v_mul_f32 v239, s89, v167
Mvva 184,68,72
v_exp_f32 v236, v236
Mvva 184,72,88
v_exp_f32 v237, v237
Mvva 188,64,60
v_exp_f32 v238, v238
Mvva 188,68,76
v_exp_f32 v239, v239
Mvva 188,72,92
s_waitcnt lgkmcnt(0)
v_fma_f32 v236, v236, v253, v253
v_fma_f32 v237, v237, v253, v253
Mvva 192,76,48
Tv 52,250,14336
v_fma_f32 v238, v238, v253, v253
Mvva 192,212,64
Tv 54,250,14848
v_fma_f32 v239, v239, v253, v253
Mvva 192,48,80
v_rcp_f32 v236, v236
Mvva 196,76,52
Tv 56,250,15360
Mvva 196,212,68
v_rcp_f32 v237, v237
Mvva 196,48,84
Tv 58,250,15872
Mvva 200,76,56
Tv 60,250,22528
Tv 62,250,23040
Mvva 200,212,72
v_rcp_f32 v238, v238
Mvva 200,48,88
v_rcp_f32 v239, v239
Mvva 204,76,60
v_mul_f32 v164, v236, v164
v_mul_f32 v165, v237, v165
v_mul_f32 v166, v238, v166
v_mul_f32 v167, v239, v167
PK 150,164,165
PK 151,166,167
buffer_store_dwordx4 v[148:151], v1, s[16:19], s85 offen sc0 sc1
s_add_u32 s85, s85, 0x20000
Tv 64,251,14336
Mvva 204,212,76
v_exp_f32 v241, v241
Mvva 204,48,92
s_waitcnt lgkmcnt(1)
v_exp_f32 v242, v242
Mvva 176,52,96
v_exp_f32 v243, v243
Mvva 176,56,112
Tv 66,251,14848
v_fma_f32 v240, v240, v254, v254
Mvva 176,60,128
Tv 68,251,15360
v_fma_f32 v241, v241, v254, v254
Mvva 180,52,100
Tv 70,251,15872
v_fma_f32 v242, v242, v254, v254
Mvva 180,56,116
ds_write_b128 v10, v[112:115] offset:28672
PK 116,116,117
PK 117,118,119
PK 118,132,133
PK 119,134,135
ds_write_b128 v10, v[116:119] offset:29696
Mvva 180,60,132
Tv 72,251,22528
v_fma_f32 v243, v243, v254, v254
Mvva 184,52,104
Tv 74,251,23040
Mvva 184,56,120
v_rcp_f32 v240, v240
Mvva 184,60,136
v_rcp_f32 v241, v241
Mvva 188,52,108
v_rcp_f32 v242, v242
Mvva 188,56,124
v_rcp_f32 v243, v243
Mvva 188,60,140
s_waitcnt lgkmcnt(0)
v_exp_f32 v244, v244
Mvva 192,64,96
s_waitcnt vmcnt(5) lgkmcnt(2)
s_barrier
Mvva 192,68,112
s_add_u32 m0, s38, 0x2000
Tv 76,250,23552
v_mul_f32 v152, v240, v152
Mvva 192,72,128
Tv 78,250,24064
v_mul_f32 v153, v241, v153
Mvva 196,64,100
Tv 212,250,32768
v_mul_f32 v154, v242, v154
Mvva 196,68,116
Tv 214,250,33280
v_mul_f32 v155, v243, v155
Mvva 196,72,132
buffer_load_dwordx4 v1, s[16:19], s32 offen sc1 lds
Mvva 200,64,104
Tv 48,250,33792
Tv 50,250,34304
Mvva 200,68,120
Tv 52,251,23552
PK 152,152,153
Mvva 200,72,136
buffer_load_dwordx4 v1, s[16:19], s32 offen offset:1024 sc1 lds
Mvva 204,64,108
Tv 54,251,24064
PK 153,154,155
Mvva 204,68,124
Tv 56,251,32768
v_mul_f32 v240, s89, v168
Mvva 204,72,140
s_waitcnt lgkmcnt(3)
buffer_load_dwordx4 v1, s[16:19], s32 offen offset:2048 sc1 lds
Mvva 176,76,144
Tv 58,251,33280
v_mul_f32 v241, s89, v169
Mvva 176,212,160
Tv 60,251,33792
v_mul_f32 v242, s89, v170
Mvva 176,48,176
buffer_load_dwordx4 v1, s[16:19], s32 offen offset:3072 sc1 lds
Mvva 180,76,148
s_add_u32 m0, s38, 0x3000
Tv 62,251,34304
v_mul_f32 v243, s89, v171
Mvva 180,212,164
v_exp_f32 v240, v240
Mvva 180,48,180
buffer_load_dwordx4 v2, s[16:19], s32 offen sc1 lds
Mvva 184,76,152
Ta 64,250,34816
Mvva 184,212,168
Ta 66,250,35328
Mvva 184,48,184
buffer_load_dwordx4 v2, s[16:19], s32 offen offset:1024 sc1 lds
Mvva 188,76,156
v_exp_f32 v241, v241
Mvva 188,212,172
Ta 68,250,35840
Mvva 188,48,188
s_waitcnt lgkmcnt(3)
buffer_load_dwordx4 v2, s[16:19], s32 offen offset:2048 sc1 lds
Mvva 192,52,144
v_exp_f32 v242, v242
Mvva 192,56,160
Ta 70,250,36352
Mvva 192,60,176
buffer_load_dwordx4 v2, s[16:19], s32 offen offset:3072 sc1 lds
s_add_u32 s32, s32, 0x2000
s_cmp_eq_u32 s32, s34
s_cselect_b32 s32, s28, s32
Mvva 196,52,148
v_exp_f32 v243, v243
Mvva 196,56,164
Ta 72,250,36864
v_fma_f32 v240, v240, v254, v254
Mvva 196,60,180
Ta 74,250,37376
v_fma_f32 v241, v241, v254, v254
Mvva 200,52,152
Ta 76,250,37888
Ta 78,250,38400
Ta 80,250,38912
Ta 82,250,39424
Ta 84,250,39936
Ta 86,250,40448
Mvva 200,56,168
v_fma_f32 v242, v242, v254, v254
v_fma_f32 v243, v243, v254, v254
Mvva 200,60,184
v_rcp_f32 v240, v240
v_rcp_f32 v241, v241
v_rcp_f32 v242, v242
v_rcp_f32 v243, v243
v_mul_f32 v168, v240, v168
v_mul_f32 v169, v241, v169
v_mul_f32 v170, v242, v170
v_mul_f32 v171, v243, v171
PK 154,168,169
PK 155,170,171
buffer_store_dwordx4 v[152:155], v1, s[16:19], s86 offen sc0 sc1
Ta 88,251,34816
Ta 90,251,35328
Mvva 204,52,156
s_add_u32 s86, s86, 0x20000
Ta 92,251,35840
Mvva 204,56,172
Ta 94,251,36352
Mvva 204,60,188
s_waitcnt lgkmcnt(4)
Ta 96,251,36864
Mvaa 176,64,192
Ta 98,251,37376
Mvaa 176,68,208
Ta 100,251,37888
Mvaa 176,72,224
Ta 102,251,38400
Mvaa 176,76,240
Ta 104,251,38912
Mvav 176,80,16
Ta 106,251,39424
Mvav 176,84,32
Ta 108,251,39936
Mvaa 180,64,196
Ta 110,251,40448
Mvaa 180,68,212
v_exp_f32 v245, v245
Mvaa 180,72,228
v_exp_f32 v246, v246
Mvaa 180,76,244
v_exp_f32 v247, v247
Mvav 180,80,20
La 0,10,24576
v_fma_f32 v244, v244, v255, v255
Mvav 180,84,36
s_waitcnt lgkmcnt(1)
La 16,10,25600
v_fma_f32 v245, v245, v255, v255
Mvaa 192,88,192
La 32,9,24576
v_fma_f32 v246, v246, v255, v255
Mvaa 192,92,208
La 48,9,25600
v_fma_f32 v247, v247, v255, v255
Mvaa 192,96,224
La 4,10,26624
PK 176,176,177
Mvaa 192,100,240
La 20,10,27648
PK 177,178,179
Mvav 192,104,16
v_rcp_f32 v244, v244
Mvav 192,108,32
v_rcp_f32 v245, v245
Mvaa 196,88,196
v_rcp_f32 v246, v246
Mvaa 196,92,212
v_rcp_f32 v247, v247
Mvaa 196,96,228
La 36,9,26624
v_mul_f32 v156, v244, v156
Mvaa 196,100,244
La 52,9,27648
v_mul_f32 v157, v245, v157
Mvav 196,104,20
La 8,10,28672
v_mul_f32 v158, v246, v158
Mvav 196,108,36
La 24,10,29696
v_mul_f32 v159, v247, v159
Mvaa 184,64,200
La 40,9,28672
PK 156,156,157
Mvaa 184,68,216
La 56,9,29696
PK 157,158,159
Mvaa 184,72,232
La 148,3,0
v_mul_f32 v244, s89, v172
Mvaa 184,76,248
La 152,3,40960
v_mul_f32 v245, s89, v173
Mvav 184,80,24
PK 178,192,193
v_mul_f32 v246, s89, v174
Mvav 184,84,40
PK 179,194,195
v_mul_f32 v247, s89, v175
Mvaa 188,64,204
v_exp_f32 v244, v244
Mvaa 188,68,220
v_exp_f32 v245, v245
Mvaa 188,72,236
ds_write_b128 v10, v[176:179] offset:30720
Mvaa 188,76,252
PK 180,180,181
PK 181,182,183
PK 182,196,197
PK 183,198,199
ds_write_b128 v10, v[180:183] offset:31744
Mvav 188,80,28
v_exp_f32 v246, v246
Mvav 188,84,44
La 156,4,16384
Mvaa 200,88,200
v_exp_f32 v247, v247
Mvaa 200,92,216
La 160,4,57344
v_fma_f32 v244, v244, v255, v255
Mvaa 200,96,232
La 164,3,1024
La 168,3,41984
La 172,4,17408
La 176,4,58368
Mvaa 200,100,248
s_waitcnt lgkmcnt(6)
s_barrier
Mvav 200,104,24
v_fma_f32 v245, v245, v255, v255
v_fma_f32 v246, v246, v255, v255
Mvav 200,108,40
La 12,10,30720
v_fma_f32 v247, v247, v255, v255
Mvaa 204,88,204
La 28,10,31744
Mvaa 204,92,220
La 44,9,30720
v_rcp_f32 v244, v244
v_rcp_f32 v245, v245
v_rcp_f32 v246, v246
v_rcp_f32 v247, v247
v_mul_f32 v172, v244, v172
v_mul_f32 v173, v245, v173
v_mul_f32 v174, v246, v174
v_mul_f32 v175, v247, v175
PK 158,172,173
PK 159,174,175
buffer_store_dwordx4 v[156:159], v1, s[16:19], s87 offen sc0 sc1
La 60,9,31744
s_add_u32 s87, s87, 0x20000
Mvaa 204,96,236
Mvaa 204,100,252
Mvav 204,104,28
Mvav 204,108,44
s_cmp_lg_u32 s50, 0
s_cbranch_scc1 M_max0
M_go0:
s_waitcnt lgkmcnt(8)
Cvaa 16,148,0,216
s_add_u32 m0, s38, 0x4000
La 180,6,0
v_min_u32 v254, 6, v15
Mvaa 16,152,4
buffer_load_dwordx4 v1, s[16:19], s33 offen sc1 lds
Mvaa 16,156,8
s_waitcnt lgkmcnt(4)
La 184,6,40960
v_lshlrev_b32 v254, 7, v254
Mvaa 16,160,12
La 188,7,16384
PK 184,184,185
Cvaa 20,148,16,220
buffer_load_dwordx4 v1, s[16:19], s33 offen offset:1024 sc1 lds
Mvaa 20,152,20
La 192,7,57344
PK 185,186,187
Mvaa 20,156,24
s_waitcnt lgkmcnt(6)
La 196,6,1024
PK 186,200,201
Mvaa 20,160,28
buffer_load_dwordx4 v1, s[16:19], s33 offen offset:2048 sc1 lds
Cvaa 24,148,32,224
La 200,6,41984
PK 187,202,203
Mvaa 24,152,36
s_add_u32 s73, s45, 0x60000
La 204,7,17408
v_mov_b32 v0, 0x3f803f80
Mvaa 24,156,40
s_waitcnt lgkmcnt(8)
buffer_load_dwordx4 v1, s[16:19], s33 offen offset:3072 sc1 lds
Mvaa 24,160,44
La 208,7,58368
v_accvgpr_write_b32 a144, v0
Cvaa 28,148,48,228
s_add_u32 m0, s38, 0x5000
v_exp_f32 v16, v16
Mvaa 28,152,52
buffer_load_dwordx4 v2, s[16:19], s33 offen sc1 lds
Mvaa 28,156,56
s_waitcnt lgkmcnt(8)
v_exp_f32 v17, v17
Mvaa 28,160,60
s_waitcnt lgkmcnt(12)
v_exp_f32 v18, v18
Cvaa 32,164,0,216
buffer_load_dwordx4 v2, s[16:19], s33 offen offset:1024 sc1 lds
Mvaa 32,168,4
v_exp_f32 v19, v19
Mvaa 32,172,8
v_exp_f32 v20, v20
Mvaa 32,176,12
buffer_load_dwordx4 v2, s[16:19], s33 offen offset:2048 sc1 lds
Cvaa 36,164,16,220
v_exp_f32 v21, v21
Mvaa 36,168,20
v_exp_f32 v22, v22
Mvaa 36,172,24
buffer_load_dwordx4 v2, s[16:19], s33 offen offset:3072 sc1 lds
Mvaa 36,176,28
v_exp_f32 v23, v23
Cvaa 40,164,32,224
s_add_u32 s33, s33, 0x2000
s_cmp_eq_u32 s33, s35
s_cselect_b32 s33, s29, s33
v_accvgpr_write_b32 a145, v0
Mvaa 40,168,36
PK 80,16,17
v_accvgpr_write_b32 a146, v0
Mvaa 40,172,40
PK 81,18,19
v_accvgpr_write_b32 a147, v0
Mvaa 40,176,44
v_exp_f32 v24, v24
Cvaa 44,164,48,228
v_exp_f32 v25, v25
Mvaa 44,168,52
buffer_store_dwordx4 v[184:187], v1, s[16:19], s73 offen
PK 188,188,189
PK 189,190,191
PK 190,204,205
Mvaa 44,172,56
v_exp_f32 v26, v26
Mvaa 44,176,60
s_waitcnt vmcnt(11) lgkmcnt(0)
s_barrier
Cvaa 48,180,0,216
s_add_u32 m0, s38, 0
La 148,3,8192
PK 191,206,207
Mvaa 48,184,4
buffer_load_dwordx4 v1, s[16:19], s32 offen sc1 lds
Mvaa 48,188,8
s_add_u32 s73, s46, 0x60000
La 152,3,49152
PK 84,20,21
Mvaa 48,192,12
La 156,4,24576
PK 85,22,23
Cvaa 52,180,16,220
buffer_load_dwordx4 v1, s[16:19], s32 offen offset:1024 sc1 lds
Mvaa 52,184,20
La 160,5,0
v_mov_b32 v214, 1
Mvaa 52,188,24
La 164,3,9216
v_mov_b32 v215, 0x10000000
Mvaa 52,192,28
buffer_load_dwordx4 v1, s[16:19], s32 offen offset:2048 sc1 lds
Cvaa 56,180,32,224
s_mov_b32 s72, 0x30000
La 168,3,50176
v_writelane_b32 v215, s78, 0
Mvaa 56,184,36
La 172,4,25600
v_writelane_b32 v215, s79, 1
Mvaa 56,188,40
buffer_load_dwordx4 v1, s[16:19], s32 offen offset:3072 sc1 lds
Mvaa 56,192,44
v_exp_f32 v27, v27
Cvaa 60,180,48,228
s_add_u32 m0, s38, 0x1000
La 176,5,1024
PK 88,24,25
Mvaa 60,184,52
buffer_load_dwordx4 v2, s[16:19], s32 offen sc1 lds
Mvaa 60,188,56
v_exp_f32 v28, v28
Mvaa 60,192,60
v_exp_f32 v29, v29
Cvaa 64,196,0,216
buffer_load_dwordx4 v2, s[16:19], s32 offen offset:1024 sc1 lds
Mvaa 64,200,4
v_exp_f32 v30, v30
Mvaa 64,204,8
v_exp_f32 v31, v31
Mvaa 64,208,12
buffer_load_dwordx4 v2, s[16:19], s32 offen offset:2048 sc1 lds
Cvaa 68,196,16,220
PK 89,26,27
PK 92,28,29
Mvaa 68,200,20
v_exp_f32 v32, v32
Mvaa 68,204,24
buffer_load_dwordx4 v2, s[16:19], s32 offen offset:3072 sc1 lds
Mvaa 68,208,28
v_exp_f32 v33, v33
Cvaa 72,196,32,224
s_add_u32 s32, s32, 0x2000
s_cmp_eq_u32 s32, s34
s_cselect_b32 s32, s28, s32
s_add_u32 m0, s38, 0x8000
Mvaa 72,200,36
buffer_store_dwordx4 v[188:191], v1, s[16:19], s73 offen
PK 93,30,31
v_exp_f32 v34, v34
Mvaa 72,204,40
v_exp_f32 v35, v35
Mvaa 72,208,44
v_exp_f32 v36, v36
Cvaa 76,196,48,228
buffer_load_dwordx4 v1, s[16:19], s33 offen sc1 lds
Mvaa 76,200,52
v_exp_f32 v37, v37
Mvaa 76,204,56
v_exp_f32 v38, v38
Mvaa 76,208,60
s_waitcnt lgkmcnt(4)
buffer_load_dwordx4 v1, s[16:19], s33 offen offset:1024 sc1 lds
Cvaa 16,148,0,216
La 180,6,8192
PK 82,32,33
Mvaa 16,152,4
La 184,6,49152
PK 83,34,35
Mvaa 16,156,8
buffer_load_dwordx4 v1, s[16:19], s33 offen offset:2048 sc1 lds
Mvaa 16,160,12
La 188,7,24576
v_accvgpr_write_b32 a212, -1
Cvaa 20,148,16,220
La 192,8,0
v_accvgpr_write_b32 a213, -1
Mvaa 20,152,20
buffer_load_dwordx4 v1, s[16:19], s33 offen offset:3072 sc1 lds
Mvaa 20,156,24
s_add_u32 m0, s38, 0x9000
La 196,6,9216
v_accvgpr_write_b32 a214, -1
Mvaa 20,160,28
La 200,6,50176
v_accvgpr_write_b32 a215, -1
Cvaa 24,148,32,224
buffer_load_dwordx4 v2, s[16:19], s33 offen sc1 lds
Mvaa 24,152,36
v_exp_f32 v39, v39
Mvaa 24,156,40
La 204,7,25600
PK 86,36,37
Mvaa 24,160,44
buffer_load_dwordx4 v2, s[16:19], s33 offen offset:1024 sc1 lds
Cvaa 28,148,48,228
La 208,8,1024
PK 87,38,39
Mvaa 28,152,52
v_exp_f32 v40, v40
Mvaa 28,156,56
buffer_load_dword v255, v254, s[8:11], s56 offen
Mvaa 28,160,60
s_waitcnt lgkmcnt(8)
v_exp_f32 v41, v41
Cvaa 32,164,0,216
v_exp_f32 v42, v42
Mvaa 32,168,4
v_exp_f32 v43, v43
Mvaa 32,172,8
buffer_load_dwordx4 v2, s[16:19], s33 offen offset:2048 sc1 lds
Mvaa 32,176,12
v_exp_f32 v44, v44
Cvaa 36,164,16,220
v_exp_f32 v45, v45
Mvaa 36,168,20
v_exp_f32 v46, v46
Mvaa 36,172,24
M_w10:
s_cbranch_execz M_w11
PK 90,40,41
PK 91,42,43
Mvaa 36,176,28
v_exp_f32 v47, v47
Cvaa 40,164,32,224
v_exp_f32 v48, v48
Mvaa 40,168,36
buffer_load_dwordx4 v2, s[16:19], s33 offen offset:3072 sc1 lds
Mvaa 40,172,40
PK 94,44,45
PK 95,46,47
Mvaa 40,176,44
v_exp_f32 v49, v49
Cvaa 44,164,48,228
v_exp_f32 v50, v50
Mvaa 44,168,52
v_exp_f32 v51, v51
Mvaa 44,172,56
PK 96,48,49
PK 97,50,51
Mvaa 44,176,60
s_waitcnt vmcnt(19) lgkmcnt(0)
s_barrier
Cvaa 48,180,0,216
s_add_u32 s33, s33, 0x2000
v_exp_f32 v52, v52
Mvaa 48,184,4
s_cmp_eq_u32 s33, s35
s_cselect_b32 s33, s29, s33
v_exp_f32 v53, v53
Mvaa 48,188,8
s_add_u32 s56, s56, 0x300
v_exp_f32 v54, v54
Mvaa 48,192,12
s_add_u32 m0, s38, 0x2000
v_exp_f32 v55, v55
PK 100,52,53
PK 101,54,55
Cvaa 52,180,16,220
v_exp_f32 v56, v56
Mvaa 52,184,20
v_exp_f32 v57, v57
Mvaa 52,188,24
v_exp_f32 v58, v58
Mvaa 52,192,28
buffer_load_dwordx4 v1, s[16:19], s32 offen sc1 lds
v_exp_f32 v59, v59
PK 104,56,57
PK 105,58,59
Cvaa 56,180,32,224
v_exp_f32 v60, v60
Mvaa 56,184,36
v_exp_f32 v61, v61
Mvaa 56,188,40
v_exp_f32 v62, v62
Mvaa 56,192,44
v_exp_f32 v63, v63
PK 108,60,61
PK 109,62,63
Cvaa 60,180,48,228
v_exp_f32 v64, v64
Mvaa 60,184,52
v_exp_f32 v65, v65
Mvaa 60,188,56
v_exp_f32 v66, v66
Mvaa 60,192,60
buffer_load_dwordx4 v1, s[16:19], s32 offen offset:1024 sc1 lds
v_exp_f32 v67, v67
PK 98,64,65
PK 99,66,67
Cvaa 64,196,0,216
v_exp_f32 v68, v68
Mvaa 64,200,4
v_exp_f32 v69, v69
Mvaa 64,204,8
v_exp_f32 v70, v70
Mvaa 64,208,12
v_exp_f32 v71, v71
PK 102,68,69
PK 103,70,71
Cvaa 68,196,16,220
v_exp_f32 v72, v72
Mvaa 68,200,20
v_exp_f32 v73, v73
Mvaa 68,204,24
v_exp_f32 v74, v74
Mvaa 68,208,28
buffer_load_dwordx4 v1, s[16:19], s32 offen offset:2048 sc1 lds
v_exp_f32 v75, v75
PK 106,72,73
PK 107,74,75
Cvaa 72,196,32,224
v_exp_f32 v76, v76
Mvaa 72,200,36
v_exp_f32 v77, v77
Mvaa 72,204,40
v_exp_f32 v78, v78
Mvaa 72,208,44
v_exp_f32 v79, v79
PK 110,76,77
PK 111,78,79
Cvaa 76,196,48,228
La 148,3,16384
Mvaa 76,200,52
La 152,6,16384
Mvaa 76,204,56
La 156,3,17408
Mvaa 76,208,60
La 160,6,17408
buffer_load_dwordx4 v1, s[16:19], s32 offen offset:3072 sc1 lds
Zaav 128,144,80
v_exp_f32 v16, v16
Maav 128,144,96
s_add_u32 m0, s38, 0x3000
v_exp_f32 v17, v17
Zaav 132,144,84
buffer_load_dwordx4 v2, s[16:19], s32 offen sc1 lds
Maav 132,144,100
v_exp_f32 v18, v18
Zaav 136,144,88
v_exp_f32 v19, v19
Maav 136,144,104
La 164,3,57344
PK 112,16,17
Zaav 140,144,92
La 168,6,57344
PK 113,18,19
Maav 140,144,108
s_waitcnt lgkmcnt(2)
v_exp_f32 v20, v20
Zvav 144,148,80
v_exp_f32 v21, v21
Mvav 144,152,96
buffer_load_dwordx4 v2, s[16:19], s32 offen offset:1024 sc1 lds
Zvav 148,148,84
v_exp_f32 v22, v22
Mvav 148,152,100
v_exp_f32 v23, v23
Zaav 64,148,88
La 172,3,58368
PK 116,20,21
Maav 64,152,104
La 176,6,58368
PK 117,22,23
Zaav 68,148,92
v_exp_f32 v24, v24
Maav 68,152,108
v_exp_f32 v25, v25
Zvav 152,156,80
v_exp_f32 v26, v26
Mvav 152,160,96
buffer_load_dwordx4 v2, s[16:19], s32 offen offset:2048 sc1 lds
Zvav 156,156,84
v_exp_f32 v27, v27
Mvav 156,160,100
La 180,4,32768
PK 120,24,25
Zaav 72,156,88
La 184,7,32768
PK 121,26,27
Maav 72,160,104
v_exp_f32 v28, v28
Zaav 76,156,92
v_exp_f32 v29, v29
Maav 76,160,108
s_waitcnt lgkmcnt(2)
v_exp_f32 v30, v30
Zvav 160,164,80
v_exp_f32 v31, v31
Mvav 160,168,96
La 188,4,33792
PK 124,28,29
Zvav 164,164,84
La 192,7,33792
PK 125,30,31
Mvav 164,168,100
buffer_load_dwordx4 v2, s[16:19], s32 offen offset:3072 sc1 lds
Zaav 80,164,88
v_exp_f32 v32, v32
Maav 80,168,104
La 196,5,8192
Zaav 84,164,92
La 200,8,8192
Maav 84,168,108
La 204,5,9216
Zvav 168,172,80
La 208,8,9216
Mvav 168,176,96
s_add_u32 s32, s32, 0x2000
s_cmp_eq_u32 s32, s34
s_cselect_b32 s32, s28, s32
Zvav 172,172,84
v_exp_f32 v33, v33
Mvav 172,176,100
v_exp_f32 v34, v34
Zaav 88,172,88
v_exp_f32 v35, v35
Maav 88,176,104
v_exp_f32 v36, v36
Zaav 92,172,92
v_exp_f32 v37, v37
Maav 92,176,108
s_waitcnt vmcnt(17) lgkmcnt(0)
s_barrier
Zvav 176,180,80
La 148,3,0
PK 114,32,33
Mvav 176,184,96
buffer_store_dword v214, v215, s[16:19], s72 offen sc0 sc1
Zvav 180,180,84
s_add_u32 m0, s38, 0x4000
La 152,3,40960
PK 115,34,35
Mvav 180,184,100
v_exp_f32 v38, v38
Zaav 96,180,88
buffer_load_dwordx4 v1, s[16:19], s33 offen sc1 lds
Maav 96,184,104
v_exp_f32 v39, v39
Zaav 100,180,92
La 156,4,16384
PK 118,36,37
Maav 100,184,108
La 160,4,57344
PK 119,38,39
Zvav 184,188,80
buffer_load_dwordx4 v1, s[16:19], s33 offen offset:1024 sc1 lds
Mvav 184,192,96
v_exp_f32 v40, v40
Zvav 188,188,84
v_exp_f32 v41, v41
Mvav 188,192,100
v_exp_f32 v42, v42
Zaav 104,188,88
v_exp_f32 v43, v43
Maav 104,192,104
La 164,3,1024
PK 122,40,41
Zaav 108,188,92
La 168,3,41984
PK 123,42,43
Maav 108,192,108
buffer_load_dwordx4 v1, s[16:19], s33 offen offset:2048 sc1 lds
Zvav 192,196,80
v_exp_f32 v44, v44
Mvav 192,200,96
v_exp_f32 v45, v45
Zvav 196,196,84
v_exp_f32 v46, v46
Mvav 196,200,100
v_exp_f32 v47, v47
Zaav 112,196,88
La 172,4,17408
PK 126,44,45
Maav 112,200,104
La 176,4,58368
PK 127,46,47
Zaav 116,196,92
buffer_load_dwordx4 v1, s[16:19], s33 offen offset:3072 sc1 lds
Maav 116,200,108
s_add_u32 s72, s72, s70
v_exp_f32 v48, v48
Zvav 200,204,80
v_exp_f32 v49, v49
Mvav 200,208,96
v_exp_f32 v50, v50
Zvav 204,204,84
v_exp_f32 v51, v51
Mvav 204,208,100
v_exp_f32 v52, v52
Zaav 120,204,88
v_exp_f32 v53, v53
Maav 120,208,104
v_exp_f32 v54, v54
Zaav 124,204,92
v_exp_f32 v55, v55
Maav 124,208,108
s_waitcnt lgkmcnt(4)
PK 128,48,49
PK 129,50,51
Cvaa 16,148,0,216
La 180,6,0
PK 132,52,53
Mvaa 16,152,4
s_add_u32 m0, s38, 0x5000
La 184,6,40960
PK 133,54,55
Mvaa 16,156,8
buffer_load_dwordx4 v2, s[16:19], s33 offen sc1 lds
Mvaa 16,160,12
La 188,7,16384
v_add_u32 v253, 0x1f800, v1
Cvaa 20,148,16,220
La 192,7,57344
v_lshrrev_b32 v0, 3, v15
Mvaa 20,152,20
buffer_load_dword v212, v254, s[4:7], s57 offen
Mvaa 20,156,24
La 196,6,1024
v_and_b32 v213, 6, v0
Mvaa 20,160,28
La 200,6,41984
v_and_b32 v214, 7, v15
Cvaa 24,148,32,224
buffer_load_dwordx4 v2, s[16:19], s33 offen offset:1024 sc1 lds
Mvaa 24,152,36
La 204,7,17408
v_xor_b32 v213, v213, v214
Mvaa 24,156,40
La 208,7,58368
v_lshlrev_b32 v213, 4, v213
Mvaa 24,160,44
s_movk_i32 s37, 0x480
v_exp_f32 v56, v56
Cvaa 28,148,48,228
v_exp_f32 v57, v57
Mvaa 28,152,52
v_exp_f32 v58, v58
Mvaa 28,156,56
v_exp_f32 v59, v59
Mvaa 28,160,60
s_waitcnt lgkmcnt(8)
buffer_load_dwordx4 v2, s[16:19], s33 offen offset:2048 sc1 lds
Cvaa 32,164,0,216
v_exp_f32 v60, v60
Mvaa 32,168,4
v_exp_f32 v61, v61
Mvaa 32,172,8
v_exp_f32 v62, v62
Mvaa 32,176,12
v_exp_f32 v63, v63
Cvaa 36,164,16,220
PK 136,56,57
PK 137,58,59
Mvaa 36,168,20
v_exp_f32 v64, v64
Mvaa 36,172,24
buffer_load_dwordx4 v2, s[16:19], s33 offen offset:3072 sc1 lds
Mvaa 36,176,28
v_exp_f32 v65, v65
Cvaa 40,164,32,224
v_exp_f32 v66, v66
Mvaa 40,168,36
v_exp_f32 v67, v67
Mvaa 40,172,40
PK 140,60,61
PK 141,62,63
Mvaa 40,176,44
v_exp_f32 v68, v68
Cvaa 44,164,48,228
v_exp_f32 v69, v69
Mvaa 44,168,52
s_add_u32 s33, s33, 0x2000
s_cmp_eq_u32 s33, s35
s_cselect_b32 s33, s29, s33
PK 130,64,65
Mvaa 44,172,56
s_add_u32 s57, s57, 0x380
v_exp_f32 v70, v70
Mvaa 44,176,60
s_waitcnt vmcnt(18) lgkmcnt(0)
s_barrier
Cvaa 48,180,0,216
La 148,3,32768
PK 131,66,67
Mvaa 48,184,4
s_add_u32 m0, s38, 0
La 152,6,32768
v_mad_u32_u24 v248, v0, s37, v213
Mvaa 48,188,8
buffer_load_dwordx4 v1, s[16:19], s32 offen sc1 lds
Mvaa 48,192,12
La 156,3,33792
v_lshrrev_b32 v0, 2, v15
Cvaa 52,180,16,220
La 160,6,33792
v_lshrrev_b32 v213, 3, v15
Mvaa 52,184,20
La 164,4,8192
v_and_b32 v213, 2, v213
Mvaa 52,188,24
La 168,7,8192
v_and_b32 v214, 3, v15
Mvaa 52,192,28
La 172,4,9216
v_xor_b32 v213, v213, v214
Cvaa 56,180,32,224
La 176,7,9216
v_lshlrev_b32 v213, 4, v213
Mvaa 56,184,36
buffer_load_dwordx4 v1, s[16:19], s32 offen offset:1024 sc1 lds
Mvaa 56,188,40
v_exp_f32 v71, v71
Mvaa 56,192,44
v_exp_f32 v72, v72
Cvaa 60,180,48,228
v_exp_f32 v73, v73
Mvaa 60,184,52
v_exp_f32 v74, v74
Mvaa 60,188,56
v_exp_f32 v75, v75
Mvaa 60,192,60
PK 134,68,69
PK 135,70,71
Cvaa 64,196,0,216
La 180,4,49152
PK 138,72,73
Mvaa 64,200,4
buffer_load_dwordx4 v1, s[16:19], s32 offen offset:2048 sc1 lds
Mvaa 64,204,8
La 184,7,49152
PK 139,74,75
Mvaa 64,208,12
La 188,4,50176
v_mad_u32_u24 v252, v0, s37, v213
Cvaa 68,196,16,220
La 192,7,50176
v_and_b32 v213, 6, v0
Mvaa 68,200,20
v_exp_f32 v76, v76
Mvaa 68,204,24
v_exp_f32 v77, v77
Mvaa 68,208,28
v_exp_f32 v78, v78
Cvaa 72,196,32,224
v_exp_f32 v79, v79
Mvaa 72,200,36
buffer_load_dwordx4 v1, s[16:19], s32 offen offset:3072 sc1 lds
Mvaa 72,204,40
PK 142,76,77
PK 143,78,79
Mvaa 72,208,44
v_exp_f32 v16, v16
Cvaa 76,196,48,228
v_exp_f32 v17, v17
Mvaa 76,200,52
v_exp_f32 v18, v18
Mvaa 76,204,56
v_exp_f32 v19, v19
Mvaa 76,208,60
v_exp_f32 v20, v20
Maav 128,144,112
La 196,5,24576
PK 80,16,17
Maav 128,144,128
s_add_u32 m0, s38, 0x1000
La 200,8,24576
PK 81,18,19
Maav 132,144,116
buffer_load_dwordx4 v2, s[16:19], s32 offen sc1 lds
Maav 132,144,132
La 204,5,25600
v_lshlrev_b32 v213, 4, v213
Maav 136,144,120
La 208,8,25600
v_lshlrev_b32 v214, 3, v214
Maav 136,144,136
v_exp_f32 v21, v21
Maav 140,144,124
v_exp_f32 v22, v22
Maav 140,144,140
s_waitcnt lgkmcnt(12)
v_exp_f32 v23, v23
Mvav 144,148,112
v_exp_f32 v24, v24
Mvav 144,152,128
buffer_load_dwordx4 v2, s[16:19], s32 offen offset:1024 sc1 lds
Mvav 148,148,116
v_exp_f32 v25, v25
Mvav 148,152,132
v_exp_f32 v26, v26
Maav 64,148,120
v_exp_f32 v27, v27
Maav 64,152,136
PK 84,20,21
PK 85,22,23
Maav 68,148,124
v_exp_f32 v28, v28
Maav 68,152,140
v_exp_f32 v29, v29
Mvav 152,156,112
v_exp_f32 v30, v30
Mvav 152,160,128
buffer_load_dwordx4 v2, s[16:19], s32 offen offset:2048 sc1 lds
Mvav 156,156,116
v_exp_f32 v31, v31
Mvav 156,160,132
PK 88,24,25
PK 89,26,27
Maav 72,156,120
v_exp_f32 v32, v32
Maav 72,160,136
v_exp_f32 v33, v33
Maav 76,156,124
v_exp_f32 v34, v34
Maav 76,160,140
s_waitcnt lgkmcnt(8)
v_exp_f32 v35, v35
Mvav 160,164,112
PK 92,28,29
PK 93,30,31
Mvav 160,168,128
buffer_load_dwordx4 v2, s[16:19], s32 offen offset:3072 sc1 lds
Mvav 164,164,116
v_exp_f32 v36, v36
Mvav 164,168,132
v_exp_f32 v37, v37
Maav 80,164,120
v_exp_f32 v38, v38
Maav 80,168,136
v_exp_f32 v39, v39
Maav 84,164,124
PK 82,32,33
PK 83,34,35
Maav 84,168,140
s_add_u32 s73, s64, 0x8000
v_exp_f32 v40, v40
Mvav 168,172,112
buffer_store_dwordx4 a[212:215], v1, s[16:19], s73 offen sc0 sc1
PK 86,36,37
PK 87,38,39
v_lshlrev_b32 v215, 7, v0
Mvav 168,176,128
s_add_u32 s32, s32, 0x2000
s_cmp_eq_u32 s32, s34
s_cselect_b32 s32, s28, s32
v_add3_u32 v215, v215, v213, v214
Mvav 172,172,116
s_lshl_b32 s37, s40, 6
v_exp_f32 v41, v41
Mvav 172,176,132
s_add_u32 s73, s64, 0x8000
v_exp_f32 v42, v42
Maav 88,172,120
buffer_store_dwordx4 a[212:215], v1, s[16:19], s73 offen offset:1024 sc0 sc1
v_exp_f32 v43, v43
PK 90,40,41
Maav 88,176,136
v_exp_f32 v44, v44
Maav 92,172,124
v_exp_f32 v45, v45
Maav 92,176,140
s_waitcnt vmcnt(20) lgkmcnt(0)
s_barrier
Mvav 176,180,112
s_add_u32 s73, s64, 0xa000
La 148,3,8192
PK 91,42,43
Mvav 176,184,128
buffer_store_dwordx4 a[212:215], v1, s[16:19], s73 offen sc0 sc1
s_add_u32 m0, s38, 0x8000
La 152,3,49152
v_xor_b32 v215, s37, v215
Mvav 180,180,116
La 156,4,24576
v_accvgpr_write_b32 a252, v215
Mvav 180,184,132
s_and_b32 s37, s2, 1
s_add_u32 s37, s37, s39
s_add_u32 s37, s37, s39
Maav 96,180,120
buffer_load_dwordx4 v1, s[16:19], s33 offen sc1 lds
Maav 96,184,136
s_mul_i32 s55, s37, 0xa000
La 160,5,0
v_add_u32 v215, s55, v1
Maav 100,180,124
La 164,3,9216
v_accvgpr_write_b32 a255, v215
Maav 100,184,140
s_xor_b32 s37, s37, 1
s_mul_i32 s37, s37, 0xa000
La 168,3,50176
Mvav 184,188,112
buffer_load_dwordx4 v1, s[16:19], s33 offen offset:1024 sc1 lds
Mvav 184,192,128
La 172,4,25600
v_add_u32 v215, s37, v1
Mvav 188,188,116
La 176,5,1024
v_accvgpr_write_b32 a253, v215
Mvav 188,192,132
v_exp_f32 v46, v46
Maav 104,188,120
v_exp_f32 v47, v47
Maav 104,192,136
v_exp_f32 v48, v48
Maav 108,188,124
v_exp_f32 v49, v49
Maav 108,192,140
buffer_load_dwordx4 v1, s[16:19], s33 offen offset:2048 sc1 lds
Mvav 192,196,112
v_exp_f32 v50, v50
Mvav 192,200,128
v_exp_f32 v51, v51
Mvav 196,196,116
PK 94,44,45
PK 95,46,47
Mvav 196,200,132
v_exp_f32 v52, v52
Maav 112,196,120
v_exp_f32 v53, v53
Maav 112,200,136
M_w11:
s_cbranch_execz M_w12
v_exp_f32 v54, v54
Maav 116,196,124
buffer_load_dwordx4 v1, s[16:19], s33 offen offset:3072 sc1 lds
Maav 116,200,140
v_exp_f32 v55, v55
Mvav 200,204,112
PK 96,48,49
PK 97,50,51
Mvav 200,208,128
v_exp_f32 v56, v56
Mvav 204,204,116
v_exp_f32 v57, v57
Mvav 204,208,132
v_exp_f32 v58, v58
Maav 120,204,120
v_exp_f32 v59, v59
Maav 120,208,136
PK 100,52,53
PK 101,54,55
Maav 124,204,124
v_exp_f32 v60, v60
Maav 124,208,140
s_waitcnt lgkmcnt(4)
v_exp_f32 v61, v61
Cvaa 16,148,0,216
La 180,6,8192
PK 104,56,57
Mvaa 16,152,4
s_add_u32 m0, s38, 0x9000
La 184,6,49152
PK 105,58,59
Mvaa 16,156,8
buffer_load_dwordx4 v2, s[16:19], s33 offen sc1 lds
Mvaa 16,160,12
La 188,7,24576
v_lshlrev_b32 v215, 6, v0
Cvaa 20,148,16,220
La 192,8,0
v_bfe_u32 v213, v15, 4, 1
Mvaa 20,152,20
buffer_load_dword v255, v254, s[8:11], s56 offen
Mvaa 20,156,24
La 196,6,9216
v_xor_b32 v213, s40, v213
Mvaa 20,160,28
La 200,6,50176
v_lshlrev_b32 v213, 5, v213
Cvaa 24,148,32,224
buffer_load_dwordx4 v2, s[16:19], s33 offen offset:1024 sc1 lds
Mvaa 24,152,36
La 204,7,25600
v_add3_u32 v215, v215, v213, v214
Mvaa 24,156,40
La 208,8,1024
v_accvgpr_write_b32 a254, v215
Mvaa 24,160,44
s_getpc_b64 s[74:75]
M2_pc:
s_lshr_b32 s76, s2, 3
s_lshl_b32 s76, s76, 2
Cvaa 28,148,48,228
s_add_u32 s76, s76, s24
s_mul_i32 s76, s76, 8
v_min_u32 v214, 7, v15
Mvaa 28,152,52
v_exp_f32 v62, v62
Mvaa 28,156,56
v_exp_f32 v63, v63
Mvaa 28,160,60
s_waitcnt lgkmcnt(8)
buffer_load_dwordx4 v2, s[16:19], s33 offen offset:2048 sc1 lds
Cvaa 32,164,0,216
v_exp_f32 v64, v64
Mvaa 32,168,4
v_exp_f32 v65, v65
Mvaa 32,172,8
v_exp_f32 v66, v66
Mvaa 32,176,12
v_exp_f32 v67, v67
Cvaa 36,164,16,220
PK 108,60,61
PK 109,62,63
Mvaa 36,168,20
v_exp_f32 v68, v68
Mvaa 36,172,24
buffer_load_dwordx4 v2, s[16:19], s33 offen offset:3072 sc1 lds
Mvaa 36,176,28
v_exp_f32 v69, v69
Cvaa 40,164,32,224
v_exp_f32 v70, v70
Mvaa 40,168,36
v_exp_f32 v71, v71
Mvaa 40,172,40
PK 98,64,65
PK 99,66,67
Mvaa 40,176,44
v_exp_f32 v72, v72
Cvaa 44,164,48,228
v_exp_f32 v73, v73
Mvaa 44,168,52
s_add_u32 s33, s33, 0x2000
s_cmp_eq_u32 s33, s35
s_cselect_b32 s33, s29, s33
PK 102,68,69
Mvaa 44,172,56
s_add_u32 s56, s56, 0x300
v_exp_f32 v74, v74
Mvaa 44,176,60
s_waitcnt vmcnt(20) lgkmcnt(0)
s_barrier
Cvaa 48,180,0,216
La 148,3,16384
PK 103,70,71
Mvaa 48,184,4
s_add_u32 m0, s38, 0x2000
La 152,6,16384
v_add_u32 v214, s76, v214
Mvaa 48,188,8
buffer_load_dwordx4 v1, s[16:19], s32 offen sc1 lds
Mvaa 48,192,12
La 156,3,17408
v_lshlrev_b32 v214, 7, v214
Cvaa 52,180,16,220
La 160,6,17408
v_min_u32 v214, M_end-M2_pc-4, v214
Mvaa 52,184,20
La 164,3,57344
v_mov_b32 v215, s75
Mvaa 52,188,24
La 168,6,57344
v_add_co_u32 v214, s[86:87], s74, v214
Mvaa 52,192,28
La 172,3,58368
v_addc_co_u32 v215, s[86:87], 0, v215, s[86:87]
Cvaa 56,180,32,224
La 176,6,58368
v_and_b32 v249, 15, v15
Mvaa 56,184,36
buffer_load_dwordx4 v1, s[16:19], s32 offen offset:1024 sc1 lds
Mvaa 56,188,40
v_exp_f32 v75, v75
Mvaa 56,192,44
v_exp_f32 v76, v76
Cvaa 60,180,48,228
v_exp_f32 v77, v77
Mvaa 60,184,52
v_exp_f32 v78, v78
Mvaa 60,188,56
v_exp_f32 v79, v79
Mvaa 60,192,60
PK 106,72,73
PK 107,74,75
Cvaa 64,196,0,216
La 180,4,32768
PK 110,76,77
Mvaa 64,200,4
buffer_load_dwordx4 v1, s[16:19], s32 offen offset:2048 sc1 lds
Mvaa 64,204,8
La 184,7,32768
PK 111,78,79
Mvaa 64,208,12
La 188,4,33792
v_lshrrev_b32 v250, 4, v15
Cvaa 68,196,16,220
La 192,7,33792
v_lshlrev_b32 v250, 2, v250
Mvaa 68,200,20
v_exp_f32 v16, v16
Mvaa 68,204,24
v_exp_f32 v17, v17
Mvaa 68,208,28
v_exp_f32 v18, v18
Cvaa 72,196,32,224
v_exp_f32 v19, v19
Mvaa 72,200,36
buffer_load_dwordx4 v1, s[16:19], s32 offen offset:3072 sc1 lds
Mvaa 72,204,40
v_exp_f32 v20, v20
Mvaa 72,208,44
v_exp_f32 v21, v21
Cvaa 76,196,48,228
v_exp_f32 v22, v22
Mvaa 76,200,52
v_exp_f32 v23, v23
Mvaa 76,204,56
PK 112,16,17
PK 113,18,19
Mvaa 76,208,60
v_exp_f32 v24, v24
Maav 128,144,80
La 196,5,8192
PK 116,20,21
Maav 128,144,96
s_add_u32 m0, s38, 0x3000
La 200,8,8192
PK 117,22,23
Maav 132,144,84
buffer_load_dwordx4 v2, s[16:19], s32 offen sc1 lds
Maav 132,144,100
La 204,5,9216
v_sub_u32 v249, v249, v250
Maav 136,144,88
La 208,8,9216
v_mov_b32 v251, 0xff800000
Maav 136,144,104
s_xor_b32 s37, s39, 0
s_lshl_b32 s37, s37, 4
v_add_u32 v250, s37, v249
Maav 140,144,92
v_exp_f32 v25, v25
Maav 140,144,108
s_waitcnt lgkmcnt(12)
v_exp_f32 v26, v26
Mvav 144,148,80
v_exp_f32 v27, v27
Mvav 144,152,96
buffer_load_dwordx4 v2, s[16:19], s32 offen offset:1024 sc1 lds
Mvav 148,148,84
v_exp_f32 v28, v28
Mvav 148,152,100
v_exp_f32 v29, v29
Maav 64,148,88
v_exp_f32 v30, v30
Maav 64,152,104
v_exp_f32 v31, v31
Maav 68,148,92
PK 120,24,25
PK 121,26,27
Maav 68,152,108
v_exp_f32 v32, v32
Mvav 152,156,80
v_exp_f32 v33, v33
Mvav 152,160,96
buffer_load_dwordx4 v2, s[16:19], s32 offen offset:2048 sc1 lds
Mvav 156,156,84
v_exp_f32 v34, v34
Mvav 156,160,100
v_exp_f32 v35, v35
Maav 72,156,88
PK 124,28,29
PK 125,30,31
Maav 72,160,104
v_exp_f32 v36, v36
Maav 76,156,92
v_exp_f32 v37, v37
Maav 76,160,108
s_waitcnt lgkmcnt(8)
v_exp_f32 v38, v38
Mvav 160,164,80
v_exp_f32 v39, v39
Mvav 160,168,96
buffer_load_dwordx4 v2, s[16:19], s32 offen offset:3072 sc1 lds
Mvav 164,164,84
PK 114,32,33
PK 115,34,35
Mvav 164,168,100
v_exp_f32 v40, v40
Maav 80,164,88
v_exp_f32 v41, v41
Maav 80,168,104
v_exp_f32 v42, v42
Maav 84,164,92
v_exp_f32 v43, v43
Maav 84,168,108
s_add_u32 s73, s64, 0xa000
PK 118,36,37
PK 119,38,39
Mvav 168,172,80
buffer_store_dwordx4 a[212:215], v1, s[16:19], s73 offen offset:1024 sc0 sc1
PK 122,40,41
v_exp_f32 v44, v44
Mvav 168,176,96
s_add_u32 s32, s32, 0x2000
s_cmp_eq_u32 s32, s34
s_cselect_b32 s32, s28, s32
PK 123,42,43
Mvav 172,172,84
v_exp_f32 v45, v45
Mvav 172,176,100
s_add_u32 s73, s64, 0xc000
v_exp_f32 v46, v46
Maav 88,172,88
buffer_store_dwordx4 a[212:215], v1, s[16:19], s73 offen sc0 sc1
v_exp_f32 v47, v47
PK 126,44,45
Maav 88,176,104
v_exp_f32 v48, v48
Maav 92,172,92
v_exp_f32 v49, v49
Maav 92,176,108
s_waitcnt vmcnt(22) lgkmcnt(0)
s_barrier
Mvav 176,180,80
s_add_u32 s73, s64, 0xc000
La 148,3,0
PK 127,46,47
Mvav 176,184,96
buffer_store_dwordx4 a[212:215], v1, s[16:19], s73 offen offset:1024 sc0 sc1
s_add_u32 m0, s38, 0x4000
La 152,3,40960
v_cmp_le_i32 s[86:87], 0, v250
Mvav 180,180,84
La 156,4,16384
v_cndmask_b32 v232, v251, v216, s[86:87]
Mvav 180,184,100
La 160,4,57344
v_cmp_le_i32 s[86:87], 1, v250
Maav 96,180,88
buffer_load_dwordx4 v1, s[16:19], s33 offen sc1 lds
Maav 96,184,104
La 164,3,1024
v_cndmask_b32 v233, v251, v217, s[86:87]
Maav 100,180,92
La 168,3,41984
v_cmp_le_i32 s[86:87], 2, v250
Maav 100,184,108
La 172,4,17408
v_cndmask_b32 v234, v251, v218, s[86:87]
Mvav 184,188,80
buffer_load_dwordx4 v1, s[16:19], s33 offen offset:1024 sc1 lds
Mvav 184,192,96
La 176,4,58368
v_cmp_le_i32 s[86:87], 3, v250
Mvav 188,188,84
v_exp_f32 v50, v50
Mvav 188,192,100
v_exp_f32 v51, v51
Maav 104,188,88
v_exp_f32 v52, v52
Maav 104,192,104
v_exp_f32 v53, v53
Maav 108,188,92
v_exp_f32 v54, v54
Maav 108,192,108
buffer_load_dwordx4 v1, s[16:19], s33 offen offset:2048 sc1 lds
Mvav 192,196,80
v_exp_f32 v55, v55
Mvav 192,200,96
PK 128,48,49
PK 129,50,51
Mvav 196,196,84
v_exp_f32 v56, v56
Mvav 196,200,100
v_exp_f32 v57, v57
Maav 112,196,88
v_exp_f32 v58, v58
Maav 112,200,104
v_exp_f32 v59, v59
Maav 116,196,92
buffer_load_dwordx4 v1, s[16:19], s33 offen offset:3072 sc1 lds
Maav 116,200,108
PK 132,52,53
PK 133,54,55
Mvav 200,204,80
v_exp_f32 v60, v60
Mvav 200,208,96
v_exp_f32 v61, v61
Mvav 204,204,84
v_exp_f32 v62, v62
Mvav 204,208,100
v_exp_f32 v63, v63
Maav 120,204,88
PK 136,56,57
PK 137,58,59
Maav 120,208,104
v_exp_f32 v64, v64
Maav 124,204,92
v_exp_f32 v65, v65
Maav 124,208,108
s_waitcnt lgkmcnt(4)
v_exp_f32 v66, v66
Cvaa 16,148,0,216
La 180,6,0
PK 140,60,61
Mvaa 16,152,4
s_add_u32 m0, s38, 0x5000
La 184,6,40960
PK 141,62,63
Mvaa 16,156,8
buffer_load_dwordx4 v2, s[16:19], s33 offen sc1 lds
Mvaa 16,160,12
La 188,7,16384
v_cndmask_b32 v235, v251, v219, s[86:87]
Cvaa 20,148,16,220
La 192,7,57344
v_cmp_le_i32 s[86:87], 16, v250
Mvaa 20,152,20
buffer_load_dword v212, v254, s[4:7], s57 offen
Mvaa 20,156,24
La 196,6,1024
v_cndmask_b32 v236, v251, v216, s[86:87]
Mvaa 20,160,28
La 200,6,41984
v_cmp_le_i32 s[86:87], 17, v250
Cvaa 24,148,32,224
buffer_load_dwordx4 v2, s[16:19], s33 offen offset:1024 sc1 lds
Mvaa 24,152,36
La 204,7,17408
v_cndmask_b32 v237, v251, v217, s[86:87]
Mvaa 24,156,40
La 208,7,58368
v_cmp_le_i32 s[86:87], 18, v250
Mvaa 24,160,44
v_exp_f32 v67, v67
Cvaa 28,148,48,228
v_exp_f32 v68, v68
Mvaa 28,152,52
v_exp_f32 v69, v69
Mvaa 28,156,56
v_exp_f32 v70, v70
Mvaa 28,160,60
s_waitcnt lgkmcnt(8)
buffer_load_dwordx4 v2, s[16:19], s33 offen offset:2048 sc1 lds
Cvaa 32,164,0,216
v_exp_f32 v71, v71
Mvaa 32,168,4
PK 130,64,65
PK 131,66,67
Mvaa 32,172,8
v_exp_f32 v72, v72
Mvaa 32,176,12
v_exp_f32 v73, v73
Cvaa 36,164,16,220
v_exp_f32 v74, v74
Mvaa 36,168,20
v_exp_f32 v75, v75
Mvaa 36,172,24
buffer_load_dwordx4 v2, s[16:19], s33 offen offset:3072 sc1 lds
Mvaa 36,176,28
PK 134,68,69
PK 135,70,71
Cvaa 40,164,32,224
v_exp_f32 v76, v76
Mvaa 40,168,36
v_exp_f32 v77, v77
Mvaa 40,172,40
v_exp_f32 v78, v78
Mvaa 40,176,44
v_exp_f32 v79, v79
Cvaa 44,164,48,228
PK 138,72,73
PK 139,74,75
Mvaa 44,168,52
s_add_u32 s33, s33, 0x2000
s_cmp_eq_u32 s33, s35
s_cselect_b32 s33, s29, s33
PK 142,76,77
Mvaa 44,172,56
s_add_u32 s57, s57, 0x380
v_exp_f32 v16, v16
Mvaa 44,176,60
s_waitcnt vmcnt(20) lgkmcnt(0)
s_barrier
Cvaa 48,180,0,216
La 148,3,32768
PK 143,78,79
Mvaa 48,184,4
s_add_u32 m0, s38, 0
La 152,6,32768
v_cndmask_b32 v238, v251, v218, s[86:87]
Mvaa 48,188,8
buffer_load_dwordx4 v1, s[16:19], s52 offen sc1 lds
Mvaa 48,192,12
La 156,3,33792
v_cmp_le_i32 s[86:87], 19, v250
Cvaa 52,180,16,220
La 160,6,33792
v_cndmask_b32 v239, v251, v219, s[86:87]
Mvaa 52,184,20
s_xor_b32 s37, s39, 1
s_lshl_b32 s37, s37, 4
La 164,4,8192
Mvaa 52,188,24
La 168,7,8192
v_add_u32 v250, s37, v249
Mvaa 52,192,28
global_load_dword v213, v[214:215], off
Cvaa 56,180,32,224
La 172,4,9216
v_cmp_le_i32 s[86:87], 0, v250
Mvaa 56,184,36
La 176,7,9216
v_cndmask_b32 v240, v251, v228, s[86:87]
Mvaa 56,188,40
buffer_load_dwordx4 v1, s[16:19], s52 offen offset:1024 sc1 lds
Mvaa 56,192,44
v_exp_f32 v17, v17
Cvaa 60,180,48,228
v_exp_f32 v18, v18
Mvaa 60,184,52
v_exp_f32 v19, v19
Mvaa 60,188,56
v_exp_f32 v20, v20
Mvaa 60,192,60
v_exp_f32 v21, v21
Cvaa 64,196,0,216
La 180,4,49152
PK 80,16,17
Mvaa 64,200,4
buffer_load_dwordx4 v1, s[16:19], s52 offen offset:2048 sc1 lds
Mvaa 64,204,8
La 184,7,49152
PK 81,18,19
Mvaa 64,208,12
La 188,4,50176
v_cmp_le_i32 s[86:87], 1, v250
Cvaa 68,196,16,220
La 192,7,50176
v_cndmask_b32 v241, v251, v229, s[86:87]
Mvaa 68,200,20
v_exp_f32 v22, v22
Mvaa 68,204,24
v_exp_f32 v23, v23
Mvaa 68,208,28
v_exp_f32 v24, v24
Cvaa 72,196,32,224
v_exp_f32 v25, v25
Mvaa 72,200,36
buffer_load_dwordx4 v1, s[16:19], s52 offen offset:3072 sc1 lds
Mvaa 72,204,40
v_exp_f32 v26, v26
Mvaa 72,208,44
v_exp_f32 v27, v27
Cvaa 76,196,48,228
PK 84,20,21
PK 85,22,23
Mvaa 76,200,52
v_exp_f32 v28, v28
Mvaa 76,204,56
v_exp_f32 v29, v29
Mvaa 76,208,60
v_exp_f32 v30, v30
Maav 128,144,112
La 196,5,24576
PK 88,24,25
Maav 128,144,128
s_add_u32 m0, s38, 0x1000
La 200,8,24576
PK 89,26,27
Maav 132,144,116
buffer_load_dwordx4 v2, s[16:19], s52 offen sc1 lds
Maav 132,144,132
La 204,5,25600
v_cmp_le_i32 s[86:87], 2, v250
Maav 136,144,120
La 208,8,25600
v_cndmask_b32 v242, v251, v230, s[86:87]
Maav 136,144,136
v_exp_f32 v31, v31
Maav 140,144,124
v_exp_f32 v32, v32
Maav 140,144,140
s_waitcnt lgkmcnt(12)
v_exp_f32 v33, v33
Mvav 144,148,112
v_exp_f32 v34, v34
Mvav 144,152,128
buffer_load_dwordx4 v2, s[16:19], s52 offen offset:1024 sc1 lds
Mvav 148,148,116
v_exp_f32 v35, v35
Mvav 148,152,132
PK 92,28,29
PK 93,30,31
Maav 64,148,120
v_exp_f32 v36, v36
Maav 64,152,136
v_exp_f32 v37, v37
Maav 68,148,124
v_exp_f32 v38, v38
Maav 68,152,140
v_exp_f32 v39, v39
Mvav 152,156,112
PK 82,32,33
PK 83,34,35
Mvav 152,160,128
buffer_load_dwordx4 v2, s[16:19], s52 offen offset:2048 sc1 lds
Mvav 156,156,116
v_exp_f32 v40, v40
Mvav 156,160,132
v_exp_f32 v41, v41
Maav 72,156,120
v_exp_f32 v42, v42
Maav 72,160,136
v_exp_f32 v43, v43
Maav 76,156,124
PK 86,36,37
PK 87,38,39
Maav 76,160,140
s_waitcnt lgkmcnt(8)
v_exp_f32 v44, v44
Mvav 160,164,112
v_exp_f32 v45, v45
Mvav 160,168,128
buffer_load_dwordx4 v2, s[16:19], s52 offen offset:3072 sc1 lds
Mvav 164,164,116
M_w12:
s_cbranch_execz M_w13
v_exp_f32 v46, v46
Mvav 164,168,132
v_exp_f32 v47, v47
Maav 80,164,120
PK 90,40,41
PK 91,42,43
Maav 80,168,136
v_exp_f32 v48, v48
Maav 84,164,124
v_exp_f32 v49, v49
Maav 84,168,140
v_exp_f32 v50, v50
Mvav 168,172,112
v_exp_f32 v51, v51
Mvav 168,176,128
PK 94,44,45
PK 95,46,47
Mvav 172,172,116
v_exp_f32 v52, v52
Mvav 172,176,132
v_exp_f32 v53, v53
Maav 88,172,120
v_exp_f32 v54, v54
Maav 88,176,136
v_exp_f32 v55, v55
Maav 92,172,124
PK 96,48,49
PK 97,50,51
Maav 92,176,140
s_waitcnt vmcnt(21) lgkmcnt(0)
s_barrier
Mvav 176,180,112
La 148,3,8192
PK 100,52,53
Mvav 176,184,128
s_add_u32 m0, s38, 0x8000
La 152,3,49152
PK 101,54,55
Mvav 180,180,116
buffer_load_dwordx4 v1, s[16:19], s33 offen sc1 lds
Mvav 180,184,132
La 156,4,24576
v_cmp_le_i32 s[86:87], 3, v250
Maav 96,180,120
La 160,5,0
v_cndmask_b32 v243, v251, v231, s[86:87]
Maav 96,184,136
La 164,3,9216
v_cmp_le_i32 s[86:87], 16, v250
Maav 100,180,124
La 168,3,50176
v_cndmask_b32 v244, v251, v228, s[86:87]
Maav 100,184,140
La 172,4,25600
v_cmp_le_i32 s[86:87], 17, v250
Mvav 184,188,112
buffer_load_dwordx4 v1, s[16:19], s33 offen offset:1024 sc1 lds
Mvav 184,192,128
La 176,5,1024
v_cndmask_b32 v245, v251, v229, s[86:87]
Mvav 188,188,116
v_exp_f32 v56, v56
Mvav 188,192,132
v_exp_f32 v57, v57
Maav 104,188,120
v_exp_f32 v58, v58
Maav 104,192,136
v_exp_f32 v59, v59
Maav 108,188,124
v_exp_f32 v60, v60
Maav 108,192,140
buffer_load_dwordx4 v1, s[16:19], s33 offen offset:2048 sc1 lds
Mvav 192,196,112
v_exp_f32 v61, v61
Mvav 192,200,128
v_exp_f32 v62, v62
Mvav 196,196,116
v_exp_f32 v63, v63
Mvav 196,200,132
PK 104,56,57
PK 105,58,59
Maav 112,196,120
v_exp_f32 v64, v64
Maav 112,200,136
v_exp_f32 v65, v65
Maav 116,196,124
buffer_load_dwordx4 v1, s[16:19], s33 offen offset:3072 sc1 lds
Maav 116,200,140
v_exp_f32 v66, v66
Mvav 200,204,112
v_exp_f32 v67, v67
Mvav 200,208,128
PK 108,60,61
PK 109,62,63
Mvav 204,204,116
v_exp_f32 v68, v68
Mvav 204,208,132
v_exp_f32 v69, v69
Maav 120,204,120
v_exp_f32 v70, v70
Maav 120,208,136
v_exp_f32 v71, v71
Maav 124,204,124
PK 98,64,65
PK 99,66,67
Maav 124,208,140
s_waitcnt lgkmcnt(4)
v_exp_f32 v72, v72
Cvaa 16,148,0,216
La 180,6,8192
PK 102,68,69
Mvaa 16,152,4
s_add_u32 m0, s38, 0x9000
La 184,6,49152
PK 103,70,71
Mvaa 16,156,8
buffer_load_dwordx4 v2, s[16:19], s33 offen sc1 lds
Mvaa 16,160,12
La 188,7,24576
v_cmp_le_i32 s[86:87], 18, v250
Cvaa 20,148,16,220
La 192,8,0
v_cndmask_b32 v246, v251, v230, s[86:87]
Mvaa 20,152,20
buffer_load_dword v255, v254, s[8:11], s56 offen
Mvaa 20,156,24
La 196,6,9216
v_cmp_le_i32 s[86:87], 19, v250
Mvaa 20,160,28
La 200,6,50176
v_cndmask_b32 v247, v251, v231, s[86:87]
Cvaa 24,148,32,224
buffer_load_dwordx4 v2, s[16:19], s33 offen offset:1024 sc1 lds
Mvaa 24,152,36
La 204,7,25600
v_add_u32 v249, 0x2000, v248
Mvaa 24,156,40
La 208,8,1024
v_add_u32 v250, 0x4000, v248
Mvaa 24,160,44
v_exp_f32 v73, v73
Cvaa 28,148,48,228
v_exp_f32 v74, v74
Mvaa 28,152,52
v_exp_f32 v75, v75
Mvaa 28,156,56
v_exp_f32 v76, v76
Mvaa 28,160,60
s_waitcnt lgkmcnt(8)
buffer_load_dwordx4 v2, s[16:19], s33 offen offset:2048 sc1 lds
Cvaa 32,164,0,216
v_exp_f32 v77, v77
Mvaa 32,168,4
v_exp_f32 v78, v78
Mvaa 32,172,8
v_exp_f32 v79, v79
Mvaa 32,176,12
PK 106,72,73
PK 107,74,75
Cvaa 36,164,16,220
v_exp_f32 v16, v16
Mvaa 36,168,20
v_exp_f32 v17, v17
Mvaa 36,172,24
buffer_load_dwordx4 v2, s[16:19], s33 offen offset:3072 sc1 lds
Mvaa 36,176,28
v_exp_f32 v18, v18
Cvaa 40,164,32,224
v_exp_f32 v19, v19
Mvaa 40,168,36
PK 110,76,77
PK 111,78,79
Mvaa 40,172,40
v_exp_f32 v20, v20
Mvaa 40,176,44
v_exp_f32 v21, v21
Cvaa 44,164,48,228
v_exp_f32 v22, v22
Mvaa 44,168,52
s_add_u32 s33, s33, 0x2000
s_cmp_eq_u32 s33, s35
s_cselect_b32 s33, s29, s33
v_add_u32 v251, 0x6000, v248
Mvaa 44,172,56
s_add_u32 s56, s56, 0x300
v_exp_f32 v23, v23
Mvaa 44,176,60
s_waitcnt vmcnt(18) lgkmcnt(0)
s_barrier
Cvaa 48,180,0,216
La 148,3,16384
PK 112,16,17
Mvaa 48,184,4
s_add_u32 m0, s38, 0x2000
La 152,6,16384
PK 113,18,19
Mvaa 48,188,8
buffer_load_dwordx4 v1, s[16:19], s32 offen sc1 lds
Mvaa 48,192,12
La 156,3,17408
PK 116,20,21
Cvaa 52,180,16,220
La 160,6,17408
PK 117,22,23
Mvaa 52,184,20
v_exp_f32 v24, v24
Mvaa 52,188,24
v_exp_f32 v25, v25
Mvaa 52,192,28
v_exp_f32 v26, v26
Cvaa 56,180,32,224
v_exp_f32 v27, v27
Mvaa 56,184,36
buffer_load_dwordx4 v1, s[16:19], s32 offen offset:1024 sc1 lds
Mvaa 56,188,40
La 164,3,57344
PK 120,24,25
Mvaa 56,192,44
La 168,6,57344
PK 121,26,27
Cvaa 60,180,48,228
v_exp_f32 v32, v32
Mvaa 60,184,52
v_exp_f32 v28, v28
Mvaa 60,188,56
v_exp_f32 v33, v33
Mvaa 60,192,60
v_exp_f32 v29, v29
Cvaa 64,196,0,216
v_exp_f32 v34, v34
Mvaa 64,200,4
buffer_load_dwordx4 v1, s[16:19], s32 offen offset:2048 sc1 lds
Mvaa 64,204,8
v_exp_f32 v30, v30
Mvaa 64,208,12
v_exp_f32 v35, v35
Cvaa 68,196,16,220
La 172,3,58368
PK 114,32,33
Mvaa 68,200,20
La 176,6,58368
PK 115,34,35
Mvaa 68,204,24
v_exp_f32 v31, v31
Mvaa 68,208,28
La 180,4,32768
PK 124,28,29
Cvaa 72,196,32,224
La 184,7,32768
PK 125,30,31
Mvaa 72,200,36
buffer_load_dwordx4 v1, s[16:19], s32 offen offset:3072 sc1 lds
Mvaa 72,204,40
v_exp_f32 v40, v40
Mvaa 72,208,44
v_exp_f32 v36, v36
Cvaa 76,196,48,228
v_exp_f32 v41, v41
Mvaa 76,200,52
v_exp_f32 v37, v37
Mvaa 76,204,56
v_exp_f32 v42, v42
Mvaa 76,208,60
v_exp_f32 v38, v38
Maav 128,144,80
v_exp_f32 v43, v43
Maav 128,144,96
s_add_u32 m0, s38, 0x3000
La 188,4,33792
PK 122,40,41
Maav 132,144,84
buffer_load_dwordx4 v2, s[16:19], s32 offen sc1 lds
Maav 132,144,100
La 192,7,33792
PK 123,42,43
Maav 136,144,88
v_exp_f32 v39, v39
Maav 136,144,104
La 196,5,8192
PK 118,36,37
Maav 140,144,92
La 200,8,8192
PK 119,38,39
Maav 140,144,108
s_waitcnt lgkmcnt(10)
v_exp_f32 v48, v48
Mvav 144,148,80
v_exp_f32 v44, v44
Mvav 144,152,96
buffer_load_dwordx4 v2, s[16:19], s32 offen offset:1024 sc1 lds
Mvav 148,148,84
v_exp_f32 v49, v49
Mvav 148,152,100
v_exp_f32 v45, v45
Maav 64,148,88
v_exp_f32 v50, v50
Maav 64,152,104
v_exp_f32 v46, v46
Maav 68,148,92
v_exp_f32 v51, v51
Maav 68,152,108
La 204,5,9216
PK 128,48,49
Mvav 152,156,80
La 208,8,9216
PK 129,50,51
Mvav 152,160,96
buffer_load_dwordx4 v2, s[16:19], s32 offen offset:2048 sc1 lds
Mvav 156,156,84
v_exp_f32 v47, v47
Mvav 156,160,100
v_exp_f32 v56, v56
Maav 72,156,88
v_exp_f32 v57, v57
Maav 72,160,104
v_exp_f32 v58, v58
Maav 76,156,92
v_exp_f32 v59, v59
Maav 76,160,108
s_waitcnt lgkmcnt(8)
PK 126,44,45
PK 127,46,47
Mvav 160,164,80
v_exp_f32 v52, v52
Mvav 160,168,96
buffer_load_dwordx4 v2, s[16:19], s32 offen offset:3072 sc1 lds
Mvav 164,164,84
v_exp_f32 v53, v53
Mvav 164,168,100
v_exp_f32 v54, v54
Maav 80,164,88
v_exp_f32 v55, v55
Maav 80,168,104
PK 136,56,57
PK 132,52,53
Maav 84,164,92
PK 137,58,59
PK 133,54,55
Maav 84,168,108
v_exp_f32 v64, v64
Mvav 168,172,80
v_exp_f32 v60, v60
Mvav 168,176,96
s_add_u32 s32, s32, 0x2000
s_cmp_eq_u32 s32, s34
s_cselect_b32 s32, s28, s32
Mvav 172,172,84
v_exp_f32 v65, v65
Mvav 172,176,100
v_exp_f32 v61, v61
Maav 88,172,88
v_exp_f32 v66, v66
Maav 88,176,104
v_exp_f32 v62, v62
Maav 92,172,92
v_exp_f32 v67, v67
Maav 92,176,108
s_waitcnt vmcnt(17) lgkmcnt(0)
s_barrier
Mvav 176,180,80
La 148,3,0
PK 130,64,65
Mvav 176,184,96
s_add_u32 m0, s38, 0x4000
La 152,3,40960
PK 131,66,67
Mvav 180,180,84
buffer_load_dwordx4 v1, s[16:19], s53 offen sc1 lds
Mvav 180,184,100
v_exp_f32 v63, v63
Maav 96,180,88
La 156,4,16384
PK 140,60,61
Maav 96,184,104
La 160,4,57344
PK 141,62,63
Maav 100,180,92
v_exp_f32 v72, v72
Maav 100,184,108
v_exp_f32 v68, v68
Mvav 184,188,80
buffer_load_dwordx4 v1, s[16:19], s53 offen offset:1024 sc1 lds
Mvav 184,192,96
v_exp_f32 v73, v73
Mvav 188,188,84
v_exp_f32 v69, v69
Mvav 188,192,100
v_exp_f32 v74, v74
Maav 104,188,88
v_exp_f32 v70, v70
Maav 104,192,104
v_exp_f32 v75, v75
Maav 108,188,92
La 164,3,1024
PK 138,72,73
Maav 108,192,108
buffer_load_dwordx4 v1, s[16:19], s53 offen offset:2048 sc1 lds
Mvav 192,196,80
La 168,3,41984
PK 139,74,75
Mvav 192,200,96
v_exp_f32 v71, v71
Mvav 196,196,84
La 172,4,17408
PK 134,68,69
Mvav 196,200,100
La 176,4,58368
PK 135,70,71
Maav 112,196,88
Maav 112,200,104
Maav 116,196,92
buffer_load_dwordx4 v1, s[16:19], s53 offen offset:3072 sc1 lds
Maav 116,200,108
Mvav 200,204,80
Mvav 200,208,96
Mvav 204,204,84
Mvav 204,208,100
Maav 120,204,88
Maav 120,208,104
Maav 124,204,92
Maav 124,208,108
s_cmp_eq_u32 s40, 1
s_cbranch_scc1 M_dg1
s_waitcnt lgkmcnt(4)
v_exp_f32 v76, v76
Cvaa 16,148,0,232
v_exp_f32 v77, v77
Mvaa 16,152,4
s_add_u32 m0, s38, 0x5000
v_exp_f32 v78, v78
Mvaa 16,156,8
buffer_load_dwordx4 v2, s[16:19], s53 offen sc1 lds
Mvaa 16,160,12
v_exp_f32 v79, v79
Cvaa 20,148,16,220
La 180,6,0
PK 142,76,77
Mvaa 20,152,20
buffer_load_dword v212, v254, s[4:7], s57 offen
Mvaa 20,156,24
La 184,6,40960
PK 143,78,79
Mvaa 20,160,28
v_exp_f32 v16, v16
Cvaa 24,148,32,224
buffer_load_dwordx4 v2, s[16:19], s53 offen offset:1024 sc1 lds
Mvaa 24,152,36
v_exp_f32 v17, v17
Mvaa 24,156,40
v_exp_f32 v18, v18
Mvaa 24,160,44
v_exp_f32 v19, v19
Cvaa 28,148,48,228
La 188,7,16384
PK 80,16,17
Mvaa 28,152,52
La 192,7,57344
PK 81,18,19
Mvaa 28,156,56
v_exp_f32 v20, v20
Mvaa 28,160,60
s_waitcnt lgkmcnt(4)
buffer_load_dwordx4 v2, s[16:19], s53 offen offset:2048 sc1 lds
Cvaa 32,164,0,236
v_exp_f32 v21, v21
Mvaa 32,168,4
v_exp_f32 v22, v22
Mvaa 32,172,8
v_exp_f32 v23, v23
Mvaa 32,176,12
La 196,6,1024
PK 84,20,21
Cvaa 36,164,16,220
La 200,6,41984
PK 85,22,23
Mvaa 36,168,20
La 204,7,17408
Mvaa 36,172,24
La 208,7,58368
Mvaa 36,176,28
buffer_load_dwordx4 v2, s[16:19], s53 offen offset:3072 sc1 lds
Cvaa 40,164,32,224
v_exp_f32 v24, v24
Mvaa 40,168,36
v_exp_f32 v25, v25
Mvaa 40,172,40
v_exp_f32 v26, v26
Mvaa 40,176,44
v_exp_f32 v27, v27
Cvaa 44,164,48,228
v_exp_f32 v28, v28
Mvaa 44,168,52
v_exp_f32 v29, v29
Mvaa 44,172,56
s_add_u32 s57, s57, 0x380
v_exp_f32 v30, v30
Mvaa 44,176,60
s_waitcnt vmcnt(17) lgkmcnt(0)
s_barrier
Cvaa 60,180,48,240
La 148,3,32768
PK 88,24,25
Mvaa 60,184,52
s_add_u32 m0, s38, 0
La 152,6,32768
PK 89,26,27
Mvaa 60,188,56
buffer_load_dwordx4 v1, s[16:19], s32 offen sc1 lds
Mvaa 60,192,60
v_exp_f32 v31, v31
Cvaa 76,196,48,244
La 156,3,33792
PK 92,28,29
Mvaa 76,200,52
La 160,6,33792
PK 93,30,31
Mvaa 76,204,56
buffer_load_dwordx4 v1, s[16:19], s32 offen offset:1024 sc1 lds
Mvaa 76,208,60
v_exp_f32 v32, v32
Maav 128,144,112
v_exp_f32 v33, v33
Maav 128,144,128
global_load_dword v213, v[214:215], off
Maav 132,144,116
v_exp_f32 v34, v34
Maav 132,144,132
v_exp_f32 v35, v35
Maav 136,144,120
buffer_load_dwordx4 v1, s[16:19], s32 offen offset:2048 sc1 lds
Maav 136,144,136
La 164,4,8192
PK 82,32,33
Maav 140,144,124
La 168,7,8192
PK 83,34,35
Maav 140,144,140
s_waitcnt lgkmcnt(2)
v_exp_f32 v36, v36
Mvav 144,148,112
buffer_load_dwordx4 v1, s[16:19], s32 offen offset:3072 sc1 lds
Mvav 144,152,128
v_exp_f32 v37, v37
Mvav 148,148,116
v_exp_f32 v38, v38
Mvav 148,152,132
v_exp_f32 v39, v39
Maav 64,148,120
La 172,4,9216
PK 86,36,37
Maav 64,152,136
s_add_u32 m0, s38, 0x1000
La 176,7,9216
PK 87,38,39
Maav 68,148,124
buffer_load_dwordx4 v2, s[16:19], s32 offen sc1 lds
Maav 68,152,140
v_exp_f32 v40, v40
Mvav 152,156,112
v_exp_f32 v41, v41
Mvav 152,160,128
v_exp_f32 v42, v42
Mvav 156,156,116
buffer_load_dwordx4 v2, s[16:19], s32 offen offset:1024 sc1 lds
Mvav 156,160,132
v_exp_f32 v43, v43
Maav 72,156,120
La 180,4,49152
PK 90,40,41
Maav 72,160,136
La 184,7,49152
PK 91,42,43
Maav 76,156,124
v_exp_f32 v44, v44
Maav 76,160,140
s_waitcnt lgkmcnt(2)
buffer_load_dwordx4 v2, s[16:19], s32 offen offset:2048 sc1 lds
Mvav 160,164,112
v_exp_f32 v45, v45
Mvav 160,168,128
La 188,4,50176
Mvav 164,164,116
La 192,7,50176
Mvav 164,168,132
v_exp_f32 v46, v46
Maav 80,164,120
M_w13:
s_cbranch_execz M_w14
buffer_load_dwordx4 v2, s[16:19], s32 offen offset:3072 sc1 lds
Maav 80,168,136
La 196,5,24576
Maav 84,164,124
La 200,8,24576
Maav 84,168,140
La 204,5,25600
Mvav 168,172,112
La 208,8,25600
Mvav 168,176,128
s_add_u32 s32, s32, 0x2000
s_cmp_eq_u32 s32, s34
s_cselect_b32 s32, s28, s32
Mvav 172,172,116
v_exp_f32 v47, v47
Mvav 172,176,132
v_exp_f32 v60, v60
Maav 88,172,120
v_exp_f32 v61, v61
Maav 88,176,136
v_exp_f32 v62, v62
Maav 92,172,124
v_exp_f32 v63, v63
Maav 92,176,140
s_waitcnt vmcnt(18) lgkmcnt(0)
s_barrier
Mvav 176,180,112
La 148,3,8192
PK 94,44,45
Mvav 176,184,128
s_add_u32 m0, s38, 0x8000
La 152,3,49152
PK 95,46,47
Mvav 180,180,116
buffer_load_dwordx4 v1, s[16:19], s33 offen sc1 lds
Mvav 180,184,132
La 156,4,24576
PK 108,60,61
Maav 96,180,120
La 160,5,0
PK 109,62,63
Maav 96,184,136
v_exp_f32 v76, v76
Maav 100,180,124
v_exp_f32 v77, v77
Maav 100,184,140
v_exp_f32 v78, v78
Mvav 184,188,112
buffer_load_dwordx4 v1, s[16:19], s33 offen offset:1024 sc1 lds
Mvav 184,192,128
v_exp_f32 v79, v79
Mvav 188,188,116
La 164,3,9216
PK 110,76,77
Mvav 188,192,132
La 168,3,50176
PK 111,78,79
Maav 104,188,120
La 172,4,25600
Maav 104,192,136
La 176,5,1024
Maav 108,188,124
Maav 108,192,140
buffer_load_dwordx4 v1, s[16:19], s33 offen offset:2048 sc1 lds
Mvav 192,196,112
Mvav 192,200,128
Mvav 196,196,116
Mvav 196,200,132
Maav 112,196,120
Maav 112,200,136
Maav 116,196,124
buffer_load_dwordx4 v1, s[16:19], s33 offen offset:3072 sc1 lds
Maav 116,200,140
Mvav 200,204,112
Mvav 200,208,128
Mvav 204,204,116
Mvav 204,208,132
Maav 120,204,120
Maav 120,208,136
Maav 124,204,124
Maav 124,208,140
s_waitcnt lgkmcnt(4)
Cvaa 16,148,0,216
La 180,6,8192
Mvaa 16,152,4
s_add_u32 m0, s38, 0x9000
La 184,6,49152
Mvaa 16,156,8
buffer_load_dwordx4 v2, s[16:19], s33 offen sc1 lds
Mvaa 16,160,12
La 188,7,24576
Cvaa 20,148,16,220
La 192,8,0
Mvaa 20,152,20
buffer_load_dword v255, v254, s[8:11], s56 offen
Mvaa 20,156,24
La 196,6,9216
Mvaa 20,160,28
v_exp_f32 v16, v16
Cvaa 24,148,32,224
buffer_load_dwordx4 v2, s[16:19], s33 offen offset:1024 sc1 lds
Mvaa 24,152,36
v_exp_f32 v17, v17
Mvaa 24,156,40
v_exp_f32 v18, v18
Mvaa 24,160,44
v_exp_f32 v19, v19
Cvaa 28,148,48,228
La 200,6,50176
PK 112,16,17
Mvaa 28,152,52
La 204,7,25600
PK 113,18,19
Mvaa 28,156,56
v_exp_f32 v20, v20
Mvaa 28,160,60
s_waitcnt lgkmcnt(7)
buffer_load_dwordx4 v2, s[16:19], s33 offen offset:2048 sc1 lds
Cvaa 32,164,0,216
v_exp_f32 v24, v24
Mvaa 32,168,4
v_exp_f32 v21, v21
Mvaa 32,172,8
v_exp_f32 v25, v25
Mvaa 32,176,12
v_exp_f32 v22, v22
Cvaa 36,164,16,220
v_exp_f32 v26, v26
Mvaa 36,168,20
v_exp_f32 v23, v23
Mvaa 36,172,24
La 208,8,1024
PK 116,20,21
Mvaa 36,176,28
buffer_load_dwordx4 v2, s[16:19], s33 offen offset:3072 sc1 lds
Cvaa 40,164,32,224
v_exp_f32 v27, v27
Mvaa 40,168,36
PK 120,24,25
PK 117,22,23
Mvaa 40,172,40
v_exp_f32 v28, v28
Mvaa 40,176,44
v_exp_f32 v29, v29
Cvaa 44,164,48,228
v_exp_f32 v30, v30
Mvaa 44,168,52
s_add_u32 s33, s33, 0x2000
s_cmp_eq_u32 s33, s35
s_cselect_b32 s33, s29, s33
PK 121,26,27
Mvaa 44,172,56
s_add_u32 s56, s56, 0x300
v_exp_f32 v32, v32
Mvaa 44,176,60
s_waitcnt vmcnt(18) lgkmcnt(0)
s_barrier
Cvaa 48,180,0,216
v_exp_f32 v33, v33
Mvaa 48,184,4
s_cmp_ge_u32 s27, 2
s_cselect_b32 s36, s32, s31
s_add_u32 s32, s32, 0x2000
s_cmp_eq_u32 s32, s34
s_cselect_b32 s32, s28, s32
Mvaa 48,188,8
s_add_u32 m0, s38, 0x2000
v_exp_f32 v34, v34
Mvaa 48,192,12
buffer_load_dwordx4 v1, s[16:19], s36 offen sc1 lds
Cvaa 52,180,16,220
v_exp_f32 v31, v31
Mvaa 52,184,20
La 148,3,16384
PK 124,28,29
Mvaa 52,188,24
buffer_load_dwordx4 v1, s[16:19], s36 offen offset:1024 sc1 lds
Mvaa 52,192,28
La 152,6,16384
PK 125,30,31
Cvaa 56,180,32,224
v_exp_f32 v35, v35
Mvaa 56,184,36
La 156,3,17408
PK 114,32,33
Mvaa 56,188,40
La 160,6,17408
PK 115,34,35
Mvaa 56,192,44
buffer_load_dwordx4 v1, s[16:19], s36 offen offset:2048 sc1 lds
Cvaa 60,180,48,228
v_exp_f32 v36, v36
Mvaa 60,184,52
v_exp_f32 v40, v40
Mvaa 60,188,56
v_exp_f32 v37, v37
Mvaa 60,192,60
v_exp_f32 v41, v41
Cvaa 64,196,0,216
buffer_load_dwordx4 v1, s[16:19], s36 offen offset:3072 sc1 lds
Mvaa 64,200,4
v_exp_f32 v38, v38
Mvaa 64,204,8
v_exp_f32 v42, v42
Mvaa 64,208,12
v_exp_f32 v39, v39
Cvaa 68,196,16,220
La 164,3,57344
PK 118,36,37
Mvaa 68,200,20
s_add_u32 m0, s38, 0x3000
La 168,6,57344
PK 119,38,39
Mvaa 68,204,24
buffer_load_dwordx4 v2, s[16:19], s36 offen sc1 lds
Mvaa 68,208,28
v_exp_f32 v43, v43
Cvaa 72,196,32,224
La 172,3,58368
PK 122,40,41
Mvaa 72,200,36
La 176,6,58368
PK 123,42,43
Mvaa 72,204,40
buffer_load_dwordx4 v2, s[16:19], s36 offen offset:1024 sc1 lds
Mvaa 72,208,44
v_exp_f32 v44, v44
Cvaa 76,196,48,228
v_exp_f32 v48, v48
Mvaa 76,200,52
v_exp_f32 v45, v45
Mvaa 76,204,56
v_exp_f32 v49, v49
Mvaa 76,208,60
buffer_load_dwordx4 v2, s[16:19], s36 offen offset:2048 sc1 lds
Maav 128,144,80
v_exp_f32 v46, v46
Maav 132,144,84
v_exp_f32 v50, v50
Maav 136,144,88
v_exp_f32 v47, v47
Maav 140,144,92
La 180,4,32768
PK 126,44,45
Maav 140,144,108
s_waitcnt lgkmcnt(5)
buffer_load_dwordx4 v2, s[16:19], s36 offen offset:3072 sc1 lds
Mvav 144,148,80
La 184,7,32768
PK 127,46,47
Mvav 148,148,84
v_exp_f32 v51, v51
Maav 64,148,88
La 188,4,33792
PK 128,48,49
Maav 68,148,92
La 192,7,33792
PK 129,50,51
Maav 68,152,108
v_exp_f32 v52, v52
Mvav 152,156,80
v_exp_f32 v56, v56
Mvav 156,156,84
v_exp_f32 v53, v53
Maav 72,156,88
v_exp_f32 v57, v57
Maav 76,156,92
v_exp_f32 v54, v54
Maav 76,160,108
s_waitcnt lgkmcnt(4)
La 196,5,8192
Mvav 160,164,80
La 200,8,8192
Mvav 164,164,84
La 204,5,9216
Maav 80,164,88
La 208,8,9216
Maav 84,164,92
v_exp_f32 v58, v58
Maav 84,168,108
v_exp_f32 v55, v55
Mvav 168,172,80
v_exp_f32 v59, v59
Mvav 172,172,84
PK 132,52,53
PK 136,56,57
Maav 88,172,88
PK 133,54,55
PK 137,58,59
Maav 92,172,92
v_exp_f32 v60, v60
Maav 92,176,108
s_waitcnt vmcnt(17) lgkmcnt(0)
s_barrier
Mvav 176,180,80
s_sub_u32 s27, s27, 1
s_add_u32 m0, s38, 0x4000
La 148,3,0
Mvav 180,180,84
buffer_load_dwordx4 v1, s[16:19], s33 offen sc1 lds
Maav 96,180,88
v_exp_f32 v64, v64
Maav 100,180,92
v_exp_f32 v61, v61
Maav 100,184,108
buffer_load_dwordx4 v1, s[16:19], s33 offen offset:1024 sc1 lds
Mvav 184,188,80
v_exp_f32 v65, v65
Mvav 188,188,84
La 152,3,40960
Maav 104,188,88
La 156,4,16384
Maav 108,188,92
La 160,4,57344
Maav 108,192,108
buffer_load_dwordx4 v1, s[16:19], s33 offen offset:2048 sc1 lds
Mvav 192,196,80
v_exp_f32 v62, v62
Mvav 196,196,84
v_exp_f32 v66, v66
Maav 112,196,88
v_exp_f32 v63, v63
Maav 116,196,92
v_exp_f32 v67, v67
Maav 116,200,108
PK 140,60,61
PK 130,64,65
Mvav 200,204,80
PK 141,62,63
PK 131,66,67
Mvav 204,204,84
La 164,3,1024
Maav 120,204,88
La 168,3,41984
La 172,4,17408
La 176,4,58368
Maav 124,204,92
buffer_load_dwordx4 v1, s[16:19], s33 offen offset:3072 sc1 lds
v_exp_f32 v68, v68
v_exp_f32 v72, v72
v_exp_f32 v69, v69
v_exp_f32 v73, v73
v_exp_f32 v70, v70
v_exp_f32 v74, v74
v_exp_f32 v71, v71
v_exp_f32 v75, v75
PK 134,68,69
PK 138,72,73
PK 135,70,71
PK 139,74,75
Maav 124,208,108
s_cmp_eq_u32 s27, 0
s_cbranch_scc1 M_X1
s_branch M_H1
M_dg1:
M_w14:
s_cbranch_execz M_w15
s_waitcnt lgkmcnt(4)
v_exp_f32 v76, v76
Cvaa 16,148,0,216
v_exp_f32 v77, v77
Mvaa 16,152,4
s_add_u32 m0, s38, 0x5000
v_exp_f32 v78, v78
Mvaa 16,156,8
buffer_load_dwordx4 v2, s[16:19], s53 offen sc1 lds
Mvaa 16,160,12
La 180,6,0
Cvaa 20,148,16,220
La 184,6,40960
Mvaa 20,152,20
La 188,7,16384
Mvaa 20,156,24
La 192,7,57344
Mvaa 20,160,28
buffer_load_dwordx4 v2, s[16:19], s53 offen offset:1024 sc1 lds
Cvaa 28,148,48,240
v_exp_f32 v79, v79
Mvaa 28,152,52
La 196,6,1024
PK 142,76,77
Mvaa 28,156,56
buffer_load_dword v212, v254, s[4:7], s57 offen
Mvaa 28,160,60
s_waitcnt lgkmcnt(5)
La 200,6,41984
PK 143,78,79
Cvaa 32,164,0,216
v_exp_f32 v16, v16
Mvaa 32,168,4
La 204,7,17408
Mvaa 32,172,8
La 208,7,58368
Mvaa 32,176,12
buffer_load_dwordx4 v2, s[16:19], s53 offen offset:2048 sc1 lds
Cvaa 36,164,16,220
v_exp_f32 v17, v17
Mvaa 36,168,20
v_exp_f32 v18, v18
Mvaa 36,172,24
buffer_load_dwordx4 v2, s[16:19], s53 offen offset:3072 sc1 lds
Mvaa 36,176,28
v_exp_f32 v19, v19
Cvaa 44,164,48,244
v_exp_f32 v20, v20
Mvaa 44,168,52
v_exp_f32 v21, v21
Mvaa 44,172,56
v_exp_f32 v22, v22
Mvaa 44,176,60
s_waitcnt vmcnt(17) lgkmcnt(0)
s_barrier
Cvaa 48,180,0,232
La 148,3,32768
PK 80,16,17
Mvaa 48,184,4
La 152,6,32768
PK 81,18,19
Mvaa 48,188,8
v_exp_f32 v23, v23
Mvaa 48,192,12
La 156,3,33792
PK 84,20,21
Cvaa 52,180,16,220
La 160,6,33792
PK 85,22,23
Mvaa 52,184,20
v_exp_f32 v28, v28
Mvaa 52,188,24
s_add_u32 s57, s57, 0x380
s_add_u32 m0, s38, 0
La 164,4,8192
Mvaa 52,192,28
buffer_load_dwordx4 v1, s[16:19], s32 offen sc1 lds
Cvaa 64,196,0,236
v_exp_f32 v29, v29
Mvaa 64,200,4
v_exp_f32 v30, v30
Mvaa 64,204,8
v_exp_f32 v31, v31
Mvaa 64,208,12
buffer_load_dwordx4 v1, s[16:19], s32 offen offset:1024 sc1 lds
Cvaa 68,196,16,220
La 168,7,8192
PK 92,28,29
Mvaa 68,200,20
La 172,4,9216
PK 93,30,31
Mvaa 68,204,24
v_exp_f32 v32, v32
Mvaa 68,208,28
global_load_dword v213, v[214:215], off
Maav 128,144,112
v_exp_f32 v33, v33
Maav 128,144,128
v_exp_f32 v34, v34
Maav 132,144,116
buffer_load_dwordx4 v1, s[16:19], s32 offen offset:2048 sc1 lds
Maav 132,144,132
v_exp_f32 v35, v35
Maav 136,144,120
La 176,7,9216
PK 82,32,33
Maav 136,144,136
buffer_load_dwordx4 v1, s[16:19], s32 offen offset:3072 sc1 lds
Maav 140,144,124
La 180,4,49152
PK 83,34,35
Maav 140,144,140
s_waitcnt lgkmcnt(5)
v_exp_f32 v36, v36
Mvav 144,148,112
v_exp_f32 v37, v37
Mvav 144,152,128
v_exp_f32 v38, v38
Mvav 148,148,116
s_add_u32 m0, s38, 0x1000
v_exp_f32 v39, v39
Mvav 148,152,132
buffer_load_dwordx4 v2, s[16:19], s32 offen sc1 lds
Maav 64,148,120
La 184,7,49152
PK 86,36,37
Maav 64,152,136
La 188,4,50176
PK 87,38,39
Maav 68,148,124
v_exp_f32 v44, v44
Maav 68,152,140
buffer_load_dwordx4 v2, s[16:19], s32 offen offset:1024 sc1 lds
Mvav 152,156,112
v_exp_f32 v45, v45
Mvav 152,160,128
v_exp_f32 v46, v46
Mvav 156,156,116
v_exp_f32 v47, v47
Mvav 156,160,132
La 192,7,50176
PK 94,44,45
Maav 72,156,120
buffer_load_dwordx4 v2, s[16:19], s32 offen offset:2048 sc1 lds
Maav 72,160,136
La 196,5,24576
PK 95,46,47
Maav 76,156,124
v_exp_f32 v48, v48
Maav 76,160,140
s_waitcnt lgkmcnt(5)
v_exp_f32 v49, v49
Mvav 160,164,112
v_exp_f32 v50, v50
Mvav 160,168,128
buffer_load_dwordx4 v2, s[16:19], s32 offen offset:3072 sc1 lds
Mvav 164,164,116
v_exp_f32 v51, v51
Mvav 164,168,132
La 200,8,24576
PK 96,48,49
Maav 80,164,120
La 204,5,25600
PK 97,50,51
Maav 80,168,136
v_exp_f32 v52, v52
Maav 84,164,124
s_add_u32 s32, s32, 0x2000
s_cmp_eq_u32 s32, s34
s_cselect_b32 s32, s28, s32
La 208,8,25600
Maav 84,168,140
v_exp_f32 v53, v53
Mvav 168,172,112
v_exp_f32 v54, v54
Mvav 168,176,128
v_exp_f32 v55, v55
Mvav 172,172,116
v_exp_f32 v64, v64
Mvav 172,176,132
v_exp_f32 v65, v65
Maav 88,172,120
v_exp_f32 v66, v66
Maav 88,176,136
v_exp_f32 v67, v67
Maav 92,172,124
PK 100,52,53
PK 101,54,55
Maav 92,176,140
s_waitcnt vmcnt(18) lgkmcnt(0)
s_barrier
Mvav 176,180,112
La 148,3,8192
PK 98,64,65
Mvav 176,184,128
s_add_u32 m0, s38, 0x8000
La 152,3,49152
PK 99,66,67
Mvav 180,180,116
buffer_load_dwordx4 v1, s[16:19], s33 offen sc1 lds
Mvav 180,184,132
v_exp_f32 v68, v68
Maav 96,180,120
v_exp_f32 v69, v69
Maav 96,184,136
v_exp_f32 v70, v70
Maav 100,180,124
v_exp_f32 v71, v71
Maav 100,184,140
La 156,4,24576
PK 102,68,69
Mvav 184,188,112
buffer_load_dwordx4 v1, s[16:19], s33 offen offset:1024 sc1 lds
Mvav 184,192,128
La 160,5,0
PK 103,70,71
Mvav 188,188,116
La 164,3,9216
Mvav 188,192,132
La 168,3,50176
Maav 104,188,120
La 172,4,25600
Maav 104,192,136
La 176,5,1024
Maav 108,188,124
Maav 108,192,140
buffer_load_dwordx4 v1, s[16:19], s33 offen offset:2048 sc1 lds
Mvav 192,196,112
Mvav 192,200,128
Mvav 196,196,116
M_w15:
s_cbranch_execz M_wd
Mvav 196,200,132
Maav 112,196,120
Maav 112,200,136
Maav 116,196,124
buffer_load_dwordx4 v1, s[16:19], s33 offen offset:3072 sc1 lds
Maav 116,200,140
Mvav 200,204,112
Mvav 200,208,128
Mvav 204,204,116
Mvav 204,208,132
Maav 120,204,120
Maav 120,208,136
Maav 124,204,124
Maav 124,208,140
s_waitcnt lgkmcnt(4)
Cvaa 16,148,0,216
La 180,6,8192
Mvaa 16,152,4
s_add_u32 m0, s38, 0x9000
La 184,6,49152
Mvaa 16,156,8
buffer_load_dwordx4 v2, s[16:19], s33 offen sc1 lds
Mvaa 16,160,12
La 188,7,24576
Cvaa 20,148,16,220
La 192,8,0
Mvaa 20,152,20
buffer_load_dword v255, v254, s[8:11], s56 offen
Mvaa 20,156,24
La 196,6,9216
Mvaa 20,160,28
v_exp_f32 v16, v16
Cvaa 24,148,32,224
buffer_load_dwordx4 v2, s[16:19], s33 offen offset:1024 sc1 lds
Mvaa 24,152,36
v_exp_f32 v17, v17
Mvaa 24,156,40
v_exp_f32 v18, v18
Mvaa 24,160,44
v_exp_f32 v19, v19
Cvaa 28,148,48,228
La 200,6,50176
PK 112,16,17
Mvaa 28,152,52
La 204,7,25600
PK 113,18,19
Mvaa 28,156,56
v_exp_f32 v20, v20
Mvaa 28,160,60
s_waitcnt lgkmcnt(7)
buffer_load_dwordx4 v2, s[16:19], s33 offen offset:2048 sc1 lds
Cvaa 32,164,0,216
v_exp_f32 v24, v24
Mvaa 32,168,4
v_exp_f32 v21, v21
Mvaa 32,172,8
v_exp_f32 v25, v25
Mvaa 32,176,12
v_exp_f32 v22, v22
Cvaa 36,164,16,220
v_exp_f32 v26, v26
Mvaa 36,168,20
v_exp_f32 v23, v23
Mvaa 36,172,24
La 208,8,1024
PK 116,20,21
Mvaa 36,176,28
buffer_load_dwordx4 v2, s[16:19], s33 offen offset:3072 sc1 lds
Cvaa 40,164,32,224
v_exp_f32 v27, v27
Mvaa 40,168,36
PK 120,24,25
PK 117,22,23
Mvaa 40,172,40
v_exp_f32 v28, v28
Mvaa 40,176,44
v_exp_f32 v29, v29
Cvaa 44,164,48,228
v_exp_f32 v30, v30
Mvaa 44,168,52
s_add_u32 s33, s33, 0x2000
s_cmp_eq_u32 s33, s35
s_cselect_b32 s33, s29, s33
PK 121,26,27
Mvaa 44,172,56
s_add_u32 s56, s56, 0x300
v_exp_f32 v32, v32
Mvaa 44,176,60
s_waitcnt vmcnt(18) lgkmcnt(0)
s_barrier
Cvaa 48,180,0,216
v_exp_f32 v33, v33
Mvaa 48,184,4
s_cmp_ge_u32 s27, 2
s_cselect_b32 s36, s32, s31
s_add_u32 s32, s32, 0x2000
s_cmp_eq_u32 s32, s34
s_cselect_b32 s32, s28, s32
Mvaa 48,188,8
s_add_u32 m0, s38, 0x2000
v_exp_f32 v34, v34
Mvaa 48,192,12
buffer_load_dwordx4 v1, s[16:19], s36 offen sc1 lds
Cvaa 52,180,16,220
v_exp_f32 v31, v31
Mvaa 52,184,20
La 148,3,16384
PK 124,28,29
Mvaa 52,188,24
buffer_load_dwordx4 v1, s[16:19], s36 offen offset:1024 sc1 lds
Mvaa 52,192,28
La 152,6,16384
PK 125,30,31
Cvaa 56,180,32,224
v_exp_f32 v35, v35
Mvaa 56,184,36
La 156,3,17408
PK 114,32,33
Mvaa 56,188,40
La 160,6,17408
PK 115,34,35
Mvaa 56,192,44
buffer_load_dwordx4 v1, s[16:19], s36 offen offset:2048 sc1 lds
Cvaa 60,180,48,228
v_exp_f32 v36, v36
Mvaa 60,184,52
v_exp_f32 v40, v40
Mvaa 60,188,56
v_exp_f32 v37, v37
Mvaa 60,192,60
v_exp_f32 v41, v41
Cvaa 64,196,0,216
buffer_load_dwordx4 v1, s[16:19], s36 offen offset:3072 sc1 lds
Mvaa 64,200,4
v_exp_f32 v38, v38
Mvaa 64,204,8
v_exp_f32 v42, v42
Mvaa 64,208,12
v_exp_f32 v39, v39
Cvaa 68,196,16,220
La 164,3,57344
PK 118,36,37
Mvaa 68,200,20
s_add_u32 m0, s38, 0x3000
La 168,6,57344
PK 119,38,39
Mvaa 68,204,24
buffer_load_dwordx4 v2, s[16:19], s36 offen sc1 lds
Mvaa 68,208,28
v_exp_f32 v43, v43
Cvaa 72,196,32,224
La 172,3,58368
PK 122,40,41
Mvaa 72,200,36
La 176,6,58368
PK 123,42,43
Mvaa 72,204,40
buffer_load_dwordx4 v2, s[16:19], s36 offen offset:1024 sc1 lds
Mvaa 72,208,44
v_exp_f32 v44, v44
Cvaa 76,196,48,228
v_exp_f32 v48, v48
Mvaa 76,200,52
v_exp_f32 v45, v45
Mvaa 76,204,56
v_exp_f32 v49, v49
Mvaa 76,208,60
buffer_load_dwordx4 v2, s[16:19], s36 offen offset:2048 sc1 lds
Maav 128,144,80
v_exp_f32 v46, v46
Maav 128,144,96
v_exp_f32 v50, v50
Maav 132,144,84
v_exp_f32 v47, v47
Maav 132,144,100
La 180,4,32768
PK 126,44,45
Maav 140,144,92
s_waitcnt lgkmcnt(5)
buffer_load_dwordx4 v2, s[16:19], s36 offen offset:3072 sc1 lds
Mvav 144,148,80
La 184,7,32768
PK 127,46,47
Mvav 144,152,96
v_exp_f32 v51, v51
Mvav 148,148,84
La 188,4,33792
PK 128,48,49
Mvav 148,152,100
La 192,7,33792
PK 129,50,51
Maav 68,148,92
v_exp_f32 v52, v52
Mvav 152,156,80
v_exp_f32 v56, v56
Mvav 152,160,96
v_exp_f32 v53, v53
Mvav 156,156,84
v_exp_f32 v57, v57
Mvav 156,160,100
v_exp_f32 v54, v54
Maav 76,156,92
s_waitcnt lgkmcnt(4)
La 196,5,8192
Mvav 160,164,80
La 200,8,8192
Mvav 160,168,96
La 204,5,9216
Mvav 164,164,84
La 208,8,9216
Mvav 164,168,100
v_exp_f32 v58, v58
Maav 84,164,92
v_exp_f32 v55, v55
Mvav 168,172,80
v_exp_f32 v59, v59
Mvav 168,176,96
PK 132,52,53
PK 136,56,57
Mvav 172,172,84
PK 133,54,55
PK 137,58,59
Mvav 172,176,100
v_exp_f32 v60, v60
Maav 92,172,92
s_waitcnt vmcnt(17) lgkmcnt(0)
s_barrier
Mvav 176,180,80
s_sub_u32 s27, s27, 1
s_add_u32 m0, s38, 0x4000
La 148,3,0
Mvav 176,184,96
buffer_load_dwordx4 v1, s[16:19], s33 offen sc1 lds
Mvav 180,180,84
v_exp_f32 v64, v64
Mvav 180,184,100
v_exp_f32 v61, v61
Maav 100,180,92
buffer_load_dwordx4 v1, s[16:19], s33 offen offset:1024 sc1 lds
Mvav 184,188,80
v_exp_f32 v65, v65
Mvav 184,192,96
La 152,3,40960
Mvav 188,188,84
La 156,4,16384
Mvav 188,192,100
La 160,4,57344
Maav 108,188,92
buffer_load_dwordx4 v1, s[16:19], s33 offen offset:2048 sc1 lds
Mvav 192,196,80
v_exp_f32 v62, v62
Mvav 192,200,96
v_exp_f32 v66, v66
Mvav 196,196,84
v_exp_f32 v63, v63
Mvav 196,200,100
v_exp_f32 v67, v67
Maav 116,196,92
PK 140,60,61
PK 130,64,65
Mvav 200,204,80
PK 141,62,63
PK 131,66,67
Mvav 200,208,96
La 164,3,1024
Mvav 204,204,84
La 168,3,41984
La 172,4,17408
La 176,4,58368
Mvav 204,208,100
buffer_load_dwordx4 v1, s[16:19], s33 offen offset:3072 sc1 lds
v_exp_f32 v68, v68
v_exp_f32 v72, v72
v_exp_f32 v69, v69
v_exp_f32 v73, v73
v_exp_f32 v70, v70
v_exp_f32 v74, v74
v_exp_f32 v71, v71
v_exp_f32 v75, v75
PK 134,68,69
PK 138,72,73
PK 135,70,71
PK 139,74,75
Maav 124,204,92
s_cmp_eq_u32 s27, 0
s_cbranch_scc1 M_X1
s_branch M_H1
M_H1:
M_w16:
s_cbranch_execz M_w17
s_waitcnt lgkmcnt(4)
v_exp_f32 v76, v76
Cvaa 16,148,0,216
v_exp_f32 v77, v77
Mvaa 16,152,4
s_add_u32 m0, s38, 0x5000
v_exp_f32 v78, v78
Mvaa 16,156,8
buffer_load_dwordx4 v2, s[16:19], s33 offen sc1 lds
Mvaa 16,160,12
v_exp_f32 v79, v79
Cvaa 20,148,16,220
La 180,6,0
PK 142,76,77
Mvaa 20,152,20
buffer_load_dword v212, v254, s[4:7], s57 offen
Mvaa 20,156,24
La 184,6,40960
PK 143,78,79
Mvaa 20,160,28
v_exp_f32 v16, v16
Cvaa 24,148,32,224
buffer_load_dwordx4 v2, s[16:19], s33 offen offset:1024 sc1 lds
Mvaa 24,152,36
v_exp_f32 v17, v17
Mvaa 24,156,40
v_exp_f32 v18, v18
Mvaa 24,160,44
v_exp_f32 v19, v19
Cvaa 28,148,48,228
La 188,7,16384
PK 80,16,17
Mvaa 28,152,52
La 192,7,57344
PK 81,18,19
Mvaa 28,156,56
v_exp_f32 v20, v20
Mvaa 28,160,60
s_waitcnt lgkmcnt(4)
buffer_load_dwordx4 v2, s[16:19], s33 offen offset:2048 sc1 lds
Cvaa 32,164,0,216
v_exp_f32 v24, v24
Mvaa 32,168,4
v_exp_f32 v21, v21
Mvaa 32,172,8
v_exp_f32 v25, v25
Mvaa 32,176,12
La 196,6,1024
Cvaa 36,164,16,220
La 200,6,41984
Mvaa 36,168,20
La 204,7,17408
Mvaa 36,172,24
La 208,7,58368
Mvaa 36,176,28
buffer_load_dwordx4 v2, s[16:19], s33 offen offset:3072 sc1 lds
Cvaa 40,164,32,224
v_exp_f32 v22, v22
Mvaa 40,168,36
v_exp_f32 v26, v26
Mvaa 40,172,40
v_exp_f32 v23, v23
Mvaa 40,176,44
v_exp_f32 v27, v27
Cvaa 44,164,48,228
PK 84,20,21
PK 88,24,25
Mvaa 44,168,52
s_add_u32 s33, s33, 0x2000
s_cmp_eq_u32 s33, s35
s_cselect_b32 s33, s29, s33
PK 85,22,23
Mvaa 44,172,56
s_add_u32 s57, s57, 0x380
v_exp_f32 v28, v28
Mvaa 44,176,60
s_waitcnt vmcnt(17) lgkmcnt(0)
s_barrier
Cvaa 48,180,0,216
La 148,3,32768
PK 89,26,27
Mvaa 48,184,4
s_cmp_ge_u32 s27, 2
s_cselect_b32 s36, s32, s30
s_add_u32 s32, s32, 0x2000
s_cmp_eq_u32 s32, s34
s_cselect_b32 s32, s28, s32
Mvaa 48,188,8
s_add_u32 m0, s38, 0
v_exp_f32 v32, v32
Mvaa 48,192,12
buffer_load_dwordx4 v1, s[16:19], s36 offen sc1 lds
Cvaa 52,180,16,220
v_exp_f32 v29, v29
Mvaa 52,184,20
v_exp_f32 v33, v33
Mvaa 52,188,24
v_exp_f32 v30, v30
Mvaa 52,192,28
global_load_dword v213, v[214:215], off
Cvaa 56,180,32,224
v_exp_f32 v34, v34
Mvaa 56,184,36
v_exp_f32 v31, v31
Mvaa 56,188,40
buffer_load_dwordx4 v1, s[16:19], s36 offen offset:1024 sc1 lds
Mvaa 56,192,44
La 152,6,32768
PK 92,28,29
Cvaa 60,180,48,228
La 156,3,33792
PK 93,30,31
Mvaa 60,184,52
v_exp_f32 v35, v35
Mvaa 60,188,56
La 160,6,33792
PK 82,32,33
Mvaa 60,192,60
La 164,4,8192
PK 83,34,35
Cvaa 64,196,0,216
v_exp_f32 v36, v36
Mvaa 64,200,4
buffer_load_dwordx4 v1, s[16:19], s36 offen offset:2048 sc1 lds
Mvaa 64,204,8
v_exp_f32 v40, v40
Mvaa 64,208,12
v_exp_f32 v37, v37
Cvaa 68,196,16,220
v_exp_f32 v41, v41
Mvaa 68,200,20
v_exp_f32 v38, v38
Mvaa 68,204,24
v_exp_f32 v42, v42
Mvaa 68,208,28
v_exp_f32 v39, v39
Cvaa 72,196,32,224
La 168,7,8192
PK 86,36,37
Mvaa 72,200,36
buffer_load_dwordx4 v1, s[16:19], s36 offen offset:3072 sc1 lds
Mvaa 72,204,40
La 172,4,9216
PK 87,38,39
Mvaa 72,208,44
v_exp_f32 v43, v43
Cvaa 76,196,48,228
La 176,7,9216
PK 90,40,41
Mvaa 76,200,52
La 180,4,49152
PK 91,42,43
Mvaa 76,204,56
v_exp_f32 v44, v44
Mvaa 76,208,60
v_exp_f32 v48, v48
Maav 128,144,112
v_exp_f32 v45, v45
Maav 128,144,128
s_add_u32 m0, s38, 0x1000
v_exp_f32 v49, v49
Maav 132,144,116
buffer_load_dwordx4 v2, s[16:19], s36 offen sc1 lds
Maav 132,144,132
v_exp_f32 v46, v46
Maav 136,144,120
v_exp_f32 v50, v50
Maav 136,144,136
v_exp_f32 v47, v47
Maav 140,144,124
La 184,7,49152
PK 94,44,45
Maav 140,144,140
s_waitcnt lgkmcnt(6)
La 188,4,50176
PK 95,46,47
Mvav 144,148,112
v_exp_f32 v51, v51
Mvav 144,152,128
buffer_load_dwordx4 v2, s[16:19], s36 offen offset:1024 sc1 lds
Mvav 148,148,116
La 192,7,50176
PK 96,48,49
Mvav 148,152,132
La 196,5,24576
PK 97,50,51
Maav 64,148,120
v_exp_f32 v52, v52
Maav 64,152,136
v_exp_f32 v56, v56
Maav 68,148,124
v_exp_f32 v53, v53
Maav 68,152,140
v_exp_f32 v57, v57
Mvav 152,156,112
v_exp_f32 v54, v54
Mvav 152,160,128
buffer_load_dwordx4 v2, s[16:19], s36 offen offset:2048 sc1 lds
Mvav 156,156,116
v_exp_f32 v58, v58
Mvav 156,160,132
v_exp_f32 v55, v55
Maav 72,156,120
La 200,8,24576
PK 100,52,53
Maav 72,160,136
La 204,5,25600
PK 101,54,55
Maav 76,156,124
v_exp_f32 v59, v59
Maav 76,160,140
s_waitcnt lgkmcnt(7)
La 208,8,25600
PK 104,56,57
Mvav 160,164,112
v_exp_f32 v60, v60
Mvav 160,168,128
buffer_load_dwordx4 v2, s[16:19], s36 offen offset:3072 sc1 lds
Mvav 164,164,116
v_exp_f32 v61, v61
Mvav 164,168,132
v_exp_f32 v62, v62
Maav 80,164,120
v_exp_f32 v63, v63
Maav 80,168,136
PK 105,58,59
PK 108,60,61
Maav 84,164,124
v_exp_f32 v64, v64
Maav 84,168,140
v_exp_f32 v65, v65
Mvav 168,172,112
v_exp_f32 v66, v66
Mvav 168,176,128
v_exp_f32 v67, v67
Mvav 172,172,116
PK 98,64,65
PK 109,62,63
Mvav 172,176,132
v_exp_f32 v68, v68
Maav 88,172,120
v_exp_f32 v69, v69
Maav 88,176,136
v_exp_f32 v70, v70
Maav 92,172,124
v_exp_f32 v71, v71
Maav 92,176,140
s_waitcnt vmcnt(18) lgkmcnt(0)
s_barrier
Mvav 176,180,112
La 148,3,8192
PK 99,66,67
Mvav 176,184,128
s_sub_u32 s27, s27, 1
s_add_u32 m0, s38, 0x8000
La 152,3,49152
Mvav 180,180,116
buffer_load_dwordx4 v1, s[16:19], s33 offen sc1 lds
Mvav 180,184,132
La 156,4,24576
PK 102,68,69
Maav 96,180,120
La 160,5,0
PK 103,70,71
Maav 96,184,136
v_exp_f32 v72, v72
Maav 100,180,124
v_exp_f32 v73, v73
Maav 100,184,140
v_exp_f32 v74, v74
Mvav 184,188,112
buffer_load_dwordx4 v1, s[16:19], s33 offen offset:1024 sc1 lds
Mvav 184,192,128
v_exp_f32 v75, v75
Mvav 188,188,116
La 164,3,9216
PK 106,72,73
Mvav 188,192,132
La 168,3,50176
PK 107,74,75
Maav 104,188,120
La 172,4,25600
Maav 104,192,136
La 176,5,1024
Maav 108,188,124
Maav 108,192,140
buffer_load_dwordx4 v1, s[16:19], s33 offen offset:2048 sc1 lds
Mvav 192,196,112
Mvav 192,200,128
Mvav 196,196,116
Mvav 196,200,132
Maav 112,196,120
Maav 112,200,136
Maav 116,196,124
buffer_load_dwordx4 v1, s[16:19], s33 offen offset:3072 sc1 lds
Maav 116,200,140
Mvav 200,204,112
Mvav 200,208,128
Mvav 204,204,116
Mvav 204,208,132
Maav 120,204,120
Maav 120,208,136
Maav 124,204,124
M_w17:
s_cbranch_execz M_wd
Maav 124,208,140
s_cmp_eq_u32 s27, 0
s_cbranch_scc1 M_X0
M_H0:
s_waitcnt lgkmcnt(4)
v_exp_f32 v76, v76
Cvaa 16,148,0,216
v_exp_f32 v77, v77
Mvaa 16,152,4
s_add_u32 m0, s38, 0x9000
v_exp_f32 v78, v78
Mvaa 16,156,8
buffer_load_dwordx4 v2, s[16:19], s33 offen sc1 lds
Mvaa 16,160,12
v_exp_f32 v79, v79
Cvaa 20,148,16,220
La 180,6,8192
PK 110,76,77
Mvaa 20,152,20
buffer_load_dword v255, v254, s[8:11], s56 offen
Mvaa 20,156,24
La 184,6,49152
PK 111,78,79
Mvaa 20,160,28
v_exp_f32 v16, v16
Cvaa 24,148,32,224
buffer_load_dwordx4 v2, s[16:19], s33 offen offset:1024 sc1 lds
Mvaa 24,152,36
v_exp_f32 v17, v17
Mvaa 24,156,40
v_exp_f32 v18, v18
Mvaa 24,160,44
v_exp_f32 v19, v19
Cvaa 28,148,48,228
La 188,7,24576
PK 112,16,17
Mvaa 28,152,52
La 192,8,0
PK 113,18,19
Mvaa 28,156,56
v_exp_f32 v20, v20
Mvaa 28,160,60
s_waitcnt lgkmcnt(4)
buffer_load_dwordx4 v2, s[16:19], s33 offen offset:2048 sc1 lds
Cvaa 32,164,0,216
v_exp_f32 v24, v24
Mvaa 32,168,4
v_exp_f32 v21, v21
Mvaa 32,172,8
v_exp_f32 v25, v25
Mvaa 32,176,12
La 196,6,9216
Cvaa 36,164,16,220
La 200,6,50176
Mvaa 36,168,20
La 204,7,25600
Mvaa 36,172,24
La 208,8,1024
Mvaa 36,176,28
buffer_load_dwordx4 v2, s[16:19], s33 offen offset:3072 sc1 lds
Cvaa 40,164,32,224
v_exp_f32 v22, v22
Mvaa 40,168,36
v_exp_f32 v26, v26
Mvaa 40,172,40
v_exp_f32 v23, v23
Mvaa 40,176,44
v_exp_f32 v27, v27
Cvaa 44,164,48,228
PK 116,20,21
PK 120,24,25
Mvaa 44,168,52
s_add_u32 s33, s33, 0x2000
s_cmp_eq_u32 s33, s35
s_cselect_b32 s33, s29, s33
PK 117,22,23
Mvaa 44,172,56
s_add_u32 s56, s56, 0x300
v_exp_f32 v28, v28
Mvaa 44,176,60
s_waitcnt vmcnt(18) lgkmcnt(0)
s_barrier
Cvaa 48,180,0,216
La 148,3,16384
PK 121,26,27
Mvaa 48,184,4
s_cmp_ge_u32 s27, 2
s_cselect_b32 s36, s32, s31
s_add_u32 s32, s32, 0x2000
s_cmp_eq_u32 s32, s34
s_cselect_b32 s32, s28, s32
Mvaa 48,188,8
s_add_u32 m0, s38, 0x2000
v_exp_f32 v32, v32
Mvaa 48,192,12
buffer_load_dwordx4 v1, s[16:19], s36 offen sc1 lds
Cvaa 52,180,16,220
v_exp_f32 v29, v29
Mvaa 52,184,20
v_exp_f32 v33, v33
Mvaa 52,188,24
v_exp_f32 v30, v30
Mvaa 52,192,28
v_exp_f32 v34, v34
Cvaa 56,180,32,224
v_exp_f32 v31, v31
Mvaa 56,184,36
buffer_load_dwordx4 v1, s[16:19], s36 offen offset:1024 sc1 lds
Mvaa 56,188,40
La 152,6,16384
PK 124,28,29
Mvaa 56,192,44
La 156,3,17408
PK 125,30,31
Cvaa 60,180,48,228
v_exp_f32 v35, v35
Mvaa 60,184,52
La 160,6,17408
PK 114,32,33
Mvaa 60,188,56
La 164,3,57344
PK 115,34,35
Mvaa 60,192,60
v_exp_f32 v36, v36
Cvaa 64,196,0,216
v_exp_f32 v40, v40
Mvaa 64,200,4
buffer_load_dwordx4 v1, s[16:19], s36 offen offset:2048 sc1 lds
Mvaa 64,204,8
v_exp_f32 v37, v37
Mvaa 64,208,12
v_exp_f32 v41, v41
Cvaa 68,196,16,220
v_exp_f32 v38, v38
Mvaa 68,200,20
v_exp_f32 v42, v42
Mvaa 68,204,24
v_exp_f32 v39, v39
Mvaa 68,208,28
La 168,6,57344
PK 118,36,37
Cvaa 72,196,32,224
La 172,3,58368
PK 119,38,39
Mvaa 72,200,36
buffer_load_dwordx4 v1, s[16:19], s36 offen offset:3072 sc1 lds
Mvaa 72,204,40
v_exp_f32 v43, v43
Mvaa 72,208,44
La 176,6,58368
PK 122,40,41
Cvaa 76,196,48,228
La 180,4,32768
PK 123,42,43
Mvaa 76,200,52
v_exp_f32 v44, v44
Mvaa 76,204,56
v_exp_f32 v48, v48
Mvaa 76,208,60
v_exp_f32 v45, v45
Maav 128,144,80
v_exp_f32 v49, v49
Maav 128,144,96
s_add_u32 m0, s38, 0x3000
v_exp_f32 v46, v46
Maav 132,144,84
buffer_load_dwordx4 v2, s[16:19], s36 offen sc1 lds
Maav 132,144,100
v_exp_f32 v50, v50
Maav 136,144,88
v_exp_f32 v47, v47
Maav 136,144,104
La 184,7,32768
PK 126,44,45
Maav 140,144,92
La 188,4,33792
PK 127,46,47
Maav 140,144,108
s_waitcnt lgkmcnt(7)
v_exp_f32 v51, v51
Mvav 144,148,80
La 192,7,33792
PK 128,48,49
Mvav 144,152,96
buffer_load_dwordx4 v2, s[16:19], s36 offen offset:1024 sc1 lds
Mvav 148,148,84
La 196,5,8192
PK 129,50,51
Mvav 148,152,100
v_exp_f32 v52, v52
Maav 64,148,88
v_exp_f32 v56, v56
Maav 64,152,104
v_exp_f32 v53, v53
Maav 68,148,92
v_exp_f32 v57, v57
Maav 68,152,108
v_exp_f32 v54, v54
Mvav 152,156,80
v_exp_f32 v58, v58
Mvav 152,160,96
buffer_load_dwordx4 v2, s[16:19], s36 offen offset:2048 sc1 lds
Mvav 156,156,84
v_exp_f32 v55, v55
Mvav 156,160,100
La 200,8,8192
PK 132,52,53
Maav 72,156,88
La 204,5,9216
PK 133,54,55
Maav 72,160,104
v_exp_f32 v59, v59
Maav 76,156,92
La 208,8,9216
PK 136,56,57
Maav 76,160,108
s_waitcnt lgkmcnt(8)
v_exp_f32 v60, v60
Mvav 160,164,80
v_exp_f32 v61, v61
Mvav 160,168,96
buffer_load_dwordx4 v2, s[16:19], s36 offen offset:3072 sc1 lds
Mvav 164,164,84
v_exp_f32 v62, v62
Mvav 164,168,100
v_exp_f32 v63, v63
Maav 80,164,88
PK 137,58,59
PK 140,60,61
Maav 80,168,104
v_exp_f32 v64, v64
Maav 84,164,92
v_exp_f32 v65, v65
Maav 84,168,108
v_exp_f32 v66, v66
Mvav 168,172,80
v_exp_f32 v67, v67
Mvav 168,176,96
PK 130,64,65
PK 141,62,63
Mvav 172,172,84
v_exp_f32 v68, v68
Mvav 172,176,100
v_exp_f32 v69, v69
Maav 88,172,88
v_exp_f32 v70, v70
Maav 88,176,104
v_exp_f32 v71, v71
Maav 92,172,92
PK 131,66,67
PK 134,68,69
Maav 92,176,108
s_waitcnt vmcnt(17) lgkmcnt(0)
s_barrier
Mvav 176,180,80
La 148,3,0
PK 135,70,71
Mvav 176,184,96
s_sub_u32 s27, s27, 1
s_add_u32 m0, s38, 0x4000
La 152,3,40960
Mvav 180,180,84
buffer_load_dwordx4 v1, s[16:19], s33 offen sc1 lds
Mvav 180,184,100
v_exp_f32 v72, v72
Maav 96,180,88
v_exp_f32 v73, v73
Maav 96,184,104
v_exp_f32 v74, v74
Maav 100,180,92
v_exp_f32 v75, v75
Maav 100,184,108
La 156,4,16384
PK 138,72,73
Mvav 184,188,80
buffer_load_dwordx4 v1, s[16:19], s33 offen offset:1024 sc1 lds
Mvav 184,192,96
La 160,4,57344
PK 139,74,75
Mvav 188,188,84
La 164,3,1024
Mvav 188,192,100
La 168,3,41984
Maav 104,188,88
La 172,4,17408
Maav 104,192,104
La 176,4,58368
Maav 108,188,92
Maav 108,192,108
buffer_load_dwordx4 v1, s[16:19], s33 offen offset:2048 sc1 lds
Mvav 192,196,80
Mvav 192,200,96
Mvav 196,196,84
Mvav 196,200,100
Maav 112,196,88
Maav 112,200,104
Maav 116,196,92
buffer_load_dwordx4 v1, s[16:19], s33 offen offset:3072 sc1 lds
Maav 116,200,108
Mvav 200,204,80
Mvav 200,208,96
Mvav 204,204,84
Mvav 204,208,100
Maav 120,204,88
Maav 120,208,104
Maav 124,204,92
Maav 124,208,108
s_cmp_eq_u32 s27, 0
s_cbranch_scc1 M_X1
s_branch M_H1
M_X1:
s_cmp_eq_u32 s51, 1
s_cbranch_scc1 M_XL1
s_branch M_X1b
M_X0:
s_cmp_eq_u32 s51, 1
s_cbranch_scc1 M_XL0
M_X0b:
s_waitcnt lgkmcnt(4)
v_exp_f32 v76, v76
Cvaa 16,148,0,216
v_exp_f32 v77, v77
Mvaa 16,152,4
s_add_u32 m0, s38, 0x9000
v_exp_f32 v78, v78
Mvaa 16,156,8
buffer_load_dwordx4 v2, s[16:19], s33 offen sc1 lds
Mvaa 16,160,12
v_exp_f32 v79, v79
Cvaa 20,148,16,220
La 180,6,8192
PK 110,76,77
Mvaa 20,152,20
La 184,6,49152
PK 111,78,79
Mvaa 20,156,24
La 188,7,24576
Mvaa 20,160,28
v_exp_f32 v16, v16
Cvaa 24,148,32,224
buffer_load_dwordx4 v2, s[16:19], s33 offen offset:1024 sc1 lds
Mvaa 24,152,36
v_exp_f32 v17, v17
Mvaa 24,156,40
v_exp_f32 v18, v18
Mvaa 24,160,44
v_exp_f32 v20, v20
Cvaa 28,148,48,228
v_exp_f32 v21, v21
Mvaa 28,152,52
v_exp_f32 v19, v19
Mvaa 28,156,56
La 192,8,0
PK 112,16,17
Mvaa 28,160,60
s_waitcnt lgkmcnt(4)
buffer_load_dwordx4 v2, s[16:19], s33 offen offset:2048 sc1 lds
Cvaa 32,164,0,216
La 196,6,9216
PK 113,18,19
Mvaa 32,168,4
v_exp_f32 v22, v22
Mvaa 32,172,8
v_exp_f32 v23, v23
Mvaa 32,176,12
La 200,6,50176
PK 116,20,21
Cvaa 36,164,16,220
La 204,7,25600
PK 117,22,23
Mvaa 36,168,20
v_exp_f32 v24, v24
Mvaa 36,172,24
La 208,8,1024
Mvaa 36,176,28
buffer_load_dwordx4 v2, s[16:19], s33 offen offset:3072 sc1 lds
Cvaa 40,164,32,224
v_exp_f32 v25, v25
Mvaa 40,168,36
v_exp_f32 v28, v28
Mvaa 40,172,40
v_exp_f32 v26, v26
Mvaa 40,176,44
v_exp_f32 v29, v29
Cvaa 44,164,48,228
v_exp_f32 v27, v27
Mvaa 44,168,52
v_exp_f32 v30, v30
Mvaa 44,172,56
v_exp_f32 v31, v31
Mvaa 44,176,60
s_waitcnt vmcnt(17) lgkmcnt(0)
s_barrier
Cvaa 48,180,0,216
La 148,3,16384
PK 120,24,25
Mvaa 48,184,4
s_add_u32 m0, s38, 0x2000
La 152,6,16384
PK 121,26,27
Mvaa 48,188,8
buffer_load_dwordx4 v1, s[16:19], s31 offen sc1 lds
Mvaa 48,192,12
La 156,3,17408
PK 124,28,29
Cvaa 52,180,16,220
La 160,6,17408
PK 125,30,31
Mvaa 52,184,20
buffer_load_dwordx4 v1, s[16:19], s31 offen offset:1024 sc1 lds
Mvaa 52,188,24
v_exp_f32 v32, v32
Mvaa 52,192,28
v_exp_f32 v33, v33
Cvaa 56,180,32,224
v_exp_f32 v36, v36
Mvaa 56,184,36
buffer_load_dwordx4 v1, s[16:19], s31 offen offset:2048 sc1 lds
Mvaa 56,188,40
v_exp_f32 v34, v34
Mvaa 56,192,44
v_exp_f32 v37, v37
Cvaa 60,180,48,228
v_exp_f32 v35, v35
Mvaa 60,184,52
buffer_load_dwordx4 v1, s[16:19], s31 offen offset:3072 sc1 lds
Mvaa 60,188,56
La 164,3,57344
PK 114,32,33
Mvaa 60,192,60
La 168,6,57344
PK 115,34,35
Cvaa 64,196,0,216
v_exp_f32 v38, v38
Mvaa 64,200,4
s_add_u32 m0, s38, 0x3000
v_exp_f32 v39, v39
Mvaa 64,204,8
buffer_load_dwordx4 v2, s[16:19], s31 offen sc1 lds
Mvaa 64,208,12
La 172,3,58368
PK 118,36,37
Cvaa 68,196,16,220
La 176,6,58368
PK 119,38,39
Mvaa 68,200,20
buffer_load_dwordx4 v2, s[16:19], s31 offen offset:1024 sc1 lds
Mvaa 68,204,24
v_exp_f32 v40, v40
Mvaa 68,208,28
v_exp_f32 v41, v41
Cvaa 72,196,32,224
v_exp_f32 v44, v44
Mvaa 72,200,36
buffer_load_dwordx4 v2, s[16:19], s31 offen offset:2048 sc1 lds
Mvaa 72,204,40
v_exp_f32 v42, v42
Mvaa 72,208,44
v_exp_f32 v45, v45
Cvaa 76,196,48,228
v_exp_f32 v43, v43
Mvaa 76,200,52
buffer_load_dwordx4 v2, s[16:19], s31 offen offset:3072 sc1 lds
Mvaa 76,204,56
La 180,4,32768
PK 122,40,41
Mvaa 76,208,60
La 184,7,32768
PK 123,42,43
Maav 128,144,80
v_exp_f32 v46, v46
Maav 128,144,96
s_add_u32 s55, s45, 0
v_exp_f32 v47, v47
Maav 132,144,84
buffer_load_dwordx4 a[0:3], v1, s[16:19], s55 offen sc1
Maav 132,144,100
La 188,4,33792
PK 126,44,45
Maav 136,144,88
La 192,7,33792
PK 127,46,47
Maav 136,144,104
s_add_u32 s55, s45, 0x20000
v_exp_f32 v56, v56
Maav 140,144,92
buffer_load_dwordx4 a[4:7], v1, s[16:19], s55 offen sc1
Maav 140,144,108
s_waitcnt lgkmcnt(8)
v_exp_f32 v57, v57
Mvav 144,148,80
v_exp_f32 v60, v60
Mvav 144,152,96
s_add_u32 s55, s45, 0x40000
v_exp_f32 v58, v58
Mvav 148,148,84
buffer_load_dwordx4 a[8:11], v1, s[16:19], s55 offen sc1
Mvav 148,152,100
v_exp_f32 v61, v61
Maav 64,148,88
v_exp_f32 v59, v59
Maav 64,152,104
s_add_u32 s55, s45, 0x60000
La 196,5,8192
PK 136,56,57
Maav 68,148,92
buffer_load_dwordx4 a[12:15], v1, s[16:19], s55 offen sc1
Maav 68,152,108
La 200,8,8192
PK 137,58,59
Mvav 152,156,80
v_exp_f32 v62, v62
Mvav 152,160,96
s_add_u32 s55, s46, 0
v_exp_f32 v63, v63
Mvav 156,156,84
buffer_load_dwordx4 a[16:19], v1, s[16:19], s55 offen sc1
Mvav 156,160,100
La 204,5,9216
PK 140,60,61
Maav 72,156,88
La 208,8,9216
PK 141,62,63
Maav 72,160,104
s_add_u32 s55, s46, 0x20000
v_exp_f32 v72, v72
Maav 76,156,92
buffer_load_dwordx4 a[20:23], v1, s[16:19], s55 offen sc1
Maav 76,160,108
s_waitcnt lgkmcnt(8)
v_exp_f32 v73, v73
Mvav 160,164,80
v_exp_f32 v76, v76
Mvav 160,168,96
s_add_u32 s55, s46, 0x40000
v_exp_f32 v74, v74
Mvav 164,164,84
buffer_load_dwordx4 a[24:27], v1, s[16:19], s55 offen sc1
Mvav 164,168,100
v_exp_f32 v77, v77
Maav 80,164,88
v_exp_f32 v75, v75
Maav 80,168,104
s_add_u32 s55, s46, 0x60000
v_exp_f32 v78, v78
Maav 84,164,92
buffer_load_dwordx4 a[28:31], v1, s[16:19], s55 offen sc1
Maav 84,168,108
v_exp_f32 v79, v79
Mvav 168,172,80
PK 138,72,73
PK 139,74,75
Mvav 168,176,96
s_add_u32 s55, s47, 0
v_exp_f32 v48, v48
Mvav 172,172,84
buffer_load_dwordx4 a[32:35], v1, s[16:19], s55 offen sc1
Mvav 172,176,100
v_exp_f32 v49, v49
Maav 88,172,88
v_exp_f32 v50, v50
Maav 88,176,104
s_add_u32 s55, s47, 0x20000
v_exp_f32 v51, v51
Maav 92,172,92
buffer_load_dwordx4 a[36:39], v1, s[16:19], s55 offen sc1
Maav 92,176,108
s_waitcnt vmcnt(18) lgkmcnt(0)
s_barrier
Mvav 176,180,80
La 148,3,32768
PK 142,76,77
Mvav 176,184,96
s_add_u32 s55, s47, 0x40000
La 152,6,32768
PK 143,78,79
Mvav 180,180,84
buffer_load_dwordx4 a[40:43], v1, s[16:19], s55 offen sc1
Mvav 180,184,100
s_andn2_b32 s73, 1, s2
s_add_u32 s73, s73, 3
La 156,3,33792
Maav 96,180,88
La 160,6,33792
v_min_u32 v0, s73, v15
Maav 96,184,104
s_add_u32 s55, s47, 0x60000
La 164,4,8192
v_lshlrev_b32 v0, 7, v0
Maav 100,180,92
buffer_load_dwordx4 a[44:47], v1, s[16:19], s55 offen sc1
Maav 100,184,108
La 168,7,8192
PK 128,48,49
Mvav 184,188,80
La 172,4,9216
PK 129,50,51
Mvav 184,192,96
buffer_load_dword v213, v0, s[16:19], s72 offen sc1
Mvav 188,188,84
s_add_u32 s55, s48, 0
v_exp_f32 v52, v52
Mvav 188,192,100
v_exp_f32 v53, v53
Maav 104,188,88
buffer_load_dwordx4 a[48:51], v1, s[16:19], s55 offen sc1
Maav 104,192,104
s_add_u32 s55, s48, 0x20000
v_exp_f32 v54, v54
Maav 108,188,92
v_exp_f32 v55, v55
Maav 108,192,108
buffer_load_dwordx4 a[52:55], v1, s[16:19], s55 offen sc1
Mvav 192,196,80
La 176,7,9216
PK 132,52,53
Mvav 192,200,96
s_add_u32 s55, s48, 0x40000
La 180,4,49152
PK 133,54,55
Mvav 196,196,84
buffer_load_dwordx4 a[56:59], v1, s[16:19], s55 offen sc1
Mvav 196,200,100
v_exp_f32 v64, v64
Maav 112,196,88
v_exp_f32 v65, v65
Maav 112,200,104
s_add_u32 s55, s48, 0x60000
v_exp_f32 v68, v68
Maav 116,196,92
buffer_load_dwordx4 a[60:63], v1, s[16:19], s55 offen sc1
Maav 116,200,108
v_exp_f32 v66, v66
Mvav 200,204,80
v_exp_f32 v69, v69
Mvav 200,208,96
s_sub_u32 s27, s26, 1
s_add_u32 s32, s28, 0x2000
s_mov_b32 s33, s29
Mvav 204,204,84
s_mov_b32 s30, 0x10000000
s_mov_b32 s31, 0x10000000
s_mov_b32 s51, 1
Mvav 204,208,100
v_exp_f32 v67, v67
Maav 120,204,88
La 184,7,49152
PK 130,64,65
Maav 120,208,104
La 188,4,50176
PK 131,66,67
Maav 124,204,92
La 192,7,50176
Maav 124,208,108
v_exp_f32 v70, v70
Maav 136,144,120
La 196,5,24576
Maav 136,144,136
La 200,8,24576
Maav 140,144,124
La 204,5,25600
Maav 140,144,140
s_waitcnt lgkmcnt(11)
La 208,8,25600
Maav 64,148,120
v_exp_f32 v71, v71
Maav 64,152,136
PK 134,68,69
PK 135,70,71
Maav 68,148,124
Maav 68,152,140
Maav 72,156,120
Maav 72,160,136
Maav 76,156,124
Maav 76,160,140
s_waitcnt lgkmcnt(0)
s_barrier
Maav 80,164,120
ds_write_b32 v9, a136 offset:23552
Maav 80,168,136
ds_write_b32 v9, a140 offset:23556
Maav 84,164,124
ds_write_b128 v9, a[64:67] offset:24576
Maav 84,168,140
s_nop 0
v_accvgpr_write_b32 a64, 0
v_accvgpr_write_b32 a65, 0
Maav 88,172,120
ds_write_b128 v9, a[68:71] offset:25600
Maav 88,176,136
v_accvgpr_write_b32 a66, 0
v_accvgpr_write_b32 a67, 0
Maav 92,172,124
v_accvgpr_write_b32 a136, 0
v_accvgpr_write_b32 a137, 0
Maav 92,176,140
ds_write_b128 v9, a[72:75] offset:26624
Maav 96,180,120
v_accvgpr_write_b32 a138, 0
v_accvgpr_write_b32 a139, 0
Maav 96,184,136
ds_write_b128 v9, a[76:79] offset:27648
Maav 100,180,124
v_accvgpr_write_b32 a72, 0
v_accvgpr_write_b32 a73, 0
Maav 100,184,140
v_accvgpr_write_b32 a74, 0
v_accvgpr_write_b32 a75, 0
Maav 104,188,120
ds_write_b128 v9, a[80:83] offset:28672
Maav 104,192,136
s_nop 0
v_accvgpr_write_b32 a80, 0
v_accvgpr_write_b32 a81, 0
Maav 108,188,124
ds_write_b128 v9, a[84:87] offset:29696
Maav 108,192,140
v_accvgpr_write_b32 a82, 0
v_accvgpr_write_b32 a83, 0
Maav 112,196,120
Maav 112,200,136
ds_write_b128 v9, a[88:91] offset:30720
Maav 116,196,124
s_nop 0
v_accvgpr_write_b32 a88, 0
v_accvgpr_write_b32 a89, 0
Maav 116,200,140
ds_write_b128 v9, a[92:95] offset:31744
Maav 120,204,120
v_accvgpr_write_b32 a90, 0
v_accvgpr_write_b32 a91, 0
Maav 120,208,136
Maav 124,204,124
ds_write_b128 v9, a[96:99] offset:32768
Maav 124,208,140
s_nop 0
v_accvgpr_write_b32 a96, 0
v_accvgpr_write_b32 a97, 0
Maav 128,144,112
ds_write_b128 v9, a[100:103] offset:33792
Maav 128,144,128
v_accvgpr_write_b32 a98, 0
v_accvgpr_write_b32 a99, 0
Maav 132,144,116
Maav 132,144,132
ds_write_b128 v9, a[104:107] offset:34816
Mvav 144,148,112
s_nop 0
v_accvgpr_write_b32 a104, 0
v_accvgpr_write_b32 a105, 0
Mvav 144,152,128
ds_write_b128 v9, a[108:111] offset:35840
Mvav 148,148,116
v_accvgpr_write_b32 a106, 0
v_accvgpr_write_b32 a107, 0
Mvav 148,152,132
v_accvgpr_read_b32 v82, a128
v_accvgpr_read_b32 v83, a132
Mvav 152,156,112
ds_write_b128 v9, a[112:115] offset:36864
Mvav 152,160,128
s_nop 0
v_accvgpr_write_b32 a112, 0
v_accvgpr_write_b32 a113, 0
Mvav 156,156,116
ds_write_b128 v9, a[116:119] offset:37888
Mvav 156,160,132
v_accvgpr_write_b32 a114, 0
v_accvgpr_write_b32 a115, 0
Mvav 160,164,112
Mvav 160,168,128
ds_write_b128 v9, a[120:123] offset:38912
Mvav 164,164,116
s_nop 0
v_accvgpr_write_b32 a120, 0
v_accvgpr_write_b32 a121, 0
Mvav 164,168,132
ds_write_b128 v9, a[124:127] offset:39936
Mvav 168,172,112
v_accvgpr_write_b32 a122, 0
v_accvgpr_write_b32 a123, 0
Mvav 168,176,128
Mvav 172,172,116
Mvav 172,176,132
s_waitcnt vmcnt(33) lgkmcnt(0)
s_barrier
Mvav 176,180,112
ds_read_b64 v[80:81], v10 offset:23552
Mvav 176,184,128
Lv 16,10,24576
Mvav 180,180,116
Lv 20,10,25600
Mvav 180,184,132
Lv 24,10,26624
Mvav 184,188,112
Lv 28,10,27648
Mvav 184,192,128
s_waitcnt vmcnt(63) lgkmcnt(4)
Lv 32,10,28672
v_add_f32 v80, v80, v82
Mvav 188,188,116
Lv 36,10,29696
v_add_f32 v81, v81, v83
Mvav 188,192,132
Lv 40,10,30720
Mvav 192,196,112
Lv 44,10,31744
Mvav 192,200,128
Lv 48,10,32768
Mvav 196,196,116
Lv 52,10,33792
Mvav 196,200,132
Lv 56,10,34816
Mvav 200,204,112
Lv 60,10,35840
Mvav 200,208,128
Lv 64,10,36864
Mvav 204,204,116
Lv 68,10,37888
Mvav 204,208,132
Lv 72,10,38912
Lv 76,10,39936
v_rcp_f32 v84, v80
v_rcp_f32 v86, v81
v_min_f32 v90, v80, v81
v_max_f32 v91, v80, v81
v_mul_f32 v84, v84, v11
v_mul_f32 v86, v86, v12
v_mov_b32 v85, v84
v_mov_b32 v87, v86
La 148,3,0
La 152,3,40960
La 156,4,16384
La 160,4,57344
La 164,3,1024
La 168,3,41984
v_cmp_gt_f32 vcc, 0x2b800000, v90
s_nop 0
s_or_b32 s49, s49, vcc_lo
s_or_b32 s49, s49, vcc_hi
v_cmp_lt_f32 vcc, 0x5f800000, v91
s_nop 0
s_or_b32 s49, s49, vcc_lo
s_or_b32 s49, s49, vcc_hi
s_waitcnt lgkmcnt(15)
s_add_u32 m0, s38, 0x4000
s_nop 0
buffer_load_dwordx4 v1, s[16:19], s54 offen sc1 lds
buffer_load_dwordx4 v1, s[16:19], s54 offen offset:1024 sc1 lds
v_pk_add_f32 v[144:145], v[144:145], v[16:17]
v_pk_add_f32 v[146:147], v[146:147], v[18:19]
v_pk_add_f32 v[148:149], v[148:149], v[20:21]
v_pk_add_f32 v[150:151], v[150:151], v[22:23]
v_pk_mul_f32 v[144:145], v[144:145], v[84:85]
v_pk_mul_f32 v[146:147], v[146:147], v[84:85]
v_pk_mul_f32 v[148:149], v[148:149], v[86:87]
v_pk_mul_f32 v[150:151], v[150:151], v[86:87]
v_pk_fma_f32 v[80:81], v[144:145], v[146:147], v[80:81]
v_pk_fma_f32 v[80:81], v[148:149], v[150:151], v[80:81]
s_waitcnt lgkmcnt(15)
buffer_load_dwordx4 v1, s[16:19], s54 offen offset:2048 sc1 lds
buffer_load_dwordx4 v1, s[16:19], s54 offen offset:3072 sc1 lds
v_pk_add_f32 v[152:153], v[152:153], v[24:25]
v_pk_add_f32 v[154:155], v[154:155], v[26:27]
v_pk_add_f32 v[156:157], v[156:157], v[28:29]
v_pk_add_f32 v[158:159], v[158:159], v[30:31]
v_pk_mul_f32 v[152:153], v[152:153], v[84:85]
v_pk_mul_f32 v[154:155], v[154:155], v[84:85]
v_pk_mul_f32 v[156:157], v[156:157], v[86:87]
v_pk_mul_f32 v[158:159], v[158:159], v[86:87]
v_pk_fma_f32 v[80:81], v[152:153], v[154:155], v[80:81]
v_pk_fma_f32 v[80:81], v[156:157], v[158:159], v[80:81]
s_waitcnt lgkmcnt(15)
s_add_u32 m0, s38, 0x5000
s_nop 0
buffer_load_dwordx4 v2, s[16:19], s54 offen sc1 lds
buffer_load_dwordx4 v2, s[16:19], s54 offen offset:1024 sc1 lds
v_pk_add_f32 v[160:161], v[160:161], v[32:33]
v_pk_add_f32 v[162:163], v[162:163], v[34:35]
v_pk_add_f32 v[164:165], v[164:165], v[36:37]
v_pk_add_f32 v[166:167], v[166:167], v[38:39]
v_pk_mul_f32 v[160:161], v[160:161], v[84:85]
v_pk_mul_f32 v[162:163], v[162:163], v[84:85]
v_pk_mul_f32 v[164:165], v[164:165], v[86:87]
v_pk_mul_f32 v[166:167], v[166:167], v[86:87]
v_pk_fma_f32 v[80:81], v[160:161], v[162:163], v[80:81]
v_pk_fma_f32 v[80:81], v[164:165], v[166:167], v[80:81]
s_waitcnt lgkmcnt(14)
La 172,4,17408
La 176,4,58368
La 180,6,0
La 184,6,40960
La 188,7,16384
La 192,7,57344
buffer_load_dwordx4 v2, s[16:19], s54 offen offset:2048 sc1 lds
buffer_load_dwordx4 v2, s[16:19], s54 offen offset:3072 sc1 lds
v_pk_add_f32 v[168:169], v[168:169], v[40:41]
v_pk_add_f32 v[170:171], v[170:171], v[42:43]
v_pk_add_f32 v[172:173], v[172:173], v[44:45]
v_pk_add_f32 v[174:175], v[174:175], v[46:47]
v_pk_mul_f32 v[168:169], v[168:169], v[84:85]
v_pk_mul_f32 v[170:171], v[170:171], v[84:85]
v_pk_mul_f32 v[172:173], v[172:173], v[86:87]
v_pk_mul_f32 v[174:175], v[174:175], v[86:87]
v_pk_fma_f32 v[80:81], v[168:169], v[170:171], v[80:81]
v_pk_fma_f32 v[80:81], v[172:173], v[174:175], v[80:81]
s_waitcnt lgkmcnt(15)
v_pk_add_f32 v[176:177], v[176:177], v[48:49]
v_pk_add_f32 v[178:179], v[178:179], v[50:51]
v_pk_add_f32 v[180:181], v[180:181], v[52:53]
v_pk_add_f32 v[182:183], v[182:183], v[54:55]
v_pk_mul_f32 v[176:177], v[176:177], v[84:85]
v_pk_mul_f32 v[178:179], v[178:179], v[84:85]
v_pk_mul_f32 v[180:181], v[180:181], v[86:87]
v_pk_mul_f32 v[182:183], v[182:183], v[86:87]
v_pk_fma_f32 v[80:81], v[176:177], v[178:179], v[80:81]
v_pk_fma_f32 v[80:81], v[180:181], v[182:183], v[80:81]
s_waitcnt lgkmcnt(15)
v_pk_add_f32 v[184:185], v[184:185], v[56:57]
v_pk_add_f32 v[186:187], v[186:187], v[58:59]
v_pk_add_f32 v[188:189], v[188:189], v[60:61]
v_pk_add_f32 v[190:191], v[190:191], v[62:63]
v_pk_mul_f32 v[184:185], v[184:185], v[84:85]
v_pk_mul_f32 v[186:187], v[186:187], v[84:85]
v_pk_mul_f32 v[188:189], v[188:189], v[86:87]
v_pk_mul_f32 v[190:191], v[190:191], v[86:87]
v_pk_fma_f32 v[80:81], v[184:185], v[186:187], v[80:81]
v_pk_fma_f32 v[80:81], v[188:189], v[190:191], v[80:81]
s_waitcnt lgkmcnt(14)
v_pk_add_f32 v[192:193], v[192:193], v[64:65]
v_pk_add_f32 v[194:195], v[194:195], v[66:67]
v_pk_add_f32 v[196:197], v[196:197], v[68:69]
v_pk_add_f32 v[198:199], v[198:199], v[70:71]
v_pk_mul_f32 v[192:193], v[192:193], v[84:85]
v_pk_mul_f32 v[194:195], v[194:195], v[84:85]
v_pk_mul_f32 v[196:197], v[196:197], v[86:87]
v_pk_mul_f32 v[198:199], v[198:199], v[86:87]
v_pk_fma_f32 v[80:81], v[192:193], v[194:195], v[80:81]
v_pk_fma_f32 v[80:81], v[196:197], v[198:199], v[80:81]
s_waitcnt lgkmcnt(12)
v_pk_add_f32 v[200:201], v[200:201], v[72:73]
v_pk_add_f32 v[202:203], v[202:203], v[74:75]
v_pk_add_f32 v[204:205], v[204:205], v[76:77]
v_pk_add_f32 v[206:207], v[206:207], v[78:79]
v_pk_mul_f32 v[200:201], v[200:201], v[84:85]
v_pk_mul_f32 v[202:203], v[202:203], v[84:85]
v_pk_mul_f32 v[204:205], v[204:205], v[86:87]
v_pk_mul_f32 v[206:207], v[206:207], v[86:87]
v_pk_fma_f32 v[80:81], v[200:201], v[202:203], v[80:81]
v_pk_fma_f32 v[80:81], v[204:205], v[206:207], v[80:81]
v_add_f32 v80, v80, v81
s_movk_i32 s37, 0x207
v_cmp_class_f32 vcc, v80, s37
s_nop 0
s_or_b32 s49, s49, vcc_lo
s_or_b32 s49, s49, vcc_hi
s_branch M_I2
M_X1b:
s_waitcnt lgkmcnt(4)
v_exp_f32 v76, v76
Cvaa 16,148,0,216
v_exp_f32 v77, v77
Mvaa 16,152,4
s_add_u32 m0, s38, 0x5000
v_exp_f32 v78, v78
Mvaa 16,156,8
buffer_load_dwordx4 v2, s[16:19], s33 offen sc1 lds
Mvaa 16,160,12
v_exp_f32 v79, v79
Cvaa 20,148,16,220
La 180,6,0
PK 142,76,77
Mvaa 20,152,20
La 184,6,40960
PK 143,78,79
Mvaa 20,156,24
La 188,7,16384
Mvaa 20,160,28
v_exp_f32 v16, v16
Cvaa 24,148,32,224
buffer_load_dwordx4 v2, s[16:19], s33 offen offset:1024 sc1 lds
Mvaa 24,152,36
v_exp_f32 v17, v17
Mvaa 24,156,40
v_exp_f32 v18, v18
Mvaa 24,160,44
v_exp_f32 v20, v20
Cvaa 28,148,48,228
v_exp_f32 v21, v21
Mvaa 28,152,52
v_exp_f32 v19, v19
Mvaa 28,156,56
La 192,7,57344
PK 80,16,17
Mvaa 28,160,60
s_waitcnt lgkmcnt(4)
buffer_load_dwordx4 v2, s[16:19], s33 offen offset:2048 sc1 lds
Cvaa 32,164,0,216
La 196,6,1024
PK 81,18,19
Mvaa 32,168,4
v_exp_f32 v22, v22
Mvaa 32,172,8
v_exp_f32 v23, v23
Mvaa 32,176,12
La 200,6,41984
PK 84,20,21
Cvaa 36,164,16,220
La 204,7,17408
PK 85,22,23
Mvaa 36,168,20
v_exp_f32 v24, v24
Mvaa 36,172,24
La 208,7,58368
Mvaa 36,176,28
buffer_load_dwordx4 v2, s[16:19], s33 offen offset:3072 sc1 lds
Cvaa 40,164,32,224
v_exp_f32 v25, v25
Mvaa 40,168,36
v_exp_f32 v28, v28
Mvaa 40,172,40
v_exp_f32 v26, v26
Mvaa 40,176,44
v_exp_f32 v29, v29
Cvaa 44,164,48,228
v_exp_f32 v27, v27
Mvaa 44,168,52
v_exp_f32 v30, v30
Mvaa 44,172,56
v_exp_f32 v31, v31
Mvaa 44,176,60
s_waitcnt vmcnt(16) lgkmcnt(0)
s_barrier
Cvaa 48,180,0,216
La 148,3,32768
PK 88,24,25
Mvaa 48,184,4
s_add_u32 m0, s38, 0
La 152,6,32768
PK 89,26,27
Mvaa 48,188,8
buffer_load_dwordx4 v1, s[16:19], s30 offen sc1 lds
Mvaa 48,192,12
La 156,3,33792
PK 92,28,29
Cvaa 52,180,16,220
La 160,6,33792
PK 93,30,31
Mvaa 52,184,20
buffer_load_dwordx4 v1, s[16:19], s30 offen offset:1024 sc1 lds
Mvaa 52,188,24
v_exp_f32 v32, v32
Mvaa 52,192,28
v_exp_f32 v33, v33
Cvaa 56,180,32,224
v_exp_f32 v36, v36
Mvaa 56,184,36
buffer_load_dwordx4 v1, s[16:19], s30 offen offset:2048 sc1 lds
Mvaa 56,188,40
v_exp_f32 v34, v34
Mvaa 56,192,44
v_exp_f32 v37, v37
Cvaa 60,180,48,228
v_exp_f32 v35, v35
Mvaa 60,184,52
buffer_load_dwordx4 v1, s[16:19], s30 offen offset:3072 sc1 lds
Mvaa 60,188,56
La 164,4,8192
PK 82,32,33
Mvaa 60,192,60
La 168,7,8192
PK 83,34,35
Cvaa 64,196,0,216
v_exp_f32 v38, v38
Mvaa 64,200,4
s_add_u32 m0, s38, 0x1000
v_exp_f32 v39, v39
Mvaa 64,204,8
buffer_load_dwordx4 v2, s[16:19], s30 offen sc1 lds
Mvaa 64,208,12
La 172,4,9216
PK 86,36,37
Cvaa 68,196,16,220
La 176,7,9216
PK 87,38,39
Mvaa 68,200,20
buffer_load_dwordx4 v2, s[16:19], s30 offen offset:1024 sc1 lds
Mvaa 68,204,24
v_exp_f32 v40, v40
Mvaa 68,208,28
v_exp_f32 v41, v41
Cvaa 72,196,32,224
v_exp_f32 v44, v44
Mvaa 72,200,36
buffer_load_dwordx4 v2, s[16:19], s30 offen offset:2048 sc1 lds
Mvaa 72,204,40
v_exp_f32 v42, v42
Mvaa 72,208,44
v_exp_f32 v45, v45
Cvaa 76,196,48,228
v_exp_f32 v43, v43
Mvaa 76,200,52
buffer_load_dwordx4 v2, s[16:19], s30 offen offset:3072 sc1 lds
Mvaa 76,204,56
La 180,4,49152
PK 90,40,41
Mvaa 76,208,60
La 184,7,49152
PK 91,42,43
Maav 128,144,112
v_exp_f32 v46, v46
Maav 128,144,128
s_add_u32 s55, s45, 0
v_exp_f32 v47, v47
Maav 132,144,116
buffer_load_dwordx4 a[0:3], v1, s[16:19], s55 offen sc1
Maav 132,144,132
La 188,4,50176
PK 94,44,45
Maav 136,144,120
La 192,7,50176
PK 95,46,47
Maav 136,144,136
s_add_u32 s55, s45, 0x20000
v_exp_f32 v56, v56
Maav 140,144,124
buffer_load_dwordx4 a[4:7], v1, s[16:19], s55 offen sc1
Maav 140,144,140
s_waitcnt lgkmcnt(8)
v_exp_f32 v57, v57
Mvav 144,148,112
v_exp_f32 v60, v60
Mvav 144,152,128
s_add_u32 s55, s45, 0x40000
v_exp_f32 v58, v58
Mvav 148,148,116
buffer_load_dwordx4 a[8:11], v1, s[16:19], s55 offen sc1
Mvav 148,152,132
v_exp_f32 v61, v61
Maav 64,148,120
v_exp_f32 v59, v59
Maav 64,152,136
s_add_u32 s55, s45, 0x60000
La 196,5,24576
PK 104,56,57
Maav 68,148,124
buffer_load_dwordx4 a[12:15], v1, s[16:19], s55 offen sc1
Maav 68,152,140
La 200,8,24576
PK 105,58,59
Mvav 152,156,112
v_exp_f32 v62, v62
Mvav 152,160,128
s_add_u32 s55, s46, 0
v_exp_f32 v63, v63
Mvav 156,156,116
buffer_load_dwordx4 a[16:19], v1, s[16:19], s55 offen sc1
Mvav 156,160,132
La 204,5,25600
PK 108,60,61
Maav 72,156,120
La 208,8,25600
PK 109,62,63
Maav 72,160,136
s_add_u32 s55, s46, 0x20000
v_exp_f32 v72, v72
Maav 76,156,124
buffer_load_dwordx4 a[20:23], v1, s[16:19], s55 offen sc1
Maav 76,160,140
s_waitcnt lgkmcnt(8)
v_exp_f32 v73, v73
Mvav 160,164,112
v_exp_f32 v76, v76
Mvav 160,168,128
s_add_u32 s55, s46, 0x40000
v_exp_f32 v74, v74
Mvav 164,164,116
buffer_load_dwordx4 a[24:27], v1, s[16:19], s55 offen sc1
Mvav 164,168,132
v_exp_f32 v77, v77
Maav 80,164,120
v_exp_f32 v75, v75
Maav 80,168,136
s_add_u32 s55, s46, 0x60000
v_exp_f32 v78, v78
Maav 84,164,124
buffer_load_dwordx4 a[28:31], v1, s[16:19], s55 offen sc1
Maav 84,168,140
v_exp_f32 v79, v79
Mvav 168,172,112
PK 106,72,73
PK 107,74,75
Mvav 168,176,128
s_add_u32 s55, s47, 0
v_exp_f32 v48, v48
Mvav 172,172,116
buffer_load_dwordx4 a[32:35], v1, s[16:19], s55 offen sc1
Mvav 172,176,132
v_exp_f32 v49, v49
Maav 88,172,120
v_exp_f32 v50, v50
Maav 88,176,136
s_add_u32 s55, s47, 0x20000
v_exp_f32 v51, v51
Maav 92,172,124
buffer_load_dwordx4 a[36:39], v1, s[16:19], s55 offen sc1
Maav 92,176,140
s_waitcnt vmcnt(18) lgkmcnt(0)
s_barrier
Mvav 176,180,112
La 148,3,16384
PK 110,76,77
Mvav 176,184,128
s_add_u32 s55, s47, 0x40000
La 152,6,16384
PK 111,78,79
Mvav 180,180,116
buffer_load_dwordx4 a[40:43], v1, s[16:19], s55 offen sc1
Mvav 180,184,132
s_andn2_b32 s73, 1, s2
s_add_u32 s73, s73, 3
La 156,3,17408
Maav 96,180,120
La 160,6,17408
v_min_u32 v0, s73, v15
Maav 96,184,136
s_add_u32 s55, s47, 0x60000
La 164,3,57344
v_lshlrev_b32 v0, 7, v0
Maav 100,180,124
buffer_load_dwordx4 a[44:47], v1, s[16:19], s55 offen sc1
Maav 100,184,140
La 168,6,57344
PK 96,48,49
Mvav 184,188,112
La 172,3,58368
PK 97,50,51
Mvav 184,192,128
buffer_load_dword v213, v0, s[16:19], s72 offen sc1
Mvav 188,188,116
s_add_u32 s55, s48, 0
v_exp_f32 v52, v52
Mvav 188,192,132
v_exp_f32 v53, v53
Maav 104,188,120
buffer_load_dwordx4 a[48:51], v1, s[16:19], s55 offen sc1
Maav 104,192,136
s_add_u32 s55, s48, 0x20000
v_exp_f32 v54, v54
Maav 108,188,124
v_exp_f32 v55, v55
Maav 108,192,140
buffer_load_dwordx4 a[52:55], v1, s[16:19], s55 offen sc1
Mvav 192,196,112
La 176,6,58368
PK 100,52,53
Mvav 192,200,128
s_add_u32 s55, s48, 0x40000
La 180,4,32768
PK 101,54,55
Mvav 196,196,116
buffer_load_dwordx4 a[56:59], v1, s[16:19], s55 offen sc1
Mvav 196,200,132
v_exp_f32 v64, v64
Maav 112,196,120
v_exp_f32 v65, v65
Maav 112,200,136
s_add_u32 s55, s48, 0x60000
v_exp_f32 v68, v68
Maav 116,196,124
buffer_load_dwordx4 a[60:63], v1, s[16:19], s55 offen sc1
Maav 116,200,140
v_exp_f32 v66, v66
Mvav 200,204,112
v_exp_f32 v69, v69
Mvav 200,208,128
s_sub_u32 s27, s26, 1
s_add_u32 s32, s28, 0x2000
s_mov_b32 s33, s29
Mvav 204,204,116
s_mov_b32 s30, 0x10000000
s_mov_b32 s31, 0x10000000
s_mov_b32 s51, 1
Mvav 204,208,132
v_exp_f32 v67, v67
Maav 120,204,120
La 184,7,32768
PK 98,64,65
Maav 120,208,136
La 188,4,33792
PK 99,66,67
Maav 124,204,124
La 192,7,33792
Maav 124,208,140
v_exp_f32 v70, v70
Maav 136,144,88
La 196,5,8192
Maav 136,144,104
La 200,8,8192
Maav 140,144,92
La 204,5,9216
Maav 140,144,108
s_waitcnt lgkmcnt(11)
La 208,8,9216
Maav 64,148,88
v_exp_f32 v71, v71
Maav 64,152,104
PK 102,68,69
PK 103,70,71
Maav 68,148,92
Maav 68,152,108
Maav 72,156,88
Maav 72,160,104
Maav 76,156,92
Maav 76,160,108
s_waitcnt lgkmcnt(0)
s_barrier
Maav 80,164,88
ds_write_b32 v9, a136 offset:23552
Maav 80,168,104
ds_write_b32 v9, a140 offset:23556
Maav 84,164,92
ds_write_b128 v9, a[64:67] offset:24576
Maav 84,168,108
s_nop 0
v_accvgpr_write_b32 a64, 0
v_accvgpr_write_b32 a65, 0
Maav 88,172,88
ds_write_b128 v9, a[68:71] offset:25600
Maav 88,176,104
v_accvgpr_write_b32 a66, 0
v_accvgpr_write_b32 a67, 0
Maav 92,172,92
v_accvgpr_write_b32 a136, 0
v_accvgpr_write_b32 a137, 0
Maav 92,176,108
ds_write_b128 v9, a[72:75] offset:26624
Maav 96,180,88
v_accvgpr_write_b32 a138, 0
v_accvgpr_write_b32 a139, 0
Maav 96,184,104
ds_write_b128 v9, a[76:79] offset:27648
Maav 100,180,92
v_accvgpr_write_b32 a72, 0
v_accvgpr_write_b32 a73, 0
Maav 100,184,108
v_accvgpr_write_b32 a74, 0
v_accvgpr_write_b32 a75, 0
Maav 104,188,88
ds_write_b128 v9, a[80:83] offset:28672
Maav 104,192,104
s_nop 0
v_accvgpr_write_b32 a80, 0
v_accvgpr_write_b32 a81, 0
Maav 108,188,92
ds_write_b128 v9, a[84:87] offset:29696
Maav 108,192,108
v_accvgpr_write_b32 a82, 0
v_accvgpr_write_b32 a83, 0
Maav 112,196,88
Maav 112,200,104
ds_write_b128 v9, a[88:91] offset:30720
Maav 116,196,92
s_nop 0
v_accvgpr_write_b32 a88, 0
v_accvgpr_write_b32 a89, 0
Maav 116,200,108
ds_write_b128 v9, a[92:95] offset:31744
Maav 120,204,88
v_accvgpr_write_b32 a90, 0
v_accvgpr_write_b32 a91, 0
Maav 120,208,104
Maav 124,204,92
ds_write_b128 v9, a[96:99] offset:32768
Maav 124,208,108
s_nop 0
v_accvgpr_write_b32 a96, 0
v_accvgpr_write_b32 a97, 0
Maav 128,144,80
ds_write_b128 v9, a[100:103] offset:33792
Maav 128,144,96
v_accvgpr_write_b32 a98, 0
v_accvgpr_write_b32 a99, 0
Maav 132,144,84
Maav 132,144,100
ds_write_b128 v9, a[104:107] offset:34816
Mvav 144,148,80
s_nop 0
v_accvgpr_write_b32 a104, 0
v_accvgpr_write_b32 a105, 0
Mvav 144,152,96
ds_write_b128 v9, a[108:111] offset:35840
Mvav 148,148,84
v_accvgpr_write_b32 a106, 0
v_accvgpr_write_b32 a107, 0
Mvav 148,152,100
v_accvgpr_read_b32 v114, a128
v_accvgpr_read_b32 v115, a132
Mvav 152,156,80
ds_write_b128 v9, a[112:115] offset:36864
Mvav 152,160,96
s_nop 0
v_accvgpr_write_b32 a112, 0
v_accvgpr_write_b32 a113, 0
Mvav 156,156,84
ds_write_b128 v9, a[116:119] offset:37888
Mvav 156,160,100
v_accvgpr_write_b32 a114, 0
v_accvgpr_write_b32 a115, 0
Mvav 160,164,80
Mvav 160,168,96
ds_write_b128 v9, a[120:123] offset:38912
Mvav 164,164,84
s_nop 0
v_accvgpr_write_b32 a120, 0
v_accvgpr_write_b32 a121, 0
Mvav 164,168,100
ds_write_b128 v9, a[124:127] offset:39936
Mvav 168,172,80
v_accvgpr_write_b32 a122, 0
v_accvgpr_write_b32 a123, 0
Mvav 168,176,96
Mvav 172,172,84
Mvav 172,176,100
s_waitcnt vmcnt(17) lgkmcnt(0)
s_barrier
Mvav 176,180,80
ds_read_b64 v[112:113], v10 offset:23552
Mvav 176,184,96
Lv 16,10,24576
Mvav 180,180,84
Lv 20,10,25600
Mvav 180,184,100
Lv 24,10,26624
Mvav 184,188,80
Lv 28,10,27648
Mvav 184,192,96
s_waitcnt lgkmcnt(4)
Lv 32,10,28672
v_add_f32 v112, v112, v114
Mvav 188,188,84
Lv 36,10,29696
v_add_f32 v113, v113, v115
Mvav 188,192,100
Lv 40,10,30720
Mvav 192,196,80
Lv 44,10,31744
Mvav 192,200,96
Lv 48,10,32768
Mvav 196,196,84
Lv 52,10,33792
Mvav 196,200,100
Lv 56,10,34816
Mvav 200,204,80
Lv 60,10,35840
Mvav 200,208,96
Lv 64,10,36864
Mvav 204,204,84
Lv 68,10,37888
Mvav 204,208,100
Lv 72,10,38912
Lv 76,10,39936
v_rcp_f32 v116, v112
v_rcp_f32 v118, v113
v_min_f32 v122, v112, v113
v_max_f32 v123, v112, v113
v_mul_f32 v116, v116, v11
v_mul_f32 v118, v118, v12
v_mov_b32 v117, v116
v_mov_b32 v119, v118
La 148,3,0
La 152,3,40960
La 156,4,16384
La 160,4,57344
La 164,3,1024
La 168,3,41984
v_cmp_gt_f32 vcc, 0x2b800000, v122
s_nop 0
s_or_b32 s49, s49, vcc_lo
s_or_b32 s49, s49, vcc_hi
v_cmp_lt_f32 vcc, 0x5f800000, v123
s_nop 0
s_or_b32 s49, s49, vcc_lo
s_or_b32 s49, s49, vcc_hi
s_waitcnt lgkmcnt(15)
s_add_u32 m0, s38, 0x4000
s_nop 0
buffer_load_dwordx4 v1, s[16:19], s54 offen sc1 lds
buffer_load_dwordx4 v1, s[16:19], s54 offen offset:1024 sc1 lds
v_pk_add_f32 v[144:145], v[144:145], v[16:17]
v_pk_add_f32 v[146:147], v[146:147], v[18:19]
v_pk_add_f32 v[148:149], v[148:149], v[20:21]
v_pk_add_f32 v[150:151], v[150:151], v[22:23]
v_pk_mul_f32 v[144:145], v[144:145], v[116:117]
v_pk_mul_f32 v[146:147], v[146:147], v[116:117]
v_pk_mul_f32 v[148:149], v[148:149], v[118:119]
v_pk_mul_f32 v[150:151], v[150:151], v[118:119]
v_pk_fma_f32 v[112:113], v[144:145], v[146:147], v[112:113]
v_pk_fma_f32 v[112:113], v[148:149], v[150:151], v[112:113]
s_waitcnt lgkmcnt(15)
buffer_load_dwordx4 v1, s[16:19], s54 offen offset:2048 sc1 lds
buffer_load_dwordx4 v1, s[16:19], s54 offen offset:3072 sc1 lds
v_pk_add_f32 v[152:153], v[152:153], v[24:25]
v_pk_add_f32 v[154:155], v[154:155], v[26:27]
v_pk_add_f32 v[156:157], v[156:157], v[28:29]
v_pk_add_f32 v[158:159], v[158:159], v[30:31]
v_pk_mul_f32 v[152:153], v[152:153], v[116:117]
v_pk_mul_f32 v[154:155], v[154:155], v[116:117]
v_pk_mul_f32 v[156:157], v[156:157], v[118:119]
v_pk_mul_f32 v[158:159], v[158:159], v[118:119]
v_pk_fma_f32 v[112:113], v[152:153], v[154:155], v[112:113]
v_pk_fma_f32 v[112:113], v[156:157], v[158:159], v[112:113]
s_waitcnt lgkmcnt(15)
s_add_u32 m0, s38, 0x5000
s_nop 0
buffer_load_dwordx4 v2, s[16:19], s54 offen sc1 lds
buffer_load_dwordx4 v2, s[16:19], s54 offen offset:1024 sc1 lds
v_pk_add_f32 v[160:161], v[160:161], v[32:33]
v_pk_add_f32 v[162:163], v[162:163], v[34:35]
v_pk_add_f32 v[164:165], v[164:165], v[36:37]
v_pk_add_f32 v[166:167], v[166:167], v[38:39]
v_pk_mul_f32 v[160:161], v[160:161], v[116:117]
v_pk_mul_f32 v[162:163], v[162:163], v[116:117]
v_pk_mul_f32 v[164:165], v[164:165], v[118:119]
v_pk_mul_f32 v[166:167], v[166:167], v[118:119]
v_pk_fma_f32 v[112:113], v[160:161], v[162:163], v[112:113]
v_pk_fma_f32 v[112:113], v[164:165], v[166:167], v[112:113]
s_waitcnt lgkmcnt(14)
La 172,4,17408
La 176,4,58368
La 180,6,0
La 184,6,40960
La 188,7,16384
La 192,7,57344
buffer_load_dwordx4 v2, s[16:19], s54 offen offset:2048 sc1 lds
buffer_load_dwordx4 v2, s[16:19], s54 offen offset:3072 sc1 lds
v_pk_add_f32 v[168:169], v[168:169], v[40:41]
v_pk_add_f32 v[170:171], v[170:171], v[42:43]
v_pk_add_f32 v[172:173], v[172:173], v[44:45]
v_pk_add_f32 v[174:175], v[174:175], v[46:47]
v_pk_mul_f32 v[168:169], v[168:169], v[116:117]
v_pk_mul_f32 v[170:171], v[170:171], v[116:117]
v_pk_mul_f32 v[172:173], v[172:173], v[118:119]
v_pk_mul_f32 v[174:175], v[174:175], v[118:119]
v_pk_fma_f32 v[112:113], v[168:169], v[170:171], v[112:113]
v_pk_fma_f32 v[112:113], v[172:173], v[174:175], v[112:113]
s_waitcnt lgkmcnt(15)
v_pk_add_f32 v[176:177], v[176:177], v[48:49]
v_pk_add_f32 v[178:179], v[178:179], v[50:51]
v_pk_add_f32 v[180:181], v[180:181], v[52:53]
v_pk_add_f32 v[182:183], v[182:183], v[54:55]
v_pk_mul_f32 v[176:177], v[176:177], v[116:117]
v_pk_mul_f32 v[178:179], v[178:179], v[116:117]
v_pk_mul_f32 v[180:181], v[180:181], v[118:119]
v_pk_mul_f32 v[182:183], v[182:183], v[118:119]
v_pk_fma_f32 v[112:113], v[176:177], v[178:179], v[112:113]
v_pk_fma_f32 v[112:113], v[180:181], v[182:183], v[112:113]
s_waitcnt lgkmcnt(15)
v_pk_add_f32 v[184:185], v[184:185], v[56:57]
v_pk_add_f32 v[186:187], v[186:187], v[58:59]
v_pk_add_f32 v[188:189], v[188:189], v[60:61]
v_pk_add_f32 v[190:191], v[190:191], v[62:63]
v_pk_mul_f32 v[184:185], v[184:185], v[116:117]
v_pk_mul_f32 v[186:187], v[186:187], v[116:117]
v_pk_mul_f32 v[188:189], v[188:189], v[118:119]
v_pk_mul_f32 v[190:191], v[190:191], v[118:119]
v_pk_fma_f32 v[112:113], v[184:185], v[186:187], v[112:113]
v_pk_fma_f32 v[112:113], v[188:189], v[190:191], v[112:113]
s_waitcnt lgkmcnt(14)
v_pk_add_f32 v[192:193], v[192:193], v[64:65]
v_pk_add_f32 v[194:195], v[194:195], v[66:67]
v_pk_add_f32 v[196:197], v[196:197], v[68:69]
v_pk_add_f32 v[198:199], v[198:199], v[70:71]
v_pk_mul_f32 v[192:193], v[192:193], v[116:117]
v_pk_mul_f32 v[194:195], v[194:195], v[116:117]
v_pk_mul_f32 v[196:197], v[196:197], v[118:119]
v_pk_mul_f32 v[198:199], v[198:199], v[118:119]
v_pk_fma_f32 v[112:113], v[192:193], v[194:195], v[112:113]
v_pk_fma_f32 v[112:113], v[196:197], v[198:199], v[112:113]
s_waitcnt lgkmcnt(12)
v_pk_add_f32 v[200:201], v[200:201], v[72:73]
v_pk_add_f32 v[202:203], v[202:203], v[74:75]
v_pk_add_f32 v[204:205], v[204:205], v[76:77]
v_pk_add_f32 v[206:207], v[206:207], v[78:79]
v_pk_mul_f32 v[200:201], v[200:201], v[116:117]
v_pk_mul_f32 v[202:203], v[202:203], v[116:117]
v_pk_mul_f32 v[204:205], v[204:205], v[118:119]
v_pk_mul_f32 v[206:207], v[206:207], v[118:119]
v_pk_fma_f32 v[112:113], v[200:201], v[202:203], v[112:113]
v_pk_fma_f32 v[112:113], v[204:205], v[206:207], v[112:113]
v_add_f32 v112, v112, v113
s_movk_i32 s37, 0x207
v_cmp_class_f32 vcc, v112, s37
s_nop 0
s_or_b32 s49, s49, vcc_lo
s_or_b32 s49, s49, vcc_hi
s_branch M_I2
.p2align 12
M_sm:
s_lshl1_add_u32 s37, s26, s40
s_cmp_eq_u32 s37, 0
s_cbranch_scc1 M_Z0
s_cmp_eq_u32 s37, 1
s_cbranch_scc1 M_Z1
s_cmp_eq_u32 s37, 2
s_cbranch_scc1 M_DL0
s_branch M_DL1
M_I2:
s_waitcnt vmcnt(12)
v_cmp_ne_u32 vcc, 1, v213
s_nop 0
s_cbranch_vccnz M_sH
M_rH:
s_cmp_lg_u32 s50, 0
s_cbranch_scc1 M_max1
M_go1:
s_cmp_lt_u32 s26, 2
s_cbranch_scc1 M_sm
s_cmp_eq_u32 s40, 1
s_cbranch_scc1 M_D1
M_D0:
s_waitcnt vmcnt(8) lgkmcnt(8)
s_add_u32 s73, s41, 0x3000000
La 196,6,1024
Cvaa 16,148,0,232
s_add_u32 m0, s38, 0x8000
La 200,6,41984
PK 144,144,145
Mvaa 16,152,4
La 204,7,17408
PK 145,146,147
Mvaa 16,156,8
La 208,7,58368
PK 146,152,153
Mvaa 16,160,12
buffer_load_dwordx4 v1, s[16:19], s33 offen sc1 lds
Cvaa 20,148,16,220
PK 147,154,155
Mvaa 20,152,20
Mvaa 20,156,24
buffer_load_dwordx4 v1, s[16:19], s33 offen offset:1024 sc1 lds
Mvaa 20,160,28
s_nop 0
v_exp_f32 v16, v16
Cvaa 24,148,32,224
v_exp_f32 v17, v17
Mvaa 24,152,36
buffer_load_dwordx4 v1, s[16:19], s33 offen offset:2048 sc1 lds
Mvaa 24,156,40
v_exp_f32 v18, v18
Mvaa 24,160,44
v_exp_f32 v19, v19
Cvaa 28,148,48,228
buffer_load_dwordx4 v1, s[16:19], s33 offen offset:3072 sc1 lds
Mvaa 28,152,52
v_exp_f32 v20, v20
Mvaa 28,156,56
v_exp_f32 v21, v21
Mvaa 28,160,60
s_waitcnt lgkmcnt(8)
buffer_store_dwordx4 v[144:147], v1, s[16:19], s73 offen sc0 sc1
PK 80,16,17
PK 81,18,19
s_add_u32 s73, s42, 0x3000000
Cvaa 32,164,0,236
s_add_u32 m0, s38, 0x9000
v_exp_f32 v22, v22
Mvaa 32,168,4
v_exp_f32 v23, v23
Mvaa 32,172,8
buffer_load_dwordx4 v2, s[16:19], s33 offen sc1 lds
Mvaa 32,176,12
v_exp_f32 v24, v24
Cvaa 36,164,16,220
v_exp_f32 v25, v25
Mvaa 36,168,20
buffer_load_dwordx4 v2, s[16:19], s33 offen offset:1024 sc1 lds
Mvaa 36,172,24
v_exp_f32 v26, v26
Mvaa 36,176,28
v_exp_f32 v27, v27
Cvaa 40,164,32,224
buffer_load_dwordx4 v2, s[16:19], s33 offen offset:2048 sc1 lds
Mvaa 40,168,36
PK 84,20,21
PK 85,22,23
Mvaa 40,172,40
v_exp_f32 v28, v28
Mvaa 40,176,44
v_exp_f32 v29, v29
Cvaa 44,164,48,228
buffer_load_dwordx4 v2, s[16:19], s33 offen offset:3072 sc1 lds
Mvaa 44,168,52
v_exp_f32 v30, v30
Mvaa 44,172,56
v_exp_f32 v31, v31
Mvaa 44,176,60
s_waitcnt vmcnt(34) lgkmcnt(0)
s_barrier
Cvaa 60,180,48,240
s_add_u32 s33, s33, 0x2000
s_cmp_eq_u32 s33, s35
s_cselect_b32 s33, s29, s33
La 148,3,8192
Mvaa 60,184,52
s_add_u32 m0, s38, 0
La 152,3,49152
La 156,4,24576
La 160,5,0
Mvaa 60,188,56
buffer_load_dwordx4 v1, s[16:19], s32 offen sc1 lds
Mvaa 60,192,60
La 164,3,9216
PK 88,24,25
Cvaa 76,196,48,244
La 168,3,50176
PK 89,26,27
Mvaa 76,200,52
buffer_load_dwordx4 v1, s[16:19], s32 offen offset:1024 sc1 lds
Mvaa 76,204,56
La 172,4,25600
PK 92,28,29
Mvaa 76,208,60
s_waitcnt lgkmcnt(3)
La 176,5,1024
PK 93,30,31
Cvaa 16,148,0,216
buffer_load_dwordx4 v1, s[16:19], s32 offen offset:2048 sc1 lds
Mvaa 16,152,4
La 180,6,8192
PK 148,148,149
Mvaa 16,156,8
La 184,6,49152
PK 149,150,151
Mvaa 16,160,12
La 188,7,24576
PK 150,156,157
Cvaa 20,148,16,220
buffer_load_dwordx4 v1, s[16:19], s32 offen offset:3072 sc1 lds
Mvaa 20,152,20
La 192,8,0
PK 151,158,159
Mvaa 20,156,24
v_exp_f32 v32, v32
Mvaa 20,160,28
buffer_store_dwordx4 v[148:151], v1, s[16:19], s73 offen sc0 sc1
La 196,6,9216
v_exp_f32 v33, v33
Cvaa 24,148,32,224
s_add_u32 m0, s38, 0x1000
s_add_u32 s73, s41, 0x3020000
La 200,6,50176
Mvaa 24,152,36
La 204,7,25600
PK 160,160,161
Mvaa 24,156,40
buffer_load_dwordx4 v2, s[16:19], s32 offen sc1 lds
Mvaa 24,160,44
La 208,8,1024
PK 161,162,163
Cvaa 28,148,48,228
v_exp_f32 v34, v34
Mvaa 28,152,52
v_exp_f32 v35, v35
Mvaa 28,156,56
PK 82,32,33
PK 83,34,35
Mvaa 28,160,60
s_waitcnt lgkmcnt(8)
v_exp_f32 v36, v36
Cvaa 32,164,0,216
v_exp_f32 v37, v37
Mvaa 32,168,4
v_exp_f32 v38, v38
Mvaa 32,172,8
buffer_load_dwordx4 v2, s[16:19], s32 offen offset:1024 sc1 lds
Mvaa 32,176,12
v_exp_f32 v39, v39
PK 86,36,37
PK 87,38,39
Cvaa 36,164,16,220
v_exp_f32 v40, v40
Mvaa 36,168,20
v_exp_f32 v41, v41
Mvaa 36,172,24
buffer_load_dwordx4 v2, s[16:19], s32 offen offset:2048 sc1 lds
Mvaa 36,176,28
v_exp_f32 v42, v42
v_exp_f32 v43, v43
PK 90,40,41
PK 91,42,43
Cvaa 40,164,32,224
v_exp_f32 v44, v44
Mvaa 40,168,36
v_exp_f32 v45, v45
Mvaa 40,172,40
buffer_load_dwordx4 v2, s[16:19], s32 offen offset:3072 sc1 lds
Mvaa 40,176,44
s_add_u32 s32, s32, 0x2000
v_exp_f32 v46, v46
v_exp_f32 v47, v47
PK 94,44,45
PK 95,46,47
Cvaa 44,164,48,228
s_cmp_eq_u32 s32, s34
s_cselect_b32 s32, s28, s32
v_exp_f32 v60, v60
Mvaa 44,168,52
v_exp_f32 v61, v61
Mvaa 44,172,56
v_exp_f32 v62, v62
Mvaa 44,176,60
s_waitcnt vmcnt(18) lgkmcnt(0)
s_barrier
Cvaa 48,180,0,216
s_cmp_ge_u32 s27, 2
s_cselect_b32 s36, s32, s31
s_add_u32 s32, s32, 0x2000
s_cmp_eq_u32 s32, s34
s_cselect_b32 s32, s28, s32
Mvaa 48,184,4
s_add_u32 m0, s38, 0x2000
La 148,3,16384
PK 162,168,169
Mvaa 48,188,8
buffer_load_dwordx4 v1, s[16:19], s36 offen sc1 lds
Mvaa 48,192,12
La 152,6,16384
PK 163,170,171
Cvaa 52,180,16,220
v_exp_f32 v63, v63
Mvaa 52,184,20
buffer_load_dwordx4 v1, s[16:19], s36 offen offset:1024 sc1 lds
Mvaa 52,188,24
La 156,3,17408
PK 108,60,61
Mvaa 52,192,28
La 160,6,17408
PK 109,62,63
Cvaa 56,180,32,224
buffer_store_dwordx4 v[160:163], v1, s[16:19], s73 offen sc0 sc1
La 164,3,57344
v_exp_f32 v76, v76
Mvaa 56,184,36
s_add_u32 s73, s42, 0x3020000
La 168,6,57344
PK 164,164,165
Mvaa 56,188,40
La 172,3,58368
PK 165,166,167
Mvaa 56,192,44
buffer_load_dwordx4 v1, s[16:19], s36 offen offset:2048 sc1 lds
Cvaa 60,180,48,228
La 176,6,58368
PK 166,172,173
Mvaa 60,184,52
v_exp_f32 v77, v77
Mvaa 60,188,56
v_exp_f32 v78, v78
Mvaa 60,192,60
buffer_load_dwordx4 v1, s[16:19], s36 offen offset:3072 sc1 lds
Cvaa 64,196,0,216
La 180,4,32768
PK 167,174,175
Mvaa 64,200,4
v_exp_f32 v79, v79
Mvaa 64,204,8
buffer_store_dwordx4 v[164:167], v1, s[16:19], s73 offen sc0 sc1
La 184,7,32768
PK 110,76,77
PK 111,78,79
Mvaa 64,208,12
s_add_u32 s73, s41, 0x3040000
La 188,4,33792
PK 176,176,177
Cvaa 68,196,16,220
s_add_u32 m0, s38, 0x3000
La 192,7,33792
PK 177,178,179
Mvaa 68,200,20
buffer_load_dwordx4 v2, s[16:19], s36 offen sc1 lds
Mvaa 68,204,24
v_exp_f32 v16, v16
Mvaa 68,208,28
v_exp_f32 v17, v17
Cvaa 72,196,32,224
v_exp_f32 v18, v18
Mvaa 72,200,36
buffer_load_dwordx4 v2, s[16:19], s36 offen offset:1024 sc1 lds
Mvaa 72,204,40
v_exp_f32 v19, v19
Mvaa 72,208,44
v_exp_f32 v20, v20
Cvaa 76,196,48,228
v_exp_f32 v21, v21
Mvaa 76,200,52
v_exp_f32 v22, v22
Mvaa 76,204,56
buffer_load_dwordx4 v2, s[16:19], s36 offen offset:2048 sc1 lds
Mvaa 76,208,60
v_exp_f32 v23, v23
Zaav 128,144,80
La 196,5,8192
PK 112,16,17
Zaav 132,144,84
La 200,8,8192
PK 113,18,19
Zaav 136,144,88
La 204,5,9216
PK 116,20,21
Zaav 140,144,92
buffer_load_dwordx4 v2, s[16:19], s36 offen offset:3072 sc1 lds
Maav 140,144,108
s_waitcnt lgkmcnt(11)
La 208,8,9216
PK 117,22,23
Zvav 144,148,80
v_exp_f32 v24, v24
Zvav 148,148,84
v_exp_f32 v25, v25
Zaav 64,148,88
v_exp_f32 v26, v26
Zaav 68,148,92
v_exp_f32 v27, v27
Maav 68,152,108
v_exp_f32 v28, v28
Zvav 152,156,80
v_exp_f32 v29, v29
Zvav 156,156,84
v_exp_f32 v30, v30
Zaav 72,156,88
PK 120,24,25
PK 121,26,27
Zaav 76,156,92
v_exp_f32 v32, v32
Maav 76,160,108
s_waitcnt lgkmcnt(8)
v_exp_f32 v33, v33
Zvav 160,164,80
v_exp_f32 v34, v34
Zvav 164,164,84
v_exp_f32 v35, v35
Zaav 80,164,88
v_exp_f32 v31, v31
Zaav 84,164,92
PK 178,184,185
PK 114,32,33
Maav 84,168,108
PK 124,28,29
PK 179,186,187
Zvav 168,172,80
PK 115,34,35
PK 125,30,31
Zvav 172,172,84
buffer_store_dwordx4 v[176:179], v1, s[16:19], s73 offen sc0 sc1
v_exp_f32 v40, v40
s_add_u32 s73, s42, 0x3040000
Zaav 88,172,88
PK 180,180,181
PK 181,182,183
PK 182,188,189
PK 183,190,191
buffer_store_dwordx4 v[180:183], v1, s[16:19], s73 offen sc0 sc1
v_exp_f32 v36, v36
s_add_u32 s73, s41, 0x3060000
Zaav 92,172,92
v_exp_f32 v41, v41
Maav 92,176,108
s_waitcnt vmcnt(12) lgkmcnt(0)
s_barrier
Zvav 176,180,80
s_sub_u32 s27, s27, 1
v_exp_f32 v37, v37
Zvav 180,180,84
s_add_u32 m0, s38, 0x4000
v_exp_f32 v42, v42
Zaav 96,180,88
v_exp_f32 v38, v38
Zaav 100,180,92
v_exp_f32 v43, v43
Maav 100,184,108
v_exp_f32 v39, v39
Zvav 184,188,80
PK 122,40,41
PK 118,36,37
Zvav 188,188,84
PK 192,192,193
PK 193,194,195
PK 194,200,201
PK 195,202,203
buffer_store_dwordx4 v[192:195], v1, s[16:19], s73 offen sc0 sc1
buffer_load_dwordx4 v1, s[16:19], s33 offen sc1 lds
PK 123,42,43
Zaav 104,188,88
s_add_u32 s73, s42, 0x3060000
PK 196,196,197
PK 197,198,199
PK 198,204,205
PK 199,206,207
buffer_store_dwordx4 v[196:199], v1, s[16:19], s73 offen sc0 sc1
PK 119,38,39
v_exp_f32 v48, v48
Zaav 108,188,92
v_exp_f32 v44, v44
Maav 108,192,108
La 148,3,0
La 152,3,40960
La 156,4,16384
La 160,4,57344
Zvav 192,196,80
buffer_load_dwordx4 v1, s[16:19], s33 offen offset:1024 sc1 lds
Zvav 196,196,84
v_exp_f32 v49, v49
Zaav 112,196,88
v_exp_f32 v45, v45
Zaav 116,196,92
v_exp_f32 v50, v50
Maav 116,200,108
buffer_load_dwordx4 v1, s[16:19], s33 offen offset:2048 sc1 lds
Zvav 200,204,80
v_exp_f32 v46, v46
Zvav 204,204,84
v_exp_f32 v51, v51
Zaav 120,204,88
La 164,3,1024
La 168,3,41984
La 172,4,17408
La 176,4,58368
Zaav 124,204,92
buffer_load_dwordx4 v1, s[16:19], s33 offen offset:3072 sc1 lds
v_exp_f32 v47, v47
PK 128,48,49
PK 126,44,45
PK 129,50,51
PK 127,46,47
v_exp_f32 v56, v56
v_exp_f32 v52, v52
v_exp_f32 v57, v57
v_exp_f32 v53, v53
v_exp_f32 v58, v58
v_exp_f32 v54, v54
v_exp_f32 v59, v59
v_exp_f32 v55, v55
PK 136,56,57
PK 132,52,53
PK 137,58,59
PK 133,54,55
v_exp_f32 v64, v64
v_exp_f32 v60, v60
v_exp_f32 v65, v65
v_exp_f32 v61, v61
v_exp_f32 v66, v66
v_exp_f32 v62, v62
v_exp_f32 v67, v67
v_exp_f32 v63, v63
PK 130,64,65
PK 140,60,61
PK 131,66,67
PK 141,62,63
v_exp_f32 v72, v72
v_exp_f32 v68, v68
v_exp_f32 v73, v73
v_exp_f32 v69, v69
v_exp_f32 v74, v74
v_exp_f32 v70, v70
v_exp_f32 v75, v75
v_exp_f32 v71, v71
PK 138,72,73
PK 134,68,69
PK 139,74,75
PK 135,70,71
Maav 124,208,108
s_cmp_eq_u32 s27, 0
s_cbranch_scc1 M_X1
s_branch M_H1
.p2align 12
M_D1:
s_waitcnt vmcnt(8) lgkmcnt(8)
s_add_u32 s73, s41, 0x3000000
La 196,6,1024
Cvaa 16,148,0,216
s_add_u32 m0, s38, 0x8000
La 200,6,41984
PK 144,144,145
Mvaa 16,152,4
La 204,7,17408
PK 145,146,147
Mvaa 16,156,8
La 208,7,58368
PK 146,152,153
Mvaa 16,160,12
buffer_load_dwordx4 v1, s[16:19], s33 offen sc1 lds
Cvaa 20,148,16,220
PK 147,154,155
Mvaa 20,152,20
Mvaa 20,156,24
buffer_load_dwordx4 v1, s[16:19], s33 offen offset:1024 sc1 lds
Mvaa 20,160,28
s_nop 0
v_exp_f32 v16, v16
Cvaa 28,148,48,240
v_exp_f32 v17, v17
Mvaa 28,152,52
buffer_load_dwordx4 v1, s[16:19], s33 offen offset:2048 sc1 lds
Mvaa 28,156,56
v_exp_f32 v18, v18
Mvaa 28,160,60
s_waitcnt lgkmcnt(8)
v_exp_f32 v19, v19
Cvaa 32,164,0,216
buffer_load_dwordx4 v1, s[16:19], s33 offen offset:3072 sc1 lds
Mvaa 32,168,4
v_exp_f32 v20, v20
Mvaa 32,172,8
v_exp_f32 v21, v21
Mvaa 32,176,12
buffer_store_dwordx4 v[144:147], v1, s[16:19], s73 offen sc0 sc1
PK 80,16,17
PK 81,18,19
s_add_u32 s73, s42, 0x3000000
Cvaa 36,164,16,220
s_add_u32 m0, s38, 0x9000
v_exp_f32 v22, v22
Mvaa 36,168,20
v_exp_f32 v23, v23
Mvaa 36,172,24
buffer_load_dwordx4 v2, s[16:19], s33 offen sc1 lds
Mvaa 36,176,28
v_exp_f32 v28, v28
Cvaa 44,164,48,244
v_exp_f32 v29, v29
Mvaa 44,168,52
buffer_load_dwordx4 v2, s[16:19], s33 offen offset:1024 sc1 lds
Mvaa 44,172,56
v_exp_f32 v30, v30
Mvaa 44,176,60
s_waitcnt vmcnt(32) lgkmcnt(0)
s_barrier
Cvaa 48,180,0,232
La 148,3,8192
PK 84,20,21
Mvaa 48,184,4
La 152,3,49152
La 156,4,24576
La 160,5,0
Mvaa 48,188,8
buffer_load_dwordx4 v2, s[16:19], s33 offen offset:2048 sc1 lds
Mvaa 48,192,12
La 164,3,9216
PK 85,22,23
Cvaa 52,180,16,220
La 168,3,50176
PK 148,148,149
Mvaa 52,184,20
buffer_load_dwordx4 v2, s[16:19], s33 offen offset:3072 sc1 lds
Mvaa 52,188,24
La 172,4,25600
PK 149,150,151
Mvaa 52,192,28
La 176,5,1024
PK 150,156,157
Cvaa 64,196,0,236
s_add_u32 s33, s33, 0x2000
s_cmp_eq_u32 s33, s35
s_cselect_b32 s33, s29, s33
s_add_u32 m0, s38, 0
Mvaa 64,200,4
buffer_load_dwordx4 v1, s[16:19], s32 offen sc1 lds
Mvaa 64,204,8
v_exp_f32 v31, v31
Mvaa 64,208,12
v_exp_f32 v32, v32
Cvaa 68,196,16,220
buffer_load_dwordx4 v1, s[16:19], s32 offen offset:1024 sc1 lds
Mvaa 68,200,20
v_exp_f32 v33, v33
Mvaa 68,204,24
v_exp_f32 v34, v34
Mvaa 68,208,28
s_waitcnt lgkmcnt(4)
v_exp_f32 v35, v35
Cvaa 16,148,0,216
buffer_load_dwordx4 v1, s[16:19], s32 offen offset:2048 sc1 lds
Mvaa 16,152,4
La 180,6,8192
PK 92,28,29
Mvaa 16,156,8
La 184,6,49152
PK 93,30,31
Mvaa 16,160,12
La 188,7,24576
PK 82,32,33
Cvaa 20,148,16,220
buffer_load_dwordx4 v1, s[16:19], s32 offen offset:3072 sc1 lds
Mvaa 20,152,20
La 192,8,0
PK 83,34,35
Mvaa 20,156,24
La 196,6,9216
PK 151,158,159
Mvaa 20,160,28
buffer_store_dwordx4 v[148:151], v1, s[16:19], s73 offen sc0 sc1
La 200,6,50176
v_exp_f32 v36, v36
Cvaa 24,148,32,224
s_add_u32 m0, s38, 0x1000
s_add_u32 s73, s41, 0x3020000
La 204,7,25600
Mvaa 24,152,36
La 208,8,1024
PK 160,160,161
Mvaa 24,156,40
buffer_load_dwordx4 v2, s[16:19], s32 offen sc1 lds
Mvaa 24,160,44
v_exp_f32 v37, v37
Cvaa 28,148,48,228
v_exp_f32 v38, v38
Mvaa 28,152,52
buffer_load_dwordx4 v2, s[16:19], s32 offen offset:1024 sc1 lds
Mvaa 28,156,56
v_exp_f32 v39, v39
Mvaa 28,160,60
s_waitcnt lgkmcnt(8)
v_exp_f32 v44, v44
Cvaa 32,164,0,216
buffer_load_dwordx4 v2, s[16:19], s32 offen offset:2048 sc1 lds
Mvaa 32,168,4
v_exp_f32 v45, v45
Mvaa 32,172,8
PK 86,36,37
PK 87,38,39
Mvaa 32,176,12
v_exp_f32 v46, v46
Cvaa 36,164,16,220
buffer_load_dwordx4 v2, s[16:19], s32 offen offset:3072 sc1 lds
Mvaa 36,168,20
v_exp_f32 v47, v47
Mvaa 36,172,24
v_exp_f32 v48, v48
Mvaa 36,176,28
v_exp_f32 v49, v49
Cvaa 40,164,32,224
s_add_u32 s32, s32, 0x2000
s_cmp_eq_u32 s32, s34
s_cselect_b32 s32, s28, s32
PK 94,44,45
Mvaa 40,168,36
v_exp_f32 v50, v50
Mvaa 40,172,40
v_exp_f32 v51, v51
Mvaa 40,176,44
PK 95,46,47
PK 96,48,49
Cvaa 44,164,48,228
v_exp_f32 v52, v52
Mvaa 44,168,52
v_exp_f32 v53, v53
Mvaa 44,172,56
v_exp_f32 v54, v54
Mvaa 44,176,60
s_waitcnt vmcnt(18) lgkmcnt(0)
s_barrier
PK 97,50,51
Cvaa 48,180,0,216
s_cmp_ge_u32 s27, 2
s_cselect_b32 s36, s32, s31
s_add_u32 s32, s32, 0x2000
s_cmp_eq_u32 s32, s34
s_cselect_b32 s32, s28, s32
Mvaa 48,184,4
s_add_u32 m0, s38, 0x2000
v_exp_f32 v55, v55
Mvaa 48,188,8
PK 100,52,53
PK 101,54,55
Mvaa 48,192,12
buffer_load_dwordx4 v1, s[16:19], s36 offen sc1 lds
Cvaa 52,180,16,220
La 148,3,16384
PK 161,162,163
Mvaa 52,184,20
La 152,6,16384
PK 162,168,169
Mvaa 52,188,24
buffer_load_dwordx4 v1, s[16:19], s36 offen offset:1024 sc1 lds
Mvaa 52,192,28
La 156,3,17408
PK 163,170,171
Cvaa 56,180,32,224
v_exp_f32 v64, v64
Mvaa 56,184,36
buffer_store_dwordx4 v[160:163], v1, s[16:19], s73 offen sc0 sc1
La 160,6,17408
v_exp_f32 v65, v65
Mvaa 56,188,40
s_add_u32 s73, s42, 0x3020000
La 164,3,57344
PK 164,164,165
Mvaa 56,192,44
La 168,6,57344
PK 165,166,167
Cvaa 60,180,48,228
v_exp_f32 v66, v66
Mvaa 60,184,52
v_exp_f32 v67, v67
Mvaa 60,188,56
PK 98,64,65
PK 99,66,67
Mvaa 60,192,60
v_exp_f32 v68, v68
Cvaa 64,196,0,216
buffer_load_dwordx4 v1, s[16:19], s36 offen offset:2048 sc1 lds
Mvaa 64,200,4
v_exp_f32 v69, v69
Mvaa 64,204,8
v_exp_f32 v70, v70
Mvaa 64,208,12
v_exp_f32 v71, v71
PK 102,68,69
PK 103,70,71
Cvaa 68,196,16,220
buffer_load_dwordx4 v1, s[16:19], s36 offen offset:3072 sc1 lds
Mvaa 68,200,20
s_add_u32 m0, s38, 0x3000
La 172,3,58368
PK 166,172,173
Mvaa 68,204,24
La 176,6,58368
PK 167,174,175
Mvaa 68,208,28
buffer_load_dwordx4 v2, s[16:19], s36 offen sc1 lds
Cvaa 72,196,32,224
v_exp_f32 v16, v16
Mvaa 72,200,36
v_exp_f32 v17, v17
Mvaa 72,204,40
buffer_load_dwordx4 v2, s[16:19], s36 offen offset:1024 sc1 lds
Mvaa 72,208,44
v_exp_f32 v18, v18
Cvaa 76,196,48,228
v_exp_f32 v19, v19
Mvaa 76,200,52
buffer_store_dwordx4 v[164:167], v1, s[16:19], s73 offen sc0 sc1
La 180,4,32768
PK 112,16,17
PK 113,18,19
Mvaa 76,204,56
s_add_u32 s73, s41, 0x3040000
La 184,7,32768
PK 176,176,177
Mvaa 76,208,60
La 188,4,33792
PK 177,178,179
Zaav 128,144,80
buffer_load_dwordx4 v2, s[16:19], s36 offen offset:2048 sc1 lds
Maav 128,144,96
La 192,7,33792
PK 178,184,185
Zaav 132,144,84
La 196,5,8192
PK 179,186,187
Maav 132,144,100
buffer_load_dwordx4 v2, s[16:19], s36 offen offset:3072 sc1 lds
Zaav 140,144,92
s_waitcnt lgkmcnt(9)
v_exp_f32 v24, v24
Zvav 144,148,80
v_exp_f32 v20, v20
Mvav 144,152,96
buffer_store_dwordx4 v[176:179], v1, s[16:19], s73 offen sc0 sc1
La 200,8,8192
v_exp_f32 v25, v25
Zvav 148,148,84
s_add_u32 s73, s42, 0x3040000
La 204,5,9216
PK 180,180,181
Mvav 148,152,100
La 208,8,9216
PK 181,182,183
Zaav 68,148,92
v_exp_f32 v21, v21
Zvav 152,156,80
v_exp_f32 v26, v26
Mvav 152,160,96
v_exp_f32 v22, v22
Zvav 156,156,84
v_exp_f32 v27, v27
Mvav 156,160,100
v_exp_f32 v23, v23
Zaav 76,156,92
s_waitcnt lgkmcnt(8)
PK 120,24,25
PK 116,20,21
Zvav 160,164,80
PK 121,26,27
PK 117,22,23
Mvav 160,168,96
v_exp_f32 v32, v32
Zvav 164,164,84
v_exp_f32 v28, v28
Mvav 164,168,100
v_exp_f32 v33, v33
Zaav 84,164,92
v_exp_f32 v29, v29
Zvav 168,172,80
v_exp_f32 v34, v34
Mvav 168,176,96
v_exp_f32 v30, v30
Zvav 172,172,84
v_exp_f32 v35, v35
Mvav 172,176,100
PK 182,188,189
PK 183,190,191
buffer_store_dwordx4 v[180:183], v1, s[16:19], s73 offen sc0 sc1
v_exp_f32 v31, v31
PK 114,32,33
Zaav 92,172,92
s_waitcnt vmcnt(12) lgkmcnt(0)
s_barrier
Zvav 176,180,80
s_add_u32 s73, s41, 0x3060000
PK 124,28,29
PK 115,34,35
Mvav 176,184,96
s_sub_u32 s27, s27, 1
PK 125,30,31
PK 192,192,193
Zvav 180,180,84
s_add_u32 m0, s38, 0x4000
v_exp_f32 v40, v40
Mvav 180,184,100
v_exp_f32 v36, v36
Zaav 100,180,92
v_exp_f32 v41, v41
Zvav 184,188,80
v_exp_f32 v37, v37
Mvav 184,192,96
PK 193,194,195
PK 194,200,201
PK 195,202,203
buffer_store_dwordx4 v[192:195], v1, s[16:19], s73 offen sc0 sc1
buffer_load_dwordx4 v1, s[16:19], s33 offen sc1 lds
s_add_u32 s73, s42, 0x3060000
Zvav 188,188,84
v_exp_f32 v42, v42
Mvav 188,192,100
PK 196,196,197
PK 197,198,199
PK 198,204,205
PK 199,206,207
buffer_store_dwordx4 v[196:199], v1, s[16:19], s73 offen sc0 sc1
v_exp_f32 v38, v38
Zaav 108,188,92
La 148,3,0
La 152,3,40960
La 156,4,16384
La 160,4,57344
Zvav 192,196,80
buffer_load_dwordx4 v1, s[16:19], s33 offen offset:1024 sc1 lds
Mvav 192,200,96
v_exp_f32 v43, v43
Zvav 196,196,84
v_exp_f32 v39, v39
Mvav 196,200,100
PK 122,40,41
PK 118,36,37
Zaav 116,196,92
buffer_load_dwordx4 v1, s[16:19], s33 offen offset:2048 sc1 lds
Zvav 200,204,80
PK 123,42,43
PK 119,38,39
Mvav 200,208,96
v_exp_f32 v48, v48
Zvav 204,204,84
La 164,3,1024
La 168,3,41984
La 172,4,17408
La 176,4,58368
Mvav 204,208,100
buffer_load_dwordx4 v1, s[16:19], s33 offen offset:3072 sc1 lds
v_exp_f32 v44, v44
v_exp_f32 v49, v49
v_exp_f32 v45, v45
v_exp_f32 v50, v50
v_exp_f32 v46, v46
v_exp_f32 v51, v51
v_exp_f32 v47, v47
PK 128,48,49
PK 126,44,45
PK 129,50,51
PK 127,46,47
v_exp_f32 v56, v56
v_exp_f32 v52, v52
v_exp_f32 v57, v57
v_exp_f32 v53, v53
v_exp_f32 v58, v58
v_exp_f32 v54, v54
v_exp_f32 v59, v59
v_exp_f32 v55, v55
PK 136,56,57
PK 132,52,53
PK 137,58,59
PK 133,54,55
v_exp_f32 v64, v64
v_exp_f32 v60, v60
v_exp_f32 v65, v65
v_exp_f32 v61, v61
v_exp_f32 v66, v66
v_exp_f32 v62, v62
v_exp_f32 v67, v67
v_exp_f32 v63, v63
PK 130,64,65
PK 140,60,61
PK 131,66,67
PK 141,62,63
v_exp_f32 v72, v72
v_exp_f32 v68, v68
v_exp_f32 v73, v73
v_exp_f32 v69, v69
v_exp_f32 v74, v74
v_exp_f32 v70, v70
v_exp_f32 v75, v75
v_exp_f32 v71, v71
PK 138,72,73
PK 134,68,69
PK 139,74,75
PK 135,70,71
Zaav 124,204,92
s_cmp_eq_u32 s27, 0
s_cbranch_scc1 M_X1
s_branch M_H1
.p2align 12
M_DL0:
s_waitcnt vmcnt(8) lgkmcnt(8)
s_add_u32 s73, s41, 0x3000000
La 196,6,1024
Cvaa 16,148,0,232
s_add_u32 m0, s38, 0x8000
La 200,6,41984
PK 144,144,145
Mvaa 16,152,4
La 204,7,17408
PK 145,146,147
Mvaa 16,156,8
La 208,7,58368
PK 146,152,153
Mvaa 16,160,12
buffer_load_dwordx4 v1, s[16:19], s33 offen sc1 lds
Cvaa 20,148,16,220
PK 147,154,155
Mvaa 20,152,20
Mvaa 20,156,24
buffer_load_dwordx4 v1, s[16:19], s33 offen offset:1024 sc1 lds
Mvaa 20,160,28
s_nop 0
v_exp_f32 v16, v16
Cvaa 24,148,32,224
v_exp_f32 v17, v17
Mvaa 24,152,36
buffer_load_dwordx4 v1, s[16:19], s33 offen offset:2048 sc1 lds
Mvaa 24,156,40
v_exp_f32 v18, v18
Mvaa 24,160,44
v_exp_f32 v19, v19
Cvaa 28,148,48,228
buffer_load_dwordx4 v1, s[16:19], s33 offen offset:3072 sc1 lds
Mvaa 28,152,52
v_exp_f32 v20, v20
Mvaa 28,156,56
v_exp_f32 v21, v21
Mvaa 28,160,60
s_waitcnt lgkmcnt(8)
buffer_store_dwordx4 v[144:147], v1, s[16:19], s73 offen sc0 sc1
PK 80,16,17
PK 81,18,19
s_add_u32 s73, s42, 0x3000000
Cvaa 32,164,0,236
s_add_u32 m0, s38, 0x9000
v_exp_f32 v22, v22
Mvaa 32,168,4
v_exp_f32 v23, v23
Mvaa 32,172,8
buffer_load_dwordx4 v2, s[16:19], s33 offen sc1 lds
Mvaa 32,176,12
v_exp_f32 v24, v24
Cvaa 36,164,16,220
v_exp_f32 v25, v25
Mvaa 36,168,20
buffer_load_dwordx4 v2, s[16:19], s33 offen offset:1024 sc1 lds
Mvaa 36,172,24
v_exp_f32 v26, v26
Mvaa 36,176,28
v_exp_f32 v27, v27
Cvaa 40,164,32,224
buffer_load_dwordx4 v2, s[16:19], s33 offen offset:2048 sc1 lds
Mvaa 40,168,36
PK 84,20,21
PK 85,22,23
Mvaa 40,172,40
v_exp_f32 v28, v28
Mvaa 40,176,44
v_exp_f32 v29, v29
Cvaa 44,164,48,228
buffer_load_dwordx4 v2, s[16:19], s33 offen offset:3072 sc1 lds
Mvaa 44,168,52
v_exp_f32 v30, v30
Mvaa 44,172,56
v_exp_f32 v31, v31
Mvaa 44,176,60
s_waitcnt vmcnt(50) lgkmcnt(0)
s_barrier
Cvaa 60,180,48,240
s_add_u32 s33, s33, 0x2000
s_cmp_eq_u32 s33, s35
s_cselect_b32 s33, s29, s33
La 148,3,8192
Mvaa 60,184,52
La 152,3,49152
La 156,4,24576
La 160,5,0
Mvaa 60,188,56
La 164,3,9216
PK 88,24,25
Mvaa 60,192,60
La 168,3,50176
PK 89,26,27
Cvaa 76,196,48,244
La 172,4,25600
PK 92,28,29
Mvaa 76,200,52
La 176,5,1024
PK 93,30,31
Mvaa 76,204,56
v_exp_f32 v32, v32
Mvaa 76,208,60
s_waitcnt lgkmcnt(4)
v_exp_f32 v33, v33
Cvaa 16,148,0,216
La 180,6,8192
PK 148,148,149
Mvaa 16,152,4
La 184,6,49152
PK 149,150,151
Mvaa 16,156,8
La 188,7,24576
PK 150,156,157
Mvaa 16,160,12
La 192,8,0
PK 151,158,159
Cvaa 20,148,16,220
buffer_store_dwordx4 v[148:151], v1, s[16:19], s73 offen sc0 sc1
La 196,6,9216
v_exp_f32 v34, v34
Mvaa 20,152,20
s_add_u32 s73, s41, 0x3020000
La 200,6,50176
PK 160,160,161
Mvaa 20,156,24
La 204,7,25600
PK 161,162,163
Mvaa 20,160,28
La 208,8,1024
PK 162,168,169
Cvaa 24,148,32,224
v_exp_f32 v35, v35
Mvaa 24,152,36
v_exp_f32 v36, v36
Mvaa 24,156,40
v_exp_f32 v37, v37
Mvaa 24,160,44
v_exp_f32 v38, v38
Cvaa 28,148,48,228
v_exp_f32 v39, v39
Mvaa 28,152,52
PK 82,32,33
PK 83,34,35
Mvaa 28,156,56
v_exp_f32 v40, v40
Mvaa 28,160,60
s_waitcnt lgkmcnt(8)
v_exp_f32 v41, v41
Cvaa 32,164,0,216
v_exp_f32 v42, v42
Mvaa 32,168,4
v_exp_f32 v43, v43
Mvaa 32,172,8
PK 86,36,37
PK 87,38,39
Mvaa 32,176,12
v_exp_f32 v44, v44
Cvaa 36,164,16,220
v_exp_f32 v45, v45
Mvaa 36,168,20
v_exp_f32 v46, v46
Mvaa 36,172,24
PK 90,40,41
PK 91,42,43
Mvaa 36,176,28
v_exp_f32 v47, v47
Cvaa 40,164,32,224
v_exp_f32 v60, v60
Mvaa 40,168,36
v_exp_f32 v61, v61
Mvaa 40,172,40
PK 94,44,45
PK 95,46,47
Mvaa 40,176,44
v_exp_f32 v62, v62
Cvaa 44,164,48,228
v_exp_f32 v63, v63
Mvaa 44,168,52
v_exp_f32 v76, v76
Mvaa 44,172,56
v_exp_f32 v77, v77
Mvaa 44,176,60
s_waitcnt vmcnt(10) lgkmcnt(0)
s_barrier
Cvaa 48,180,0,216
La 148,3,16384
PK 108,60,61
Mvaa 48,184,4
s_add_u32 m0, s38, 0
s_add_u32 s36, s60, 0
La 152,6,16384
Mvaa 48,188,8
buffer_load_dwordx4 v248, s[4:7], s36 offen lds
Mvaa 48,192,12
La 156,3,17408
PK 109,62,63
Cvaa 52,180,16,220
La 160,6,17408
PK 163,170,171
Mvaa 52,184,20
buffer_store_dwordx4 v[160:163], v1, s[16:19], s73 offen sc0 sc1
La 164,3,57344
v_exp_f32 v78, v78
Mvaa 52,188,24
s_add_u32 s73, s42, 0x3020000
La 168,6,57344
PK 164,164,165
Mvaa 52,192,28
La 172,3,58368
PK 165,166,167
Cvaa 56,180,32,224
buffer_load_dwordx4 v249, s[4:7], s36 offen offset:1024 lds
Mvaa 56,184,36
La 176,6,58368
PK 166,172,173
Mvaa 56,188,40
v_exp_f32 v79, v79
Mvaa 56,192,44
buffer_load_dwordx4 v250, s[4:7], s36 offen offset:2048 lds
Cvaa 60,180,48,228
v_exp_f32 v16, v16
Mvaa 60,184,52
v_exp_f32 v17, v17
Mvaa 60,188,56
v_exp_f32 v18, v18
Mvaa 60,192,60
v_exp_f32 v19, v19
Cvaa 64,196,0,216
buffer_load_dwordx4 v251, s[4:7], s36 offen offset:3072 lds
Mvaa 64,200,4
La 180,4,32768
PK 110,76,77
Mvaa 64,204,8
La 184,7,32768
PK 111,78,79
Mvaa 64,208,12
La 188,4,33792
PK 167,174,175
Cvaa 68,196,16,220
buffer_store_dwordx4 v[164:167], v1, s[16:19], s73 offen sc0 sc1
La 192,7,33792
s_add_u32 s73, s41, 0x3040000
PK 176,176,177
Mvaa 68,200,20
s_add_u32 m0, s38, 0x2000
s_add_u32 s36, s58, 0
PK 177,178,179
Mvaa 68,204,24
v_exp_f32 v20, v20
Mvaa 68,208,28
buffer_load_dwordx4 v1, s[16:19], s36 offen sc1 lds
Cvaa 72,196,32,224
v_exp_f32 v21, v21
Mvaa 72,200,36
v_exp_f32 v22, v22
Mvaa 72,204,40
buffer_load_dwordx4 v1, s[16:19], s36 offen offset:1024 sc1 lds
Mvaa 72,208,44
v_exp_f32 v23, v23
Cvaa 76,196,48,228
PK 178,184,185
PK 179,186,187
Mvaa 76,200,52
buffer_store_dwordx4 v[176:179], v1, s[16:19], s73 offen sc0 sc1
PK 112,16,17
PK 113,18,19
s_add_u32 s73, s42, 0x3040000
Mvaa 76,204,56
v_exp_f32 v24, v24
Mvaa 76,208,60
v_exp_f32 v25, v25
Zaav 128,144,80
buffer_load_dwordx4 v253, s[16:19], s36 offen offset:2048 sc1 lds
Zaav 132,144,84
La 196,5,8192
PK 180,180,181
Zaav 136,144,88
La 200,8,8192
PK 181,182,183
Zaav 140,144,92
La 204,5,9216
PK 182,188,189
Maav 140,144,108
s_waitcnt lgkmcnt(11)
buffer_load_dwordx4 v253, s[16:19], s36 offen offset:3072 sc1 lds
Zvav 144,148,80
La 208,8,9216
PK 116,20,21
Zvav 148,148,84
v_exp_f32 v26, v26
Zaav 64,148,88
v_exp_f32 v27, v27
Zaav 68,148,92
PK 183,190,191
PK 117,22,23
Maav 68,152,108
buffer_store_dwordx4 v[180:183], v1, s[16:19], s73 offen sc0 sc1
s_add_u32 m0, s38, 0x1000
s_add_u32 s36, s60, 0x9000
PK 120,24,25
Zvav 152,156,80
s_add_u32 s73, s41, 0x3060000
v_exp_f32 v28, v28
Zvav 156,156,84
v_exp_f32 v29, v29
Zaav 72,156,88
buffer_load_dwordx4 v248, s[4:7], s36 offen lds
Zaav 76,156,92
v_exp_f32 v30, v30
Maav 76,160,108
s_waitcnt lgkmcnt(8)
v_exp_f32 v31, v31
Zvav 160,164,80
buffer_load_dwordx4 v249, s[4:7], s36 offen offset:1024 lds
Zvav 164,164,84
PK 121,26,27
PK 124,28,29
Zaav 80,164,88
v_exp_f32 v32, v32
Zaav 84,164,92
v_exp_f32 v33, v33
Maav 84,168,108
buffer_load_dwordx4 v250, s[4:7], s36 offen offset:2048 lds
Zvav 168,172,80
v_exp_f32 v34, v34
Zvav 172,172,84
v_exp_f32 v35, v35
Zaav 88,172,88
PK 125,30,31
PK 192,192,193
Zaav 92,172,92
v_exp_f32 v36, v36
Maav 92,176,108
s_waitcnt vmcnt(16) lgkmcnt(0)
s_barrier
Zvav 176,180,80
buffer_load_dwordx4 v251, s[4:7], s36 offen offset:3072 lds
Zvav 180,180,84
La 148,3,32768
PK 193,194,195
Zaav 96,180,88
PK 194,200,201
PK 195,202,203
Zaav 100,180,92
v_exp_f32 v37, v37
Maav 100,184,108
buffer_store_dwordx4 v[192:195], v1, s[16:19], s73 offen sc0 sc1
PK 114,32,33
v_exp_f32 v38, v38
Zvav 184,188,80
s_add_u32 s73, s42, 0x3060000
PK 115,34,35
PK 196,196,197
Zvav 188,188,84
s_add_u32 m0, s38, 0x3000
v_exp_f32 v40, v40
Zaav 104,188,88
PK 197,198,199
PK 198,204,205
PK 199,206,207
buffer_store_dwordx4 v[196:199], v1, s[16:19], s73 offen sc0 sc1
v_exp_f32 v39, v39
PK 118,36,37
Zaav 108,188,92
s_add_u32 s36, s61, 0
v_exp_f32 v41, v41
Maav 108,192,108
La 152,6,32768
PK 119,38,39
Zvav 192,196,80
buffer_load_dwordx4 v252, s[4:7], s36 offen lds
Zvav 196,196,84
s_add_u32 m0, s38, 0x3400
La 156,3,33792
La 160,6,33792
Zaav 112,196,88
s_add_u32 s36, s61, 0x12000
v_exp_f32 v42, v42
Zaav 116,196,92
v_exp_f32 v44, v44
Maav 116,200,108
v_exp_f32 v43, v43
Zvav 200,204,80
La 164,4,8192
La 168,7,8192
La 172,4,9216
La 176,7,9216
buffer_load_dwordx4 v252, s[4:7], s36 offen lds
Zvav 204,204,84
v_exp_f32 v45, v45
Zaav 120,204,88
PK 122,40,41
PK 123,42,43
Zaav 124,204,92
v_exp_f32 v46, v46
Maav 124,208,108
La 180,4,49152
La 184,7,49152
La 188,4,50176
La 192,7,50176
v_exp_f32 v56, v56
v_exp_f32 v57, v57
v_exp_f32 v58, v58
v_exp_f32 v59, v59
PK 136,56,57
PK 137,58,59
v_exp_f32 v72, v72
v_exp_f32 v73, v73
v_exp_f32 v74, v74
v_exp_f32 v75, v75
PK 138,72,73
PK 139,74,75
Maav 136,144,120
v_exp_f32 v47, v47
PK 126,44,45
PK 127,46,47
Maav 136,144,136
v_exp_f32 v60, v60
v_exp_f32 v61, v61
v_exp_f32 v62, v62
v_exp_f32 v63, v63
PK 140,60,61
PK 141,62,63
v_exp_f32 v76, v76
v_exp_f32 v77, v77
v_exp_f32 v78, v78
v_exp_f32 v79, v79
PK 142,76,77
PK 143,78,79
Maav 140,144,124
La 196,5,24576
v_accvgpr_read_b32 v232, a252
Maav 140,144,140
s_waitcnt lgkmcnt(9)
La 200,8,24576
v_accvgpr_read_b32 v244, a253
Maav 64,148,120
La 204,5,25600
La 208,8,25600
Maav 64,152,136
v_exp_f32 v48, v48
Maav 68,148,124
v_exp_f32 v49, v49
Maav 68,152,140
v_exp_f32 v50, v50
Maav 72,156,120
v_exp_f32 v52, v52
Maav 72,160,136
v_exp_f32 v51, v51
Maav 76,156,124
v_exp_f32 v53, v53
Maav 76,160,140
s_waitcnt lgkmcnt(0)
s_barrier
Maav 80,164,120
ds_write_b32 v9, a136 offset:15360
Maav 80,168,136
ds_write_b32 v9, a140 offset:15364
Maav 84,164,124
ds_write_b128 v9, a[64:67] offset:24576
Maav 84,168,140
v_exp_f32 v54, v54
Maav 88,172,120
ds_write_b128 v9, a[68:71] offset:25600
Maav 88,176,136
v_exp_f32 v55, v55
Maav 92,172,124
PK 128,48,49
PK 129,50,51
Maav 92,176,140
ds_write_b128 v9, a[72:75] offset:26624
Maav 96,180,120
v_exp_f32 v64, v64
Maav 96,184,136
ds_write_b128 v9, a[76:79] offset:27648
Maav 100,180,124
v_exp_f32 v65, v65
Maav 100,184,140
v_exp_f32 v66, v66
Maav 104,188,120
ds_write_b128 v9, a[80:83] offset:28672
Maav 104,192,136
v_exp_f32 v67, v67
Maav 108,188,124
ds_write_b128 v9, a[84:87] offset:29696
Maav 108,192,140
PK 132,52,53
PK 133,54,55
Maav 112,196,120
v_exp_f32 v68, v68
Maav 112,200,136
ds_write_b128 v9, a[88:91] offset:30720
Maav 116,196,124
v_exp_f32 v69, v69
Maav 116,200,140
ds_write_b128 v9, a[92:95] offset:31744
Maav 120,204,120
v_exp_f32 v70, v70
Maav 120,208,136
v_exp_f32 v71, v71
Maav 124,204,124
ds_write_b128 v9, a[96:99] offset:32768
Maav 124,208,140
PK 130,64,65
PK 131,66,67
Maav 128,144,112
ds_write_b128 v9, a[100:103] offset:33792
Maav 128,144,128
PK 134,68,69
PK 135,70,71
Maav 132,144,116
v_accvgpr_read_b32 v240, a254
v_xor_b32 v233, 32, v232
Maav 132,144,132
ds_write_b128 v9, a[104:107] offset:34816
Mvav 144,148,112
v_accvgpr_read_b32 v245, a255
v_add_u32 v234, 0xa000, v232
Mvav 144,152,128
ds_write_b128 v9, a[108:111] offset:35840
Mvav 148,148,116
v_add_u32 v235, 0xa000, v233
v_add_u32 v236, 0x14000, v232
Mvav 148,152,132
v_add_u32 v237, 0x14000, v233
v_add_u32 v238, 0x1e000, v232
Mvav 152,156,112
ds_write_b128 v9, a[112:115] offset:36864
Mvav 152,160,128
v_add_u32 v239, 0x1e000, v233
v_add_u32 v241, 0xa000, v240
Mvav 156,156,116
ds_write_b128 v9, a[116:119] offset:37888
Mvav 156,160,132
v_add_u32 v242, 0x14000, v240
v_add_u32 v243, 0x1e000, v240
Mvav 160,164,112
v_accvgpr_read_b32 v82, a128
v_accvgpr_read_b32 v83, a132
Mvav 160,168,128
ds_write_b128 v9, a[120:123] offset:38912
Mvav 164,164,116
Mvav 164,168,132
ds_write_b128 v9, a[124:127] offset:39936
Mvav 168,172,112
Mvav 168,176,128
Mvav 172,172,116
Mvav 172,176,132
s_waitcnt vmcnt(1) lgkmcnt(0)
s_barrier
Mvav 176,180,112
ds_read_b64 v[80:81], v10 offset:15360
Mvav 176,184,128
Lv 16,10,24576
Mvav 180,180,116
Lv 20,10,25600
Mvav 180,184,132
Lv 24,10,26624
Mvav 184,188,112
Lv 28,10,27648
Mvav 184,192,128
s_waitcnt vmcnt(33) lgkmcnt(4)
Lv 32,10,28672
v_add_f32 v80, v80, v82
Mvav 188,188,116
Lv 36,10,29696
v_add_f32 v81, v81, v83
Mvav 188,192,132
Lv 40,10,30720
Mvav 192,196,112
Lv 44,10,31744
Mvav 192,200,128
Lv 48,10,32768
Mvav 196,196,116
Lv 52,10,33792
Mvav 196,200,132
Lv 56,10,34816
Mvav 200,204,112
Lv 60,10,35840
Mvav 200,208,128
Lv 64,10,36864
Mvav 204,204,116
Lv 68,10,37888
Mvav 204,208,132
Lv 72,10,38912
Lv 76,10,39936
v_rcp_f32 v84, v80
v_rcp_f32 v86, v81
v_min_f32 v90, v80, v81
v_max_f32 v91, v80, v81
v_mul_f32 v84, v84, v13
v_mul_f32 v86, v86, v14
v_mov_b32 v85, v84
v_mov_b32 v87, v86
Ta 32,232,0
Ta 34,232,2048
Ta 36,232,4096
Ta 38,232,6144
La 0,244,8192
La 4,244,10240
v_cmp_gt_f32 vcc, 0x2b800000, v90
s_nop 0
s_or_b32 s49, s49, vcc_lo
s_or_b32 s49, s49, vcc_hi
v_cmp_lt_f32 vcc, 0x5f800000, v91
s_nop 0
s_or_b32 s49, s49, vcc_lo
s_or_b32 s49, s49, vcc_hi
s_waitcnt lgkmcnt(15)
s_add_u32 m0, s38, 0x4000
s_add_u32 s36, s58, 0x40000
buffer_load_dwordx4 v1, s[16:19], s36 offen sc1 lds
buffer_load_dwordx4 v1, s[16:19], s36 offen offset:1024 sc1 lds
v_pk_add_f32 v[144:145], v[144:145], v[16:17]
v_pk_add_f32 v[146:147], v[146:147], v[18:19]
v_pk_add_f32 v[148:149], v[148:149], v[20:21]
v_pk_add_f32 v[150:151], v[150:151], v[22:23]
v_pk_mul_f32 v[144:145], v[144:145], v[84:85]
v_pk_mul_f32 v[146:147], v[146:147], v[84:85]
v_pk_mul_f32 v[148:149], v[148:149], v[86:87]
v_pk_mul_f32 v[150:151], v[150:151], v[86:87]
v_pk_fma_f32 v[80:81], v[144:145], v[146:147], v[80:81]
v_pk_fma_f32 v[80:81], v[148:149], v[150:151], v[80:81]
s_waitcnt lgkmcnt(15)
buffer_load_dwordx4 v253, s[16:19], s36 offen offset:2048 sc1 lds
buffer_load_dwordx4 v253, s[16:19], s36 offen offset:3072 sc1 lds
v_pk_add_f32 v[152:153], v[152:153], v[24:25]
v_pk_add_f32 v[154:155], v[154:155], v[26:27]
v_pk_add_f32 v[156:157], v[156:157], v[28:29]
v_pk_add_f32 v[158:159], v[158:159], v[30:31]
v_pk_mul_f32 v[152:153], v[152:153], v[84:85]
v_pk_mul_f32 v[154:155], v[154:155], v[84:85]
v_pk_mul_f32 v[156:157], v[156:157], v[86:87]
v_pk_mul_f32 v[158:159], v[158:159], v[86:87]
v_pk_fma_f32 v[80:81], v[152:153], v[154:155], v[80:81]
v_pk_fma_f32 v[80:81], v[156:157], v[158:159], v[80:81]
s_waitcnt lgkmcnt(15)
s_add_u32 m0, s38, 0x5000
s_add_u32 s36, s60, 0x12000
buffer_load_dwordx4 v248, s[4:7], s36 offen lds
buffer_load_dwordx4 v249, s[4:7], s36 offen offset:1024 lds
v_pk_add_f32 v[160:161], v[160:161], v[32:33]
v_pk_add_f32 v[162:163], v[162:163], v[34:35]
v_pk_add_f32 v[164:165], v[164:165], v[36:37]
v_pk_add_f32 v[166:167], v[166:167], v[38:39]
v_pk_mul_f32 v[160:161], v[160:161], v[84:85]
v_pk_mul_f32 v[162:163], v[162:163], v[84:85]
v_pk_mul_f32 v[164:165], v[164:165], v[86:87]
v_pk_mul_f32 v[166:167], v[166:167], v[86:87]
v_pk_fma_f32 v[80:81], v[160:161], v[162:163], v[80:81]
v_pk_fma_f32 v[80:81], v[164:165], v[166:167], v[80:81]
s_waitcnt lgkmcnt(14)
Ta 40,233,0
Ta 42,233,2048
Ta 44,233,4096
Ta 46,233,6144
Ta 48,234,0
Ta 50,234,2048
Ta 52,234,4096
Ta 54,234,6144
La 8,244,9216
La 12,244,11264
buffer_load_dwordx4 v250, s[4:7], s36 offen offset:2048 lds
buffer_load_dwordx4 v251, s[4:7], s36 offen offset:3072 lds
v_pk_add_f32 v[168:169], v[168:169], v[40:41]
v_pk_add_f32 v[170:171], v[170:171], v[42:43]
v_pk_add_f32 v[172:173], v[172:173], v[44:45]
v_pk_add_f32 v[174:175], v[174:175], v[46:47]
v_pk_mul_f32 v[168:169], v[168:169], v[84:85]
v_pk_mul_f32 v[170:171], v[170:171], v[84:85]
v_pk_mul_f32 v[172:173], v[172:173], v[86:87]
v_pk_mul_f32 v[174:175], v[174:175], v[86:87]
v_pk_fma_f32 v[80:81], v[168:169], v[170:171], v[80:81]
v_pk_fma_f32 v[80:81], v[172:173], v[174:175], v[80:81]
s_waitcnt lgkmcnt(15)
s_add_u32 m0, s38, 0x8000
s_add_u32 s36, s60, 0x1b000
buffer_load_dwordx4 v248, s[4:7], s36 offen lds
buffer_load_dwordx4 v249, s[4:7], s36 offen offset:1024 lds
v_pk_add_f32 v[176:177], v[176:177], v[48:49]
v_pk_add_f32 v[178:179], v[178:179], v[50:51]
v_pk_add_f32 v[180:181], v[180:181], v[52:53]
v_pk_add_f32 v[182:183], v[182:183], v[54:55]
v_pk_mul_f32 v[176:177], v[176:177], v[84:85]
v_pk_mul_f32 v[178:179], v[178:179], v[84:85]
v_pk_mul_f32 v[180:181], v[180:181], v[86:87]
v_pk_mul_f32 v[182:183], v[182:183], v[86:87]
v_pk_fma_f32 v[80:81], v[176:177], v[178:179], v[80:81]
v_pk_fma_f32 v[80:81], v[180:181], v[182:183], v[80:81]
s_waitcnt lgkmcnt(15)
buffer_load_dwordx4 v250, s[4:7], s36 offen offset:2048 lds
buffer_load_dwordx4 v251, s[4:7], s36 offen offset:3072 lds
v_pk_add_f32 v[184:185], v[184:185], v[56:57]
v_pk_add_f32 v[186:187], v[186:187], v[58:59]
v_pk_add_f32 v[188:189], v[188:189], v[60:61]
v_pk_add_f32 v[190:191], v[190:191], v[62:63]
v_pk_mul_f32 v[184:185], v[184:185], v[84:85]
v_pk_mul_f32 v[186:187], v[186:187], v[84:85]
v_pk_mul_f32 v[188:189], v[188:189], v[86:87]
v_pk_mul_f32 v[190:191], v[190:191], v[86:87]
v_pk_fma_f32 v[80:81], v[184:185], v[186:187], v[80:81]
v_pk_fma_f32 v[80:81], v[188:189], v[190:191], v[80:81]
s_waitcnt lgkmcnt(15)
v_pk_add_f32 v[192:193], v[192:193], v[64:65]
v_pk_add_f32 v[194:195], v[194:195], v[66:67]
v_pk_add_f32 v[196:197], v[196:197], v[68:69]
v_pk_add_f32 v[198:199], v[198:199], v[70:71]
v_pk_mul_f32 v[192:193], v[192:193], v[84:85]
v_pk_mul_f32 v[194:195], v[194:195], v[84:85]
v_pk_mul_f32 v[196:197], v[196:197], v[86:87]
v_pk_mul_f32 v[198:199], v[198:199], v[86:87]
v_pk_fma_f32 v[80:81], v[192:193], v[194:195], v[80:81]
v_pk_fma_f32 v[80:81], v[196:197], v[198:199], v[80:81]
s_waitcnt lgkmcnt(15)
v_pk_add_f32 v[200:201], v[200:201], v[72:73]
v_pk_add_f32 v[202:203], v[202:203], v[74:75]
v_pk_add_f32 v[204:205], v[204:205], v[76:77]
v_pk_add_f32 v[206:207], v[206:207], v[78:79]
v_pk_mul_f32 v[200:201], v[200:201], v[84:85]
v_pk_mul_f32 v[202:203], v[202:203], v[84:85]
v_pk_mul_f32 v[204:205], v[204:205], v[86:87]
v_pk_mul_f32 v[206:207], v[206:207], v[86:87]
v_pk_fma_f32 v[80:81], v[200:201], v[202:203], v[80:81]
v_pk_fma_f32 v[80:81], v[204:205], v[206:207], v[80:81]
v_add_f32 v80, v80, v81
s_movk_i32 s37, 0x207
v_cmp_class_f32 vcc, v80, s37
s_nop 0
s_or_b32 s49, s49, vcc_lo
s_or_b32 s49, s49, vcc_hi
s_bitcmp1_b32 s2, 0
s_cbranch_scc0 M_C0
s_branch M_C1
M_DL1:
s_waitcnt vmcnt(8) lgkmcnt(8)
s_add_u32 s73, s41, 0x3000000
La 196,6,1024
Cvaa 16,148,0,216
s_add_u32 m0, s38, 0x8000
La 200,6,41984
PK 144,144,145
Mvaa 16,152,4
La 204,7,17408
PK 145,146,147
Mvaa 16,156,8
La 208,7,58368
PK 146,152,153
Mvaa 16,160,12
buffer_load_dwordx4 v1, s[16:19], s33 offen sc1 lds
Cvaa 20,148,16,220
PK 147,154,155
Mvaa 20,152,20
Mvaa 20,156,24
buffer_load_dwordx4 v1, s[16:19], s33 offen offset:1024 sc1 lds
Mvaa 20,160,28
s_nop 0
v_exp_f32 v16, v16
Cvaa 28,148,48,240
v_exp_f32 v17, v17
Mvaa 28,152,52
buffer_load_dwordx4 v1, s[16:19], s33 offen offset:2048 sc1 lds
Mvaa 28,156,56
v_exp_f32 v18, v18
Mvaa 28,160,60
s_waitcnt lgkmcnt(8)
v_exp_f32 v19, v19
Cvaa 32,164,0,216
buffer_load_dwordx4 v1, s[16:19], s33 offen offset:3072 sc1 lds
Mvaa 32,168,4
v_exp_f32 v20, v20
Mvaa 32,172,8
v_exp_f32 v21, v21
Mvaa 32,176,12
buffer_store_dwordx4 v[144:147], v1, s[16:19], s73 offen sc0 sc1
PK 80,16,17
PK 81,18,19
s_add_u32 s73, s42, 0x3000000
Cvaa 36,164,16,220
s_add_u32 m0, s38, 0x9000
v_exp_f32 v22, v22
Mvaa 36,168,20
v_exp_f32 v23, v23
Mvaa 36,172,24
buffer_load_dwordx4 v2, s[16:19], s33 offen sc1 lds
Mvaa 36,176,28
v_exp_f32 v28, v28
Cvaa 44,164,48,244
v_exp_f32 v29, v29
Mvaa 44,168,52
buffer_load_dwordx4 v2, s[16:19], s33 offen offset:1024 sc1 lds
Mvaa 44,172,56
v_exp_f32 v30, v30
Mvaa 44,176,60
s_waitcnt vmcnt(48) lgkmcnt(0)
s_barrier
Cvaa 48,180,0,232
La 148,3,8192
PK 84,20,21
Mvaa 48,184,4
La 152,3,49152
La 156,4,24576
La 160,5,0
Mvaa 48,188,8
buffer_load_dwordx4 v2, s[16:19], s33 offen offset:2048 sc1 lds
Mvaa 48,192,12
La 164,3,9216
PK 85,22,23
Cvaa 52,180,16,220
La 168,3,50176
PK 148,148,149
Mvaa 52,184,20
buffer_load_dwordx4 v2, s[16:19], s33 offen offset:3072 sc1 lds
Mvaa 52,188,24
La 172,4,25600
PK 149,150,151
Mvaa 52,192,28
La 176,5,1024
PK 150,156,157
Cvaa 64,196,0,236
s_add_u32 s33, s33, 0x2000
s_cmp_eq_u32 s33, s35
s_cselect_b32 s33, s29, s33
PK 151,158,159
Mvaa 64,200,4
buffer_store_dwordx4 v[148:151], v1, s[16:19], s73 offen sc0 sc1
v_exp_f32 v31, v31
PK 92,28,29
Mvaa 64,204,8
s_add_u32 s73, s41, 0x3020000
v_exp_f32 v32, v32
Mvaa 64,208,12
v_exp_f32 v33, v33
Cvaa 68,196,16,220
v_exp_f32 v34, v34
Mvaa 68,200,20
v_exp_f32 v35, v35
Mvaa 68,204,24
PK 93,30,31
PK 82,32,33
Mvaa 68,208,28
s_waitcnt lgkmcnt(4)
v_exp_f32 v36, v36
Cvaa 16,148,0,216
La 180,6,8192
PK 83,34,35
Mvaa 16,152,4
La 184,6,49152
PK 160,160,161
Mvaa 16,156,8
La 188,7,24576
PK 161,162,163
Mvaa 16,160,12
La 192,8,0
PK 162,168,169
Cvaa 20,148,16,220
La 196,6,9216
PK 163,170,171
Mvaa 20,152,20
buffer_store_dwordx4 v[160:163], v1, s[16:19], s73 offen sc0 sc1
La 200,6,50176
v_exp_f32 v37, v37
Mvaa 20,156,24
s_add_u32 s73, s42, 0x3020000
La 204,7,25600
PK 164,164,165
Mvaa 20,160,28
La 208,8,1024
PK 165,166,167
Cvaa 24,148,32,224
v_exp_f32 v38, v38
Mvaa 24,152,36
v_exp_f32 v39, v39
Mvaa 24,156,40
v_exp_f32 v44, v44
Mvaa 24,160,44
v_exp_f32 v45, v45
Cvaa 28,148,48,228
v_exp_f32 v46, v46
Mvaa 28,152,52
v_exp_f32 v47, v47
Mvaa 28,156,56
PK 86,36,37
PK 87,38,39
Mvaa 28,160,60
s_waitcnt lgkmcnt(8)
v_exp_f32 v48, v48
Cvaa 32,164,0,216
v_exp_f32 v49, v49
Mvaa 32,168,4
v_exp_f32 v50, v50
Mvaa 32,172,8
v_exp_f32 v51, v51
Mvaa 32,176,12
PK 94,44,45
PK 95,46,47
Cvaa 36,164,16,220
v_exp_f32 v52, v52
Mvaa 36,168,20
v_exp_f32 v53, v53
Mvaa 36,172,24
v_exp_f32 v54, v54
Mvaa 36,176,28
v_exp_f32 v55, v55
Cvaa 40,164,32,224
PK 96,48,49
PK 97,50,51
Mvaa 40,168,36
v_exp_f32 v64, v64
Mvaa 40,172,40
v_exp_f32 v65, v65
Mvaa 40,176,44
v_exp_f32 v66, v66
Cvaa 44,164,48,228
v_exp_f32 v67, v67
Mvaa 44,168,52
PK 100,52,53
PK 101,54,55
Mvaa 44,172,56
v_exp_f32 v68, v68
Mvaa 44,176,60
s_waitcnt vmcnt(11) lgkmcnt(0)
s_barrier
Cvaa 48,180,0,216
La 148,3,16384
PK 98,64,65
Mvaa 48,184,4
s_add_u32 m0, s38, 0
s_add_u32 s36, s60, 0
La 152,6,16384
Mvaa 48,188,8
buffer_load_dwordx4 v248, s[4:7], s36 offen lds
Mvaa 48,192,12
La 156,3,17408
PK 99,66,67
Cvaa 52,180,16,220
La 160,6,17408
PK 166,172,173
Mvaa 52,184,20
La 164,3,57344
PK 167,174,175
Mvaa 52,188,24
buffer_load_dwordx4 v249, s[4:7], s36 offen offset:1024 lds
Mvaa 52,192,28
v_exp_f32 v69, v69
Cvaa 56,180,32,224
v_exp_f32 v70, v70
Mvaa 56,184,36
buffer_store_dwordx4 v[164:167], v1, s[16:19], s73 offen sc0 sc1
v_exp_f32 v71, v71
PK 102,68,69
Mvaa 56,188,40
s_add_u32 s73, s41, 0x3040000
La 168,6,57344
PK 103,70,71
Mvaa 56,192,44
La 172,3,58368
PK 176,176,177
Cvaa 60,180,48,228
buffer_load_dwordx4 v250, s[4:7], s36 offen offset:2048 lds
Mvaa 60,184,52
La 176,6,58368
PK 177,178,179
Mvaa 60,188,56
v_exp_f32 v16, v16
Mvaa 60,192,60
v_exp_f32 v17, v17
Cvaa 64,196,0,216
buffer_load_dwordx4 v251, s[4:7], s36 offen offset:3072 lds
Mvaa 64,200,4
La 180,4,32768
PK 178,184,185
Mvaa 64,204,8
La 184,7,32768
PK 179,186,187
Mvaa 64,208,12
buffer_store_dwordx4 v[176:179], v1, s[16:19], s73 offen sc0 sc1
La 188,4,33792
La 192,7,33792
Cvaa 68,196,16,220
s_add_u32 s73, s42, 0x3040000
v_exp_f32 v18, v18
Mvaa 68,200,20
s_add_u32 m0, s38, 0x2000
s_add_u32 s36, s58, 0
PK 180,180,181
Mvaa 68,204,24
buffer_load_dwordx4 v1, s[16:19], s36 offen sc1 lds
Mvaa 68,208,28
v_exp_f32 v20, v20
Cvaa 72,196,32,224
v_exp_f32 v19, v19
Mvaa 72,200,36
v_exp_f32 v21, v21
Mvaa 72,204,40
buffer_load_dwordx4 v1, s[16:19], s36 offen offset:1024 sc1 lds
Mvaa 72,208,44
v_exp_f32 v22, v22
Cvaa 76,196,48,228
v_exp_f32 v23, v23
Mvaa 76,200,52
PK 112,16,17
PK 113,18,19
Mvaa 76,204,56
v_exp_f32 v24, v24
Mvaa 76,208,60
buffer_load_dwordx4 v253, s[16:19], s36 offen offset:2048 sc1 lds
Zaav 128,144,80
La 196,5,8192
PK 116,20,21
Maav 128,144,96
La 200,8,8192
PK 117,22,23
Zaav 132,144,84
La 204,5,9216
PK 181,182,183
Maav 132,144,100
La 208,8,9216
PK 182,188,189
Zaav 140,144,92
s_waitcnt lgkmcnt(12)
buffer_load_dwordx4 v253, s[16:19], s36 offen offset:3072 sc1 lds
Zvav 144,148,80
v_exp_f32 v25, v25
Mvav 144,152,96
v_exp_f32 v26, v26
Zvav 148,148,84
v_exp_f32 v28, v28
Mvav 148,152,100
v_exp_f32 v27, v27
Zaav 68,148,92
s_add_u32 m0, s38, 0x1000
s_add_u32 s36, s60, 0x9000
PK 183,190,191
Zvav 152,156,80
buffer_load_dwordx4 v248, s[4:7], s36 offen lds
Mvav 152,160,96
v_exp_f32 v29, v29
Zvav 156,156,84
v_exp_f32 v30, v30
Mvav 156,160,100
buffer_store_dwordx4 v[180:183], v1, s[16:19], s73 offen sc0 sc1
PK 120,24,25
PK 121,26,27
s_add_u32 s73, s41, 0x3060000
Zaav 76,156,92
s_waitcnt lgkmcnt(8)
v_exp_f32 v32, v32
Zvav 160,164,80
v_exp_f32 v31, v31
Mvav 160,168,96
buffer_load_dwordx4 v249, s[4:7], s36 offen offset:1024 lds
Zvav 164,164,84
v_exp_f32 v33, v33
Mvav 164,168,100
v_exp_f32 v34, v34
Zaav 84,164,92
buffer_load_dwordx4 v250, s[4:7], s36 offen offset:2048 lds
Zvav 168,172,80
v_exp_f32 v35, v35
Mvav 168,176,96
PK 124,28,29
PK 125,30,31
Zvav 172,172,84
v_exp_f32 v36, v36
Mvav 172,176,100
v_exp_f32 v37, v37
Zaav 92,172,92
s_waitcnt vmcnt(16) lgkmcnt(0)
s_barrier
Zvav 176,180,80
buffer_load_dwordx4 v251, s[4:7], s36 offen offset:3072 lds
Mvav 176,184,96
La 148,3,32768
PK 192,192,193
Zvav 180,180,84
La 152,6,32768
PK 193,194,195
Mvav 180,184,100
PK 194,200,201
PK 114,32,33
Zaav 100,180,92
s_add_u32 m0, s38, 0x3000
v_exp_f32 v38, v38
Zvav 184,188,80
s_add_u32 s36, s61, 0
PK 195,202,203
PK 115,34,35
Mvav 184,192,96
buffer_store_dwordx4 v[192:195], v1, s[16:19], s73 offen sc0 sc1
v_exp_f32 v40, v40
s_add_u32 s73, s42, 0x3060000
Zvav 188,188,84
v_exp_f32 v39, v39
Mvav 188,192,100
PK 196,196,197
PK 197,198,199
PK 198,204,205
PK 199,206,207
buffer_store_dwordx4 v[196:199], v1, s[16:19], s73 offen sc0 sc1
v_exp_f32 v41, v41
PK 118,36,37
Zaav 108,188,92
La 156,3,33792
PK 119,38,39
Zvav 192,196,80
buffer_load_dwordx4 v252, s[4:7], s36 offen lds
Mvav 192,200,96
s_add_u32 m0, s38, 0x3400
s_add_u32 s36, s61, 0x12000
La 160,6,33792
Zvav 196,196,84
v_exp_f32 v42, v42
Mvav 196,200,100
v_exp_f32 v44, v44
Zaav 116,196,92
v_exp_f32 v43, v43
Zvav 200,204,80
La 164,4,8192
La 168,7,8192
La 172,4,9216
La 176,7,9216
buffer_load_dwordx4 v252, s[4:7], s36 offen lds
Mvav 200,208,96
v_exp_f32 v45, v45
Zvav 204,204,84
PK 122,40,41
PK 123,42,43
Mvav 204,208,100
v_exp_f32 v46, v46
Zaav 124,204,92
La 180,4,49152
La 184,7,49152
La 188,4,50176
La 192,7,50176
v_exp_f32 v56, v56
v_exp_f32 v57, v57
v_exp_f32 v58, v58
v_exp_f32 v59, v59
PK 136,56,57
PK 137,58,59
v_exp_f32 v72, v72
v_exp_f32 v73, v73
v_exp_f32 v74, v74
v_exp_f32 v75, v75
PK 138,72,73
PK 139,74,75
Maav 136,144,120
v_exp_f32 v47, v47
PK 126,44,45
PK 127,46,47
Maav 136,144,136
v_exp_f32 v60, v60
v_exp_f32 v61, v61
v_exp_f32 v62, v62
v_exp_f32 v63, v63
PK 140,60,61
PK 141,62,63
v_exp_f32 v76, v76
v_exp_f32 v77, v77
v_exp_f32 v78, v78
v_exp_f32 v79, v79
PK 142,76,77
PK 143,78,79
Maav 140,144,124
La 196,5,24576
v_accvgpr_read_b32 v232, a252
Maav 140,144,140
s_waitcnt lgkmcnt(9)
La 200,8,24576
v_accvgpr_read_b32 v244, a253
Maav 64,148,120
La 204,5,25600
La 208,8,25600
Maav 64,152,136
v_exp_f32 v48, v48
Maav 68,148,124
v_exp_f32 v49, v49
Maav 68,152,140
v_exp_f32 v50, v50
Maav 72,156,120
v_exp_f32 v52, v52
Maav 72,160,136
v_exp_f32 v51, v51
Maav 76,156,124
v_exp_f32 v53, v53
Maav 76,160,140
s_waitcnt lgkmcnt(0)
s_barrier
Maav 80,164,120
ds_write_b32 v9, a136 offset:15360
Maav 80,168,136
ds_write_b32 v9, a140 offset:15364
Maav 84,164,124
ds_write_b128 v9, a[64:67] offset:24576
Maav 84,168,140
v_exp_f32 v54, v54
Maav 88,172,120
ds_write_b128 v9, a[68:71] offset:25600
Maav 88,176,136
v_exp_f32 v55, v55
Maav 92,172,124
PK 128,48,49
PK 129,50,51
Maav 92,176,140
ds_write_b128 v9, a[72:75] offset:26624
Maav 96,180,120
v_exp_f32 v64, v64
Maav 96,184,136
ds_write_b128 v9, a[76:79] offset:27648
Maav 100,180,124
v_exp_f32 v65, v65
Maav 100,184,140
v_exp_f32 v66, v66
Maav 104,188,120
ds_write_b128 v9, a[80:83] offset:28672
Maav 104,192,136
v_exp_f32 v67, v67
Maav 108,188,124
ds_write_b128 v9, a[84:87] offset:29696
Maav 108,192,140
PK 132,52,53
PK 133,54,55
Maav 112,196,120
v_exp_f32 v68, v68
Maav 112,200,136
ds_write_b128 v9, a[88:91] offset:30720
Maav 116,196,124
v_exp_f32 v69, v69
Maav 116,200,140
ds_write_b128 v9, a[92:95] offset:31744
Maav 120,204,120
v_exp_f32 v70, v70
Maav 120,208,136
v_exp_f32 v71, v71
Maav 124,204,124
ds_write_b128 v9, a[96:99] offset:32768
Maav 124,208,140
PK 130,64,65
PK 131,66,67
Maav 128,144,112
ds_write_b128 v9, a[100:103] offset:33792
Maav 128,144,128
PK 134,68,69
PK 135,70,71
Maav 132,144,116
v_accvgpr_read_b32 v240, a254
v_xor_b32 v233, 32, v232
Maav 132,144,132
ds_write_b128 v9, a[104:107] offset:34816
Mvav 144,148,112
v_accvgpr_read_b32 v245, a255
v_add_u32 v234, 0xa000, v232
Mvav 144,152,128
ds_write_b128 v9, a[108:111] offset:35840
Mvav 148,148,116
v_add_u32 v235, 0xa000, v233
v_add_u32 v236, 0x14000, v232
Mvav 148,152,132
v_add_u32 v237, 0x14000, v233
v_add_u32 v238, 0x1e000, v232
Mvav 152,156,112
ds_write_b128 v9, a[112:115] offset:36864
Mvav 152,160,128
v_add_u32 v239, 0x1e000, v233
v_add_u32 v241, 0xa000, v240
Mvav 156,156,116
ds_write_b128 v9, a[116:119] offset:37888
Mvav 156,160,132
v_add_u32 v242, 0x14000, v240
v_add_u32 v243, 0x1e000, v240
Mvav 160,164,112
v_accvgpr_read_b32 v82, a128
v_accvgpr_read_b32 v83, a132
Mvav 160,168,128
ds_write_b128 v9, a[120:123] offset:38912
Mvav 164,164,116
Mvav 164,168,132
ds_write_b128 v9, a[124:127] offset:39936
Mvav 168,172,112
Mvav 168,176,128
Mvav 172,172,116
Mvav 172,176,132
s_waitcnt vmcnt(1) lgkmcnt(0)
s_barrier
Mvav 176,180,112
ds_read_b64 v[80:81], v10 offset:15360
Mvav 176,184,128
Lv 16,10,24576
Mvav 180,180,116
Lv 20,10,25600
Mvav 180,184,132
Lv 24,10,26624
Mvav 184,188,112
Lv 28,10,27648
Mvav 184,192,128
s_waitcnt vmcnt(33) lgkmcnt(4)
Lv 32,10,28672
v_add_f32 v80, v80, v82
Mvav 188,188,116
Lv 36,10,29696
v_add_f32 v81, v81, v83
Mvav 188,192,132
Lv 40,10,30720
Mvav 192,196,112
Lv 44,10,31744
Mvav 192,200,128
Lv 48,10,32768
Mvav 196,196,116
Lv 52,10,33792
Mvav 196,200,132
Lv 56,10,34816
Mvav 200,204,112
Lv 60,10,35840
Mvav 200,208,128
Lv 64,10,36864
Mvav 204,204,116
Lv 68,10,37888
Mvav 204,208,132
Lv 72,10,38912
Lv 76,10,39936
v_rcp_f32 v84, v80
v_rcp_f32 v86, v81
v_min_f32 v90, v80, v81
v_max_f32 v91, v80, v81
v_mul_f32 v84, v84, v13
v_mul_f32 v86, v86, v14
v_mov_b32 v85, v84
v_mov_b32 v87, v86
Ta 32,232,0
Ta 34,232,2048
Ta 36,232,4096
Ta 38,232,6144
La 0,244,8192
La 4,244,10240
v_cmp_gt_f32 vcc, 0x2b800000, v90
s_nop 0
s_or_b32 s49, s49, vcc_lo
s_or_b32 s49, s49, vcc_hi
v_cmp_lt_f32 vcc, 0x5f800000, v91
s_nop 0
s_or_b32 s49, s49, vcc_lo
s_or_b32 s49, s49, vcc_hi
s_waitcnt lgkmcnt(15)
s_add_u32 m0, s38, 0x4000
s_add_u32 s36, s58, 0x40000
buffer_load_dwordx4 v1, s[16:19], s36 offen sc1 lds
buffer_load_dwordx4 v1, s[16:19], s36 offen offset:1024 sc1 lds
v_pk_add_f32 v[144:145], v[144:145], v[16:17]
v_pk_add_f32 v[146:147], v[146:147], v[18:19]
v_pk_add_f32 v[148:149], v[148:149], v[20:21]
v_pk_add_f32 v[150:151], v[150:151], v[22:23]
v_pk_mul_f32 v[144:145], v[144:145], v[84:85]
v_pk_mul_f32 v[146:147], v[146:147], v[84:85]
v_pk_mul_f32 v[148:149], v[148:149], v[86:87]
v_pk_mul_f32 v[150:151], v[150:151], v[86:87]
v_pk_fma_f32 v[80:81], v[144:145], v[146:147], v[80:81]
v_pk_fma_f32 v[80:81], v[148:149], v[150:151], v[80:81]
s_waitcnt lgkmcnt(15)
buffer_load_dwordx4 v253, s[16:19], s36 offen offset:2048 sc1 lds
buffer_load_dwordx4 v253, s[16:19], s36 offen offset:3072 sc1 lds
v_pk_add_f32 v[152:153], v[152:153], v[24:25]
v_pk_add_f32 v[154:155], v[154:155], v[26:27]
v_pk_add_f32 v[156:157], v[156:157], v[28:29]
v_pk_add_f32 v[158:159], v[158:159], v[30:31]
v_pk_mul_f32 v[152:153], v[152:153], v[84:85]
v_pk_mul_f32 v[154:155], v[154:155], v[84:85]
v_pk_mul_f32 v[156:157], v[156:157], v[86:87]
v_pk_mul_f32 v[158:159], v[158:159], v[86:87]
v_pk_fma_f32 v[80:81], v[152:153], v[154:155], v[80:81]
v_pk_fma_f32 v[80:81], v[156:157], v[158:159], v[80:81]
s_waitcnt lgkmcnt(15)
s_add_u32 m0, s38, 0x5000
s_add_u32 s36, s60, 0x12000
buffer_load_dwordx4 v248, s[4:7], s36 offen lds
buffer_load_dwordx4 v249, s[4:7], s36 offen offset:1024 lds
v_pk_add_f32 v[160:161], v[160:161], v[32:33]
v_pk_add_f32 v[162:163], v[162:163], v[34:35]
v_pk_add_f32 v[164:165], v[164:165], v[36:37]
v_pk_add_f32 v[166:167], v[166:167], v[38:39]
v_pk_mul_f32 v[160:161], v[160:161], v[84:85]
v_pk_mul_f32 v[162:163], v[162:163], v[84:85]
v_pk_mul_f32 v[164:165], v[164:165], v[86:87]
v_pk_mul_f32 v[166:167], v[166:167], v[86:87]
v_pk_fma_f32 v[80:81], v[160:161], v[162:163], v[80:81]
v_pk_fma_f32 v[80:81], v[164:165], v[166:167], v[80:81]
s_waitcnt lgkmcnt(14)
Ta 40,233,0
Ta 42,233,2048
Ta 44,233,4096
Ta 46,233,6144
Ta 48,234,0
Ta 50,234,2048
Ta 52,234,4096
Ta 54,234,6144
La 8,244,9216
La 12,244,11264
buffer_load_dwordx4 v250, s[4:7], s36 offen offset:2048 lds
buffer_load_dwordx4 v251, s[4:7], s36 offen offset:3072 lds
v_pk_add_f32 v[168:169], v[168:169], v[40:41]
v_pk_add_f32 v[170:171], v[170:171], v[42:43]
v_pk_add_f32 v[172:173], v[172:173], v[44:45]
v_pk_add_f32 v[174:175], v[174:175], v[46:47]
v_pk_mul_f32 v[168:169], v[168:169], v[84:85]
v_pk_mul_f32 v[170:171], v[170:171], v[84:85]
v_pk_mul_f32 v[172:173], v[172:173], v[86:87]
v_pk_mul_f32 v[174:175], v[174:175], v[86:87]
v_pk_fma_f32 v[80:81], v[168:169], v[170:171], v[80:81]
v_pk_fma_f32 v[80:81], v[172:173], v[174:175], v[80:81]
s_waitcnt lgkmcnt(15)
s_add_u32 m0, s38, 0x8000
s_add_u32 s36, s60, 0x1b000
buffer_load_dwordx4 v248, s[4:7], s36 offen lds
buffer_load_dwordx4 v249, s[4:7], s36 offen offset:1024 lds
v_pk_add_f32 v[176:177], v[176:177], v[48:49]
v_pk_add_f32 v[178:179], v[178:179], v[50:51]
v_pk_add_f32 v[180:181], v[180:181], v[52:53]
v_pk_add_f32 v[182:183], v[182:183], v[54:55]
v_pk_mul_f32 v[176:177], v[176:177], v[84:85]
v_pk_mul_f32 v[178:179], v[178:179], v[84:85]
v_pk_mul_f32 v[180:181], v[180:181], v[86:87]
v_pk_mul_f32 v[182:183], v[182:183], v[86:87]
v_pk_fma_f32 v[80:81], v[176:177], v[178:179], v[80:81]
v_pk_fma_f32 v[80:81], v[180:181], v[182:183], v[80:81]
s_waitcnt lgkmcnt(15)
buffer_load_dwordx4 v250, s[4:7], s36 offen offset:2048 lds
buffer_load_dwordx4 v251, s[4:7], s36 offen offset:3072 lds
v_pk_add_f32 v[184:185], v[184:185], v[56:57]
v_pk_add_f32 v[186:187], v[186:187], v[58:59]
v_pk_add_f32 v[188:189], v[188:189], v[60:61]
v_pk_add_f32 v[190:191], v[190:191], v[62:63]
v_pk_mul_f32 v[184:185], v[184:185], v[84:85]
v_pk_mul_f32 v[186:187], v[186:187], v[84:85]
v_pk_mul_f32 v[188:189], v[188:189], v[86:87]
v_pk_mul_f32 v[190:191], v[190:191], v[86:87]
v_pk_fma_f32 v[80:81], v[184:185], v[186:187], v[80:81]
v_pk_fma_f32 v[80:81], v[188:189], v[190:191], v[80:81]
s_waitcnt lgkmcnt(15)
v_pk_add_f32 v[192:193], v[192:193], v[64:65]
v_pk_add_f32 v[194:195], v[194:195], v[66:67]
v_pk_add_f32 v[196:197], v[196:197], v[68:69]
v_pk_add_f32 v[198:199], v[198:199], v[70:71]
v_pk_mul_f32 v[192:193], v[192:193], v[84:85]
v_pk_mul_f32 v[194:195], v[194:195], v[84:85]
v_pk_mul_f32 v[196:197], v[196:197], v[86:87]
v_pk_mul_f32 v[198:199], v[198:199], v[86:87]
v_pk_fma_f32 v[80:81], v[192:193], v[194:195], v[80:81]
v_pk_fma_f32 v[80:81], v[196:197], v[198:199], v[80:81]
s_waitcnt lgkmcnt(15)
v_pk_add_f32 v[200:201], v[200:201], v[72:73]
v_pk_add_f32 v[202:203], v[202:203], v[74:75]
v_pk_add_f32 v[204:205], v[204:205], v[76:77]
v_pk_add_f32 v[206:207], v[206:207], v[78:79]
v_pk_mul_f32 v[200:201], v[200:201], v[84:85]
v_pk_mul_f32 v[202:203], v[202:203], v[84:85]
v_pk_mul_f32 v[204:205], v[204:205], v[86:87]
v_pk_mul_f32 v[206:207], v[206:207], v[86:87]
v_pk_fma_f32 v[80:81], v[200:201], v[202:203], v[80:81]
v_pk_fma_f32 v[80:81], v[204:205], v[206:207], v[80:81]
v_add_f32 v80, v80, v81
s_movk_i32 s37, 0x207
v_cmp_class_f32 vcc, v80, s37
s_nop 0
s_or_b32 s49, s49, vcc_lo
s_or_b32 s49, s49, vcc_hi
s_bitcmp1_b32 s2, 0
s_cbranch_scc0 M_C0
s_branch M_C1
.p2align 12
M_Z0:
s_waitcnt vmcnt(8) lgkmcnt(8)
s_add_u32 s73, s41, 0x3000000
La 196,6,1024
Cvaa 16,148,0,232
La 200,6,41984
PK 144,144,145
Mvaa 16,152,4
La 204,7,17408
PK 145,146,147
Mvaa 16,156,8
La 208,7,58368
PK 146,152,153
Mvaa 16,160,12
PK 147,154,155
Cvaa 20,148,16,220
buffer_store_dwordx4 v[144:147], v1, s[16:19], s73 offen sc0 sc1
Mvaa 20,152,20
s_add_u32 s73, s42, 0x3000000
PK 148,148,149
PK 149,150,151
Mvaa 20,156,24
PK 150,156,157
PK 151,158,159
Mvaa 20,160,28
v_exp_f32 v16, v16
Cvaa 24,148,32,224
buffer_store_dwordx4 v[148:151], v1, s[16:19], s73 offen sc0 sc1
v_exp_f32 v17, v17
Mvaa 24,152,36
v_exp_f32 v18, v18
Mvaa 24,156,40
v_exp_f32 v19, v19
Mvaa 24,160,44
s_add_u32 s73, s41, 0x3020000
v_exp_f32 v20, v20
Cvaa 28,148,48,228
v_exp_f32 v21, v21
Mvaa 28,152,52
v_exp_f32 v22, v22
Mvaa 28,156,56
v_exp_f32 v23, v23
Mvaa 28,160,60
s_waitcnt lgkmcnt(8)
PK 80,16,17
PK 84,20,21
Cvaa 32,164,0,236
PK 81,18,19
PK 85,22,23
Mvaa 32,168,4
v_exp_f32 v24, v24
Mvaa 32,172,8
v_exp_f32 v25, v25
Mvaa 32,176,12
v_exp_f32 v28, v28
Cvaa 36,164,16,220
v_exp_f32 v29, v29
Mvaa 36,168,20
v_exp_f32 v26, v26
Mvaa 36,172,24
v_exp_f32 v30, v30
Mvaa 36,176,28
v_exp_f32 v27, v27
Cvaa 40,164,32,224
v_exp_f32 v31, v31
Mvaa 40,168,36
PK 88,24,25
PK 92,28,29
Mvaa 40,172,40
PK 89,26,27
PK 93,30,31
Mvaa 40,176,44
v_exp_f32 v32, v32
Cvaa 44,164,48,228
v_exp_f32 v36, v36
Mvaa 44,168,52
v_exp_f32 v33, v33
Mvaa 44,172,56
v_exp_f32 v37, v37
Mvaa 44,176,60
s_waitcnt vmcnt(2) lgkmcnt(0)
s_barrier
Cvaa 60,180,48,240
s_add_u32 m0, s38, 0
v_exp_f32 v34, v34
Mvaa 60,184,52
s_add_u32 s36, s60, 0
v_exp_f32 v38, v38
Mvaa 60,188,56
v_exp_f32 v35, v35
Mvaa 60,192,60
La 148,3,16384
La 152,6,16384
La 156,3,17408
La 160,6,17408
Cvaa 76,196,48,244
v_exp_f32 v39, v39
Mvaa 76,200,52
PK 82,32,33
PK 86,36,37
Mvaa 76,204,56
buffer_load_dwordx4 v248, s[4:7], s36 offen lds
PK 83,34,35
v_exp_f32 v40, v40
v_exp_f32 v41, v41
v_exp_f32 v42, v42
v_exp_f32 v43, v43
PK 90,40,41
PK 91,42,43
Mvaa 76,208,60
buffer_load_dwordx4 v249, s[4:7], s36 offen offset:1024 lds
PK 87,38,39
v_exp_f32 v44, v44
v_exp_f32 v45, v45
v_exp_f32 v46, v46
v_exp_f32 v47, v47
PK 94,44,45
PK 95,46,47
Zaav 136,144,88
buffer_load_dwordx4 v250, s[4:7], s36 offen offset:2048 lds
v_exp_f32 v60, v60
v_exp_f32 v76, v76
v_exp_f32 v61, v61
v_exp_f32 v77, v77
v_exp_f32 v62, v62
v_exp_f32 v78, v78
v_exp_f32 v63, v63
v_exp_f32 v79, v79
PK 108,60,61
PK 110,76,77
PK 109,62,63
PK 111,78,79
Zaav 140,144,92
La 164,3,57344
La 168,6,57344
La 172,3,58368
buffer_load_dwordx4 v251, s[4:7], s36 offen offset:3072 lds
La 176,6,58368
Maav 140,144,108
s_waitcnt lgkmcnt(4)
s_add_u32 m0, s38, 0x2000
s_add_u32 s36, s58, 0
buffer_load_dwordx4 v1, s[16:19], s36 offen sc1 lds
Zaav 64,148,88
buffer_load_dwordx4 v1, s[16:19], s36 offen offset:1024 sc1 lds
Zaav 68,148,92
buffer_load_dwordx4 v253, s[16:19], s36 offen offset:2048 sc1 lds
Maav 68,152,108
La 180,4,32768
La 184,7,32768
La 188,4,33792
buffer_load_dwordx4 v253, s[16:19], s36 offen offset:3072 sc1 lds
La 192,7,33792
Zaav 72,156,88
s_add_u32 m0, s38, 0x1000
s_add_u32 s36, s60, 0x9000
buffer_load_dwordx4 v248, s[4:7], s36 offen lds
Zaav 76,156,92
La 196,5,8192
La 200,8,8192
buffer_load_dwordx4 v249, s[4:7], s36 offen offset:1024 lds
La 204,5,9216
La 208,8,9216
Maav 76,160,108
s_waitcnt lgkmcnt(8)
buffer_load_dwordx4 v250, s[4:7], s36 offen offset:2048 lds
Zaav 80,164,88
buffer_load_dwordx4 v251, s[4:7], s36 offen offset:3072 lds
Zaav 84,164,92
s_add_u32 m0, s38, 0x3000
s_add_u32 s36, s61, 0
buffer_load_dwordx4 v252, s[4:7], s36 offen lds
Maav 84,168,108
s_waitcnt lgkmcnt(0)
s_barrier
s_add_u32 m0, s38, 0x3400
s_add_u32 s36, s61, 0x12000
buffer_load_dwordx4 v252, s[4:7], s36 offen lds
Zaav 88,172,88
ds_write_b32 v9, a136 offset:15360
Zaav 92,172,92
ds_write_b32 v9, a140 offset:15364
Maav 92,176,108
ds_write_b128 v9, a[64:67] offset:24576
Zaav 96,180,88
PK 160,160,161
PK 161,162,163
Zaav 100,180,92
ds_write_b128 v9, a[68:71] offset:25600
Maav 100,184,108
PK 162,168,169
PK 163,170,171
Zaav 104,188,88
buffer_store_dwordx4 v[160:163], v1, s[16:19], s73 offen sc0 sc1
s_add_u32 s73, s42, 0x3020000
PK 164,164,165
PK 165,166,167
Zaav 108,188,92
ds_write_b128 v9, a[72:75] offset:26624
Maav 108,192,108
PK 166,172,173
PK 167,174,175
Zaav 112,196,88
ds_write_b128 v9, a[76:79] offset:27648
Zaav 116,196,92
buffer_store_dwordx4 v[164:167], v1, s[16:19], s73 offen sc0 sc1
s_add_u32 s73, s41, 0x3040000
PK 176,176,177
PK 177,178,179
Maav 116,200,108
PK 178,184,185
PK 179,186,187
Zaav 120,204,88
ds_write_b128 v9, a[80:83] offset:28672
Zaav 124,204,92
buffer_store_dwordx4 v[176:179], v1, s[16:19], s73 offen sc0 sc1
s_add_u32 s73, s42, 0x3040000
PK 180,180,181
PK 181,182,183
Maav 124,208,108
ds_write_b128 v9, a[84:87] offset:29696
Zaav 128,144,80
PK 182,188,189
PK 183,190,191
Zaav 132,144,84
buffer_store_dwordx4 v[180:183], v1, s[16:19], s73 offen sc0 sc1
s_add_u32 s73, s41, 0x3060000
PK 192,192,193
PK 193,194,195
Zvav 144,148,80
ds_write_b128 v9, a[88:91] offset:30720
Zvav 148,148,84
PK 194,200,201
PK 195,202,203
Zvav 152,156,80
ds_write_b128 v9, a[92:95] offset:31744
Zvav 156,156,84
buffer_store_dwordx4 v[192:195], v1, s[16:19], s73 offen sc0 sc1
s_add_u32 s73, s42, 0x3060000
PK 196,196,197
PK 197,198,199
Zvav 160,164,80
v_accvgpr_read_b32 v232, a252
PK 198,204,205
Zvav 164,164,84
ds_write_b128 v9, a[96:99] offset:32768
Zvav 168,172,80
v_accvgpr_read_b32 v244, a253
PK 199,206,207
Zvav 172,172,84
ds_write_b128 v9, a[100:103] offset:33792
Zvav 176,180,80
v_accvgpr_read_b32 v240, a254
v_xor_b32 v233, 32, v232
Zvav 180,180,84
buffer_store_dwordx4 v[196:199], v1, s[16:19], s73 offen sc0 sc1
v_accvgpr_read_b32 v245, a255
v_add_u32 v234, 0xa000, v232
v_add_u32 v235, 0xa000, v233
Zvav 184,188,80
ds_write_b128 v9, a[104:107] offset:34816
Zvav 188,188,84
v_add_u32 v236, 0x14000, v232
v_add_u32 v237, 0x14000, v233
Zvav 192,196,80
ds_write_b128 v9, a[108:111] offset:35840
Zvav 196,196,84
v_add_u32 v238, 0x1e000, v232
v_add_u32 v239, 0x1e000, v233
Zvav 200,204,80
v_add_u32 v241, 0xa000, v240
v_add_u32 v242, 0x14000, v240
Zvav 204,204,84
ds_write_b128 v9, a[112:115] offset:36864
ds_write_b128 v9, a[116:119] offset:37888
ds_write_b128 v9, a[120:123] offset:38912
ds_write_b128 v9, a[124:127] offset:39936
s_waitcnt vmcnt(7) lgkmcnt(0)
s_barrier
ds_read_b64 v[112:113], v10 offset:15360
Lv 16,10,24576
Lv 20,10,25600
Lv 24,10,26624
Lv 28,10,27648
Lv 32,10,28672
Lv 36,10,29696
Lv 40,10,30720
Lv 44,10,31744
Lv 48,10,32768
Lv 52,10,33792
Lv 56,10,34816
Lv 60,10,35840
Lv 64,10,36864
Lv 68,10,37888
Lv 72,10,38912
Lv 76,10,39936
v_add_u32 v243, 0x1e000, v240
v_accvgpr_read_b32 v114, a128
v_accvgpr_read_b32 v115, a132
s_waitcnt lgkmcnt(15)
v_add_f32 v112, v112, v114
v_add_f32 v113, v113, v115
v_rcp_f32 v116, v112
v_rcp_f32 v118, v113
v_min_f32 v122, v112, v113
v_max_f32 v123, v112, v113
v_mul_f32 v116, v116, v13
v_mul_f32 v118, v118, v14
v_mov_b32 v117, v116
v_mov_b32 v119, v118
Ta 32,232,0
Ta 34,232,2048
Ta 36,232,4096
Ta 38,232,6144
La 0,244,8192
La 4,244,10240
v_cmp_gt_f32 vcc, 0x2b800000, v122
s_nop 0
s_or_b32 s49, s49, vcc_lo
s_or_b32 s49, s49, vcc_hi
v_cmp_lt_f32 vcc, 0x5f800000, v123
s_nop 0
s_or_b32 s49, s49, vcc_lo
s_or_b32 s49, s49, vcc_hi
s_waitcnt lgkmcnt(15)
s_add_u32 m0, s38, 0x4000
s_add_u32 s36, s58, 0x40000
buffer_load_dwordx4 v1, s[16:19], s36 offen sc1 lds
buffer_load_dwordx4 v1, s[16:19], s36 offen offset:1024 sc1 lds
v_pk_add_f32 v[144:145], v[144:145], v[16:17]
v_pk_add_f32 v[146:147], v[146:147], v[18:19]
v_pk_add_f32 v[148:149], v[148:149], v[20:21]
v_pk_add_f32 v[150:151], v[150:151], v[22:23]
v_pk_mul_f32 v[144:145], v[144:145], v[116:117]
v_pk_mul_f32 v[146:147], v[146:147], v[116:117]
v_pk_mul_f32 v[148:149], v[148:149], v[118:119]
v_pk_mul_f32 v[150:151], v[150:151], v[118:119]
v_pk_fma_f32 v[112:113], v[144:145], v[146:147], v[112:113]
v_pk_fma_f32 v[112:113], v[148:149], v[150:151], v[112:113]
s_waitcnt lgkmcnt(15)
buffer_load_dwordx4 v253, s[16:19], s36 offen offset:2048 sc1 lds
buffer_load_dwordx4 v253, s[16:19], s36 offen offset:3072 sc1 lds
v_pk_add_f32 v[152:153], v[152:153], v[24:25]
v_pk_add_f32 v[154:155], v[154:155], v[26:27]
v_pk_add_f32 v[156:157], v[156:157], v[28:29]
v_pk_add_f32 v[158:159], v[158:159], v[30:31]
v_pk_mul_f32 v[152:153], v[152:153], v[116:117]
v_pk_mul_f32 v[154:155], v[154:155], v[116:117]
v_pk_mul_f32 v[156:157], v[156:157], v[118:119]
v_pk_mul_f32 v[158:159], v[158:159], v[118:119]
v_pk_fma_f32 v[112:113], v[152:153], v[154:155], v[112:113]
v_pk_fma_f32 v[112:113], v[156:157], v[158:159], v[112:113]
s_waitcnt lgkmcnt(15)
s_add_u32 m0, s38, 0x5000
s_add_u32 s36, s60, 0x12000
buffer_load_dwordx4 v248, s[4:7], s36 offen lds
buffer_load_dwordx4 v249, s[4:7], s36 offen offset:1024 lds
v_pk_add_f32 v[160:161], v[160:161], v[32:33]
v_pk_add_f32 v[162:163], v[162:163], v[34:35]
v_pk_add_f32 v[164:165], v[164:165], v[36:37]
v_pk_add_f32 v[166:167], v[166:167], v[38:39]
v_pk_mul_f32 v[160:161], v[160:161], v[116:117]
v_pk_mul_f32 v[162:163], v[162:163], v[116:117]
v_pk_mul_f32 v[164:165], v[164:165], v[118:119]
v_pk_mul_f32 v[166:167], v[166:167], v[118:119]
v_pk_fma_f32 v[112:113], v[160:161], v[162:163], v[112:113]
v_pk_fma_f32 v[112:113], v[164:165], v[166:167], v[112:113]
s_waitcnt lgkmcnt(14)
Ta 40,233,0
Ta 42,233,2048
Ta 44,233,4096
Ta 46,233,6144
Ta 48,234,0
Ta 50,234,2048
Ta 52,234,4096
Ta 54,234,6144
La 8,244,9216
La 12,244,11264
buffer_load_dwordx4 v250, s[4:7], s36 offen offset:2048 lds
buffer_load_dwordx4 v251, s[4:7], s36 offen offset:3072 lds
v_pk_add_f32 v[168:169], v[168:169], v[40:41]
v_pk_add_f32 v[170:171], v[170:171], v[42:43]
v_pk_add_f32 v[172:173], v[172:173], v[44:45]
v_pk_add_f32 v[174:175], v[174:175], v[46:47]
v_pk_mul_f32 v[168:169], v[168:169], v[116:117]
v_pk_mul_f32 v[170:171], v[170:171], v[116:117]
v_pk_mul_f32 v[172:173], v[172:173], v[118:119]
v_pk_mul_f32 v[174:175], v[174:175], v[118:119]
v_pk_fma_f32 v[112:113], v[168:169], v[170:171], v[112:113]
v_pk_fma_f32 v[112:113], v[172:173], v[174:175], v[112:113]
s_waitcnt lgkmcnt(15)
s_add_u32 m0, s38, 0x8000
s_add_u32 s36, s60, 0x1b000
buffer_load_dwordx4 v248, s[4:7], s36 offen lds
buffer_load_dwordx4 v249, s[4:7], s36 offen offset:1024 lds
v_pk_add_f32 v[176:177], v[176:177], v[48:49]
v_pk_add_f32 v[178:179], v[178:179], v[50:51]
v_pk_add_f32 v[180:181], v[180:181], v[52:53]
v_pk_add_f32 v[182:183], v[182:183], v[54:55]
v_pk_mul_f32 v[176:177], v[176:177], v[116:117]
v_pk_mul_f32 v[178:179], v[178:179], v[116:117]
v_pk_mul_f32 v[180:181], v[180:181], v[118:119]
v_pk_mul_f32 v[182:183], v[182:183], v[118:119]
v_pk_fma_f32 v[112:113], v[176:177], v[178:179], v[112:113]
v_pk_fma_f32 v[112:113], v[180:181], v[182:183], v[112:113]
s_waitcnt lgkmcnt(15)
buffer_load_dwordx4 v250, s[4:7], s36 offen offset:2048 lds
buffer_load_dwordx4 v251, s[4:7], s36 offen offset:3072 lds
v_pk_add_f32 v[184:185], v[184:185], v[56:57]
v_pk_add_f32 v[186:187], v[186:187], v[58:59]
v_pk_add_f32 v[188:189], v[188:189], v[60:61]
v_pk_add_f32 v[190:191], v[190:191], v[62:63]
v_pk_mul_f32 v[184:185], v[184:185], v[116:117]
v_pk_mul_f32 v[186:187], v[186:187], v[116:117]
v_pk_mul_f32 v[188:189], v[188:189], v[118:119]
v_pk_mul_f32 v[190:191], v[190:191], v[118:119]
v_pk_fma_f32 v[112:113], v[184:185], v[186:187], v[112:113]
v_pk_fma_f32 v[112:113], v[188:189], v[190:191], v[112:113]
s_waitcnt lgkmcnt(15)
v_pk_add_f32 v[192:193], v[192:193], v[64:65]
v_pk_add_f32 v[194:195], v[194:195], v[66:67]
v_pk_add_f32 v[196:197], v[196:197], v[68:69]
v_pk_add_f32 v[198:199], v[198:199], v[70:71]
v_pk_mul_f32 v[192:193], v[192:193], v[116:117]
v_pk_mul_f32 v[194:195], v[194:195], v[116:117]
v_pk_mul_f32 v[196:197], v[196:197], v[118:119]
v_pk_mul_f32 v[198:199], v[198:199], v[118:119]
v_pk_fma_f32 v[112:113], v[192:193], v[194:195], v[112:113]
v_pk_fma_f32 v[112:113], v[196:197], v[198:199], v[112:113]
s_waitcnt lgkmcnt(15)
v_pk_add_f32 v[200:201], v[200:201], v[72:73]
v_pk_add_f32 v[202:203], v[202:203], v[74:75]
v_pk_add_f32 v[204:205], v[204:205], v[76:77]
v_pk_add_f32 v[206:207], v[206:207], v[78:79]
v_pk_mul_f32 v[200:201], v[200:201], v[116:117]
v_pk_mul_f32 v[202:203], v[202:203], v[116:117]
v_pk_mul_f32 v[204:205], v[204:205], v[118:119]
v_pk_mul_f32 v[206:207], v[206:207], v[118:119]
v_pk_fma_f32 v[112:113], v[200:201], v[202:203], v[112:113]
v_pk_fma_f32 v[112:113], v[204:205], v[206:207], v[112:113]
v_add_f32 v112, v112, v113
s_movk_i32 s37, 0x207
v_cmp_class_f32 vcc, v112, s37
s_nop 0
s_or_b32 s49, s49, vcc_lo
s_or_b32 s49, s49, vcc_hi
s_bitcmp1_b32 s2, 0
s_cbranch_scc0 M_C0
s_branch M_C1
.p2align 12
M_Z1:
s_waitcnt vmcnt(8) lgkmcnt(8)
s_add_u32 s73, s41, 0x3000000
La 196,6,1024
Cvaa 16,148,0,216
La 200,6,41984
PK 144,144,145
Mvaa 16,152,4
La 204,7,17408
PK 145,146,147
Mvaa 16,156,8
La 208,7,58368
PK 146,152,153
Mvaa 16,160,12
PK 147,154,155
Cvaa 20,148,16,220
buffer_store_dwordx4 v[144:147], v1, s[16:19], s73 offen sc0 sc1
Mvaa 20,152,20
s_add_u32 s73, s42, 0x3000000
PK 148,148,149
PK 149,150,151
Mvaa 20,156,24
PK 150,156,157
PK 151,158,159
Mvaa 20,160,28
v_exp_f32 v16, v16
Cvaa 28,148,48,240
buffer_store_dwordx4 v[148:151], v1, s[16:19], s73 offen sc0 sc1
v_exp_f32 v17, v17
Mvaa 28,152,52
v_exp_f32 v18, v18
Mvaa 28,156,56
v_exp_f32 v19, v19
Mvaa 28,160,60
s_waitcnt lgkmcnt(8)
s_add_u32 s73, s41, 0x3020000
PK 80,16,17
Cvaa 32,164,0,216
v_exp_f32 v20, v20
Mvaa 32,168,4
v_exp_f32 v21, v21
Mvaa 32,172,8
v_exp_f32 v22, v22
Mvaa 32,176,12
v_exp_f32 v23, v23
Cvaa 36,164,16,220
PK 84,20,21
PK 81,18,19
Mvaa 36,168,20
v_exp_f32 v28, v28
Mvaa 36,172,24
v_exp_f32 v29, v29
Mvaa 36,176,28
v_exp_f32 v30, v30
Cvaa 44,164,48,244
v_exp_f32 v31, v31
Mvaa 44,168,52
PK 85,22,23
PK 92,28,29
Mvaa 44,172,56
v_exp_f32 v32, v32
Mvaa 44,176,60
s_waitcnt vmcnt(2) lgkmcnt(0)
s_barrier
Cvaa 48,180,0,232
s_add_u32 m0, s38, 0
s_add_u32 s36, s60, 0
La 148,3,16384
Mvaa 48,184,4
buffer_load_dwordx4 v248, s[4:7], s36 offen lds
Mvaa 48,188,8
La 152,6,16384
PK 93,30,31
Mvaa 48,192,12
La 156,3,17408
PK 160,160,161
Cvaa 52,180,16,220
buffer_load_dwordx4 v249, s[4:7], s36 offen offset:1024 lds
Mvaa 52,184,20
La 160,6,17408
PK 161,162,163
Mvaa 52,188,24
La 164,3,57344
PK 162,168,169
Mvaa 52,192,28
buffer_load_dwordx4 v250, s[4:7], s36 offen offset:2048 lds
Cvaa 64,196,0,236
v_exp_f32 v33, v33
Mvaa 64,200,4
buffer_load_dwordx4 v251, s[4:7], s36 offen offset:3072 lds
Mvaa 64,204,8
s_add_u32 m0, s38, 0x2000
s_add_u32 s36, s58, 0
buffer_load_dwordx4 v1, s[16:19], s36 offen sc1 lds
Mvaa 64,208,12
buffer_load_dwordx4 v1, s[16:19], s36 offen offset:1024 sc1 lds
Cvaa 68,196,16,220
buffer_load_dwordx4 v253, s[16:19], s36 offen offset:2048 sc1 lds
Mvaa 68,200,20
La 168,6,57344
La 172,3,58368
La 176,6,58368
buffer_load_dwordx4 v253, s[16:19], s36 offen offset:3072 sc1 lds
Mvaa 68,204,24
s_add_u32 m0, s38, 0x1000
s_add_u32 s36, s60, 0x9000
buffer_load_dwordx4 v248, s[4:7], s36 offen lds
v_exp_f32 v34, v34
v_exp_f32 v35, v35
PK 82,32,33
PK 83,34,35
v_exp_f32 v44, v44
v_exp_f32 v45, v45
v_exp_f32 v46, v46
v_exp_f32 v47, v47
PK 94,44,45
PK 95,46,47
Mvaa 68,208,28
La 180,4,32768
La 184,7,32768
La 188,4,33792
La 192,7,33792
buffer_load_dwordx4 v249, s[4:7], s36 offen offset:1024 lds
Zaav 140,144,92
s_waitcnt lgkmcnt(8)
buffer_load_dwordx4 v250, s[4:7], s36 offen offset:2048 lds
Zaav 68,148,92
La 196,5,8192
La 200,8,8192
buffer_load_dwordx4 v251, s[4:7], s36 offen offset:3072 lds
La 204,5,9216
La 208,8,9216
Zaav 76,156,92
s_waitcnt lgkmcnt(8)
s_add_u32 m0, s38, 0x3000
s_add_u32 s36, s61, 0
buffer_load_dwordx4 v252, s[4:7], s36 offen lds
Zaav 84,164,92
s_add_u32 m0, s38, 0x3400
s_add_u32 s36, s61, 0x12000
buffer_load_dwordx4 v252, s[4:7], s36 offen lds
Zaav 92,172,92
s_waitcnt lgkmcnt(4)
v_exp_f32 v36, v36
Zaav 100,180,92
v_exp_f32 v37, v37
Zaav 108,188,92
s_waitcnt lgkmcnt(0)
v_exp_f32 v38, v38
Zaav 116,196,92
v_exp_f32 v39, v39
Zaav 124,204,92
PK 86,36,37
PK 87,38,39
v_exp_f32 v48, v48
v_exp_f32 v49, v49
v_exp_f32 v50, v50
v_exp_f32 v51, v51
PK 96,48,49
PK 97,50,51
v_exp_f32 v64, v64
v_exp_f32 v65, v65
v_exp_f32 v66, v66
v_exp_f32 v67, v67
PK 98,64,65
PK 99,66,67
Zaav 128,144,80
v_exp_f32 v52, v52
Maav 128,144,96
v_exp_f32 v53, v53
v_exp_f32 v54, v54
v_exp_f32 v55, v55
PK 100,52,53
PK 101,54,55
v_exp_f32 v68, v68
v_exp_f32 v69, v69
v_exp_f32 v70, v70
v_exp_f32 v71, v71
PK 102,68,69
PK 103,70,71
Zaav 132,144,84
s_waitcnt lgkmcnt(0)
s_barrier
Maav 132,144,100
ds_write_b32 v9, a136 offset:15360
Zvav 144,148,80
ds_write_b32 v9, a140 offset:15364
Mvav 144,152,96
ds_write_b128 v9, a[64:67] offset:24576
Zvav 148,148,84
PK 163,170,171
v_accvgpr_read_b32 v232, a252
Mvav 148,152,100
ds_write_b128 v9, a[68:71] offset:25600
Zvav 152,156,80
buffer_store_dwordx4 v[160:163], v1, s[16:19], s73 offen sc0 sc1
s_add_u32 s73, s42, 0x3020000
PK 164,164,165
PK 165,166,167
Mvav 152,160,96
PK 166,172,173
PK 167,174,175
Zvav 156,156,84
ds_write_b128 v9, a[72:75] offset:26624
buffer_store_dwordx4 v[164:167], v1, s[16:19], s73 offen sc0 sc1
s_add_u32 s73, s41, 0x3040000
PK 176,176,177
PK 177,178,179
Mvav 156,160,100
PK 178,184,185
PK 179,186,187
Zvav 160,164,80
ds_write_b128 v9, a[76:79] offset:27648
Mvav 160,168,96
buffer_store_dwordx4 v[176:179], v1, s[16:19], s73 offen sc0 sc1
s_add_u32 s73, s42, 0x3040000
PK 180,180,181
PK 181,182,183
Zvav 164,164,84
PK 182,188,189
PK 183,190,191
Mvav 164,168,100
ds_write_b128 v9, a[80:83] offset:28672
Zvav 168,172,80
buffer_store_dwordx4 v[180:183], v1, s[16:19], s73 offen sc0 sc1
s_add_u32 s73, s41, 0x3060000
PK 192,192,193
PK 193,194,195
Mvav 168,176,96
ds_write_b128 v9, a[84:87] offset:29696
Zvav 172,172,84
PK 194,200,201
PK 195,202,203
Mvav 172,176,100
buffer_store_dwordx4 v[192:195], v1, s[16:19], s73 offen sc0 sc1
s_add_u32 s73, s42, 0x3060000
PK 196,196,197
PK 197,198,199
Zvav 176,180,80
ds_write_b128 v9, a[88:91] offset:30720
Mvav 176,184,96
PK 198,204,205
PK 199,206,207
Zvav 180,180,84
ds_write_b128 v9, a[92:95] offset:31744
Mvav 180,184,100
buffer_store_dwordx4 v[196:199], v1, s[16:19], s73 offen sc0 sc1
v_accvgpr_read_b32 v244, a253
v_accvgpr_read_b32 v240, a254
v_xor_b32 v233, 32, v232
Zvav 184,188,80
v_accvgpr_read_b32 v245, a255
v_add_u32 v234, 0xa000, v232
Mvav 184,192,96
ds_write_b128 v9, a[96:99] offset:32768
Zvav 188,188,84
v_add_u32 v235, 0xa000, v233
v_add_u32 v236, 0x14000, v232
Mvav 188,192,100
ds_write_b128 v9, a[100:103] offset:33792
Zvav 192,196,80
v_add_u32 v237, 0x14000, v233
v_add_u32 v238, 0x1e000, v232
Mvav 192,200,96
v_add_u32 v239, 0x1e000, v233
v_add_u32 v241, 0xa000, v240
Zvav 196,196,84
ds_write_b128 v9, a[104:107] offset:34816
Mvav 196,200,100
v_add_u32 v242, 0x14000, v240
v_add_u32 v243, 0x1e000, v240
Zvav 200,204,80
ds_write_b128 v9, a[108:111] offset:35840
Mvav 200,208,96
v_accvgpr_read_b32 v114, a128
v_accvgpr_read_b32 v115, a132
Zvav 204,204,84
Mvav 204,208,100
ds_write_b128 v9, a[112:115] offset:36864
ds_write_b128 v9, a[116:119] offset:37888
ds_write_b128 v9, a[120:123] offset:38912
ds_write_b128 v9, a[124:127] offset:39936
s_waitcnt vmcnt(7) lgkmcnt(0)
s_barrier
ds_read_b64 v[112:113], v10 offset:15360
Lv 16,10,24576
Lv 20,10,25600
Lv 24,10,26624
Lv 28,10,27648
Lv 32,10,28672
Lv 36,10,29696
Lv 40,10,30720
Lv 44,10,31744
Lv 48,10,32768
Lv 52,10,33792
Lv 56,10,34816
Lv 60,10,35840
Lv 64,10,36864
Lv 68,10,37888
Lv 72,10,38912
Lv 76,10,39936
s_waitcnt lgkmcnt(15)
v_add_f32 v112, v112, v114
v_add_f32 v113, v113, v115
v_rcp_f32 v116, v112
v_rcp_f32 v118, v113
v_min_f32 v122, v112, v113
v_max_f32 v123, v112, v113
v_mul_f32 v116, v116, v13
v_mul_f32 v118, v118, v14
v_mov_b32 v117, v116
v_mov_b32 v119, v118
Ta 32,232,0
Ta 34,232,2048
Ta 36,232,4096
Ta 38,232,6144
La 0,244,8192
La 4,244,10240
v_cmp_gt_f32 vcc, 0x2b800000, v122
s_nop 0
s_or_b32 s49, s49, vcc_lo
s_or_b32 s49, s49, vcc_hi
v_cmp_lt_f32 vcc, 0x5f800000, v123
s_nop 0
s_or_b32 s49, s49, vcc_lo
s_or_b32 s49, s49, vcc_hi
s_waitcnt lgkmcnt(15)
s_add_u32 m0, s38, 0x4000
s_add_u32 s36, s58, 0x40000
buffer_load_dwordx4 v1, s[16:19], s36 offen sc1 lds
buffer_load_dwordx4 v1, s[16:19], s36 offen offset:1024 sc1 lds
v_pk_add_f32 v[144:145], v[144:145], v[16:17]
v_pk_add_f32 v[146:147], v[146:147], v[18:19]
v_pk_add_f32 v[148:149], v[148:149], v[20:21]
v_pk_add_f32 v[150:151], v[150:151], v[22:23]
v_pk_mul_f32 v[144:145], v[144:145], v[116:117]
v_pk_mul_f32 v[146:147], v[146:147], v[116:117]
v_pk_mul_f32 v[148:149], v[148:149], v[118:119]
v_pk_mul_f32 v[150:151], v[150:151], v[118:119]
v_pk_fma_f32 v[112:113], v[144:145], v[146:147], v[112:113]
v_pk_fma_f32 v[112:113], v[148:149], v[150:151], v[112:113]
s_waitcnt lgkmcnt(15)
buffer_load_dwordx4 v253, s[16:19], s36 offen offset:2048 sc1 lds
buffer_load_dwordx4 v253, s[16:19], s36 offen offset:3072 sc1 lds
v_pk_add_f32 v[152:153], v[152:153], v[24:25]
v_pk_add_f32 v[154:155], v[154:155], v[26:27]
v_pk_add_f32 v[156:157], v[156:157], v[28:29]
v_pk_add_f32 v[158:159], v[158:159], v[30:31]
v_pk_mul_f32 v[152:153], v[152:153], v[116:117]
v_pk_mul_f32 v[154:155], v[154:155], v[116:117]
v_pk_mul_f32 v[156:157], v[156:157], v[118:119]
v_pk_mul_f32 v[158:159], v[158:159], v[118:119]
v_pk_fma_f32 v[112:113], v[152:153], v[154:155], v[112:113]
v_pk_fma_f32 v[112:113], v[156:157], v[158:159], v[112:113]
s_waitcnt lgkmcnt(15)
s_add_u32 m0, s38, 0x5000
s_add_u32 s36, s60, 0x12000
buffer_load_dwordx4 v248, s[4:7], s36 offen lds
buffer_load_dwordx4 v249, s[4:7], s36 offen offset:1024 lds
v_pk_add_f32 v[160:161], v[160:161], v[32:33]
v_pk_add_f32 v[162:163], v[162:163], v[34:35]
v_pk_add_f32 v[164:165], v[164:165], v[36:37]
v_pk_add_f32 v[166:167], v[166:167], v[38:39]
v_pk_mul_f32 v[160:161], v[160:161], v[116:117]
v_pk_mul_f32 v[162:163], v[162:163], v[116:117]
v_pk_mul_f32 v[164:165], v[164:165], v[118:119]
v_pk_mul_f32 v[166:167], v[166:167], v[118:119]
v_pk_fma_f32 v[112:113], v[160:161], v[162:163], v[112:113]
v_pk_fma_f32 v[112:113], v[164:165], v[166:167], v[112:113]
s_waitcnt lgkmcnt(14)
Ta 40,233,0
Ta 42,233,2048
Ta 44,233,4096
Ta 46,233,6144
Ta 48,234,0
Ta 50,234,2048
Ta 52,234,4096
Ta 54,234,6144
La 8,244,9216
La 12,244,11264
buffer_load_dwordx4 v250, s[4:7], s36 offen offset:2048 lds
buffer_load_dwordx4 v251, s[4:7], s36 offen offset:3072 lds
v_pk_add_f32 v[168:169], v[168:169], v[40:41]
v_pk_add_f32 v[170:171], v[170:171], v[42:43]
v_pk_add_f32 v[172:173], v[172:173], v[44:45]
v_pk_add_f32 v[174:175], v[174:175], v[46:47]
v_pk_mul_f32 v[168:169], v[168:169], v[116:117]
v_pk_mul_f32 v[170:171], v[170:171], v[116:117]
v_pk_mul_f32 v[172:173], v[172:173], v[118:119]
v_pk_mul_f32 v[174:175], v[174:175], v[118:119]
v_pk_fma_f32 v[112:113], v[168:169], v[170:171], v[112:113]
v_pk_fma_f32 v[112:113], v[172:173], v[174:175], v[112:113]
s_waitcnt lgkmcnt(15)
s_add_u32 m0, s38, 0x8000
s_add_u32 s36, s60, 0x1b000
buffer_load_dwordx4 v248, s[4:7], s36 offen lds
buffer_load_dwordx4 v249, s[4:7], s36 offen offset:1024 lds
v_pk_add_f32 v[176:177], v[176:177], v[48:49]
v_pk_add_f32 v[178:179], v[178:179], v[50:51]
v_pk_add_f32 v[180:181], v[180:181], v[52:53]
v_pk_add_f32 v[182:183], v[182:183], v[54:55]
v_pk_mul_f32 v[176:177], v[176:177], v[116:117]
v_pk_mul_f32 v[178:179], v[178:179], v[116:117]
v_pk_mul_f32 v[180:181], v[180:181], v[118:119]
v_pk_mul_f32 v[182:183], v[182:183], v[118:119]
v_pk_fma_f32 v[112:113], v[176:177], v[178:179], v[112:113]
v_pk_fma_f32 v[112:113], v[180:181], v[182:183], v[112:113]
s_waitcnt lgkmcnt(15)
buffer_load_dwordx4 v250, s[4:7], s36 offen offset:2048 lds
buffer_load_dwordx4 v251, s[4:7], s36 offen offset:3072 lds
v_pk_add_f32 v[184:185], v[184:185], v[56:57]
v_pk_add_f32 v[186:187], v[186:187], v[58:59]
v_pk_add_f32 v[188:189], v[188:189], v[60:61]
v_pk_add_f32 v[190:191], v[190:191], v[62:63]
v_pk_mul_f32 v[184:185], v[184:185], v[116:117]
v_pk_mul_f32 v[186:187], v[186:187], v[116:117]
v_pk_mul_f32 v[188:189], v[188:189], v[118:119]
v_pk_mul_f32 v[190:191], v[190:191], v[118:119]
v_pk_fma_f32 v[112:113], v[184:185], v[186:187], v[112:113]
v_pk_fma_f32 v[112:113], v[188:189], v[190:191], v[112:113]
s_waitcnt lgkmcnt(15)
v_pk_add_f32 v[192:193], v[192:193], v[64:65]
v_pk_add_f32 v[194:195], v[194:195], v[66:67]
v_pk_add_f32 v[196:197], v[196:197], v[68:69]
v_pk_add_f32 v[198:199], v[198:199], v[70:71]
v_pk_mul_f32 v[192:193], v[192:193], v[116:117]
v_pk_mul_f32 v[194:195], v[194:195], v[116:117]
v_pk_mul_f32 v[196:197], v[196:197], v[118:119]
v_pk_mul_f32 v[198:199], v[198:199], v[118:119]
v_pk_fma_f32 v[112:113], v[192:193], v[194:195], v[112:113]
v_pk_fma_f32 v[112:113], v[196:197], v[198:199], v[112:113]
s_waitcnt lgkmcnt(15)
v_pk_add_f32 v[200:201], v[200:201], v[72:73]
v_pk_add_f32 v[202:203], v[202:203], v[74:75]
v_pk_add_f32 v[204:205], v[204:205], v[76:77]
v_pk_add_f32 v[206:207], v[206:207], v[78:79]
v_pk_mul_f32 v[200:201], v[200:201], v[116:117]
v_pk_mul_f32 v[202:203], v[202:203], v[116:117]
v_pk_mul_f32 v[204:205], v[204:205], v[118:119]
v_pk_mul_f32 v[206:207], v[206:207], v[118:119]
v_pk_fma_f32 v[112:113], v[200:201], v[202:203], v[112:113]
v_pk_fma_f32 v[112:113], v[204:205], v[206:207], v[112:113]
v_add_f32 v112, v112, v113
s_movk_i32 s37, 0x207
v_cmp_class_f32 vcc, v112, s37
s_nop 0
s_or_b32 s49, s49, vcc_lo
s_or_b32 s49, s49, vcc_hi
s_bitcmp1_b32 s2, 0
s_cbranch_scc0 M_C0
s_branch M_C1
M_max0:
s_waitcnt vmcnt(0) lgkmcnt(0)
v_mov_b32 v106, 0xff800000
v_and_b32 v104, 15, v15
v_lshrrev_b32 v105, 4, v15
v_lshlrev_b32 v105, 2, v105
v_sub_u32 v104, v104, v105
s_and_b32 s37, s41, 0x1ffff
s_lshr_b32 s37, s37, 6
v_add_u32 v100, s37, v104
v_mov_b32 v96, v106
s_and_b32 s37, s42, 0x1ffff
s_lshr_b32 s37, s37, 6
v_add_u32 v101, s37, v104
v_mov_b32 v97, v106
s_and_b32 s37, s43, 0x1ffff
s_lshr_b32 s37, s37, 6
v_add_u32 v102, s37, v104
v_mov_b32 v98, v106
s_and_b32 s37, s44, 0x1ffff
s_lshr_b32 s37, s37, 6
v_add_u32 v103, s37, v104
v_mov_b32 v99, v106
s_mov_b32 s74, 0
s_or_b32 s75, s37, 0x7f
s_mul_i32 s76, s25, 0x80000
s_add_u32 s76, s76, 0x1000000
M_maxl0:
s_add_u32 s55, s76, 0
buffer_load_dwordx4 v[80:83], v1, s[16:19], s55 offen sc1
s_add_u32 s55, s76, 0x20000
buffer_load_dwordx4 v[84:87], v1, s[16:19], s55 offen sc1
s_add_u32 s55, s76, 0x40000
buffer_load_dwordx4 v[88:91], v1, s[16:19], s55 offen sc1
s_add_u32 s55, s76, 0x60000
buffer_load_dwordx4 v[92:95], v1, s[16:19], s55 offen sc1
s_waitcnt vmcnt(0)
Zvva 16,80,0
Mvva 16,84,4
Mvva 16,88,8
Mvva 16,92,12
Zvva 20,80,16
Mvva 20,84,20
Mvva 20,88,24
Mvva 20,92,28
Zvva 24,80,32
Mvva 24,84,36
Mvva 24,88,40
Mvva 24,92,44
Zvva 28,80,48
Mvva 28,84,52
Mvva 28,88,56
Mvva 28,92,60
s_add_u32 s37, s74, 0
v_cmp_le_i32 vcc, s37, v100
s_nop 1
v_cndmask_b32 v104, v106, v16, vcc
v_max_f32 v96, v96, v104
s_add_u32 s37, s74, 1
v_cmp_le_i32 vcc, s37, v100
s_nop 1
v_cndmask_b32 v104, v106, v17, vcc
v_max_f32 v96, v96, v104
s_add_u32 s37, s74, 2
v_cmp_le_i32 vcc, s37, v100
s_nop 1
v_cndmask_b32 v104, v106, v18, vcc
v_max_f32 v96, v96, v104
s_add_u32 s37, s74, 3
v_cmp_le_i32 vcc, s37, v100
s_nop 1
v_cndmask_b32 v104, v106, v19, vcc
v_max_f32 v96, v96, v104
s_add_u32 s37, s74, 0
v_cmp_le_i32 vcc, s37, v101
s_nop 1
v_cndmask_b32 v104, v106, v20, vcc
v_max_f32 v97, v97, v104
s_add_u32 s37, s74, 1
v_cmp_le_i32 vcc, s37, v101
s_nop 1
v_cndmask_b32 v104, v106, v21, vcc
v_max_f32 v97, v97, v104
s_add_u32 s37, s74, 2
v_cmp_le_i32 vcc, s37, v101
s_nop 1
v_cndmask_b32 v104, v106, v22, vcc
v_max_f32 v97, v97, v104
s_add_u32 s37, s74, 3
v_cmp_le_i32 vcc, s37, v101
s_nop 1
v_cndmask_b32 v104, v106, v23, vcc
v_max_f32 v97, v97, v104
s_add_u32 s37, s74, 0
v_cmp_le_i32 vcc, s37, v102
s_nop 1
v_cndmask_b32 v104, v106, v24, vcc
v_max_f32 v98, v98, v104
s_add_u32 s37, s74, 1
v_cmp_le_i32 vcc, s37, v102
s_nop 1
v_cndmask_b32 v104, v106, v25, vcc
v_max_f32 v98, v98, v104
s_add_u32 s37, s74, 2
v_cmp_le_i32 vcc, s37, v102
s_nop 1
v_cndmask_b32 v104, v106, v26, vcc
v_max_f32 v98, v98, v104
s_add_u32 s37, s74, 3
v_cmp_le_i32 vcc, s37, v102
s_nop 1
v_cndmask_b32 v104, v106, v27, vcc
v_max_f32 v98, v98, v104
s_add_u32 s37, s74, 0
v_cmp_le_i32 vcc, s37, v103
s_nop 1
v_cndmask_b32 v104, v106, v28, vcc
v_max_f32 v99, v99, v104
s_add_u32 s37, s74, 1
v_cmp_le_i32 vcc, s37, v103
s_nop 1
v_cndmask_b32 v104, v106, v29, vcc
v_max_f32 v99, v99, v104
s_add_u32 s37, s74, 2
v_cmp_le_i32 vcc, s37, v103
s_nop 1
v_cndmask_b32 v104, v106, v30, vcc
v_max_f32 v99, v99, v104
s_add_u32 s37, s74, 3
v_cmp_le_i32 vcc, s37, v103
s_nop 1
v_cndmask_b32 v104, v106, v31, vcc
v_max_f32 v99, v99, v104
s_add_u32 s76, s76, 0x400
s_add_u32 s74, s74, 16
s_cmp_lt_u32 s74, s75
s_cbranch_scc1 M_maxl0
v_mov_b32 v104, v96
s_nop 1
v_permlane32_swap_b32 v96, v104
v_max_f32 v96, v96, v104
v_mov_b32 v104, v96
s_nop 1
v_permlane16_swap_b32 v96, v104
v_max_f32 v96, v96, v104
v_sub_f32 v216, 0, v96
v_sub_f32 v217, 0, v96
v_sub_f32 v218, 0, v96
v_sub_f32 v219, 0, v96
v_mov_b32 v104, v97
s_nop 1
v_permlane32_swap_b32 v97, v104
v_max_f32 v97, v97, v104
v_mov_b32 v104, v97
s_nop 1
v_permlane16_swap_b32 v97, v104
v_max_f32 v97, v97, v104
v_sub_f32 v220, 0, v97
v_sub_f32 v221, 0, v97
v_sub_f32 v222, 0, v97
v_sub_f32 v223, 0, v97
v_mov_b32 v104, v98
s_nop 1
v_permlane32_swap_b32 v98, v104
v_max_f32 v98, v98, v104
v_mov_b32 v104, v98
s_nop 1
v_permlane16_swap_b32 v98, v104
v_max_f32 v98, v98, v104
v_sub_f32 v224, 0, v98
v_sub_f32 v225, 0, v98
v_sub_f32 v226, 0, v98
v_sub_f32 v227, 0, v98
v_mov_b32 v104, v99
s_nop 1
v_permlane32_swap_b32 v99, v104
v_max_f32 v99, v99, v104
v_mov_b32 v104, v99
s_nop 1
v_permlane16_swap_b32 v99, v104
v_max_f32 v99, v99, v104
v_sub_f32 v228, 0, v99
v_sub_f32 v229, 0, v99
v_sub_f32 v230, 0, v99
v_sub_f32 v231, 0, v99
v_and_b32 v16, 15, v15
v_lshrrev_b32 v17, 4, v15
v_lshlrev_b32 v17, 2, v17
v_sub_u32 v16, v16, v17
v_mov_b32 v19, 0xff800000
s_xor_b32 s37, s39, 0
s_lshl_b32 s37, s37, 4
v_add_u32 v17, s37, v16
v_cmp_le_i32 s[86:87], 0, v17
s_nop 1
v_cndmask_b32 v232, v19, v216, s[86:87]
v_cmp_le_i32 s[86:87], 1, v17
s_nop 1
v_cndmask_b32 v233, v19, v217, s[86:87]
v_cmp_le_i32 s[86:87], 2, v17
s_nop 1
v_cndmask_b32 v234, v19, v218, s[86:87]
v_cmp_le_i32 s[86:87], 3, v17
s_nop 1
v_cndmask_b32 v235, v19, v219, s[86:87]
v_cmp_le_i32 s[86:87], 16, v17
s_nop 1
v_cndmask_b32 v236, v19, v216, s[86:87]
v_cmp_le_i32 s[86:87], 17, v17
s_nop 1
v_cndmask_b32 v237, v19, v217, s[86:87]
v_cmp_le_i32 s[86:87], 18, v17
s_nop 1
v_cndmask_b32 v238, v19, v218, s[86:87]
v_cmp_le_i32 s[86:87], 19, v17
s_nop 1
v_cndmask_b32 v239, v19, v219, s[86:87]
s_xor_b32 s37, s39, 1
s_lshl_b32 s37, s37, 4
v_add_u32 v17, s37, v16
v_cmp_le_i32 s[86:87], 0, v17
s_nop 1
v_cndmask_b32 v240, v19, v228, s[86:87]
v_cmp_le_i32 s[86:87], 1, v17
s_nop 1
v_cndmask_b32 v241, v19, v229, s[86:87]
v_cmp_le_i32 s[86:87], 2, v17
s_nop 1
v_cndmask_b32 v242, v19, v230, s[86:87]
v_cmp_le_i32 s[86:87], 3, v17
s_nop 1
v_cndmask_b32 v243, v19, v231, s[86:87]
v_cmp_le_i32 s[86:87], 16, v17
s_nop 1
v_cndmask_b32 v244, v19, v228, s[86:87]
v_cmp_le_i32 s[86:87], 17, v17
s_nop 1
v_cndmask_b32 v245, v19, v229, s[86:87]
v_cmp_le_i32 s[86:87], 18, v17
s_nop 1
v_cndmask_b32 v246, v19, v230, s[86:87]
v_cmp_le_i32 s[86:87], 19, v17
s_nop 1
v_cndmask_b32 v247, v19, v231, s[86:87]
s_branch M_go0
M_max1:
s_waitcnt vmcnt(0) lgkmcnt(0)
v_mov_b32 v106, 0xff800000
v_and_b32 v104, 15, v15
v_lshrrev_b32 v105, 4, v15
v_lshlrev_b32 v105, 2, v105
v_sub_u32 v104, v104, v105
s_and_b32 s37, s45, 0x1ffff
s_lshr_b32 s37, s37, 6
v_add_u32 v100, s37, v104
v_mov_b32 v96, v106
s_and_b32 s37, s46, 0x1ffff
s_lshr_b32 s37, s37, 6
v_add_u32 v101, s37, v104
v_mov_b32 v97, v106
s_and_b32 s37, s47, 0x1ffff
s_lshr_b32 s37, s37, 6
v_add_u32 v102, s37, v104
v_mov_b32 v98, v106
s_and_b32 s37, s48, 0x1ffff
s_lshr_b32 s37, s37, 6
v_add_u32 v103, s37, v104
v_mov_b32 v99, v106
s_mov_b32 s74, 0
s_or_b32 s75, s37, 0x7f
s_mul_i32 s76, s25, 0x80000
s_add_u32 s76, s76, 0x1000000
M_maxl1:
s_add_u32 s55, s76, 0
buffer_load_dwordx4 v[80:83], v1, s[16:19], s55 offen sc1
s_add_u32 s55, s76, 0x20000
buffer_load_dwordx4 v[84:87], v1, s[16:19], s55 offen sc1
s_add_u32 s55, s76, 0x40000
buffer_load_dwordx4 v[88:91], v1, s[16:19], s55 offen sc1
s_add_u32 s55, s76, 0x60000
buffer_load_dwordx4 v[92:95], v1, s[16:19], s55 offen sc1
s_waitcnt vmcnt(0)
Zvva 16,80,0
Mvva 16,84,4
Mvva 16,88,8
Mvva 16,92,12
Zvva 20,80,16
Mvva 20,84,20
Mvva 20,88,24
Mvva 20,92,28
Zvva 24,80,32
Mvva 24,84,36
Mvva 24,88,40
Mvva 24,92,44
Zvva 28,80,48
Mvva 28,84,52
Mvva 28,88,56
Mvva 28,92,60
s_add_u32 s37, s74, 0
v_cmp_le_i32 vcc, s37, v100
s_nop 1
v_cndmask_b32 v104, v106, v16, vcc
v_max_f32 v96, v96, v104
s_add_u32 s37, s74, 1
v_cmp_le_i32 vcc, s37, v100
s_nop 1
v_cndmask_b32 v104, v106, v17, vcc
v_max_f32 v96, v96, v104
s_add_u32 s37, s74, 2
v_cmp_le_i32 vcc, s37, v100
s_nop 1
v_cndmask_b32 v104, v106, v18, vcc
v_max_f32 v96, v96, v104
s_add_u32 s37, s74, 3
v_cmp_le_i32 vcc, s37, v100
s_nop 1
v_cndmask_b32 v104, v106, v19, vcc
v_max_f32 v96, v96, v104
s_add_u32 s37, s74, 0
v_cmp_le_i32 vcc, s37, v101
s_nop 1
v_cndmask_b32 v104, v106, v20, vcc
v_max_f32 v97, v97, v104
s_add_u32 s37, s74, 1
v_cmp_le_i32 vcc, s37, v101
s_nop 1
v_cndmask_b32 v104, v106, v21, vcc
v_max_f32 v97, v97, v104
s_add_u32 s37, s74, 2
v_cmp_le_i32 vcc, s37, v101
s_nop 1
v_cndmask_b32 v104, v106, v22, vcc
v_max_f32 v97, v97, v104
s_add_u32 s37, s74, 3
v_cmp_le_i32 vcc, s37, v101
s_nop 1
v_cndmask_b32 v104, v106, v23, vcc
v_max_f32 v97, v97, v104
s_add_u32 s37, s74, 0
v_cmp_le_i32 vcc, s37, v102
s_nop 1
v_cndmask_b32 v104, v106, v24, vcc
v_max_f32 v98, v98, v104
s_add_u32 s37, s74, 1
v_cmp_le_i32 vcc, s37, v102
s_nop 1
v_cndmask_b32 v104, v106, v25, vcc
v_max_f32 v98, v98, v104
s_add_u32 s37, s74, 2
v_cmp_le_i32 vcc, s37, v102
s_nop 1
v_cndmask_b32 v104, v106, v26, vcc
v_max_f32 v98, v98, v104
s_add_u32 s37, s74, 3
v_cmp_le_i32 vcc, s37, v102
s_nop 1
v_cndmask_b32 v104, v106, v27, vcc
v_max_f32 v98, v98, v104
s_add_u32 s37, s74, 0
v_cmp_le_i32 vcc, s37, v103
s_nop 1
v_cndmask_b32 v104, v106, v28, vcc
v_max_f32 v99, v99, v104
s_add_u32 s37, s74, 1
v_cmp_le_i32 vcc, s37, v103
s_nop 1
v_cndmask_b32 v104, v106, v29, vcc
v_max_f32 v99, v99, v104
s_add_u32 s37, s74, 2
v_cmp_le_i32 vcc, s37, v103
s_nop 1
v_cndmask_b32 v104, v106, v30, vcc
v_max_f32 v99, v99, v104
s_add_u32 s37, s74, 3
v_cmp_le_i32 vcc, s37, v103
s_nop 1
v_cndmask_b32 v104, v106, v31, vcc
v_max_f32 v99, v99, v104
s_add_u32 s76, s76, 0x400
s_add_u32 s74, s74, 16
s_cmp_lt_u32 s74, s75
s_cbranch_scc1 M_maxl1
v_mov_b32 v104, v96
s_nop 1
v_permlane32_swap_b32 v96, v104
v_max_f32 v96, v96, v104
v_mov_b32 v104, v96
s_nop 1
v_permlane16_swap_b32 v96, v104
v_max_f32 v96, v96, v104
v_sub_f32 v216, 0, v96
v_sub_f32 v217, 0, v96
v_sub_f32 v218, 0, v96
v_sub_f32 v219, 0, v96
v_mov_b32 v104, v97
s_nop 1
v_permlane32_swap_b32 v97, v104
v_max_f32 v97, v97, v104
v_mov_b32 v104, v97
s_nop 1
v_permlane16_swap_b32 v97, v104
v_max_f32 v97, v97, v104
v_sub_f32 v220, 0, v97
v_sub_f32 v221, 0, v97
v_sub_f32 v222, 0, v97
v_sub_f32 v223, 0, v97
v_mov_b32 v104, v98
s_nop 1
v_permlane32_swap_b32 v98, v104
v_max_f32 v98, v98, v104
v_mov_b32 v104, v98
s_nop 1
v_permlane16_swap_b32 v98, v104
v_max_f32 v98, v98, v104
v_sub_f32 v224, 0, v98
v_sub_f32 v225, 0, v98
v_sub_f32 v226, 0, v98
v_sub_f32 v227, 0, v98
v_mov_b32 v104, v99
s_nop 1
v_permlane32_swap_b32 v99, v104
v_max_f32 v99, v99, v104
v_mov_b32 v104, v99
s_nop 1
v_permlane16_swap_b32 v99, v104
v_max_f32 v99, v99, v104
v_sub_f32 v228, 0, v99
v_sub_f32 v229, 0, v99
v_sub_f32 v230, 0, v99
v_sub_f32 v231, 0, v99
v_and_b32 v16, 15, v15
v_lshrrev_b32 v17, 4, v15
v_lshlrev_b32 v17, 2, v17
v_sub_u32 v16, v16, v17
v_mov_b32 v19, 0xff800000
s_xor_b32 s37, s39, 0
s_lshl_b32 s37, s37, 4
v_add_u32 v17, s37, v16
v_cmp_le_i32 s[86:87], 0, v17
s_nop 1
v_cndmask_b32 v232, v19, v216, s[86:87]
v_cmp_le_i32 s[86:87], 1, v17
s_nop 1
v_cndmask_b32 v233, v19, v217, s[86:87]
v_cmp_le_i32 s[86:87], 2, v17
s_nop 1
v_cndmask_b32 v234, v19, v218, s[86:87]
v_cmp_le_i32 s[86:87], 3, v17
s_nop 1
v_cndmask_b32 v235, v19, v219, s[86:87]
v_cmp_le_i32 s[86:87], 16, v17
s_nop 1
v_cndmask_b32 v236, v19, v216, s[86:87]
v_cmp_le_i32 s[86:87], 17, v17
s_nop 1
v_cndmask_b32 v237, v19, v217, s[86:87]
v_cmp_le_i32 s[86:87], 18, v17
s_nop 1
v_cndmask_b32 v238, v19, v218, s[86:87]
v_cmp_le_i32 s[86:87], 19, v17
s_nop 1
v_cndmask_b32 v239, v19, v219, s[86:87]
s_xor_b32 s37, s39, 1
s_lshl_b32 s37, s37, 4
v_add_u32 v17, s37, v16
v_cmp_le_i32 s[86:87], 0, v17
s_nop 1
v_cndmask_b32 v240, v19, v228, s[86:87]
v_cmp_le_i32 s[86:87], 1, v17
s_nop 1
v_cndmask_b32 v241, v19, v229, s[86:87]
v_cmp_le_i32 s[86:87], 2, v17
s_nop 1
v_cndmask_b32 v242, v19, v230, s[86:87]
v_cmp_le_i32 s[86:87], 3, v17
s_nop 1
v_cndmask_b32 v243, v19, v231, s[86:87]
v_cmp_le_i32 s[86:87], 16, v17
s_nop 1
v_cndmask_b32 v244, v19, v228, s[86:87]
v_cmp_le_i32 s[86:87], 17, v17
s_nop 1
v_cndmask_b32 v245, v19, v229, s[86:87]
v_cmp_le_i32 s[86:87], 18, v17
s_nop 1
v_cndmask_b32 v246, v19, v230, s[86:87]
v_cmp_le_i32 s[86:87], 19, v17
s_nop 1
v_cndmask_b32 v247, v19, v231, s[86:87]
s_branch M_go1
M_redo:
s_waitcnt vmcnt(0) lgkmcnt(0)
s_barrier
s_mov_b32 s50, -1
s_branch M_start
M_sB0:
buffer_load_dword v213, v214, s[16:19], s70 offen sc1
s_add_u32 s88, s88, 1
s_waitcnt vmcnt(0)
s_cmp_gt_u32 s88, 0x40000
s_cbranch_scc1 M_rB0
v_cmp_ne_u32 vcc, 1, v213
s_nop 0
s_cbranch_vccnz M_sB0
s_branch M_rB0
M_sB1:
buffer_load_dword v213, v214, s[16:19], s70 offen sc1
s_add_u32 s88, s88, 1
s_waitcnt vmcnt(0)
s_cmp_gt_u32 s88, 0x40000
s_cbranch_scc1 M_rB1
v_cmp_ne_u32 vcc, 1, v213
s_nop 0
s_cbranch_vccnz M_sB1
s_branch M_rB1
M_sK:
buffer_load_dword v220, v221, s[16:19], s72 offen sc1
s_add_u32 s88, s88, 1
s_waitcnt vmcnt(0)
s_cmp_gt_u32 s88, 0x40000
s_cbranch_scc1 M_rK
v_cmp_ne_u32 vcc, 1, v220
s_nop 0
s_cbranch_vccnz M_sK
s_branch M_rK
M_sZ:
buffer_load_dword v6, v7, s[20:23], 0 offen sc1
s_add_u32 s88, s88, 1
s_waitcnt vmcnt(0)
s_cmp_gt_u32 s88, 0x40000
s_cbranch_scc1 M_rZ
v_cmp_ne_u32 vcc, 1, v6
s_nop 0
s_cbranch_vccnz M_sZ
s_branch M_rZ
M_sH:
buffer_load_dword v213, v0, s[16:19], s72 offen sc1
s_add_u32 s88, s88, 1
s_waitcnt vmcnt(0)
s_cmp_gt_u32 s88, 0x40000
s_cbranch_scc1 M_rH
v_cmp_ne_u32 vcc, 1, v213
s_nop 0
s_cbranch_vccnz M_sH
s_branch M_rH
M_C0:
s_waitcnt vmcnt(44) lgkmcnt(2)
s_add_u32 s73, s45, 0x3000000
PK 144,144,145
Zvaa 16,32,0
s_lshl_b32 s84, s24, 4
La 16,245,8192
PK 145,146,147
Mvaa 16,36,4
s_add_u32 m0, s38, 0x9000
s_add_u32 s36, s58, 0x80000
La 20,245,10240
Zvaa 32,40,0
buffer_load_dwordx4 v1, s[16:19], s36 offen sc1 lds
Mvaa 32,44,4
Ta 56,235,0
PK 146,152,153
Zvaa 48,48,0
Ta 58,235,2048
PK 147,154,155
Mvaa 48,52,4
s_waitcnt vmcnt(56) lgkmcnt(4)
buffer_store_dwordx4 v[144:147], v1, s[16:19], s73 offen sc0 sc1
Ta 60,235,4096
Ta 62,235,6144
Zvaa 20,32,8
Ta 64,236,0
v_mov_b32 v12, s84
Mvaa 20,36,12
s_add_u32 s73, s46, 0x3000000
La 24,245,9216
PK 148,148,149
Zvaa 36,40,8
buffer_load_dwordx4 v1, s[16:19], s36 offen offset:1024 sc1 lds
Mvaa 36,44,12
Ta 66,236,2048
PK 149,150,151
Zvaa 52,48,8
La 28,245,11264
PK 150,156,157
Mvaa 52,52,12
s_waitcnt vmcnt(56) lgkmcnt(8)
buffer_load_dwordx4 v253, s[16:19], s36 offen offset:2048 sc1 lds
Zvaa 24,32,16
Ta 68,236,4096
PK 151,158,159
Mvaa 24,36,20
Ta 70,236,6144
v_mov_b32 v10, s49
Zvaa 40,40,16
Ta 72,237,0
Mvaa 40,44,20
Ta 74,237,2048
Zvaa 56,48,16
Ta 76,237,4096
Mvaa 56,52,20
s_waitcnt vmcnt(55) lgkmcnt(5)
Ta 78,237,6144
Zvaa 28,32,24
buffer_store_dwordx4 v[148:151], v1, s[16:19], s73 offen sc0 sc1
s_add_u32 s73, s45, 0x3020000
PK 160,160,161
PK 161,162,163
Mvaa 28,36,28
Ta 80,238,0
PK 162,168,169
Zvaa 44,40,24
Ta 82,238,2048
PK 163,170,171
Mvaa 44,44,28
buffer_load_dwordx4 v253, s[16:19], s36 offen offset:3072 sc1 lds
Zvaa 60,48,24
s_add_u32 m0, s38, 0x3800
s_add_u32 s36, s61, 0x24000
Ta 84,238,4096
Mvaa 60,52,28
s_waitcnt vmcnt(48) lgkmcnt(3)
Ta 86,238,6144
Zvaa 64,56,0
buffer_load_dwordx4 v252, s[4:7], s36 offen lds
Mvaa 64,60,4
Ta 88,239,0
Zvaa 80,64,0
s_add_u32 m0, s38, 0x6000
s_add_u32 s36, s60, 0x24000
Ta 90,239,2048
Mvaa 80,68,4
buffer_store_dwordx4 v[160:163], v1, s[16:19], s73 offen sc0 sc1
Ta 92,239,4096
Ta 94,239,6144
Zvaa 96,72,0
s_add_u32 s73, s46, 0x3020000
Ta 96,240,12288
PK 164,164,165
Mvaa 96,76,4
Ta 98,241,12288
PK 165,166,167
Zvaa 68,56,8
buffer_load_dwordx4 v248, s[4:7], s36 offen lds
Mvaa 68,60,12
ds_write_b32 v12, v10 offset:15368
Zvaa 84,64,8
Ta 100,242,12288
PK 166,172,173
Mvaa 84,68,12
buffer_load_dwordx4 v249, s[4:7], s36 offen offset:1024 lds
Zvaa 100,72,8
Ta 102,243,12288
PK 167,174,175
Mvaa 100,76,12
v_and_b32 v12, 48, v1
Zvaa 72,56,16
buffer_store_dwordx4 v[164:167], v1, s[16:19], s73 offen sc0 sc1
s_add_u32 s73, s45, 0x3040000
PK 176,176,177
PK 177,178,179
Mvaa 72,60,20
PK 178,184,185
PK 179,186,187
Zvaa 88,64,16
Mvaa 88,68,20
buffer_load_dwordx4 v250, s[4:7], s36 offen offset:2048 lds
Zvaa 104,72,16
Mvaa 104,76,20
Zvaa 76,56,24
buffer_store_dwordx4 v[176:179], v1, s[16:19], s73 offen sc0 sc1
s_add_u32 s73, s46, 0x3040000
PK 180,180,181
PK 181,182,183
Mvaa 76,60,28
s_waitcnt vmcnt(13) lgkmcnt(0)
s_barrier
Zvaa 92,64,24
ds_read_b32 v10, v12 offset:15368
PK 182,188,189
Mvaa 92,68,28
buffer_load_dwordx4 v251, s[4:7], s36 offen offset:3072 lds
Zvaa 108,72,24
s_add_u32 m0, s38, 0x7000
s_add_u32 s36, s60, 0x2d000
Ta 32,232,20480
Mvaa 108,76,28
s_waitcnt lgkmcnt(2)
Ta 34,232,22528
PK 183,190,191
Zvaa 112,80,0
buffer_store_dwordx4 v[180:183], v1, s[16:19], s73 offen sc0 sc1
Ta 36,232,32768
Ta 38,232,34816
Mvaa 112,84,4
s_add_u32 s73, s45, 0x3060000
Ta 40,233,20480
PK 192,192,193
Zvaa 128,88,0
Ta 42,233,22528
PK 193,194,195
Mvaa 128,92,4
buffer_load_dwordx4 v248, s[4:7], s36 offen lds
Zvaa 216,96,0
Ta 44,233,32768
PK 194,200,201
Mvaa 216,100,4
s_waitcnt lgkmcnt(7)
v_cmp_lt_u32 vcc, s50, v10
s_nop 0
s_cbranch_vccnz M_redo
Zvaa 116,80,8
buffer_load_dwordx4 v249, s[4:7], s36 offen offset:1024 lds
Mvaa 116,84,12
Ta 46,233,34816
PK 195,202,203
Zvaa 132,88,8
Ta 48,234,20480
Mvaa 132,92,12
buffer_store_dwordx4 v[192:195], v1, s[16:19], s73 offen sc0 sc1
Ta 50,234,22528
Ta 52,234,32768
Zvaa 220,96,8
s_add_u32 s73, s46, 0x3060000
La 224,244,16384
PK 196,196,197
Mvaa 220,100,12
Ta 54,234,34816
PK 197,198,199
Zvaa 120,80,16
buffer_load_dwordx4 v250, s[4:7], s36 offen offset:2048 lds
Mvaa 120,84,20
La 228,244,18432
PK 198,204,205
Zvaa 136,88,16
La 232,244,17408
PK 199,206,207
Mvaa 136,92,20
buffer_load_dwordx4 v251, s[4:7], s36 offen offset:3072 lds
Zvaa 224,96,16
La 236,244,19456
Mvaa 224,100,20
La 240,245,16384
Zvaa 124,80,24
buffer_store_dwordx4 v[196:199], v1, s[16:19], s73 offen sc0 sc1
s_add_u32 m0, s38, 0
s_add_u32 s36, s58, 0xc0000
La 244,245,18432
Mvaa 124,84,28
Ta 56,235,20480
Zvaa 140,88,24
Ta 58,235,22528
Mvaa 140,92,28
buffer_load_dwordx4 v1, s[16:19], s36 offen sc1 lds
Zvaa 228,96,24
Ta 60,235,32768
Mvaa 228,100,28
s_waitcnt vmcnt(63) lgkmcnt(7)
Ta 62,235,34816
Mvaa 16,32,224
buffer_load_dwordx4 v1, s[16:19], s36 offen offset:1024 sc1 lds
Mvaa 16,36,228
Ta 64,236,20480
Mvaa 32,40,224
La 248,245,17408
Mvaa 32,44,228
Ta 66,236,22528
v_and_b32 v215, 15, v15
Mvaa 48,48,224
buffer_load_dwordx4 v253, s[16:19], s36 offen offset:2048 sc1 lds
Mvaa 48,52,228
s_waitcnt lgkmcnt(9)
La 252,245,19456
v_lshlrev_b32 v214, 7, v215
Mvaa 20,32,232
s_movk_i32 s37, 0x480
Ta 68,236,32768
v_mul_u32_u24 v215, s37, v215
Mvaa 20,36,236
Ta 70,236,34816
v_lshrrev_b32 v8, 4, v15
Mvaa 36,40,232
Ta 72,237,20480
v_lshlrev_b32 v8, 3, v8
Mvaa 36,44,236
buffer_load_dwordx4 v253, s[16:19], s36 offen offset:3072 sc1 lds
Mvaa 52,48,232
Ta 74,237,22528
v_add_u32 v8, v8, v215
Mvaa 52,52,236
s_waitcnt lgkmcnt(12)
Ta 76,237,32768
v_and_b32 v7, 31, v15
Mvaa 24,32,240
Ta 78,237,34816
v_mul_u32_u24 v7, s37, v7
Mvaa 24,36,244
Ta 80,238,20480
v_and_b32 v215, 32, v15
Mvaa 40,40,240
s_add_u32 m0, s38, 0x3000
s_add_u32 s36, s61, 0x36000
Ta 82,238,22528
Mvaa 40,44,244
buffer_load_dwordx4 v252, s[4:7], s36 offen lds
Mvaa 56,48,240
Ta 84,238,32768
v_lshrrev_b32 v215, 1, v215
Mvaa 56,52,244
s_waitcnt lgkmcnt(9)
Ta 86,238,34816
v_add_u32 v7, v7, v215
Mvaa 28,32,248
Ta 88,239,20480
v_mov_b32 v0, 1
Mvaa 28,36,252
s_add_u32 m0, s38, 0x1000
s_add_u32 s36, s60, 0x36000
Ta 90,239,22528
Mvaa 44,40,248
buffer_load_dwordx4 v248, s[4:7], s36 offen lds
Mvaa 44,44,252
Ta 92,239,32768
v_mov_b32 v215, 0x10000000
Mvaa 60,48,248
Ta 94,239,34816
v_writelane_b32 v215, s78, 0
Mvaa 60,52,252
s_waitcnt vmcnt(63) lgkmcnt(8)
Ta 96,240,13312
v_writelane_b32 v215, s79, 1
Mvaa 64,56,224
buffer_load_dwordx4 v249, s[4:7], s36 offen offset:1024 lds
Mvaa 64,60,228
Ta 98,241,13312
Mvaa 80,64,224
Ta 100,242,13312
Mvaa 80,68,228
Ta 102,243,13312
Mvaa 96,72,224
Mvaa 96,76,228
buffer_load_dwordx4 v250, s[4:7], s36 offen offset:2048 lds
Mvaa 68,56,232
Mvaa 68,60,236
Mvaa 84,64,232
Mvaa 84,68,236
Mvaa 100,72,232
buffer_load_dwordx4 v251, s[4:7], s36 offen offset:3072 lds
Mvaa 100,76,236
Mvaa 72,56,240
Mvaa 72,60,244
Mvaa 88,64,240
Mvaa 88,68,244
s_add_u32 m0, s38, 0x2000
s_add_u32 s36, s60, 0x3f000
Mvaa 104,72,240
buffer_load_dwordx4 v248, s[4:7], s36 offen lds
Mvaa 104,76,244
Mvaa 76,56,248
Mvaa 76,60,252
s_waitcnt vmcnt(11) lgkmcnt(0)
s_barrier
Mvaa 92,64,248
buffer_load_dwordx4 v249, s[4:7], s36 offen offset:1024 lds
Mvaa 92,68,252
Ta 32,232,24576
Mvaa 108,72,248
Ta 34,232,26624
Mvaa 108,76,252
s_waitcnt lgkmcnt(2)
Ta 36,232,28672
Mvaa 112,80,224
Ta 38,232,30720
Mvaa 112,84,228
buffer_load_dwordx4 v250, s[4:7], s36 offen offset:2048 lds
Mvaa 128,88,224
Ta 40,233,24576
Mvaa 128,92,228
Ta 42,233,26624
Mvaa 216,96,224
Ta 44,233,28672
Mvaa 216,100,228
Ta 46,233,30720
Mvaa 116,80,232
buffer_load_dwordx4 v251, s[4:7], s36 offen offset:3072 lds
Mvaa 116,84,236
Ta 48,234,24576
Mvaa 132,88,232
Ta 50,234,26624
Mvaa 132,92,236
Ta 52,234,28672
Mvaa 220,96,232
La 0,244,36864
Mvaa 220,100,236
s_add_u32 m0, s38, 0x4000
s_add_u32 s36, s58, 0x100000
Ta 54,234,30720
Mvaa 120,80,240
buffer_load_dwordx4 v1, s[16:19], s36 offen sc1 lds
Mvaa 120,84,244
La 4,244,38912
Mvaa 136,88,240
La 8,244,37888
Mvaa 136,92,244
La 12,244,39936
Mvaa 224,96,240
buffer_load_dwordx4 v1, s[16:19], s36 offen offset:1024 sc1 lds
Mvaa 224,100,244
La 16,245,36864
Mvaa 124,80,248
La 20,245,38912
Mvaa 124,84,252
Ta 56,235,24576
Mvaa 140,88,248
Ta 58,235,26624
Mvaa 140,92,252
buffer_load_dwordx4 v253, s[16:19], s36 offen offset:2048 sc1 lds
Mvaa 228,96,248
Ta 60,235,28672
Mvaa 228,100,252
s_waitcnt vmcnt(63) lgkmcnt(7)
Ta 62,235,30720
Mvaa 16,32,0
Ta 64,236,24576
Mvaa 16,36,4
La 24,245,37888
Mvaa 32,40,0
buffer_load_dwordx4 v253, s[16:19], s36 offen offset:3072 sc1 lds
Mvaa 32,44,4
Ta 66,236,26624
Mvaa 48,48,0
La 28,245,39936
Mvaa 48,52,4
s_waitcnt vmcnt(63) lgkmcnt(10)
Ta 68,236,28672
Mvaa 20,32,8
Ta 70,236,30720
Mvaa 20,36,12
s_add_u32 m0, s38, 0x3400
s_add_u32 s36, s61, 0x48000
Ta 72,237,24576
Mvaa 36,40,8
buffer_load_dwordx4 v252, s[4:7], s36 offen lds
Mvaa 36,44,12
Ta 74,237,26624
Mvaa 52,48,8
Ta 76,237,28672
Mvaa 52,52,12
s_waitcnt vmcnt(63) lgkmcnt(13)
Ta 78,237,30720
Mvaa 24,32,16
s_add_u32 m0, s38, 0x5000
s_add_u32 s36, s60, 0x48000
Ta 80,238,24576
Mvaa 24,36,20
buffer_load_dwordx4 v248, s[4:7], s36 offen lds
Mvaa 40,40,16
Ta 82,238,26624
Mvaa 40,44,20
Ta 84,238,28672
Mvaa 56,48,16
Ta 86,238,30720
Mvaa 56,52,20
s_waitcnt vmcnt(63) lgkmcnt(10)
buffer_load_dwordx4 v249, s[4:7], s36 offen offset:1024 lds
Mvaa 28,32,24
Ta 88,239,24576
Mvaa 28,36,28
Ta 90,239,26624
Mvaa 44,40,24
Ta 92,239,28672
Mvaa 44,44,28
Ta 94,239,30720
Mvaa 60,48,24
buffer_load_dwordx4 v250, s[4:7], s36 offen offset:2048 lds
Mvaa 60,52,28
s_waitcnt vmcnt(63) lgkmcnt(8)
Ta 96,240,14336
Mvaa 64,56,0
Ta 98,241,14336
Mvaa 64,60,4
Ta 100,242,14336
Mvaa 80,64,0
Ta 102,243,14336
Mvaa 80,68,4
buffer_load_dwordx4 v251, s[4:7], s36 offen offset:3072 lds
Mvaa 96,72,0
Mvaa 96,76,4
Mvaa 68,56,8
Mvaa 68,60,12
Mvaa 84,64,8
s_add_u32 m0, s38, 0x8000
s_add_u32 s36, s60, 0x51000
Mvaa 84,68,12
buffer_load_dwordx4 v248, s[4:7], s36 offen lds
Mvaa 100,72,8
Mvaa 100,76,12
Mvaa 72,56,16
Mvaa 72,60,20
buffer_load_dwordx4 v249, s[4:7], s36 offen offset:1024 lds
Mvaa 88,64,16
Mvaa 88,68,20
Mvaa 104,72,16
Mvaa 104,76,20
Mvaa 76,56,24
buffer_load_dwordx4 v250, s[4:7], s36 offen offset:2048 lds
Mvaa 76,60,28
s_waitcnt vmcnt(12) lgkmcnt(0)
s_barrier
Mvaa 92,64,24
Ta 32,232,4096
Mvaa 92,68,28
Ta 34,232,6144
Mvaa 108,72,24
Ta 36,232,8192
Mvaa 108,76,28
s_waitcnt lgkmcnt(3)
buffer_load_dwordx4 v251, s[4:7], s36 offen offset:3072 lds
Mvaa 112,80,0
Ta 38,232,10240
Mvaa 112,84,4
Ta 40,233,4096
Mvaa 128,88,0
Ta 42,233,6144
Mvaa 128,92,4
Ta 44,233,8192
Mvaa 216,96,0
s_add_u32 m0, s38, 0x6000
s_add_u32 s36, s58, 0x140000
Ta 46,233,10240
Mvaa 216,100,4
buffer_load_dwordx4 v1, s[16:19], s36 offen sc1 lds
Mvaa 116,80,8
Ta 48,234,4096
Mvaa 116,84,12
Ta 50,234,6144
Mvaa 132,88,8
Ta 52,234,8192
Mvaa 132,92,12
buffer_load_dwordx4 v1, s[16:19], s36 offen offset:1024 sc1 lds
Mvaa 220,96,8
La 224,244,0
Mvaa 220,100,12
Ta 54,234,10240
Mvaa 120,80,16
La 228,244,2048
Mvaa 120,84,20
La 232,244,1024
Mvaa 136,88,16
buffer_load_dwordx4 v253, s[16:19], s36 offen offset:2048 sc1 lds
Mvaa 136,92,20
La 236,244,3072
Mvaa 224,96,16
La 240,245,0
Mvaa 224,100,20
La 244,245,2048
Mvaa 124,80,24
Ta 56,235,4096
Mvaa 124,84,28
buffer_load_dwordx4 v253, s[16:19], s36 offen offset:3072 sc1 lds
Mvaa 140,88,24
Ta 58,235,6144
Mvaa 140,92,28
Ta 60,235,8192
Mvaa 228,96,24
Ta 62,235,10240
Mvaa 228,100,28
s_waitcnt vmcnt(63) lgkmcnt(8)
Ta 64,236,4096
Mvaa 16,32,224
s_add_u32 m0, s38, 0x3800
s_add_u32 s36, s61, 0x5a000
La 248,245,1024
Mvaa 16,36,228
buffer_load_dwordx4 v252, s[4:7], s36 offen lds
Mvaa 32,40,224
Ta 66,236,6144
Mvaa 32,44,228
La 252,245,3072
Mvaa 48,48,224
Ta 68,236,8192
Mvaa 48,52,228
s_waitcnt lgkmcnt(11)
s_add_u32 m0, s38, 0x7000
s_add_u32 s36, s60, 0x5a000
Mvaa 20,32,232
buffer_load_dwordx4 v248, s[4:7], s36 offen lds
Mvaa 20,36,236
Ta 70,236,10240
Mvaa 36,40,232
Ta 72,237,4096
Mvaa 36,44,236
Ta 74,237,6144
Mvaa 52,48,232
buffer_load_dwordx4 v249, s[4:7], s36 offen offset:1024 lds
Mvaa 52,52,236
s_waitcnt lgkmcnt(12)
Ta 76,237,8192
Mvaa 24,32,240
Ta 78,237,10240
Mvaa 24,36,244
Ta 80,238,4096
Mvaa 40,40,240
Ta 82,238,6144
Mvaa 40,44,244
buffer_load_dwordx4 v250, s[4:7], s36 offen offset:2048 lds
Mvaa 56,48,240
Ta 84,238,8192
Mvaa 56,52,244
s_waitcnt lgkmcnt(9)
Ta 86,238,10240
Mvaa 28,32,248
Ta 88,239,4096
Mvaa 28,36,252
Ta 90,239,6144
Mvaa 44,40,248
buffer_load_dwordx4 v251, s[4:7], s36 offen offset:3072 lds
Mvaa 44,44,252
Ta 92,239,8192
Mvaa 60,48,248
Ta 94,239,10240
Mvaa 60,52,252
s_waitcnt vmcnt(63) lgkmcnt(8)
Ta 96,240,12288
Mvaa 64,56,224
Ta 98,241,12288
Mvaa 64,60,228
s_add_u32 m0, s38, 0x9000
s_add_u32 s36, s60, 0x63000
Ta 100,242,12288
Mvaa 80,64,224
buffer_load_dwordx4 v248, s[4:7], s36 offen lds
Mvaa 80,68,228
Ta 102,243,12288
Mvaa 96,72,224
Mvaa 96,76,228
Mvaa 68,56,232
buffer_load_dwordx4 v249, s[4:7], s36 offen offset:1024 lds
Mvaa 68,60,236
Mvaa 84,64,232
Mvaa 84,68,236
Mvaa 100,72,232
Mvaa 100,76,236
buffer_load_dwordx4 v250, s[4:7], s36 offen offset:2048 lds
Mvaa 72,56,240
Mvaa 72,60,244
Mvaa 88,64,240
Mvaa 88,68,244
Mvaa 104,72,240
buffer_load_dwordx4 v251, s[4:7], s36 offen offset:3072 lds
Mvaa 104,76,244
Mvaa 76,56,248
Mvaa 76,60,252
s_waitcnt vmcnt(13) lgkmcnt(0)
s_barrier
Mvaa 92,64,248
buffer_store_dword v0, v215, s[16:19], 0 offen sc0 sc1
Mvaa 92,68,252
s_add_u32 m0, s38, 0
s_add_u32 s36, s58, 0x180000
Ta 32,232,20480
Mvaa 108,72,248
Ta 34,232,22528
Mvaa 108,76,252
s_waitcnt lgkmcnt(2)
buffer_load_dwordx4 v1, s[16:19], s36 offen sc1 lds
Mvaa 112,80,224
Ta 36,232,32768
Mvaa 112,84,228
Ta 38,232,34816
Mvaa 128,88,224
buffer_load_dwordx4 v1, s[16:19], s36 offen offset:1024 sc1 lds
Mvaa 128,92,228
Ta 40,233,20480
v_and_b32 v214, 0x180, v214
Mvaa 216,96,224
Ta 42,233,22528
v_mov_b32 v215, 0x10000000
Mvaa 216,100,228
Ta 44,233,32768
v_writelane_b32 v215, s77, 0
Mvaa 116,80,232
s_and_b32 s37, s2, 1
s_lshl_b32 s37, s37, 3
Ta 46,233,34816
Mvaa 116,84,236
buffer_load_dwordx4 v253, s[16:19], s36 offen offset:2048 sc1 lds
Mvaa 132,88,232
Ta 48,234,20480
v_add_u32 v3, s37, v245
Mvaa 132,92,236
Ta 50,234,22528
v_add_u32 v4, s37, v244
Mvaa 220,96,232
Ta 52,234,32768
v_xor_b32 v246, 8, v4
Mvaa 220,100,236
La 0,244,16384
v_xor_b32 v247, 8, v3
Mvaa 120,80,240
buffer_load_dwordx4 v253, s[16:19], s36 offen offset:3072 sc1 lds
Mvaa 120,84,244
Ta 54,234,34816
Mvaa 136,88,240
La 4,244,18432
Mvaa 136,92,244
La 8,244,17408
Mvaa 224,96,240
La 12,244,19456
Mvaa 224,100,244
s_add_u32 m0, s38, 0x3000
s_add_u32 s36, s61, 0x6c000
La 16,245,16384
Mvaa 124,80,248
buffer_load_dwordx4 v252, s[4:7], s36 offen lds
Mvaa 124,84,252
La 20,245,18432
Mvaa 140,88,248
Ta 56,235,20480
Mvaa 140,92,252
Ta 58,235,22528
Mvaa 228,96,248
s_add_u32 m0, s38, 0x1000
s_add_u32 s36, s60, 0x6c000
Ta 60,235,32768
Mvaa 228,100,252
s_waitcnt vmcnt(63) lgkmcnt(7)
buffer_load_dwordx4 v248, s[4:7], s36 offen lds
Mvaa 16,32,0
Ta 62,235,34816
Mvaa 16,36,4
Ta 64,236,20480
Mvaa 32,40,0
La 24,245,17408
Mvaa 32,44,4
buffer_load_dwordx4 v249, s[4:7], s36 offen offset:1024 lds
Mvaa 48,48,0
Ta 66,236,22528
Mvaa 48,52,4
s_waitcnt vmcnt(63) lgkmcnt(9)
La 28,245,19456
Mvaa 20,32,8
Ta 68,236,32768
Mvaa 20,36,12
Ta 70,236,34816
Mvaa 36,40,8
buffer_load_dwordx4 v250, s[4:7], s36 offen offset:2048 lds
Mvaa 36,44,12
Ta 72,237,20480
Mvaa 52,48,8
Ta 74,237,22528
Mvaa 52,52,12
s_waitcnt vmcnt(63) lgkmcnt(12)
Ta 76,237,32768
Mvaa 24,32,16
Ta 78,237,34816
Mvaa 24,36,20
buffer_load_dwordx4 v251, s[4:7], s36 offen offset:3072 lds
Mvaa 40,40,16
Ta 80,238,20480
Mvaa 40,44,20
Ta 82,238,22528
Mvaa 56,48,16
Ta 84,238,32768
Mvaa 56,52,20
s_waitcnt vmcnt(63) lgkmcnt(9)
Ta 86,238,34816
Mvaa 28,32,24
s_add_u32 m0, s38, 0x2000
s_add_u32 s36, s60, 0x75000
Ta 88,239,20480
Mvaa 28,36,28
buffer_load_dwordx4 v248, s[4:7], s36 offen lds
Mvaa 44,40,24
Ta 90,239,22528
Mvaa 44,44,28
Ta 92,239,32768
Mvaa 60,48,24
Ta 94,239,34816
Mvaa 60,52,28
s_waitcnt vmcnt(63) lgkmcnt(8)
buffer_load_dwordx4 v249, s[4:7], s36 offen offset:1024 lds
Mvaa 64,56,0
Ta 96,240,13312
Mvaa 64,60,4
Ta 98,241,13312
Mvaa 80,64,0
Ta 100,242,13312
Mvaa 80,68,4
Ta 102,243,13312
Mvaa 96,72,0
buffer_load_dwordx4 v250, s[4:7], s36 offen offset:2048 lds
Mvaa 96,76,4
Mvaa 68,56,8
Mvaa 68,60,12
Mvaa 84,64,8
Mvaa 84,68,12
buffer_load_dwordx4 v251, s[4:7], s36 offen offset:3072 lds
Mvaa 100,72,8
Mvaa 100,76,12
Mvaa 72,56,16
Mvaa 72,60,20
Mvaa 88,64,16
Mvaa 88,68,20
Mvaa 104,72,16
Mvaa 104,76,20
Mvaa 76,56,24
Mvaa 76,60,28
s_waitcnt vmcnt(14) lgkmcnt(0)
s_barrier
Mvaa 92,64,24
Ta 32,232,28672
Mvaa 92,68,28
s_add_u32 m0, s38, 0x4000
s_add_u32 s36, s58, 0x1c0000
Ta 34,232,30720
Mvaa 108,72,24
buffer_load_dwordx4 v1, s[16:19], s36 offen sc1 lds
Mvaa 108,76,28
s_waitcnt lgkmcnt(2)
Ta 36,232,36864
Mvaa 112,80,0
Ta 38,232,38912
Mvaa 112,84,4
Ta 40,233,28672
Mvaa 128,88,0
buffer_load_dwordx4 v1, s[16:19], s36 offen offset:1024 sc1 lds
Mvaa 128,92,4
Ta 42,233,30720
Mvaa 216,96,0
Ta 44,233,36864
Mvaa 216,100,4
Ta 46,233,38912
Mvaa 116,80,8
Ta 48,234,28672
Mvaa 116,84,12
buffer_load_dwordx4 v253, s[16:19], s36 offen offset:2048 sc1 lds
Mvaa 132,88,8
Ta 50,234,30720
Mvaa 132,92,12
Ta 52,234,36864
Mvaa 220,96,8
La 224,244,24576
Mvaa 220,100,12
Ta 54,234,38912
Mvaa 120,80,16
buffer_load_dwordx4 v253, s[16:19], s36 offen offset:3072 sc1 lds
Mvaa 120,84,20
La 228,244,26624
Mvaa 136,88,16
La 232,244,25600
Mvaa 136,92,20
La 236,244,27648
Mvaa 224,96,16
La 240,245,24576
Mvaa 224,100,20
s_add_u32 m0, s38, 0x3400
s_add_u32 s36, s61, 0x7e000
La 244,245,26624
Mvaa 124,80,24
buffer_load_dwordx4 v252, s[4:7], s36 offen lds
Mvaa 124,84,28
Ta 56,235,28672
Mvaa 140,88,24
Ta 58,235,30720
Mvaa 140,92,28
Ta 60,235,36864
Mvaa 228,96,24
s_add_u32 m0, s38, 0x5000
s_add_u32 s36, s60, 0x7e000
Ta 62,235,38912
Mvaa 228,100,28
s_waitcnt vmcnt(63) lgkmcnt(8)
buffer_load_dwordx4 v248, s[4:7], s36 offen lds
Mvaa 16,32,224
Ta 64,236,28672
Mvaa 16,36,228
La 248,245,25600
Mvaa 32,40,224
Ta 66,236,30720
Mvaa 32,44,228
buffer_load_dwordx4 v249, s[4:7], s36 offen offset:1024 lds
Mvaa 48,48,224
La 252,245,27648
Mvaa 48,52,228
s_waitcnt lgkmcnt(10)
Ta 68,236,36864
Mvaa 20,32,232
Ta 70,236,38912
Mvaa 20,36,236
Ta 72,237,28672
Mvaa 36,40,232
buffer_load_dwordx4 v250, s[4:7], s36 offen offset:2048 lds
Mvaa 36,44,236
Ta 74,237,30720
Mvaa 52,48,232
Ta 76,237,36864
Mvaa 52,52,236
s_waitcnt lgkmcnt(13)
Ta 78,237,38912
Mvaa 24,32,240
Ta 80,238,28672
Mvaa 24,36,244
buffer_load_dwordx4 v251, s[4:7], s36 offen offset:3072 lds
Mvaa 40,40,240
Ta 82,238,30720
Mvaa 40,44,244
Ta 84,238,36864
Mvaa 56,48,240
Ta 86,238,38912
Mvaa 56,52,244
s_waitcnt lgkmcnt(10)
Ta 88,239,28672
Mvaa 28,32,248
s_add_u32 m0, s38, 0x8000
s_add_u32 s36, s60, 0x87000
Ta 90,239,30720
Mvaa 28,36,252
buffer_load_dwordx4 v248, s[4:7], s36 offen lds
Mvaa 44,40,248
Ta 92,239,36864
Mvaa 44,44,252
Ta 94,239,38912
Mvaa 60,48,248
Ta 96,240,14336
Mvaa 60,52,252
s_waitcnt vmcnt(63) lgkmcnt(9)
buffer_load_dwordx4 v249, s[4:7], s36 offen offset:1024 lds
Mvaa 64,56,224
Ta 98,241,14336
Mvaa 64,60,228
Ta 100,242,14336
Mvaa 80,64,224
Ta 102,243,14336
Mvaa 80,68,228
Mvaa 96,72,224
buffer_load_dwordx4 v250, s[4:7], s36 offen offset:2048 lds
Mvaa 96,76,228
Mvaa 68,56,232
Mvaa 68,60,236
Mvaa 84,64,232
Mvaa 84,68,236
buffer_load_dwordx4 v251, s[4:7], s36 offen offset:3072 lds
Mvaa 100,72,232
Mvaa 100,76,236
Mvaa 72,56,240
Mvaa 72,60,244
Mvaa 88,64,240
Mvaa 88,68,244
Mvaa 104,72,240
Mvaa 104,76,244
Mvaa 76,56,248
Mvaa 76,60,252
s_waitcnt vmcnt(13) lgkmcnt(0)
s_barrier
Mvaa 92,64,248
Ta 32,232,4096
Mvaa 92,68,252
s_add_u32 m0, s38, 0x6000
s_add_u32 s36, s58, 0x200000
Ta 34,232,6144
Mvaa 108,72,248
buffer_load_dwordx4 v1, s[16:19], s36 offen sc1 lds
Mvaa 108,76,252
s_waitcnt lgkmcnt(2)
Ta 36,232,8192
Mvaa 112,80,224
Ta 38,232,10240
Mvaa 112,84,228
Ta 40,233,4096
Mvaa 128,88,224
buffer_load_dwordx4 v1, s[16:19], s36 offen offset:1024 sc1 lds
Mvaa 128,92,228
Ta 42,233,6144
Mvaa 216,96,224
Ta 44,233,8192
Mvaa 216,100,228
Ta 46,233,10240
Mvaa 116,80,232
Ta 48,234,4096
Mvaa 116,84,236
buffer_load_dwordx4 v253, s[16:19], s36 offen offset:2048 sc1 lds
Mvaa 132,88,232
Ta 50,234,6144
Mvaa 132,92,236
Ta 52,234,8192
Mvaa 220,96,232
La 0,244,0
Mvaa 220,100,236
Ta 54,234,10240
Mvaa 120,80,240
buffer_load_dwordx4 v253, s[16:19], s36 offen offset:3072 sc1 lds
Mvaa 120,84,244
La 4,244,2048
Mvaa 136,88,240
La 8,244,1024
Mvaa 136,92,244
La 12,244,3072
Mvaa 224,96,240
La 16,245,0
Mvaa 224,100,244
s_add_u32 m0, s38, 0x3800
s_add_u32 s36, s61, 0x90000
La 20,245,2048
Mvaa 124,80,248
buffer_load_dwordx4 v252, s[4:7], s36 offen lds
Mvaa 124,84,252
Ta 56,235,4096
Mvaa 140,88,248
Ta 58,235,6144
Mvaa 140,92,252
Ta 60,235,8192
Mvaa 228,96,248
s_add_u32 m0, s38, 0x7000
s_add_u32 s36, s60, 0x90000
Ta 62,235,10240
Mvaa 228,100,252
s_waitcnt vmcnt(63) lgkmcnt(8)
buffer_load_dwordx4 v248, s[4:7], s36 offen lds
Mvaa 16,32,0
Ta 64,236,4096
Mvaa 16,36,4
La 24,245,1024
Mvaa 32,40,0
Ta 66,236,6144
Mvaa 32,44,4
buffer_load_dwordx4 v249, s[4:7], s36 offen offset:1024 lds
Mvaa 48,48,0
La 28,245,3072
Mvaa 48,52,4
s_waitcnt vmcnt(63) lgkmcnt(10)
Ta 68,236,8192
Mvaa 20,32,8
Ta 70,236,10240
Mvaa 20,36,12
Ta 72,237,4096
Mvaa 36,40,8
buffer_load_dwordx4 v250, s[4:7], s36 offen offset:2048 lds
Mvaa 36,44,12
Ta 74,237,6144
Mvaa 52,48,8
Ta 76,237,8192
Mvaa 52,52,12
s_waitcnt vmcnt(63) lgkmcnt(13)
Ta 78,237,10240
Mvaa 24,32,16
Ta 80,238,4096
Mvaa 24,36,20
buffer_load_dwordx4 v251, s[4:7], s36 offen offset:3072 lds
Mvaa 40,40,16
Ta 82,238,6144
Mvaa 40,44,20
Ta 84,238,8192
Mvaa 56,48,16
Ta 86,238,10240
Mvaa 56,52,20
s_waitcnt vmcnt(63) lgkmcnt(10)
Ta 88,239,4096
Mvaa 28,32,24
s_add_u32 m0, s38, 0x9000
s_add_u32 s36, s60, 0x99000
Ta 90,239,6144
Mvaa 28,36,28
buffer_load_dwordx4 v248, s[4:7], s36 offen lds
Mvaa 44,40,24
Ta 92,239,8192
Mvaa 44,44,28
Ta 94,239,10240
Mvaa 60,48,24
Ta 96,240,12288
Mvaa 60,52,28
s_waitcnt vmcnt(63) lgkmcnt(9)
buffer_load_dwordx4 v249, s[4:7], s36 offen offset:1024 lds
Mvaa 64,56,0
Ta 98,241,12288
Mvaa 64,60,4
Ta 100,242,12288
Mvaa 80,64,0
Ta 102,243,12288
Mvaa 80,68,4
Mvaa 96,72,0
buffer_load_dwordx4 v250, s[4:7], s36 offen offset:2048 lds
Mvaa 96,76,4
Mvaa 68,56,8
Mvaa 68,60,12
Mvaa 84,64,8
Mvaa 84,68,12
buffer_load_dwordx4 v251, s[4:7], s36 offen offset:3072 lds
Mvaa 100,72,8
Mvaa 100,76,12
Mvaa 72,56,16
Mvaa 72,60,20
Mvaa 88,64,16
Mvaa 88,68,20
Mvaa 104,72,16
Mvaa 104,76,20
Mvaa 76,56,24
Mvaa 76,60,28
s_waitcnt vmcnt(13) lgkmcnt(0)
s_barrier
Mvaa 92,64,24
Ta 32,232,20480
Mvaa 92,68,28
s_add_u32 m0, s38, 0
s_add_u32 s36, s58, 0x240000
Ta 34,232,22528
Mvaa 108,72,24
buffer_load_dwordx4 v1, s[16:19], s36 offen sc1 lds
Mvaa 108,76,28
s_waitcnt lgkmcnt(2)
Ta 36,232,32768
Mvaa 112,80,0
Ta 38,232,34816
Mvaa 112,84,4
Ta 40,233,20480
Mvaa 128,88,0
buffer_load_dwordx4 v1, s[16:19], s36 offen offset:1024 sc1 lds
Mvaa 128,92,4
Ta 42,233,22528
Mvaa 216,96,0
Ta 44,233,32768
Mvaa 216,100,4
Ta 46,233,34816
Mvaa 116,80,8
Ta 48,234,20480
Mvaa 116,84,12
buffer_load_dwordx4 v253, s[16:19], s36 offen offset:2048 sc1 lds
Mvaa 132,88,8
Ta 50,234,22528
Mvaa 132,92,12
Ta 52,234,32768
Mvaa 220,96,8
La 224,244,16384
Mvaa 220,100,12
Ta 54,234,34816
Mvaa 120,80,16
buffer_load_dwordx4 v253, s[16:19], s36 offen offset:3072 sc1 lds
Mvaa 120,84,20
La 228,244,18432
Mvaa 136,88,16
La 232,244,17408
Mvaa 136,92,20
La 236,244,19456
Mvaa 224,96,16
La 240,245,16384
Mvaa 224,100,20
s_add_u32 m0, s38, 0x3000
s_add_u32 s36, s61, 0xa2000
La 244,245,18432
Mvaa 124,80,24
buffer_load_dwordx4 v252, s[4:7], s36 offen lds
Mvaa 124,84,28
Ta 56,235,20480
Mvaa 140,88,24
Ta 58,235,22528
Mvaa 140,92,28
Ta 60,235,32768
Mvaa 228,96,24
s_add_u32 m0, s38, 0x1000
s_add_u32 s36, s60, 0xa2000
Ta 62,235,34816
Mvaa 228,100,28
s_waitcnt vmcnt(63) lgkmcnt(8)
buffer_load_dwordx4 v248, s[4:7], s36 offen lds
Mvaa 16,32,224
Ta 64,236,20480
Mvaa 16,36,228
La 248,245,17408
Mvaa 32,40,224
Ta 66,236,22528
Mvaa 32,44,228
buffer_load_dwordx4 v249, s[4:7], s36 offen offset:1024 lds
Mvaa 48,48,224
La 252,245,19456
Mvaa 48,52,228
s_waitcnt lgkmcnt(10)
Ta 68,236,32768
Mvaa 20,32,232
Ta 70,236,34816
Mvaa 20,36,236
Ta 72,237,20480
Mvaa 36,40,232
buffer_load_dwordx4 v250, s[4:7], s36 offen offset:2048 lds
Mvaa 36,44,236
Ta 74,237,22528
Mvaa 52,48,232
Ta 76,237,32768
Mvaa 52,52,236
s_waitcnt lgkmcnt(13)
Ta 78,237,34816
Mvaa 24,32,240
Ta 80,238,20480
Mvaa 24,36,244
buffer_load_dwordx4 v251, s[4:7], s36 offen offset:3072 lds
Mvaa 40,40,240
Ta 82,238,22528
Mvaa 40,44,244
Ta 84,238,32768
Mvaa 56,48,240
Ta 86,238,34816
Mvaa 56,52,244
s_waitcnt lgkmcnt(10)
Ta 88,239,20480
Mvaa 28,32,248
s_add_u32 m0, s38, 0x2000
s_add_u32 s36, s60, 0xab000
Ta 90,239,22528
Mvaa 28,36,252
buffer_load_dwordx4 v248, s[4:7], s36 offen lds
Mvaa 44,40,248
Ta 92,239,32768
Mvaa 44,44,252
Ta 94,239,34816
Mvaa 60,48,248
buffer_load_dword v213, v214, s[16:19], s70 offen sc1
Mvaa 60,52,252
s_waitcnt vmcnt(63) lgkmcnt(8)
Ta 96,240,13312
Mvaa 64,56,224
Ta 98,241,13312
Mvaa 64,60,228
buffer_load_dwordx4 v249, s[4:7], s36 offen offset:1024 lds
Mvaa 80,64,224
Ta 100,242,13312
Mvaa 80,68,228
Ta 102,243,13312
Mvaa 96,72,224
buffer_load_dwordx4 v250, s[4:7], s36 offen offset:2048 lds
Mvaa 96,76,228
Mvaa 68,56,232
Mvaa 68,60,236
Mvaa 84,64,232
Mvaa 84,68,236
buffer_load_dwordx4 v251, s[4:7], s36 offen offset:3072 lds
Mvaa 100,72,232
Mvaa 100,76,236
Mvaa 72,56,240
Mvaa 72,60,244
Mvaa 88,64,240
Mvaa 88,68,244
Mvaa 104,72,240
Mvaa 104,76,244
Mvaa 76,56,248
Mvaa 76,60,252
s_waitcnt vmcnt(14) lgkmcnt(0)
s_barrier
Mvaa 92,64,248
Ta 32,232,28672
Mvaa 92,68,252
s_add_u32 m0, s38, 0x4000
s_add_u32 s36, s62, 0
Ta 34,232,30720
Mvaa 108,72,248
buffer_load_dwordx4 v248, s[8:11], s36 offen lds
Mvaa 108,76,252
s_waitcnt lgkmcnt(2)
Ta 36,232,36864
Mvaa 112,80,224
Ta 38,232,38912
Mvaa 112,84,228
buffer_load_dwordx4 v249, s[8:11], s36 offen offset:1024 lds
Mvaa 128,88,224
Ta 40,233,28672
Mvaa 128,92,228
Ta 42,233,30720
Mvaa 216,96,224
Ta 44,233,36864
Mvaa 216,100,228
buffer_load_dwordx4 v250, s[8:11], s36 offen offset:2048 lds
Mvaa 116,80,232
Ta 46,233,38912
Mvaa 116,84,236
Ta 48,234,28672
Mvaa 132,88,232
Ta 50,234,30720
Mvaa 132,92,236
buffer_load_dwordx4 v251, s[8:11], s36 offen offset:3072 lds
Mvaa 220,96,232
Ta 52,234,36864
Mvaa 220,100,236
ds_read2st64_b64 a[0:3], v246 offset0:48 offset1:50
Mvaa 120,80,240
Ta 54,234,38912
Mvaa 120,84,244
s_add_u32 m0, s38, 0x3400
s_add_u32 s36, s63, 0
ds_read2st64_b64 a[4:7], v246 offset0:52 offset1:54
Mvaa 136,88,240
buffer_load_dwordx4 v252, s[8:11], s36 offen lds
Mvaa 136,92,244
ds_read2st64_b64 a[8:11], v247 offset0:48 offset1:50
Mvaa 224,96,240
ds_read2st64_b64 a[12:15], v247 offset0:52 offset1:54
Mvaa 224,100,244
s_add_u32 m0, s38, 0x5000
s_add_u32 s36, s62, 0x12000
ds_read2st64_b64 a[16:19], v3 offset0:48 offset1:50
Mvaa 124,80,248
buffer_load_dwordx4 v248, s[8:11], s36 offen lds
Mvaa 124,84,252
ds_read2st64_b64 a[20:23], v3 offset0:52 offset1:54
Mvaa 140,88,248
Ta 56,235,28672
Mvaa 140,92,252
buffer_load_dwordx4 v249, s[8:11], s36 offen offset:1024 lds
Mvaa 228,96,248
Ta 58,235,30720
Mvaa 228,100,252
s_waitcnt vmcnt(63) lgkmcnt(6)
Ta 60,235,36864
Mvaa 16,32,0
s_waitcnt vmcnt(10)
v_cmp_ne_u32 vcc, 1, v213
s_nop 0
s_cbranch_vccnz M_sB0
M_rB0:
Mvaa 16,36,4
buffer_load_dwordx4 v250, s[8:11], s36 offen offset:2048 lds
Mvaa 32,40,0
Ta 62,235,38912
v_and_b32 v214, 7, v15
Mvaa 32,44,4
Ta 64,236,28672
v_max_u32 v214, 1, v214
Mvaa 48,48,0
ds_read2st64_b64 a[24:27], v4 offset0:48 offset1:50
v_xor_b32 v214, s2, v214
Mvaa 48,52,4
s_waitcnt vmcnt(63) lgkmcnt(8)
buffer_load_dwordx4 v251, s[8:11], s36 offen offset:3072 lds
Mvaa 20,32,8
Ta 66,236,30720
v_and_b32 v214, 7, v214
Mvaa 20,36,12
ds_read2st64_b64 a[28:31], v4 offset0:52 offset1:54
v_lshlrev_b32 v214, 8, v214
Mvaa 36,40,8
Ta 68,236,36864
Mvaa 36,44,12
s_add_u32 m0, s38, 0x8000
s_add_u32 s36, s59, 0
Ta 70,236,38912
Mvaa 52,48,8
buffer_load_dwordx4 v1, s[16:19], s36 offen sc1 lds
Mvaa 52,52,12
s_waitcnt vmcnt(63) lgkmcnt(10)
Ta 72,237,28672
Mvaa 24,32,16
Ta 74,237,30720
Mvaa 24,36,20
buffer_load_dwordx4 v1, s[16:19], s36 offen offset:1024 sc1 lds
Mvaa 40,40,16
Ta 76,237,36864
Mvaa 40,44,20
Ta 78,237,38912
Mvaa 56,48,16
Ta 80,238,28672
Mvaa 56,52,20
s_waitcnt vmcnt(63) lgkmcnt(7)
buffer_load_dwordx4 v253, s[16:19], s36 offen offset:2048 sc1 lds
Mvaa 28,32,24
Ta 82,238,30720
Mvaa 28,36,28
Ta 84,238,36864
Mvaa 44,40,24
Ta 86,238,38912
Mvaa 44,44,28
buffer_load_dwordx4 v253, s[16:19], s36 offen offset:3072 sc1 lds
Mvaa 60,48,24
Ta 88,239,28672
Mvaa 60,52,28
s_waitcnt vmcnt(63) lgkmcnt(5)
Ta 90,239,30720
Mvaa 64,56,0
Ta 92,239,36864
Mvaa 64,60,4
Ta 94,239,38912
Mvaa 80,64,0
Ta 96,240,14336
Mvaa 80,68,4
Ta 98,241,14336
Mvaa 96,72,0
Ta 100,242,14336
Mvaa 96,76,4
Ta 102,243,14336
Mvaa 68,56,8
Mvaa 68,60,12
Mvaa 84,64,8
Mvaa 84,68,12
Mvaa 100,72,8
Mvaa 100,76,12
Mvaa 72,56,16
Mvaa 72,60,20
Mvaa 88,64,16
Mvaa 88,68,20
Mvaa 104,72,16
Mvaa 104,76,20
Mvaa 76,56,24
Mvaa 76,60,28
s_waitcnt vmcnt(13) lgkmcnt(0)
s_barrier
Mvaa 92,64,24
Ta 32,232,4096
Mvaa 92,68,28
s_add_u32 m0, s38, 0x6000
s_add_u32 s36, s59, 0x40000
Ta 34,232,6144
Mvaa 108,72,24
buffer_load_dwordx4 v1, s[16:19], s36 offen sc1 lds
Mvaa 108,76,28
s_waitcnt lgkmcnt(2)
Ta 36,232,8192
Mvaa 112,80,0
Ta 38,232,10240
Mvaa 112,84,4
buffer_load_dwordx4 v1, s[16:19], s36 offen offset:1024 sc1 lds
Mvaa 128,88,0
Ta 40,233,4096
Mvaa 128,92,4
Ta 42,233,6144
Mvaa 216,96,0
Ta 44,233,8192
Mvaa 216,100,4
buffer_load_dwordx4 v253, s[16:19], s36 offen offset:2048 sc1 lds
Mvaa 116,80,8
Ta 46,233,10240
Mvaa 116,84,12
Ta 48,234,4096
Mvaa 132,88,8
Ta 50,234,6144
Mvaa 132,92,12
buffer_load_dwordx4 v253, s[16:19], s36 offen offset:3072 sc1 lds
Mvaa 220,96,8
Ta 52,234,8192
Mvaa 220,100,12
La 224,244,0
Mvaa 120,80,16
Ta 54,234,10240
Mvaa 120,84,20
s_add_u32 m0, s38, 0x3800
s_add_u32 s36, s63, 0x12000
La 228,244,2048
Mvaa 136,88,16
buffer_load_dwordx4 v252, s[8:11], s36 offen lds
Mvaa 136,92,20
La 232,244,1024
Mvaa 224,96,16
La 236,244,3072
Mvaa 224,100,20
s_add_u32 m0, s38, 0x7000
s_add_u32 s36, s59, 0x80000
La 240,245,0
Mvaa 124,80,24
buffer_load_dwordx4 v1, s[16:19], s36 offen sc1 lds
Mvaa 124,84,28
La 244,245,2048
Mvaa 140,88,24
Ta 56,235,4096
Mvaa 140,92,28
buffer_load_dwordx4 v1, s[16:19], s36 offen offset:1024 sc1 lds
Mvaa 228,96,24
Ta 58,235,6144
Mvaa 228,100,28
s_waitcnt vmcnt(63) lgkmcnt(6)
Ta 60,235,8192
Mvaa 16,32,224
Ta 62,235,10240
Mvaa 16,36,228
buffer_load_dwordx4 v253, s[16:19], s36 offen offset:2048 sc1 lds
Mvaa 32,40,224
Ta 64,236,4096
Mvaa 32,44,228
La 248,245,1024
Mvaa 48,48,224
Ta 66,236,6144
Mvaa 48,52,228
s_waitcnt lgkmcnt(9)
buffer_load_dwordx4 v253, s[16:19], s36 offen offset:3072 sc1 lds
Mvaa 20,32,232
La 252,245,3072
Mvaa 20,36,236
Ta 68,236,8192
Mvaa 36,40,232
Ta 70,236,10240
Mvaa 36,44,236
s_add_u32 m0, s38, 0x9000
s_add_u32 s36, s62, 0x24000
Ta 72,237,4096
Mvaa 52,48,232
buffer_load_dwordx4 v248, s[8:11], s36 offen lds
Mvaa 52,52,236
s_waitcnt lgkmcnt(11)
Ta 74,237,6144
Mvaa 24,32,240
Ta 76,237,8192
Mvaa 24,36,244
buffer_load_dwordx4 v249, s[8:11], s36 offen offset:1024 lds
Mvaa 40,40,240
Ta 78,237,10240
Mvaa 40,44,244
Ta 80,238,4096
Mvaa 56,48,240
Ta 82,238,6144
Mvaa 56,52,244
s_waitcnt lgkmcnt(8)
buffer_load_dwordx4 v250, s[8:11], s36 offen offset:2048 lds
Mvaa 28,32,248
Ta 84,238,8192
Mvaa 28,36,252
Ta 86,238,10240
Mvaa 44,40,248
Ta 88,239,4096
Mvaa 44,44,252
buffer_load_dwordx4 v251, s[8:11], s36 offen offset:3072 lds
Mvaa 60,48,248
Ta 90,239,6144
Mvaa 60,52,252
s_waitcnt vmcnt(63) lgkmcnt(6)
Ta 92,239,8192
Mvaa 64,56,224
Ta 94,239,10240
Mvaa 64,60,228
Ta 96,240,12288
Mvaa 80,64,224
Ta 98,241,12288
Mvaa 80,68,228
Ta 100,242,12288
Mvaa 96,72,224
Ta 102,243,12288
Mvaa 96,76,228
Mvaa 68,56,232
Mvaa 68,60,236
Mvaa 84,64,232
Mvaa 84,68,236
Mvaa 100,72,232
Mvaa 100,76,236
Mvaa 72,56,240
Mvaa 72,60,244
Mvaa 88,64,240
Mvaa 88,68,244
Mvaa 104,72,240
Mvaa 104,76,244
Mvaa 76,56,248
Mvaa 76,60,252
s_waitcnt vmcnt(13) lgkmcnt(0)
s_barrier
Mvaa 92,64,248
Tv 144,232,16384
Mvaa 92,68,252
s_add_u32 m0, s38, 0x3000
s_add_u32 s36, s63, 0x24000
Tv 146,232,18432
Mvaa 108,72,248
buffer_load_dwordx4 v252, s[8:11], s36 offen lds
Mvaa 108,76,252
s_waitcnt lgkmcnt(2)
Tv 148,234,16384
Mvaa 112,80,224
Tv 150,234,18432
Mvaa 112,84,228
s_add_u32 m0, s38, 0
s_add_u32 s36, s59, 0xc0000
Tv 152,233,16384
Mvaa 128,88,224
buffer_load_dwordx4 v1, s[16:19], s36 offen sc1 lds
Mvaa 128,92,228
Tv 154,233,18432
Mvaa 216,96,224
Tv 156,235,16384
Mvaa 216,100,228
buffer_load_dwordx4 v1, s[16:19], s36 offen offset:1024 sc1 lds
Mvaa 116,80,232
Tv 158,235,18432
Mvaa 116,84,236
Tv 160,236,16384
Mvaa 132,88,232
Tv 162,236,18432
Mvaa 132,92,236
buffer_load_dwordx4 v253, s[16:19], s36 offen offset:2048 sc1 lds
Mvaa 220,96,232
Tv 164,238,16384
Mvaa 220,100,236
La 128,244,32768
Mvaa 120,80,240
Tv 166,238,18432
Mvaa 120,84,244
buffer_load_dwordx4 v253, s[16:19], s36 offen offset:3072 sc1 lds
Mvaa 136,88,240
La 132,244,34816
Mvaa 136,92,244
La 136,244,33792
Mvaa 224,96,240
La 140,244,35840
Mvaa 224,100,244
s_add_u32 m0, s38, 0x1000
s_add_u32 s36, s62, 0x36000
Tv 168,237,16384
Mvaa 124,80,248
buffer_load_dwordx4 v248, s[8:11], s36 offen lds
Mvaa 124,84,252
La 144,245,32768
Mvaa 140,88,248
Tv 170,237,18432
Mvaa 140,92,252
buffer_load_dwordx4 v249, s[8:11], s36 offen offset:1024 lds
Mvaa 228,96,248
La 148,245,34816
Mvaa 228,100,252
s_waitcnt lgkmcnt(6)
Tv 172,239,16384
Mvva 16,144,128
Tv 174,239,18432
Mvva 16,148,132
buffer_load_dwordx4 v250, s[8:11], s36 offen offset:2048 lds
Mvva 32,152,128
Tv 176,240,13312
Mvva 32,156,132
Tv 178,241,13312
Mvva 48,160,128
Tv 180,242,13312
Mvva 48,164,132
s_waitcnt lgkmcnt(9)
buffer_load_dwordx4 v251, s[8:11], s36 offen offset:3072 lds
Mvva 20,144,136
La 152,245,33792
Mvva 20,148,140
Tv 182,243,13312
Mvva 36,152,136
La 156,245,35840
Mvva 36,156,140
Mvva 52,160,136
Mvva 52,164,140
s_waitcnt lgkmcnt(8)
Mvva 24,144,144
Mvva 24,148,148
Mvva 40,152,144
Mvva 40,156,148
Mvva 56,160,144
Mvva 56,164,148
s_waitcnt lgkmcnt(0)
s_waitcnt vmcnt(17) lgkmcnt(0)
s_barrier
Mvva 28,144,152
Tv 184,232,20480
Mvva 28,148,156
s_add_u32 m0, s38, 0x3400
s_add_u32 s36, s63, 0x36000
Tv 186,232,22528
Mvva 44,152,152
buffer_load_dwordx4 v252, s[8:11], s36 offen lds
Mvva 44,156,156
Tv 188,234,20480
Mvva 60,160,152
Tv 190,234,22528
Mvva 60,164,156
s_waitcnt lgkmcnt(5)
s_add_u32 m0, s38, 0x2000
s_add_u32 s36, s59, 0x100000
Mvva 64,168,128
buffer_load_dwordx4 v1, s[16:19], s36 offen sc1 lds
Mvva 64,172,132
Tv 192,233,20480
Mvva 216,176,128
Tv 194,233,22528
Mvva 216,180,132
buffer_load_dwordx4 v1, s[16:19], s36 offen offset:1024 sc1 lds
Mvva 68,168,136
Tv 196,235,20480
Mvva 68,172,140
Tv 198,235,22528
Mvva 220,176,136
Tv 200,236,20480
Mvva 220,180,140
Tv 202,236,22528
Mvva 72,168,144
Tv 204,238,20480
Mvva 72,172,148
La 160,244,24576
Mvva 224,176,144
Tv 206,238,22528
La 164,244,26624
Mvva 224,180,148
buffer_load_dwordx4 v253, s[16:19], s36 offen offset:2048 sc1 lds
Mvva 76,168,152
La 168,244,25600
Mvva 76,172,156
La 172,244,27648
Mvva 228,176,152
buffer_load_dwordx4 v253, s[16:19], s36 offen offset:3072 sc1 lds
Mvva 228,180,156
s_waitcnt lgkmcnt(2)
s_add_u32 m0, s38, 0x4000
s_add_u32 s36, s62, 0x48000
Mvva 16,184,160
Tv 144,237,20480
Mvva 16,188,164
buffer_load_dwordx4 v248, s[8:11], s36 offen lds
Mvva 32,192,160
La 176,245,24576
Mvva 32,196,164
Tv 146,237,22528
Mvva 48,200,160
buffer_load_dwordx4 v249, s[8:11], s36 offen offset:1024 lds
Mvva 48,204,164
s_waitcnt lgkmcnt(3)
La 180,245,26624
Mvva 20,184,168
Tv 148,239,20480
Mvva 20,188,172
Tv 150,239,22528
Mvva 36,192,168
Tv 152,240,14336
Mvva 36,196,172
Tv 154,241,14336
Mvva 52,200,168
Tv 156,242,14336
Mvva 52,204,172
s_waitcnt lgkmcnt(5)
La 184,245,25600
Mvva 24,184,176
Tv 158,243,14336
La 188,245,27648
Mvva 24,188,180
buffer_load_dwordx4 v250, s[8:11], s36 offen offset:2048 lds
Mvva 40,192,176
Mvva 40,196,180
Mvva 56,200,176
buffer_load_dwordx4 v251, s[8:11], s36 offen offset:3072 lds
Mvva 56,204,180
s_waitcnt lgkmcnt(0)
s_waitcnt vmcnt(17) lgkmcnt(0)
s_barrier
Mvva 28,184,184
Tv 160,232,36864
Mvva 28,188,188
s_add_u32 m0, s38, 0x3800
s_add_u32 s36, s63, 0x48000
Tv 162,232,38912
Mvva 44,192,184
buffer_load_dwordx4 v252, s[8:11], s36 offen lds
Mvva 44,196,188
Tv 164,234,36864
Mvva 60,200,184
Tv 166,234,38912
Mvva 60,204,188
s_waitcnt lgkmcnt(5)
s_add_u32 m0, s38, 0x8000
s_add_u32 s36, s59, 0x140000
Mvva 64,144,160
buffer_load_dwordx4 v1, s[16:19], s36 offen sc1 lds
Mvva 64,148,164
Tv 168,233,36864
Mvva 216,152,160
Tv 170,233,38912
Mvva 216,156,164
buffer_load_dwordx4 v1, s[16:19], s36 offen offset:1024 sc1 lds
Mvva 68,144,168
Tv 172,235,36864
Mvva 68,148,172
Tv 174,235,38912
Mvva 220,152,168
Tv 176,236,36864
Mvva 220,156,172
Tv 178,236,38912
Mvva 72,144,176
Tv 180,238,36864
Mvva 72,148,180
La 192,244,28672
Mvva 224,152,176
Tv 182,238,38912
La 196,244,30720
Mvva 224,156,180
buffer_load_dwordx4 v253, s[16:19], s36 offen offset:2048 sc1 lds
Mvva 76,144,184
La 200,244,29696
Mvva 76,148,188
La 204,244,31744
Mvva 228,152,184
buffer_load_dwordx4 v253, s[16:19], s36 offen offset:3072 sc1 lds
Mvva 228,156,188
s_waitcnt lgkmcnt(2)
s_add_u32 m0, s38, 0x5000
s_add_u32 s36, s62, 0x5a000
Mvva 16,160,192
Tv 184,237,36864
Mvva 16,164,196
buffer_load_dwordx4 v248, s[8:11], s36 offen lds
Mvva 32,168,192
La 208,245,28672
Mvva 32,172,196
Tv 186,237,38912
Mvva 48,176,192
buffer_load_dwordx4 v249, s[8:11], s36 offen offset:1024 lds
Mvva 48,180,196
s_waitcnt lgkmcnt(3)
La 212,245,30720
Mvva 20,160,200
Tv 188,239,36864
Mvva 20,164,204
Tv 190,239,38912
Mvva 36,168,200
Tv 192,240,12288
Mvva 36,172,204
Tv 194,241,12288
Mvva 52,176,200
Tv 196,242,12288
Mvva 52,180,204
s_waitcnt lgkmcnt(5)
La 216,245,29696
Mvva 24,160,208
Tv 198,243,12288
La 220,245,31744
Mvva 24,164,212
buffer_load_dwordx4 v250, s[8:11], s36 offen offset:2048 lds
Mvva 40,168,208
Mvva 40,172,212
Mvva 56,176,208
buffer_load_dwordx4 v251, s[8:11], s36 offen offset:3072 lds
Mvva 56,180,212
s_waitcnt lgkmcnt(0)
s_waitcnt vmcnt(17) lgkmcnt(0)
s_barrier
Mvva 28,160,216
Tv 200,232,4096
Mvva 28,164,220
s_add_u32 m0, s38, 0x3000
s_add_u32 s36, s63, 0x5a000
Tv 202,232,6144
Mvva 44,168,216
buffer_load_dwordx4 v252, s[8:11], s36 offen lds
Mvva 44,172,220
Tv 204,234,4096
Mvva 60,176,216
Tv 206,234,6144
Mvva 60,180,220
s_waitcnt lgkmcnt(5)
s_add_u32 m0, s38, 0x6000
s_add_u32 s36, s59, 0x180000
Mvva 64,184,192
buffer_load_dwordx4 v1, s[16:19], s36 offen sc1 lds
Mvva 64,188,196
Tv 144,233,4096
Mvva 216,192,192
Tv 146,233,6144
Mvva 216,196,196
buffer_load_dwordx4 v1, s[16:19], s36 offen offset:1024 sc1 lds
Mvva 68,184,200
Tv 148,235,4096
Mvva 68,188,204
Tv 150,235,6144
Mvva 220,192,200
Tv 152,236,4096
Mvva 220,196,204
Tv 154,236,6144
Mvva 72,184,208
Tv 156,238,4096
Mvva 72,188,212
La 224,244,0
Mvva 224,192,208
Tv 158,238,6144
La 228,244,2048
Mvva 224,196,212
buffer_load_dwordx4 v253, s[16:19], s36 offen offset:2048 sc1 lds
Mvva 76,184,216
La 232,244,1024
Mvva 76,188,220
La 236,244,3072
Mvva 228,192,216
buffer_load_dwordx4 v253, s[16:19], s36 offen offset:3072 sc1 lds
Mvva 228,196,220
s_waitcnt lgkmcnt(2)
s_add_u32 m0, s38, 0x7000
s_add_u32 s36, s62, 0x6c000
Mvva 16,200,224
Tv 160,237,4096
Mvva 16,204,228
buffer_load_dwordx4 v248, s[8:11], s36 offen lds
Mvva 32,144,224
La 240,245,0
Mvva 32,148,228
Tv 162,237,6144
Mvva 48,152,224
buffer_load_dwordx4 v249, s[8:11], s36 offen offset:1024 lds
Mvva 48,156,228
s_waitcnt lgkmcnt(3)
La 244,245,2048
Mvva 20,200,232
Tv 164,239,4096
Mvva 20,204,236
Tv 166,239,6144
Mvva 36,144,232
Tv 168,240,13312
Mvva 36,148,236
Tv 170,241,13312
Mvva 52,152,232
Tv 172,242,13312
Mvva 52,156,236
s_waitcnt lgkmcnt(5)
La 248,245,1024
Mvva 24,200,240
Tv 174,243,13312
La 252,245,3072
Mvva 24,204,244
buffer_load_dwordx4 v250, s[8:11], s36 offen offset:2048 lds
Mvva 40,144,240
Mvva 40,148,244
Mvva 56,152,240
buffer_load_dwordx4 v251, s[8:11], s36 offen offset:3072 lds
Mvva 56,156,244
s_waitcnt lgkmcnt(0)
s_waitcnt vmcnt(17) lgkmcnt(0)
s_barrier
Mvva 28,200,248
Tv 176,232,16384
Mvva 28,204,252
s_add_u32 m0, s38, 0x3400
s_add_u32 s36, s63, 0x6c000
Tv 178,232,18432
Mvva 44,144,248
buffer_load_dwordx4 v252, s[8:11], s36 offen lds
Mvva 44,148,252
Tv 180,234,16384
Mvva 60,152,248
Tv 182,234,18432
Mvva 60,156,252
s_waitcnt lgkmcnt(5)
s_add_u32 m0, s38, 0x9000
s_add_u32 s36, s59, 0x1c0000
Mvva 64,160,224
buffer_load_dwordx4 v1, s[16:19], s36 offen sc1 lds
Mvva 64,164,228
Tv 184,233,16384
Mvva 216,168,224
Tv 186,233,18432
Mvva 216,172,228
buffer_load_dwordx4 v1, s[16:19], s36 offen offset:1024 sc1 lds
Mvva 68,160,232
Tv 188,235,16384
Mvva 68,164,236
Tv 190,235,18432
Mvva 220,168,232
Tv 192,236,16384
Mvva 220,172,236
Tv 194,236,18432
Mvva 72,160,240
Tv 196,238,16384
Mvva 72,164,244
La 0,244,8192
Mvva 224,168,240
Tv 198,238,18432
La 4,244,10240
Mvva 224,172,244
buffer_load_dwordx4 v253, s[16:19], s36 offen offset:2048 sc1 lds
Mvva 76,160,248
La 8,244,9216
Mvva 76,164,252
La 12,244,11264
Mvva 228,168,248
buffer_load_dwordx4 v253, s[16:19], s36 offen offset:3072 sc1 lds
Mvva 228,172,252
s_waitcnt lgkmcnt(2)
s_add_u32 m0, s38, 0
s_add_u32 s36, s62, 0x7e000
Mvva 16,176,0
Tv 200,237,16384
Mvva 16,180,4
buffer_load_dwordx4 v248, s[8:11], s36 offen lds
Mvva 32,184,0
La 16,245,8192
Mvva 32,188,4
Tv 202,237,18432
Mvva 48,192,0
buffer_load_dwordx4 v249, s[8:11], s36 offen offset:1024 lds
Mvva 48,196,4
s_waitcnt lgkmcnt(3)
La 20,245,10240
Mvva 20,176,8
Tv 204,239,16384
Mvva 20,180,12
Tv 206,239,18432
Mvva 36,184,8
Tv 144,240,14336
Mvva 36,188,12
Tv 146,241,14336
Mvva 52,192,8
Tv 148,242,14336
Mvva 52,196,12
s_waitcnt lgkmcnt(5)
La 24,245,9216
Mvva 24,176,16
Tv 150,243,14336
La 28,245,11264
Mvva 24,180,20
buffer_load_dwordx4 v250, s[8:11], s36 offen offset:2048 lds
Mvva 40,184,16
Mvva 40,188,20
Mvva 56,192,16
buffer_load_dwordx4 v251, s[8:11], s36 offen offset:3072 lds
Mvva 56,196,20
s_waitcnt lgkmcnt(0)
s_waitcnt vmcnt(17) lgkmcnt(0)
s_barrier
Mvva 28,176,24
Tv 152,232,20480
Mvva 28,180,28
s_add_u32 m0, s38, 0x3800
s_add_u32 s36, s63, 0x7e000
Tv 154,232,22528
Mvva 44,184,24
buffer_load_dwordx4 v252, s[8:11], s36 offen lds
Mvva 44,188,28
Tv 156,234,20480
Mvva 60,192,24
Tv 158,234,22528
Mvva 60,196,28
s_waitcnt lgkmcnt(5)
s_add_u32 m0, s38, 0x1000
s_add_u32 s36, s66, 0
Mvva 64,200,0
buffer_load_dwordx4 v248, s[8:11], s36 offen lds
Mvva 64,204,4
Tv 160,233,20480
Mvva 216,144,0
Tv 162,233,22528
Mvva 216,148,4
buffer_load_dwordx4 v249, s[8:11], s36 offen offset:1024 lds
Mvva 68,200,8
Tv 164,235,20480
Mvva 68,204,12
Tv 166,235,22528
Mvva 220,144,8
Tv 168,236,20480
Mvva 220,148,12
Tv 170,236,22528
Mvva 72,200,16
Tv 172,238,20480
Mvva 72,204,20
La 32,244,32768
Mvva 224,144,16
Tv 174,238,22528
La 36,244,34816
Mvva 224,148,20
buffer_load_dwordx4 v250, s[8:11], s36 offen offset:2048 lds
Mvva 76,200,24
La 40,244,33792
Mvva 76,204,28
La 44,244,35840
Mvva 228,144,24
buffer_load_dwordx4 v251, s[8:11], s36 offen offset:3072 lds
Mvva 228,148,28
s_waitcnt lgkmcnt(2)
s_add_u32 m0, s38, 0x2000
s_add_u32 s36, s66, 0x12000
Mvva 16,152,32
Tv 176,237,20480
Mvva 16,156,36
buffer_load_dwordx4 v248, s[8:11], s36 offen lds
Mvva 32,160,32
La 48,245,32768
Mvva 32,164,36
Tv 178,237,22528
Mvva 48,168,32
buffer_load_dwordx4 v249, s[8:11], s36 offen offset:1024 lds
Mvva 48,172,36
s_waitcnt lgkmcnt(3)
La 52,245,34816
Mvva 20,152,40
Tv 180,239,20480
Mvva 20,156,44
Tv 182,239,22528
Mvva 36,160,40
Tv 184,240,12288
Mvva 36,164,44
Tv 186,241,12288
Mvva 52,168,40
Tv 188,242,12288
Mvva 52,172,44
s_waitcnt lgkmcnt(5)
La 56,245,33792
Mvva 24,152,48
Tv 190,243,12288
La 60,245,35840
Mvva 24,156,52
buffer_load_dwordx4 v250, s[8:11], s36 offen offset:2048 lds
Mvva 40,160,48
Mvva 40,164,52
Mvva 56,168,48
buffer_load_dwordx4 v251, s[8:11], s36 offen offset:3072 lds
Mvva 56,172,52
s_waitcnt lgkmcnt(0)
s_waitcnt vmcnt(17) lgkmcnt(0)
s_barrier
Mvva 28,152,56
s_add_u32 m0, s38, 0x4000
s_add_u32 s36, s66, 0x24000
Tv 192,232,28672
Mvva 28,156,60
buffer_load_dwordx4 v248, s[8:11], s36 offen lds
Mvva 44,160,56
s_movk_i32 s74, 0x3f80
s_mov_b32 s75, 0x3f800000
s_lshl_b32 s76, s24, 11
Mvva 44,164,60
Tv 194,232,30720
v_add_u32 v9, s67, v1
Mvva 60,168,56
buffer_load_dwordx4 v249, s[8:11], s36 offen offset:1024 lds
Mvva 60,172,60
s_waitcnt lgkmcnt(3)
s_xor_b32 s41, s2, 7
s_mul_i32 s41, s41, 0x12000
Mvva 64,176,32
s_add_u32 s41, s41, s76
s_add_u32 s41, s41, 0x6400000
Tv 196,234,28672
Mvva 64,180,36
s_xor_b32 s42, s2, 6
s_mul_i32 s42, s42, 0x12000
Tv 198,234,30720
Mvva 216,184,32
s_add_u32 s42, s42, s76
s_add_u32 s42, s42, 0x6402000
Tv 200,233,28672
Mvva 216,188,36
s_xor_b32 s43, s2, 5
s_mul_i32 s43, s43, 0x12000
Tv 202,233,30720
Mvva 68,176,40
s_add_u32 s43, s43, s76
s_add_u32 s43, s43, 0x6404000
Tv 204,235,28672
Mvva 68,180,44
s_xor_b32 s44, s2, 4
s_mul_i32 s44, s44, 0x12000
Tv 206,235,30720
Mvva 220,184,40
s_add_u32 s44, s44, s76
s_add_u32 s44, s44, 0x6406000
Tv 144,236,28672
Mvva 220,188,44
buffer_load_dwordx4 v250, s[8:11], s36 offen offset:2048 lds
Mvva 72,176,48
s_xor_b32 s45, s2, 3
s_mul_i32 s45, s45, 0x12000
Tv 146,236,30720
Mvva 72,180,52
s_add_u32 s45, s45, s76
s_add_u32 s45, s45, 0x6408000
Tv 148,238,28672
Mvva 224,184,48
s_xor_b32 s46, s2, 2
La 64,244,24576
Tv 150,238,30720
La 68,244,26624
Mvva 224,188,52
buffer_load_dwordx4 v251, s[8:11], s36 offen offset:3072 lds
Mvva 76,176,56
s_add_u32 m0, s38, 0x5000
s_add_u32 s36, s66, 0x36000
s_mul_i32 s46, s46, 0x12000
Mvva 76,180,60
s_add_u32 s46, s46, s76
s_add_u32 s46, s46, 0x640a000
s_xor_b32 s47, s2, 1
Mvva 228,184,56
buffer_load_dwordx4 v248, s[8:11], s36 offen lds
Mvva 228,188,60
s_waitcnt lgkmcnt(0)
s_mul_i32 s47, s47, 0x12000
La 72,244,25600
Mvva 16,192,64
s_add_u32 s47, s47, s76
s_add_u32 s47, s47, 0x640c000
La 76,244,27648
Mvva 16,196,68
buffer_load_dwordx4 v249, s[8:11], s36 offen offset:1024 lds
Mvva 32,200,64
s_xor_b32 s48, s2, 0
s_mul_i32 s48, s48, 0x12000
s_add_u32 s48, s48, s76
Mvva 32,204,68
s_add_u32 s48, s48, 0x640e000
Tv 152,237,28672
Mvva 48,144,64
La 80,245,24576
Mvva 48,148,68
s_waitcnt lgkmcnt(2)
Tv 154,237,30720
Mvva 20,192,72
La 84,245,26624
Mvva 20,196,76
buffer_load_dwordx4 v250, s[8:11], s36 offen offset:2048 lds
Mvva 36,200,72
Tv 156,239,28672
Mvva 36,204,76
Tv 158,239,30720
Mvva 52,144,72
Tv 160,240,13312
Mvva 52,148,76
s_waitcnt lgkmcnt(3)
buffer_load_dwordx4 v251, s[8:11], s36 offen offset:3072 lds
Mvva 24,192,80
s_add_u32 m0, s38, 0x8000
Tv 162,241,13312
Tv 164,242,13312
La 88,245,25600
Tv 166,243,13312
La 92,245,27648
Mvva 24,196,84
s_add_u32 s36, s66, 0x48000
Mvva 40,200,80
buffer_load_dwordx4 v248, s[8:11], s36 offen lds
Mvva 40,204,84
Mvva 56,144,80
Mvva 56,148,84
s_waitcnt lgkmcnt(0)
s_waitcnt vmcnt(17) lgkmcnt(0)
s_barrier
Mvva 28,192,88
buffer_load_dwordx4 v249, s[8:11], s36 offen offset:1024 lds
Mvva 28,196,92
Tv 168,232,0
Mvva 44,200,88
Tv 170,232,2048
Mvva 44,204,92
buffer_load_dwordx4 v250, s[8:11], s36 offen offset:2048 lds
Mvva 60,144,88
Tv 172,234,0
Mvva 60,148,92
s_waitcnt lgkmcnt(4)
Tv 174,234,2048
Mvva 64,152,64
buffer_load_dwordx4 v251, s[8:11], s36 offen offset:3072 lds
Mvva 64,156,68
s_add_u32 m0, s38, 0x6000
s_add_u32 s36, s66, 0x5a000
Tv 176,233,0
Mvva 216,160,64
Tv 178,233,2048
Mvva 216,164,68
buffer_load_dwordx4 v248, s[8:11], s36 offen lds
Mvva 68,152,72
Tv 180,235,0
Mvva 68,156,76
Tv 182,235,2048
Mvva 220,160,72
Tv 184,236,0
Mvva 220,164,76
Tv 186,236,2048
Mvva 72,152,80
Tv 188,238,0
Mvva 72,156,84
La 96,244,36864
Mvva 224,160,80
Tv 190,238,2048
La 100,244,38912
Mvva 224,164,84
buffer_load_dwordx4 v249, s[8:11], s36 offen offset:1024 lds
Mvva 76,152,88
La 104,244,37888
Mvva 76,156,92
La 108,244,39936
Mvva 228,160,88
buffer_load_dwordx4 v250, s[8:11], s36 offen offset:2048 lds
Mvva 228,164,92
s_waitcnt lgkmcnt(2)
Tv 192,237,0
Mvva 16,168,96
La 112,245,36864
Mvva 16,172,100
buffer_load_dwordx4 v251, s[8:11], s36 offen offset:3072 lds
Mvva 32,176,96
s_add_u32 m0, s38, 0x7000
s_add_u32 s36, s66, 0x6c000
Tv 194,237,2048
Mvva 32,180,100
La 116,245,38912
Mvva 48,184,96
buffer_load_dwordx4 v248, s[8:11], s36 offen lds
Mvva 48,188,100
s_waitcnt lgkmcnt(4)
Tv 196,239,0
Mvva 20,168,104
Tv 198,239,2048
Mvva 20,172,108
buffer_load_dwordx4 v249, s[8:11], s36 offen offset:1024 lds
Mvva 36,176,104
Tv 200,240,14336
Mvva 36,180,108
Tv 202,241,14336
Mvva 52,184,104
Tv 204,242,14336
Mvva 52,188,108
s_waitcnt lgkmcnt(5)
s_add_u32 s73, s64, 0
La 120,245,37888
Mvva 24,168,112
Tv 206,243,14336
La 124,245,39936
Mvva 24,172,116
buffer_load_dwordx4 v250, s[8:11], s36 offen offset:2048 lds
Mvva 40,176,112
PK 16,16,17
PK 17,18,19
Mvva 40,180,116
PK 18,20,21
PK 19,22,23
Mvva 56,184,112
buffer_load_dwordx4 v251, s[8:11], s36 offen offset:3072 lds
Mvva 56,188,116
s_waitcnt lgkmcnt(0)
s_waitcnt vmcnt(16) lgkmcnt(0)
s_barrier
Mvva 28,168,120
Tv 144,232,4096
Mvva 28,172,124
buffer_store_dwordx4 v[16:19], v1, s[16:19], s73 offen sc0 sc1
s_add_u32 s73, s64, 0
PK 32,32,33
s_add_u32 m0, s38, 0
Mvva 44,176,120
s_add_u32 s36, s66, 0x7e000
Tv 146,232,6144
PK 33,34,35
Mvva 44,180,124
Tv 148,234,4096
PK 34,36,37
Mvva 60,184,120
buffer_load_dwordx4 v248, s[8:11], s36 offen lds
Mvva 60,188,124
s_waitcnt lgkmcnt(4)
Tv 150,234,6144
PK 35,38,39
Mvva 64,192,96
Tv 152,233,4096
Mvva 64,196,100
buffer_store_dwordx4 v[32:35], v1, s[16:19], s73 offen offset:1024 sc0 sc1
Tv 154,233,6144
Tv 156,235,4096
Mvva 216,200,96
s_add_u32 s73, s64, 0x4000
Tv 158,235,6144
PK 48,48,49
Mvva 216,204,100
Tv 160,232,8192
PK 49,50,51
Mvva 68,192,104
buffer_load_dwordx4 v249, s[8:11], s36 offen offset:1024 lds
Mvva 68,196,108
Tv 162,232,10240
PK 50,52,53
Mvva 220,200,104
Tv 164,234,8192
PK 51,54,55
Mvva 220,204,108
buffer_load_dwordx4 v250, s[8:11], s36 offen offset:2048 lds
Mvva 72,192,112
Tv 166,234,10240
Mvva 72,196,116
Tv 168,233,8192
Mvva 224,200,112
buffer_store_dwordx4 v[48:51], v1, s[16:19], s73 offen sc0 sc1
s_add_u32 s73, s64, 0x2000
PK 24,24,25
PK 25,26,27
Mvva 224,204,116
Tv 170,233,10240
PK 26,28,29
Mvva 76,192,120
Tv 172,235,8192
PK 27,30,31
Mvva 76,196,124
buffer_load_dwordx4 v251, s[8:11], s36 offen offset:3072 lds
Mvva 228,200,120
Tv 174,235,10240
Mvva 228,204,124
s_waitcnt lgkmcnt(8)
Tv 176,232,16384
Mvva 80,144,128
buffer_store_dwordx4 v[24:27], v1, s[16:19], s73 offen sc0 sc1
s_add_u32 s73, s64, 0x2000
PK 40,40,41
PK 41,42,43
Mvva 80,148,132
Tv 178,232,18432
PK 42,44,45
Mvva 96,152,128
Tv 180,234,16384
PK 43,46,47
Mvva 96,156,132
Tv 182,234,18432
Mvva 84,144,136
Tv 184,233,16384
Mvva 84,148,140
Tv 186,233,18432
Mvva 100,152,136
Tv 188,235,16384
Mvva 100,156,140
buffer_store_dwordx4 v[40:43], v1, s[16:19], s73 offen offset:1024 sc0 sc1
Tv 190,235,18432
Mvva 88,144,144
s_add_u32 s73, s64, 0x6000
PK 56,56,57
PK 57,58,59
Mvva 88,148,148
PK 58,60,61
PK 59,62,63
Mvva 104,152,144
Mvva 104,156,148
Mvva 92,144,152
Mvva 92,148,156
Mvva 108,152,152
Mvva 108,156,156
s_waitcnt lgkmcnt(8)
Mvva 80,160,160
buffer_store_dwordx4 v[56:59], v1, s[16:19], s73 offen sc0 sc1
Mvva 80,164,164
s_add_u32 s73, s64, 0x4000
PK 64,64,65
PK 65,66,67
Mvva 96,168,160
PK 66,68,69
PK 67,70,71
Mvva 96,172,164
Mvva 84,160,168
Mvva 84,164,172
Mvva 100,168,168
Mvva 100,172,172
Mvva 88,160,176
Mvva 88,164,180
s_waitcnt vmcnt(14)
s_barrier
Mvva 104,168,176
buffer_store_dwordx4 v[64:67], v1, s[16:19], s73 offen offset:1024 sc0 sc1
Tv 192,232,20480
Tv 194,232,22528
Mvva 104,172,180
s_xor_b32 s73, s65, 0
Tv 196,234,20480
PK 216,216,217
Mvva 92,160,184
Tv 198,234,22528
PK 217,218,219
Mvva 92,164,188
Tv 200,233,20480
PK 218,220,221
Mvva 108,168,184
Tv 202,233,22528
PK 219,222,223
Mvva 108,172,188
s_waitcnt lgkmcnt(6)
Tv 204,235,20480
Mvva 80,176,192
Tv 206,235,22528
Mvva 80,180,196
Tv 144,232,32768
Mvva 96,184,192
buffer_store_dwordx4 v[216:219], v1, s[16:19], s73 offen sc0 sc1
Tv 146,232,34816
Tv 148,234,32768
Mvva 96,188,196
s_add_u32 s73, s64, 0x6000
Tv 150,234,34816
PK 72,72,73
Mvva 84,176,200
Tv 152,233,32768
PK 73,74,75
Mvva 84,180,204
Tv 154,233,34816
PK 74,76,77
Mvva 100,184,200
Tv 156,235,32768
PK 75,78,79
Mvva 100,188,204
Tv 158,235,34816
Mvva 88,176,208
Tv 160,232,24576
Mvva 88,180,212
Tv 162,232,26624
Mvva 104,184,208
Tv 164,234,24576
Mvva 104,188,212
buffer_store_dwordx4 v[72:75], v1, s[16:19], s73 offen offset:1024 sc0 sc1
Tv 166,234,26624
Tv 168,233,24576
Mvva 92,176,216
s_xor_b32 s73, s65, 0x800
Tv 170,233,26624
PK 224,224,225
Mvva 92,180,220
Tv 172,235,24576
PK 225,226,227
Mvva 108,184,216
Tv 174,235,26624
PK 226,228,229
Mvva 108,188,220
s_waitcnt lgkmcnt(15)
PK 227,230,231
Mvva 80,192,224
Mvva 80,196,228
Mvva 96,200,224
Mvva 96,204,228
Mvva 84,192,232
buffer_store_dwordx4 v[224:227], v1, s[16:19], s73 offen sc0 sc1
Mvva 84,196,236
Mvva 100,200,232
Mvva 100,204,236
Mvva 88,192,240
Mvva 88,196,244
Mvva 104,200,240
Mvva 104,204,244
Mvva 92,192,248
Mvva 92,196,252
Mvva 108,200,248
Mvva 108,204,252
s_waitcnt lgkmcnt(8)
Mvva 80,144,0
Mvva 80,148,4
Mvva 96,152,0
Mvva 96,156,4
Mvva 84,144,8
Mvva 84,148,12
Mvva 100,152,8
Mvva 100,156,12
Mvva 88,144,16
Mvva 88,148,20
s_waitcnt vmcnt(7)
s_barrier
Mvva 104,152,16
Tv 176,232,28672
Mvva 104,156,20
Tv 178,232,30720
Mvva 92,144,24
Tv 180,234,28672
Mvva 92,148,28
Tv 182,234,30720
Mvva 108,152,24
Tv 184,233,28672
Mvva 108,156,28
s_waitcnt lgkmcnt(5)
Tv 186,233,30720
Mvva 80,160,32
Tv 188,235,28672
Mvva 80,164,36
Tv 190,235,30720
Mvva 96,168,32
Tv 192,232,0
Mvva 96,172,36
Tv 194,232,2048
Mvva 84,160,40
Tv 196,234,0
Mvva 84,164,44
Tv 198,234,2048
Mvva 100,168,40
Tv 200,233,0
Mvva 100,172,44
Tv 202,233,2048
Mvva 88,160,48
Tv 204,235,0
Mvva 88,164,52
Tv 206,235,2048
Mvva 104,168,48
Tv 144,236,4096
Mvva 104,172,52
Tv 146,236,6144
Mvva 92,160,56
Tv 148,238,4096
Mvva 92,164,60
Tv 150,238,6144
Mvva 108,168,56
Tv 152,237,4096
Mvva 108,172,60
s_waitcnt lgkmcnt(13)
Tv 154,237,6144
Mvva 80,176,64
Tv 156,239,4096
Mvva 80,180,68
Tv 158,239,6144
Mvva 96,184,64
Tv 160,236,8192
Mvva 96,188,68
Tv 162,236,10240
Mvva 84,176,72
Tv 164,238,8192
Mvva 84,180,76
Tv 166,238,10240
Mvva 100,184,72
Tv 168,237,8192
Mvva 100,188,76
Tv 170,237,10240
Mvva 88,176,80
Tv 172,239,8192
Mvva 88,180,84
Tv 174,239,10240
Mvva 104,184,80
Mvva 104,188,84
Mvva 92,176,88
Mvva 92,180,92
Mvva 108,184,88
Mvva 108,188,92
s_waitcnt lgkmcnt(15)
Mvva 80,192,96
Tv 176,236,16384
Mvva 80,196,100
Tv 178,236,18432
Mvva 96,200,96
Tv 180,238,16384
Mvva 96,204,100
buffer_load_dword v213, v214, s[16:19], s71 offen sc1
Mvva 84,192,104
Tv 182,238,18432
Mvva 84,196,108
s_waitcnt vmcnt(1)
s_barrier
Mvva 100,200,104
buffer_store_dword v0, v215, s[16:19], 0 offen sc0 sc1
Mvva 100,204,108
Tv 184,237,16384
Mvva 88,192,112
Tv 186,237,18432
Mvva 88,196,116
s_add_u32 s73, s64, 0x8000
Tv 188,239,16384
PK 80,80,81
Mvva 104,200,112
Tv 190,239,18432
PK 81,82,83
Mvva 104,204,116
PK 82,84,85
PK 83,86,87
Mvva 92,192,120
buffer_store_dwordx4 v[80:83], v1, s[16:19], s73 offen sc0 sc1
s_add_u32 s73, s64, 0x8000
PK 96,96,97
PK 97,98,99
Mvva 92,196,124
PK 98,100,101
PK 99,102,103
Mvva 108,200,120
Mvva 108,204,124
s_waitcnt lgkmcnt(15)
Mvva 112,144,128
Tv 192,236,20480
Mvva 112,148,132
Tv 194,236,22528
Mvva 128,152,128
buffer_store_dwordx4 v[96:99], v1, s[16:19], s73 offen offset:1024 sc0 sc1
Tv 196,238,20480
Tv 198,238,22528
Mvva 128,156,132
s_add_u32 s73, s64, 0xa000
Tv 200,237,20480
PK 88,88,89
Mvva 116,144,136
Tv 202,237,22528
PK 89,90,91
Mvva 116,148,140
Tv 204,239,20480
PK 90,92,93
Mvva 132,152,136
Tv 206,239,22528
PK 91,94,95
Mvva 132,156,140
s_waitcnt lgkmcnt(15)
Mvva 112,160,160
Tv 144,236,32768
Mvva 112,164,164
Tv 146,236,34816
Mvva 128,168,160
Tv 148,238,32768
Mvva 128,172,164
buffer_store_dwordx4 v[88:91], v1, s[16:19], s73 offen sc0 sc1
Tv 150,238,34816
Tv 152,237,32768
Mvva 116,160,168
s_add_u32 s73, s64, 0xa000
Tv 154,237,34816
PK 104,104,105
Mvva 116,164,172
Tv 156,239,32768
PK 105,106,107
Mvva 132,168,168
Tv 158,239,34816
PK 106,108,109
Mvva 132,172,172
s_waitcnt lgkmcnt(15)
PK 107,110,111
Mvva 112,176,192
Tv 160,236,24576
Mvva 112,180,196
Tv 162,236,26624
Mvva 128,184,192
Tv 164,238,24576
Mvva 128,188,196
Tv 166,238,26624
Mvva 116,176,200
buffer_store_dwordx4 v[104:107], v1, s[16:19], s73 offen offset:1024 sc0 sc1
Tv 168,237,24576
Tv 170,237,26624
Mvva 116,180,204
Tv 172,239,24576
Mvva 132,184,200
Tv 174,239,26624
Mvva 132,188,204
s_waitcnt lgkmcnt(15)
s_waitcnt vmcnt(5)
v_cmp_ne_u32 vcc, 1, v213
s_nop 0
s_and_b32 s28, vcc_lo, 0xfe
s_cmp_lg_u32 s28, 0
s_cselect_b32 s55, 0x10000000, 0
v_or_b32 v229, s55, v1
Mvva 112,192,224
s_bitcmp1_b32 s28, 7
s_cselect_b32 s30, 0x10000000, s41
s_bitcmp1_b32 s28, 6
s_cselect_b32 s31, 0x10000000, s42
s_bitcmp1_b32 s28, 5
s_cselect_b32 s32, 0x10000000, s43
Mvva 112,196,228
s_bitcmp1_b32 s28, 4
s_cselect_b32 s33, 0x10000000, s44
Tv 176,236,28672
Mvva 128,200,224
buffer_load_dwordx4 v[16:19], v1, s[16:19], s30 offen sc1
Mvva 128,204,228
Tv 178,236,30720
Mvva 116,192,232
Tv 180,238,28672
Mvva 116,196,236
buffer_load_dwordx4 v[20:23], v1, s[16:19], s30 offen offset:1024 sc1
Mvva 132,200,232
Tv 182,238,30720
Mvva 132,204,236
s_waitcnt lgkmcnt(12)
Tv 184,237,28672
Mvva 112,144,0
buffer_load_dwordx4 v[24:27], v1, s[16:19], s31 offen sc1
Mvva 112,148,4
Tv 186,237,30720
Mvva 128,152,0
Tv 188,239,28672
Mvva 128,156,4
Tv 190,239,30720
Mvva 116,144,8
buffer_load_dwordx4 v[28:31], v1, s[16:19], s31 offen offset:1024 sc1
Mvva 116,148,12
Tv 192,236,0
Mvva 132,152,8
Tv 194,236,2048
Mvva 132,156,12
s_waitcnt lgkmcnt(10)
Tv 196,238,0
Mvva 112,160,32
buffer_load_dwordx4 v[32:35], v1, s[16:19], s32 offen sc1
Mvva 112,164,36
Tv 198,238,2048
Mvva 128,168,32
Tv 200,237,0
Mvva 128,172,36
Tv 202,237,2048
Mvva 116,160,40
buffer_load_dwordx4 v[36:39], v1, s[16:19], s32 offen offset:1024 sc1
Mvva 116,164,44
Tv 204,239,0
Mvva 132,168,40
Tv 206,239,2048
Mvva 132,172,44
s_waitcnt lgkmcnt(8)
Tv 144,236,4096
Mvva 112,176,64
buffer_load_dwordx4 v[40:43], v1, s[16:19], s33 offen sc1
Mvva 112,180,68
Tv 146,236,6144
Mvva 128,184,64
Tv 148,238,4096
Mvva 128,188,68
Tv 150,238,6144
Mvva 116,176,72
buffer_load_dwordx4 v[44:47], v1, s[16:19], s33 offen offset:1024 sc1
Mvva 116,180,76
Tv 152,237,4096
Mvva 132,184,72
Tv 154,237,6144
Mvva 132,188,76
s_waitcnt lgkmcnt(6)
Tv 156,239,4096
Mvva 112,192,96
s_bitcmp1_b32 s28, 3
s_cselect_b32 s34, 0x10000000, s45
s_bitcmp1_b32 s28, 2
s_cselect_b32 s35, 0x10000000, s46
s_bitcmp1_b32 s28, 1
s_cselect_b32 s52, 0x10000000, s47
Mvva 112,196,100
s_add_u32 s36, s30, 0xe800
Tv 158,239,6144
Mvva 128,200,96
Tv 160,236,8192
Mvva 128,204,100
Tv 162,236,10240
Mvva 116,192,104
Tv 164,238,8192
Mvva 116,196,108
Tv 166,238,10240
Mvva 132,200,104
Tv 168,237,8192
Mvva 132,204,108
s_waitcnt lgkmcnt(5)
Tv 170,237,10240
Mvva 120,144,144
buffer_load_dwordx2 v[48:49], v9, s[16:19], s36 offen sc1
Mvva 120,148,148
s_add_u32 s36, s31, 0xc800
s_add_u32 s73, s64, 0xc000
Tv 172,239,8192
Mvva 136,152,144
Tv 174,239,10240
PK 112,112,113
Mvva 136,156,148
Tv 176,236,16384
PK 113,114,115
Mvva 124,144,152
buffer_load_dwordx2 v[50:51], v9, s[16:19], s36 offen sc1
Mvva 124,148,156
s_add_u32 s36, s32, 0xa800
Tv 178,236,18432
PK 114,116,117
Mvva 140,152,152
Tv 180,238,16384
PK 115,118,119
Mvva 140,156,156
s_waitcnt lgkmcnt(3)
Tv 182,238,18432
Mvva 120,160,176
buffer_load_dwordx2 v[52:53], v9, s[16:19], s36 offen sc1
Mvva 120,164,180
buffer_store_dwordx4 v[112:115], v1, s[16:19], s73 offen sc0 sc1
Tv 184,237,16384
Tv 186,237,18432
Mvva 136,168,176
s_add_u32 s73, s64, 0xc000
Tv 188,239,16384
Tv 190,239,18432
Mvva 136,172,180
PK 128,128,129
PK 129,130,131
PK 130,132,133
PK 131,134,135
buffer_store_dwordx4 v[128:131], v1, s[16:19], s73 offen offset:1024 sc0 sc1
Tv 192,236,20480
s_add_u32 s36, s33, 0x8800
Mvva 124,160,184
buffer_load_dwordx2 v[54:55], v9, s[16:19], s36 offen sc1
Mvva 124,164,188
s_add_u32 s36, s34, 0x6800
Tv 194,236,22528
Mvva 140,168,184
Tv 196,238,20480
Mvva 140,172,188
s_waitcnt lgkmcnt(3)
Tv 198,238,22528
Mvva 120,176,208
buffer_load_dwordx2 v[56:57], v9, s[16:19], s36 offen sc1
Mvva 120,180,212
s_add_u32 s36, s35, 0x4800
Tv 200,237,20480
Mvva 136,184,208
Tv 202,237,22528
Tv 204,239,20480
Tv 206,239,22528
Mvva 136,188,212
Tv 144,236,32768
Mvva 124,176,216
buffer_load_dwordx2 v[58:59], v9, s[16:19], s36 offen sc1
Mvva 124,180,220
s_add_u32 s36, s52, 0x2800
Tv 146,236,34816
Mvva 140,184,216
Tv 148,238,32768
Mvva 140,188,220
s_waitcnt lgkmcnt(3)
buffer_load_dword v213, v214, s[16:19], s71 offen sc1
Mvva 120,192,240
buffer_load_dwordx2 v[60:61], v9, s[16:19], s36 offen sc1
Mvva 120,196,244
s_add_u32 s36, s48, 0x800
Tv 150,238,34816
Mvva 136,200,240
Tv 152,237,32768
Tv 154,237,34816
Tv 156,239,32768
Tv 158,239,34816
Mvva 136,204,244
Tv 160,236,24576
Mvva 124,192,248
buffer_load_dwordx2 v[62:63], v9, s[16:19], s36 offen sc1
Mvva 124,196,252
Tv 162,236,26624
Mvva 140,200,248
Tv 164,238,24576
Mvva 140,204,252
s_waitcnt lgkmcnt(3)
Tv 166,238,26624
Mvva 120,144,16
buffer_load_dwordx4 v[84:87], v229, s[16:19], s45 offen sc1
Mvva 120,148,20
Tv 168,237,24576
Mvva 136,152,16
Tv 170,237,26624
Tv 172,239,24576
Tv 174,239,26624
Mvva 136,156,20
Tv 176,236,28672
Mvva 124,144,24
buffer_load_dwordx4 v[92:95], v229, s[16:19], s45 offen offset:1024 sc1
Mvva 124,148,28
Tv 178,236,30720
Mvva 140,152,24
Tv 180,238,28672
Mvva 140,156,28
s_waitcnt lgkmcnt(3)
Tv 182,238,30720
Mvva 120,160,48
buffer_load_dwordx4 v[100:103], v229, s[16:19], s46 offen sc1
Mvva 120,164,52
Tv 184,237,28672
Mvva 136,168,48
Tv 186,237,30720
Tv 188,239,28672
Tv 190,239,30720
Mvva 136,172,52
Tv 192,236,0
Mvva 124,160,56
buffer_load_dwordx4 v[108:111], v229, s[16:19], s46 offen offset:1024 sc1
Mvva 124,164,60
Tv 194,236,2048
Mvva 140,168,56
Tv 196,238,0
Mvva 140,172,60
s_waitcnt lgkmcnt(3)
Tv 198,238,2048
Mvva 120,176,80
Tv 200,237,0
Mvva 120,180,84
Tv 202,237,2048
Mvva 136,184,80
Tv 204,239,0
Tv 206,239,2048
Mvva 136,188,84
buffer_load_dwordx4 v[220:223], v229, s[16:19], s47 offen sc1
Mvva 124,176,88
Mvva 124,180,92
Mvva 140,184,88
buffer_load_dwordx4 v[224:227], v229, s[16:19], s47 offen offset:1024 sc1
Mvva 140,188,92
s_waitcnt lgkmcnt(0)
Mvva 120,192,112
Mvva 120,196,116
Mvva 136,200,112
Mvva 136,204,116
Mvva 124,192,120
Mvva 124,196,124
Mvva 140,200,120
Mvva 140,204,124
s_branch M_T
M_XL0:
s_waitcnt lgkmcnt(4)
v_exp_f32 v76, v76
Cvaa 16,148,0,216
v_exp_f32 v77, v77
Mvaa 16,152,4
s_add_u32 m0, s38, 0x9000
v_exp_f32 v78, v78
Mvaa 16,156,8
buffer_load_dwordx4 v2, s[16:19], s33 offen sc1 lds
Mvaa 16,160,12
v_exp_f32 v79, v79
Cvaa 20,148,16,220
La 180,6,8192
PK 110,76,77
Mvaa 20,152,20
La 184,6,49152
PK 111,78,79
Mvaa 20,156,24
La 188,7,24576
Mvaa 20,160,28
v_exp_f32 v16, v16
Cvaa 24,148,32,224
buffer_load_dwordx4 v2, s[16:19], s33 offen offset:1024 sc1 lds
Mvaa 24,152,36
v_exp_f32 v17, v17
Mvaa 24,156,40
v_exp_f32 v18, v18
Mvaa 24,160,44
v_exp_f32 v20, v20
Cvaa 28,148,48,228
v_exp_f32 v21, v21
Mvaa 28,152,52
v_exp_f32 v19, v19
Mvaa 28,156,56
La 192,8,0
PK 112,16,17
Mvaa 28,160,60
s_waitcnt lgkmcnt(4)
buffer_load_dwordx4 v2, s[16:19], s33 offen offset:2048 sc1 lds
Cvaa 32,164,0,216
La 196,6,9216
PK 113,18,19
Mvaa 32,168,4
v_exp_f32 v22, v22
Mvaa 32,172,8
v_exp_f32 v23, v23
Mvaa 32,176,12
La 200,6,50176
PK 116,20,21
Cvaa 36,164,16,220
La 204,7,25600
PK 117,22,23
Mvaa 36,168,20
v_exp_f32 v24, v24
Mvaa 36,172,24
La 208,8,1024
Mvaa 36,176,28
buffer_load_dwordx4 v2, s[16:19], s33 offen offset:3072 sc1 lds
Cvaa 40,164,32,224
v_exp_f32 v25, v25
Mvaa 40,168,36
v_exp_f32 v28, v28
Mvaa 40,172,40
v_exp_f32 v26, v26
Mvaa 40,176,44
v_exp_f32 v29, v29
Cvaa 44,164,48,228
v_exp_f32 v27, v27
Mvaa 44,168,52
v_exp_f32 v30, v30
Mvaa 44,172,56
v_exp_f32 v31, v31
Mvaa 44,176,60
s_waitcnt vmcnt(8) lgkmcnt(0)
s_barrier
Cvaa 48,180,0,216
La 148,3,16384
PK 120,24,25
Mvaa 48,184,4
s_add_u32 m0, s38, 0
s_add_u32 s36, s60, 0
La 152,6,16384
Mvaa 48,188,8
buffer_load_dwordx4 v248, s[4:7], s36 offen lds
Mvaa 48,192,12
La 156,3,17408
PK 121,26,27
Cvaa 52,180,16,220
La 160,6,17408
PK 124,28,29
Mvaa 52,184,20
La 164,3,57344
PK 125,30,31
Mvaa 52,188,24
v_exp_f32 v32, v32
Mvaa 52,192,28
buffer_load_dwordx4 v249, s[4:7], s36 offen offset:1024 lds
Cvaa 56,180,32,224
v_exp_f32 v33, v33
Mvaa 56,184,36
v_exp_f32 v36, v36
Mvaa 56,188,40
v_exp_f32 v34, v34
Mvaa 56,192,44
v_exp_f32 v37, v37
Cvaa 60,180,48,228
v_exp_f32 v35, v35
Mvaa 60,184,52
buffer_load_dwordx4 v250, s[4:7], s36 offen offset:2048 lds
Mvaa 60,188,56
La 168,6,57344
PK 114,32,33
Mvaa 60,192,60
La 172,3,58368
PK 115,34,35
Cvaa 64,196,0,216
v_exp_f32 v38, v38
Mvaa 64,200,4
v_exp_f32 v39, v39
Mvaa 64,204,8
La 176,6,58368
PK 118,36,37
Mvaa 64,208,12
buffer_load_dwordx4 v251, s[4:7], s36 offen offset:3072 lds
Cvaa 68,196,16,220
La 180,4,32768
PK 119,38,39
Mvaa 68,200,20
v_exp_f32 v40, v40
Mvaa 68,204,24
v_exp_f32 v41, v41
Mvaa 68,208,28
v_exp_f32 v44, v44
Cvaa 72,196,32,224
v_exp_f32 v42, v42
Mvaa 72,200,36
s_add_u32 m0, s38, 0x2000
s_add_u32 s36, s58, 0
La 184,7,32768
Mvaa 72,204,40
buffer_load_dwordx4 v1, s[16:19], s36 offen sc1 lds
Mvaa 72,208,44
v_exp_f32 v45, v45
Cvaa 76,196,48,228
v_exp_f32 v43, v43
Mvaa 76,200,52
La 188,4,33792
PK 122,40,41
Mvaa 76,204,56
La 192,7,33792
PK 123,42,43
Mvaa 76,208,60
buffer_load_dwordx4 v1, s[16:19], s36 offen offset:1024 sc1 lds
Maav 128,144,80
v_exp_f32 v46, v46
Maav 128,144,96
v_exp_f32 v47, v47
Maav 132,144,84
La 196,5,8192
PK 126,44,45
Maav 132,144,100
La 200,8,8192
PK 127,46,47
Maav 136,144,88
v_exp_f32 v56, v56
Maav 136,144,104
buffer_load_dwordx4 v253, s[16:19], s36 offen offset:2048 sc1 lds
Maav 140,144,92
v_exp_f32 v57, v57
Maav 140,144,108
s_waitcnt lgkmcnt(10)
v_exp_f32 v60, v60
Mvav 144,148,80
v_exp_f32 v58, v58
Mvav 144,152,96
v_exp_f32 v61, v61
Mvav 148,148,84
v_exp_f32 v59, v59
Mvav 148,152,100
buffer_load_dwordx4 v253, s[16:19], s36 offen offset:3072 sc1 lds
Maav 64,148,88
La 204,5,9216
PK 136,56,57
Maav 64,152,104
La 208,8,9216
PK 137,58,59
Maav 68,148,92
v_exp_f32 v62, v62
Maav 68,152,108
v_exp_f32 v63, v63
Mvav 152,156,80
v_exp_f32 v72, v72
Mvav 152,160,96
s_add_u32 m0, s38, 0x1000
s_add_u32 s36, s60, 0x9000
PK 140,60,61
Mvav 156,156,84
buffer_load_dwordx4 v248, s[4:7], s36 offen lds
Mvav 156,160,100
v_exp_f32 v73, v73
Maav 72,156,88
v_exp_f32 v74, v74
Maav 72,160,104
v_exp_f32 v75, v75
Maav 76,156,92
PK 141,62,63
PK 138,72,73
Maav 76,160,108
s_waitcnt lgkmcnt(8)
buffer_load_dwordx4 v249, s[4:7], s36 offen offset:1024 lds
Mvav 160,164,80
v_exp_f32 v76, v76
Mvav 160,168,96
v_exp_f32 v77, v77
Mvav 164,164,84
v_exp_f32 v78, v78
Mvav 164,168,100
v_exp_f32 v79, v79
Maav 80,164,88
PK 139,74,75
PK 142,76,77
Maav 80,168,104
buffer_load_dwordx4 v250, s[4:7], s36 offen offset:2048 lds
Maav 84,164,92
v_exp_f32 v48, v48
Maav 84,168,108
v_exp_f32 v49, v49
Mvav 168,172,80
v_exp_f32 v50, v50
Mvav 168,176,96
v_exp_f32 v51, v51
Mvav 172,172,84
PK 143,78,79
PK 128,48,49
Mvav 172,176,100
buffer_load_dwordx4 v251, s[4:7], s36 offen offset:3072 lds
Maav 88,172,88
v_exp_f32 v52, v52
Maav 88,176,104
v_exp_f32 v53, v53
Maav 92,172,92
v_exp_f32 v54, v54
Maav 92,176,108
s_waitcnt vmcnt(12) lgkmcnt(0)
s_barrier
Mvav 176,180,80
La 148,3,32768
PK 129,50,51
Mvav 176,184,96
s_add_u32 m0, s38, 0x3000
s_add_u32 s36, s61, 0
La 152,6,32768
Mvav 180,180,84
buffer_load_dwordx4 v252, s[4:7], s36 offen lds
Mvav 180,184,100
v_exp_f32 v55, v55
Maav 96,180,88
La 156,3,33792
PK 132,52,53
Maav 96,184,104
La 160,6,33792
PK 133,54,55
Maav 100,180,92
v_exp_f32 v64, v64
Maav 100,184,108
s_add_u32 m0, s38, 0x3400
s_add_u32 s36, s61, 0x12000
La 164,4,8192
Mvav 184,188,80
buffer_load_dwordx4 v252, s[4:7], s36 offen lds
Mvav 184,192,96
v_exp_f32 v65, v65
Mvav 188,188,84
v_exp_f32 v68, v68
Mvav 188,192,100
v_exp_f32 v66, v66
Maav 104,188,88
v_exp_f32 v69, v69
Maav 104,192,104
v_exp_f32 v67, v67
Maav 108,188,92
La 168,7,8192
PK 130,64,65
Maav 108,192,108
La 172,4,9216
PK 131,66,67
Mvav 192,196,80
v_exp_f32 v70, v70
Mvav 192,200,96
v_exp_f32 v71, v71
Mvav 196,196,84
La 176,7,9216
PK 134,68,69
Mvav 196,200,100
La 180,4,49152
PK 135,70,71
Maav 112,196,88
La 184,7,49152
Maav 112,200,104
La 188,4,50176
Maav 116,196,92
La 192,7,50176
Maav 116,200,108
Mvav 200,204,80
Mvav 200,208,96
Mvav 204,204,84
Mvav 204,208,100
Maav 120,204,88
Maav 120,208,104
Maav 124,204,92
Maav 124,208,108
Maav 136,144,120
La 196,5,24576
Maav 136,144,136
La 200,8,24576
Maav 140,144,124
La 204,5,25600
Maav 140,144,140
s_waitcnt lgkmcnt(11)
La 208,8,25600
v_accvgpr_read_b32 v232, a252
Maav 64,148,120
v_accvgpr_read_b32 v244, a253
v_accvgpr_read_b32 v240, a254
Maav 64,152,136
v_xor_b32 v233, 32, v232
v_accvgpr_read_b32 v245, a255
Maav 68,148,124
v_add_u32 v234, 0xa000, v232
v_add_u32 v235, 0xa000, v233
Maav 68,152,140
v_add_u32 v236, 0x14000, v232
v_add_u32 v237, 0x14000, v233
Maav 72,156,120
v_add_u32 v238, 0x1e000, v232
v_add_u32 v239, 0x1e000, v233
Maav 72,160,136
v_add_u32 v241, 0xa000, v240
v_add_u32 v242, 0x14000, v240
Maav 76,156,124
v_add_u32 v243, 0x1e000, v240
Maav 76,160,140
s_waitcnt lgkmcnt(0)
s_barrier
Maav 80,164,120
ds_write_b32 v9, a136 offset:15360
Maav 80,168,136
ds_write_b32 v9, a140 offset:15364
Maav 84,164,124
ds_write_b128 v9, a[64:67] offset:24576
Maav 84,168,140
Maav 88,172,120
ds_write_b128 v9, a[68:71] offset:25600
Maav 88,176,136
Maav 92,172,124
Maav 92,176,140
ds_write_b128 v9, a[72:75] offset:26624
Maav 96,180,120
Maav 96,184,136
ds_write_b128 v9, a[76:79] offset:27648
Maav 100,180,124
Maav 100,184,140
Maav 104,188,120
ds_write_b128 v9, a[80:83] offset:28672
Maav 104,192,136
Maav 108,188,124
ds_write_b128 v9, a[84:87] offset:29696
Maav 108,192,140
Maav 112,196,120
Maav 112,200,136
ds_write_b128 v9, a[88:91] offset:30720
Maav 116,196,124
Maav 116,200,140
ds_write_b128 v9, a[92:95] offset:31744
Maav 120,204,120
Maav 120,208,136
Maav 124,204,124
ds_write_b128 v9, a[96:99] offset:32768
Maav 124,208,140
Maav 128,144,112
ds_write_b128 v9, a[100:103] offset:33792
Maav 128,144,128
Maav 132,144,116
Maav 132,144,132
ds_write_b128 v9, a[104:107] offset:34816
Mvav 144,148,112
Mvav 144,152,128
ds_write_b128 v9, a[108:111] offset:35840
Mvav 148,148,116
Mvav 148,152,132
v_accvgpr_read_b32 v82, a128
s_nop 0
v_accvgpr_read_b32 v83, a132
Mvav 152,156,112
ds_write_b128 v9, a[112:115] offset:36864
Mvav 152,160,128
Mvav 156,156,116
ds_write_b128 v9, a[116:119] offset:37888
Mvav 156,160,132
Mvav 160,164,112
Mvav 160,168,128
ds_write_b128 v9, a[120:123] offset:38912
Mvav 164,164,116
Mvav 164,168,132
ds_write_b128 v9, a[124:127] offset:39936
Mvav 168,172,112
Mvav 168,176,128
Mvav 172,172,116
Mvav 172,176,132
s_waitcnt vmcnt(1) lgkmcnt(0)
s_barrier
Mvav 176,180,112
ds_read_b64 v[80:81], v10 offset:15360
Mvav 176,184,128
Lv 16,10,24576
Mvav 180,180,116
Lv 20,10,25600
Mvav 180,184,132
Lv 24,10,26624
Mvav 184,188,112
Lv 28,10,27648
Mvav 184,192,128
s_waitcnt lgkmcnt(4)
Lv 32,10,28672
v_add_f32 v80, v80, v82
Mvav 188,188,116
Lv 36,10,29696
v_add_f32 v81, v81, v83
Mvav 188,192,132
Lv 40,10,30720
Mvav 192,196,112
Lv 44,10,31744
Mvav 192,200,128
Lv 48,10,32768
Mvav 196,196,116
Lv 52,10,33792
Mvav 196,200,132
Lv 56,10,34816
Mvav 200,204,112
Lv 60,10,35840
Mvav 200,208,128
Lv 64,10,36864
Mvav 204,204,116
Lv 68,10,37888
Mvav 204,208,132
Lv 72,10,38912
Lv 76,10,39936
v_rcp_f32 v84, v80
v_rcp_f32 v86, v81
v_min_f32 v90, v80, v81
v_max_f32 v91, v80, v81
v_mul_f32 v84, v84, v13
v_mul_f32 v86, v86, v14
v_mov_b32 v85, v84
v_mov_b32 v87, v86
Ta 32,232,0
Ta 34,232,2048
Ta 36,232,4096
Ta 38,232,6144
La 0,244,8192
La 4,244,10240
v_cmp_gt_f32 vcc, 0x2b800000, v90
s_nop 0
s_or_b32 s49, s49, vcc_lo
s_or_b32 s49, s49, vcc_hi
v_cmp_lt_f32 vcc, 0x5f800000, v91
s_nop 0
s_or_b32 s49, s49, vcc_lo
s_or_b32 s49, s49, vcc_hi
s_waitcnt lgkmcnt(15)
s_add_u32 m0, s38, 0x4000
s_add_u32 s36, s58, 0x40000
buffer_load_dwordx4 v1, s[16:19], s36 offen sc1 lds
buffer_load_dwordx4 v1, s[16:19], s36 offen offset:1024 sc1 lds
v_pk_add_f32 v[144:145], v[144:145], v[16:17]
v_pk_add_f32 v[146:147], v[146:147], v[18:19]
v_pk_add_f32 v[148:149], v[148:149], v[20:21]
v_pk_add_f32 v[150:151], v[150:151], v[22:23]
v_pk_mul_f32 v[144:145], v[144:145], v[84:85]
v_pk_mul_f32 v[146:147], v[146:147], v[84:85]
v_pk_mul_f32 v[148:149], v[148:149], v[86:87]
v_pk_mul_f32 v[150:151], v[150:151], v[86:87]
v_pk_fma_f32 v[80:81], v[144:145], v[146:147], v[80:81]
v_pk_fma_f32 v[80:81], v[148:149], v[150:151], v[80:81]
s_waitcnt lgkmcnt(15)
buffer_load_dwordx4 v253, s[16:19], s36 offen offset:2048 sc1 lds
buffer_load_dwordx4 v253, s[16:19], s36 offen offset:3072 sc1 lds
v_pk_add_f32 v[152:153], v[152:153], v[24:25]
v_pk_add_f32 v[154:155], v[154:155], v[26:27]
v_pk_add_f32 v[156:157], v[156:157], v[28:29]
v_pk_add_f32 v[158:159], v[158:159], v[30:31]
v_pk_mul_f32 v[152:153], v[152:153], v[84:85]
v_pk_mul_f32 v[154:155], v[154:155], v[84:85]
v_pk_mul_f32 v[156:157], v[156:157], v[86:87]
v_pk_mul_f32 v[158:159], v[158:159], v[86:87]
v_pk_fma_f32 v[80:81], v[152:153], v[154:155], v[80:81]
v_pk_fma_f32 v[80:81], v[156:157], v[158:159], v[80:81]
s_waitcnt lgkmcnt(15)
s_add_u32 m0, s38, 0x5000
s_add_u32 s36, s60, 0x12000
buffer_load_dwordx4 v248, s[4:7], s36 offen lds
buffer_load_dwordx4 v249, s[4:7], s36 offen offset:1024 lds
v_pk_add_f32 v[160:161], v[160:161], v[32:33]
v_pk_add_f32 v[162:163], v[162:163], v[34:35]
v_pk_add_f32 v[164:165], v[164:165], v[36:37]
v_pk_add_f32 v[166:167], v[166:167], v[38:39]
v_pk_mul_f32 v[160:161], v[160:161], v[84:85]
v_pk_mul_f32 v[162:163], v[162:163], v[84:85]
v_pk_mul_f32 v[164:165], v[164:165], v[86:87]
v_pk_mul_f32 v[166:167], v[166:167], v[86:87]
v_pk_fma_f32 v[80:81], v[160:161], v[162:163], v[80:81]
v_pk_fma_f32 v[80:81], v[164:165], v[166:167], v[80:81]
s_waitcnt lgkmcnt(14)
Ta 40,233,0
Ta 42,233,2048
Ta 44,233,4096
Ta 46,233,6144
Ta 48,234,0
Ta 50,234,2048
Ta 52,234,4096
Ta 54,234,6144
La 8,244,9216
La 12,244,11264
buffer_load_dwordx4 v250, s[4:7], s36 offen offset:2048 lds
buffer_load_dwordx4 v251, s[4:7], s36 offen offset:3072 lds
v_pk_add_f32 v[168:169], v[168:169], v[40:41]
v_pk_add_f32 v[170:171], v[170:171], v[42:43]
v_pk_add_f32 v[172:173], v[172:173], v[44:45]
v_pk_add_f32 v[174:175], v[174:175], v[46:47]
v_pk_mul_f32 v[168:169], v[168:169], v[84:85]
v_pk_mul_f32 v[170:171], v[170:171], v[84:85]
v_pk_mul_f32 v[172:173], v[172:173], v[86:87]
v_pk_mul_f32 v[174:175], v[174:175], v[86:87]
v_pk_fma_f32 v[80:81], v[168:169], v[170:171], v[80:81]
v_pk_fma_f32 v[80:81], v[172:173], v[174:175], v[80:81]
s_waitcnt lgkmcnt(15)
s_add_u32 m0, s38, 0x8000
s_add_u32 s36, s60, 0x1b000
buffer_load_dwordx4 v248, s[4:7], s36 offen lds
buffer_load_dwordx4 v249, s[4:7], s36 offen offset:1024 lds
v_pk_add_f32 v[176:177], v[176:177], v[48:49]
v_pk_add_f32 v[178:179], v[178:179], v[50:51]
v_pk_add_f32 v[180:181], v[180:181], v[52:53]
v_pk_add_f32 v[182:183], v[182:183], v[54:55]
v_pk_mul_f32 v[176:177], v[176:177], v[84:85]
v_pk_mul_f32 v[178:179], v[178:179], v[84:85]
v_pk_mul_f32 v[180:181], v[180:181], v[86:87]
v_pk_mul_f32 v[182:183], v[182:183], v[86:87]
v_pk_fma_f32 v[80:81], v[176:177], v[178:179], v[80:81]
v_pk_fma_f32 v[80:81], v[180:181], v[182:183], v[80:81]
s_waitcnt lgkmcnt(15)
buffer_load_dwordx4 v250, s[4:7], s36 offen offset:2048 lds
buffer_load_dwordx4 v251, s[4:7], s36 offen offset:3072 lds
v_pk_add_f32 v[184:185], v[184:185], v[56:57]
v_pk_add_f32 v[186:187], v[186:187], v[58:59]
v_pk_add_f32 v[188:189], v[188:189], v[60:61]
v_pk_add_f32 v[190:191], v[190:191], v[62:63]
v_pk_mul_f32 v[184:185], v[184:185], v[84:85]
v_pk_mul_f32 v[186:187], v[186:187], v[84:85]
v_pk_mul_f32 v[188:189], v[188:189], v[86:87]
v_pk_mul_f32 v[190:191], v[190:191], v[86:87]
v_pk_fma_f32 v[80:81], v[184:185], v[186:187], v[80:81]
v_pk_fma_f32 v[80:81], v[188:189], v[190:191], v[80:81]
s_waitcnt lgkmcnt(15)
v_pk_add_f32 v[192:193], v[192:193], v[64:65]
v_pk_add_f32 v[194:195], v[194:195], v[66:67]
v_pk_add_f32 v[196:197], v[196:197], v[68:69]
v_pk_add_f32 v[198:199], v[198:199], v[70:71]
v_pk_mul_f32 v[192:193], v[192:193], v[84:85]
v_pk_mul_f32 v[194:195], v[194:195], v[84:85]
v_pk_mul_f32 v[196:197], v[196:197], v[86:87]
v_pk_mul_f32 v[198:199], v[198:199], v[86:87]
v_pk_fma_f32 v[80:81], v[192:193], v[194:195], v[80:81]
v_pk_fma_f32 v[80:81], v[196:197], v[198:199], v[80:81]
s_waitcnt lgkmcnt(15)
v_pk_add_f32 v[200:201], v[200:201], v[72:73]
v_pk_add_f32 v[202:203], v[202:203], v[74:75]
v_pk_add_f32 v[204:205], v[204:205], v[76:77]
v_pk_add_f32 v[206:207], v[206:207], v[78:79]
v_pk_mul_f32 v[200:201], v[200:201], v[84:85]
v_pk_mul_f32 v[202:203], v[202:203], v[84:85]
v_pk_mul_f32 v[204:205], v[204:205], v[86:87]
v_pk_mul_f32 v[206:207], v[206:207], v[86:87]
v_pk_fma_f32 v[80:81], v[200:201], v[202:203], v[80:81]
v_pk_fma_f32 v[80:81], v[204:205], v[206:207], v[80:81]
v_add_f32 v80, v80, v81
s_movk_i32 s37, 0x207
v_cmp_class_f32 vcc, v80, s37
s_nop 0
s_or_b32 s49, s49, vcc_lo
s_or_b32 s49, s49, vcc_hi
s_bitcmp1_b32 s2, 0
s_cbranch_scc0 M_C0
s_branch M_C1
M_XL1:
s_waitcnt lgkmcnt(4)
v_exp_f32 v76, v76
Cvaa 16,148,0,216
v_exp_f32 v77, v77
Mvaa 16,152,4
s_add_u32 m0, s38, 0x5000
v_exp_f32 v78, v78
Mvaa 16,156,8
buffer_load_dwordx4 v2, s[16:19], s33 offen sc1 lds
Mvaa 16,160,12
v_exp_f32 v79, v79
Cvaa 20,148,16,220
La 180,6,0
PK 142,76,77
Mvaa 20,152,20
La 184,6,40960
PK 143,78,79
Mvaa 20,156,24
La 188,7,16384
Mvaa 20,160,28
v_exp_f32 v16, v16
Cvaa 24,148,32,224
buffer_load_dwordx4 v2, s[16:19], s33 offen offset:1024 sc1 lds
Mvaa 24,152,36
v_exp_f32 v17, v17
Mvaa 24,156,40
v_exp_f32 v18, v18
Mvaa 24,160,44
v_exp_f32 v20, v20
Cvaa 28,148,48,228
v_exp_f32 v21, v21
Mvaa 28,152,52
v_exp_f32 v19, v19
Mvaa 28,156,56
La 192,7,57344
PK 80,16,17
Mvaa 28,160,60
s_waitcnt lgkmcnt(4)
buffer_load_dwordx4 v2, s[16:19], s33 offen offset:2048 sc1 lds
Cvaa 32,164,0,216
La 196,6,1024
PK 81,18,19
Mvaa 32,168,4
v_exp_f32 v22, v22
Mvaa 32,172,8
v_exp_f32 v23, v23
Mvaa 32,176,12
La 200,6,41984
PK 84,20,21
Cvaa 36,164,16,220
La 204,7,17408
PK 85,22,23
Mvaa 36,168,20
v_exp_f32 v24, v24
Mvaa 36,172,24
La 208,7,58368
Mvaa 36,176,28
buffer_load_dwordx4 v2, s[16:19], s33 offen offset:3072 sc1 lds
Cvaa 40,164,32,224
v_exp_f32 v25, v25
Mvaa 40,168,36
v_exp_f32 v28, v28
Mvaa 40,172,40
v_exp_f32 v26, v26
Mvaa 40,176,44
v_exp_f32 v29, v29
Cvaa 44,164,48,228
v_exp_f32 v27, v27
Mvaa 44,168,52
v_exp_f32 v30, v30
Mvaa 44,172,56
v_exp_f32 v31, v31
Mvaa 44,176,60
s_waitcnt vmcnt(8) lgkmcnt(0)
s_barrier
Cvaa 48,180,0,216
La 148,3,32768
PK 88,24,25
Mvaa 48,184,4
s_add_u32 m0, s38, 0
s_add_u32 s36, s60, 0
La 152,6,32768
Mvaa 48,188,8
buffer_load_dwordx4 v248, s[4:7], s36 offen lds
Mvaa 48,192,12
La 156,3,33792
PK 89,26,27
Cvaa 52,180,16,220
La 160,6,33792
PK 92,28,29
Mvaa 52,184,20
La 164,4,8192
PK 93,30,31
Mvaa 52,188,24
v_exp_f32 v32, v32
Mvaa 52,192,28
buffer_load_dwordx4 v249, s[4:7], s36 offen offset:1024 lds
Cvaa 56,180,32,224
v_exp_f32 v33, v33
Mvaa 56,184,36
v_exp_f32 v36, v36
Mvaa 56,188,40
v_exp_f32 v34, v34
Mvaa 56,192,44
v_exp_f32 v37, v37
Cvaa 60,180,48,228
v_exp_f32 v35, v35
Mvaa 60,184,52
buffer_load_dwordx4 v250, s[4:7], s36 offen offset:2048 lds
Mvaa 60,188,56
La 168,7,8192
PK 82,32,33
Mvaa 60,192,60
La 172,4,9216
PK 83,34,35
Cvaa 64,196,0,216
v_exp_f32 v38, v38
Mvaa 64,200,4
v_exp_f32 v39, v39
Mvaa 64,204,8
La 176,7,9216
PK 86,36,37
Mvaa 64,208,12
buffer_load_dwordx4 v251, s[4:7], s36 offen offset:3072 lds
Cvaa 68,196,16,220
La 180,4,49152
PK 87,38,39
Mvaa 68,200,20
v_exp_f32 v40, v40
Mvaa 68,204,24
v_exp_f32 v41, v41
Mvaa 68,208,28
v_exp_f32 v44, v44
Cvaa 72,196,32,224
v_exp_f32 v42, v42
Mvaa 72,200,36
s_add_u32 m0, s38, 0x2000
s_add_u32 s36, s58, 0
La 184,7,49152
Mvaa 72,204,40
buffer_load_dwordx4 v1, s[16:19], s36 offen sc1 lds
Mvaa 72,208,44
v_exp_f32 v45, v45
Cvaa 76,196,48,228
v_exp_f32 v43, v43
Mvaa 76,200,52
La 188,4,50176
PK 90,40,41
Mvaa 76,204,56
La 192,7,50176
PK 91,42,43
Mvaa 76,208,60
buffer_load_dwordx4 v1, s[16:19], s36 offen offset:1024 sc1 lds
Maav 128,144,112
v_exp_f32 v46, v46
Maav 128,144,128
v_exp_f32 v47, v47
Maav 132,144,116
La 196,5,24576
PK 94,44,45
Maav 132,144,132
La 200,8,24576
PK 95,46,47
Maav 136,144,120
v_exp_f32 v56, v56
Maav 136,144,136
buffer_load_dwordx4 v253, s[16:19], s36 offen offset:2048 sc1 lds
Maav 140,144,124
v_exp_f32 v57, v57
Maav 140,144,140
s_waitcnt lgkmcnt(10)
v_exp_f32 v60, v60
Mvav 144,148,112
v_exp_f32 v58, v58
Mvav 144,152,128
v_exp_f32 v61, v61
Mvav 148,148,116
v_exp_f32 v59, v59
Mvav 148,152,132
buffer_load_dwordx4 v253, s[16:19], s36 offen offset:3072 sc1 lds
Maav 64,148,120
La 204,5,25600
PK 104,56,57
Maav 64,152,136
La 208,8,25600
PK 105,58,59
Maav 68,148,124
v_exp_f32 v62, v62
Maav 68,152,140
v_exp_f32 v63, v63
Mvav 152,156,112
v_exp_f32 v72, v72
Mvav 152,160,128
s_add_u32 m0, s38, 0x1000
s_add_u32 s36, s60, 0x9000
PK 108,60,61
Mvav 156,156,116
buffer_load_dwordx4 v248, s[4:7], s36 offen lds
Mvav 156,160,132
v_exp_f32 v73, v73
Maav 72,156,120
v_exp_f32 v74, v74
Maav 72,160,136
v_exp_f32 v75, v75
Maav 76,156,124
PK 109,62,63
PK 106,72,73
Maav 76,160,140
s_waitcnt lgkmcnt(8)
buffer_load_dwordx4 v249, s[4:7], s36 offen offset:1024 lds
Mvav 160,164,112
v_exp_f32 v76, v76
Mvav 160,168,128
v_exp_f32 v77, v77
Mvav 164,164,116
v_exp_f32 v78, v78
Mvav 164,168,132
v_exp_f32 v79, v79
Maav 80,164,120
PK 107,74,75
PK 110,76,77
Maav 80,168,136
buffer_load_dwordx4 v250, s[4:7], s36 offen offset:2048 lds
Maav 84,164,124
v_exp_f32 v48, v48
Maav 84,168,140
v_exp_f32 v49, v49
Mvav 168,172,112
v_exp_f32 v50, v50
Mvav 168,176,128
v_exp_f32 v51, v51
Mvav 172,172,116
PK 111,78,79
PK 96,48,49
Mvav 172,176,132
buffer_load_dwordx4 v251, s[4:7], s36 offen offset:3072 lds
Maav 88,172,120
v_exp_f32 v52, v52
Maav 88,176,136
v_exp_f32 v53, v53
Maav 92,172,124
v_exp_f32 v54, v54
Maav 92,176,140
s_waitcnt vmcnt(12) lgkmcnt(0)
s_barrier
Mvav 176,180,112
La 148,3,16384
PK 97,50,51
Mvav 176,184,128
s_add_u32 m0, s38, 0x3000
s_add_u32 s36, s61, 0
La 152,6,16384
Mvav 180,180,116
buffer_load_dwordx4 v252, s[4:7], s36 offen lds
Mvav 180,184,132
v_exp_f32 v55, v55
Maav 96,180,120
La 156,3,17408
PK 100,52,53
Maav 96,184,136
La 160,6,17408
PK 101,54,55
Maav 100,180,124
v_exp_f32 v64, v64
Maav 100,184,140
s_add_u32 m0, s38, 0x3400
s_add_u32 s36, s61, 0x12000
La 164,3,57344
Mvav 184,188,112
buffer_load_dwordx4 v252, s[4:7], s36 offen lds
Mvav 184,192,128
v_exp_f32 v65, v65
Mvav 188,188,116
v_exp_f32 v68, v68
Mvav 188,192,132
v_exp_f32 v66, v66
Maav 104,188,120
v_exp_f32 v69, v69
Maav 104,192,136
v_exp_f32 v67, v67
Maav 108,188,124
La 168,6,57344
PK 98,64,65
Maav 108,192,140
La 172,3,58368
PK 99,66,67
Mvav 192,196,112
v_exp_f32 v70, v70
Mvav 192,200,128
v_exp_f32 v71, v71
Mvav 196,196,116
La 176,6,58368
PK 102,68,69
Mvav 196,200,132
La 180,4,32768
PK 103,70,71
Maav 112,196,120
La 184,7,32768
Maav 112,200,136
La 188,4,33792
Maav 116,196,124
La 192,7,33792
Maav 116,200,140
Mvav 200,204,112
Mvav 200,208,128
Mvav 204,204,116
Mvav 204,208,132
Maav 120,204,120
Maav 120,208,136
Maav 124,204,124
Maav 124,208,140
Maav 136,144,88
La 196,5,8192
Maav 136,144,104
La 200,8,8192
Maav 140,144,92
La 204,5,9216
Maav 140,144,108
s_waitcnt lgkmcnt(11)
La 208,8,9216
v_accvgpr_read_b32 v232, a252
Maav 64,148,88
v_accvgpr_read_b32 v244, a253
v_accvgpr_read_b32 v240, a254
Maav 64,152,104
v_xor_b32 v233, 32, v232
v_accvgpr_read_b32 v245, a255
Maav 68,148,92
v_add_u32 v234, 0xa000, v232
v_add_u32 v235, 0xa000, v233
Maav 68,152,108
v_add_u32 v236, 0x14000, v232
v_add_u32 v237, 0x14000, v233
Maav 72,156,88
v_add_u32 v238, 0x1e000, v232
v_add_u32 v239, 0x1e000, v233
Maav 72,160,104
v_add_u32 v241, 0xa000, v240
v_add_u32 v242, 0x14000, v240
Maav 76,156,92
v_add_u32 v243, 0x1e000, v240
Maav 76,160,108
s_waitcnt lgkmcnt(0)
s_barrier
Maav 80,164,88
ds_write_b32 v9, a136 offset:15360
Maav 80,168,104
ds_write_b32 v9, a140 offset:15364
Maav 84,164,92
ds_write_b128 v9, a[64:67] offset:24576
Maav 84,168,108
Maav 88,172,88
ds_write_b128 v9, a[68:71] offset:25600
Maav 88,176,104
Maav 92,172,92
Maav 92,176,108
ds_write_b128 v9, a[72:75] offset:26624
Maav 96,180,88
Maav 96,184,104
ds_write_b128 v9, a[76:79] offset:27648
Maav 100,180,92
Maav 100,184,108
Maav 104,188,88
ds_write_b128 v9, a[80:83] offset:28672
Maav 104,192,104
Maav 108,188,92
ds_write_b128 v9, a[84:87] offset:29696
Maav 108,192,108
Maav 112,196,88
Maav 112,200,104
ds_write_b128 v9, a[88:91] offset:30720
Maav 116,196,92
Maav 116,200,108
ds_write_b128 v9, a[92:95] offset:31744
Maav 120,204,88
Maav 120,208,104
Maav 124,204,92
ds_write_b128 v9, a[96:99] offset:32768
Maav 124,208,108
Maav 128,144,80
ds_write_b128 v9, a[100:103] offset:33792
Maav 128,144,96
Maav 132,144,84
Maav 132,144,100
ds_write_b128 v9, a[104:107] offset:34816
Mvav 144,148,80
Mvav 144,152,96
ds_write_b128 v9, a[108:111] offset:35840
Mvav 148,148,84
Mvav 148,152,100
v_accvgpr_read_b32 v114, a128
s_nop 0
v_accvgpr_read_b32 v115, a132
Mvav 152,156,80
ds_write_b128 v9, a[112:115] offset:36864
Mvav 152,160,96
Mvav 156,156,84
ds_write_b128 v9, a[116:119] offset:37888
Mvav 156,160,100
Mvav 160,164,80
Mvav 160,168,96
ds_write_b128 v9, a[120:123] offset:38912
Mvav 164,164,84
Mvav 164,168,100
ds_write_b128 v9, a[124:127] offset:39936
Mvav 168,172,80
Mvav 168,176,96
Mvav 172,172,84
Mvav 172,176,100
s_waitcnt vmcnt(1) lgkmcnt(0)
s_barrier
Mvav 176,180,80
ds_read_b64 v[112:113], v10 offset:15360
Mvav 176,184,96
Lv 16,10,24576
Mvav 180,180,84
Lv 20,10,25600
Mvav 180,184,100
Lv 24,10,26624
Mvav 184,188,80
Lv 28,10,27648
Mvav 184,192,96
s_waitcnt lgkmcnt(4)
Lv 32,10,28672
v_add_f32 v112, v112, v114
Mvav 188,188,84
Lv 36,10,29696
v_add_f32 v113, v113, v115
Mvav 188,192,100
Lv 40,10,30720
Mvav 192,196,80
Lv 44,10,31744
Mvav 192,200,96
Lv 48,10,32768
Mvav 196,196,84
Lv 52,10,33792
Mvav 196,200,100
Lv 56,10,34816
Mvav 200,204,80
Lv 60,10,35840
Mvav 200,208,96
Lv 64,10,36864
Mvav 204,204,84
Lv 68,10,37888
Mvav 204,208,100
Lv 72,10,38912
Lv 76,10,39936
v_rcp_f32 v116, v112
v_rcp_f32 v118, v113
v_min_f32 v122, v112, v113
v_max_f32 v123, v112, v113
v_mul_f32 v116, v116, v13
v_mul_f32 v118, v118, v14
v_mov_b32 v117, v116
v_mov_b32 v119, v118
Ta 32,232,0
Ta 34,232,2048
Ta 36,232,4096
Ta 38,232,6144
La 0,244,8192
La 4,244,10240
v_cmp_gt_f32 vcc, 0x2b800000, v122
s_nop 0
s_or_b32 s49, s49, vcc_lo
s_or_b32 s49, s49, vcc_hi
v_cmp_lt_f32 vcc, 0x5f800000, v123
s_nop 0
s_or_b32 s49, s49, vcc_lo
s_or_b32 s49, s49, vcc_hi
s_waitcnt lgkmcnt(15)
s_add_u32 m0, s38, 0x4000
s_add_u32 s36, s58, 0x40000
buffer_load_dwordx4 v1, s[16:19], s36 offen sc1 lds
buffer_load_dwordx4 v1, s[16:19], s36 offen offset:1024 sc1 lds
v_pk_add_f32 v[144:145], v[144:145], v[16:17]
v_pk_add_f32 v[146:147], v[146:147], v[18:19]
v_pk_add_f32 v[148:149], v[148:149], v[20:21]
v_pk_add_f32 v[150:151], v[150:151], v[22:23]
v_pk_mul_f32 v[144:145], v[144:145], v[116:117]
v_pk_mul_f32 v[146:147], v[146:147], v[116:117]
v_pk_mul_f32 v[148:149], v[148:149], v[118:119]
v_pk_mul_f32 v[150:151], v[150:151], v[118:119]
v_pk_fma_f32 v[112:113], v[144:145], v[146:147], v[112:113]
v_pk_fma_f32 v[112:113], v[148:149], v[150:151], v[112:113]
s_waitcnt lgkmcnt(15)
buffer_load_dwordx4 v253, s[16:19], s36 offen offset:2048 sc1 lds
buffer_load_dwordx4 v253, s[16:19], s36 offen offset:3072 sc1 lds
v_pk_add_f32 v[152:153], v[152:153], v[24:25]
v_pk_add_f32 v[154:155], v[154:155], v[26:27]
v_pk_add_f32 v[156:157], v[156:157], v[28:29]
v_pk_add_f32 v[158:159], v[158:159], v[30:31]
v_pk_mul_f32 v[152:153], v[152:153], v[116:117]
v_pk_mul_f32 v[154:155], v[154:155], v[116:117]
v_pk_mul_f32 v[156:157], v[156:157], v[118:119]
v_pk_mul_f32 v[158:159], v[158:159], v[118:119]
v_pk_fma_f32 v[112:113], v[152:153], v[154:155], v[112:113]
v_pk_fma_f32 v[112:113], v[156:157], v[158:159], v[112:113]
s_waitcnt lgkmcnt(15)
s_add_u32 m0, s38, 0x5000
s_add_u32 s36, s60, 0x12000
buffer_load_dwordx4 v248, s[4:7], s36 offen lds
buffer_load_dwordx4 v249, s[4:7], s36 offen offset:1024 lds
v_pk_add_f32 v[160:161], v[160:161], v[32:33]
v_pk_add_f32 v[162:163], v[162:163], v[34:35]
v_pk_add_f32 v[164:165], v[164:165], v[36:37]
v_pk_add_f32 v[166:167], v[166:167], v[38:39]
v_pk_mul_f32 v[160:161], v[160:161], v[116:117]
v_pk_mul_f32 v[162:163], v[162:163], v[116:117]
v_pk_mul_f32 v[164:165], v[164:165], v[118:119]
v_pk_mul_f32 v[166:167], v[166:167], v[118:119]
v_pk_fma_f32 v[112:113], v[160:161], v[162:163], v[112:113]
v_pk_fma_f32 v[112:113], v[164:165], v[166:167], v[112:113]
s_waitcnt lgkmcnt(14)
Ta 40,233,0
Ta 42,233,2048
Ta 44,233,4096
Ta 46,233,6144
Ta 48,234,0
Ta 50,234,2048
Ta 52,234,4096
Ta 54,234,6144
La 8,244,9216
La 12,244,11264
buffer_load_dwordx4 v250, s[4:7], s36 offen offset:2048 lds
buffer_load_dwordx4 v251, s[4:7], s36 offen offset:3072 lds
v_pk_add_f32 v[168:169], v[168:169], v[40:41]
v_pk_add_f32 v[170:171], v[170:171], v[42:43]
v_pk_add_f32 v[172:173], v[172:173], v[44:45]
v_pk_add_f32 v[174:175], v[174:175], v[46:47]
v_pk_mul_f32 v[168:169], v[168:169], v[116:117]
v_pk_mul_f32 v[170:171], v[170:171], v[116:117]
v_pk_mul_f32 v[172:173], v[172:173], v[118:119]
v_pk_mul_f32 v[174:175], v[174:175], v[118:119]
v_pk_fma_f32 v[112:113], v[168:169], v[170:171], v[112:113]
v_pk_fma_f32 v[112:113], v[172:173], v[174:175], v[112:113]
s_waitcnt lgkmcnt(15)
s_add_u32 m0, s38, 0x8000
s_add_u32 s36, s60, 0x1b000
buffer_load_dwordx4 v248, s[4:7], s36 offen lds
buffer_load_dwordx4 v249, s[4:7], s36 offen offset:1024 lds
v_pk_add_f32 v[176:177], v[176:177], v[48:49]
v_pk_add_f32 v[178:179], v[178:179], v[50:51]
v_pk_add_f32 v[180:181], v[180:181], v[52:53]
v_pk_add_f32 v[182:183], v[182:183], v[54:55]
v_pk_mul_f32 v[176:177], v[176:177], v[116:117]
v_pk_mul_f32 v[178:179], v[178:179], v[116:117]
v_pk_mul_f32 v[180:181], v[180:181], v[118:119]
v_pk_mul_f32 v[182:183], v[182:183], v[118:119]
v_pk_fma_f32 v[112:113], v[176:177], v[178:179], v[112:113]
v_pk_fma_f32 v[112:113], v[180:181], v[182:183], v[112:113]
s_waitcnt lgkmcnt(15)
buffer_load_dwordx4 v250, s[4:7], s36 offen offset:2048 lds
buffer_load_dwordx4 v251, s[4:7], s36 offen offset:3072 lds
v_pk_add_f32 v[184:185], v[184:185], v[56:57]
v_pk_add_f32 v[186:187], v[186:187], v[58:59]
v_pk_add_f32 v[188:189], v[188:189], v[60:61]
v_pk_add_f32 v[190:191], v[190:191], v[62:63]
v_pk_mul_f32 v[184:185], v[184:185], v[116:117]
v_pk_mul_f32 v[186:187], v[186:187], v[116:117]
v_pk_mul_f32 v[188:189], v[188:189], v[118:119]
v_pk_mul_f32 v[190:191], v[190:191], v[118:119]
v_pk_fma_f32 v[112:113], v[184:185], v[186:187], v[112:113]
v_pk_fma_f32 v[112:113], v[188:189], v[190:191], v[112:113]
s_waitcnt lgkmcnt(15)
v_pk_add_f32 v[192:193], v[192:193], v[64:65]
v_pk_add_f32 v[194:195], v[194:195], v[66:67]
v_pk_add_f32 v[196:197], v[196:197], v[68:69]
v_pk_add_f32 v[198:199], v[198:199], v[70:71]
v_pk_mul_f32 v[192:193], v[192:193], v[116:117]
v_pk_mul_f32 v[194:195], v[194:195], v[116:117]
v_pk_mul_f32 v[196:197], v[196:197], v[118:119]
v_pk_mul_f32 v[198:199], v[198:199], v[118:119]
v_pk_fma_f32 v[112:113], v[192:193], v[194:195], v[112:113]
v_pk_fma_f32 v[112:113], v[196:197], v[198:199], v[112:113]
s_waitcnt lgkmcnt(15)
v_pk_add_f32 v[200:201], v[200:201], v[72:73]
v_pk_add_f32 v[202:203], v[202:203], v[74:75]
v_pk_add_f32 v[204:205], v[204:205], v[76:77]
v_pk_add_f32 v[206:207], v[206:207], v[78:79]
v_pk_mul_f32 v[200:201], v[200:201], v[116:117]
v_pk_mul_f32 v[202:203], v[202:203], v[116:117]
v_pk_mul_f32 v[204:205], v[204:205], v[118:119]
v_pk_mul_f32 v[206:207], v[206:207], v[118:119]
v_pk_fma_f32 v[112:113], v[200:201], v[202:203], v[112:113]
v_pk_fma_f32 v[112:113], v[204:205], v[206:207], v[112:113]
v_add_f32 v112, v112, v113
s_movk_i32 s37, 0x207
v_cmp_class_f32 vcc, v112, s37
s_nop 0
s_or_b32 s49, s49, vcc_lo
s_or_b32 s49, s49, vcc_hi
s_bitcmp1_b32 s2, 0
s_cbranch_scc0 M_C0
s_branch M_C1
M_C1:
s_waitcnt vmcnt(44) lgkmcnt(2)
s_add_u32 s73, s45, 0x3000000
PK 144,144,145
Zvaa 16,32,0
s_lshl_b32 s84, s24, 4
La 16,245,8192
PK 145,146,147
Mvaa 16,36,4
s_add_u32 m0, s38, 0x9000
s_add_u32 s36, s58, 0x80000
La 20,245,10240
Zvaa 32,40,0
buffer_load_dwordx4 v1, s[16:19], s36 offen sc1 lds
Mvaa 32,44,4
Ta 56,235,0
PK 146,152,153
Zvaa 48,48,0
Ta 58,235,2048
PK 147,154,155
Mvaa 48,52,4
s_waitcnt vmcnt(56) lgkmcnt(4)
buffer_store_dwordx4 v[144:147], v1, s[16:19], s73 offen sc0 sc1
Ta 60,235,4096
Ta 62,235,6144
Zvaa 20,32,8
Ta 64,236,0
v_mov_b32 v12, s84
Mvaa 20,36,12
s_add_u32 s73, s46, 0x3000000
La 24,245,9216
PK 148,148,149
Zvaa 36,40,8
buffer_load_dwordx4 v1, s[16:19], s36 offen offset:1024 sc1 lds
Mvaa 36,44,12
Ta 66,236,2048
PK 149,150,151
Zvaa 52,48,8
La 28,245,11264
PK 150,156,157
Mvaa 52,52,12
s_waitcnt vmcnt(56) lgkmcnt(8)
buffer_load_dwordx4 v253, s[16:19], s36 offen offset:2048 sc1 lds
Zvaa 24,32,16
Ta 68,236,4096
PK 151,158,159
Mvaa 24,36,20
Ta 70,236,6144
v_mov_b32 v10, s49
Zvaa 40,40,16
Ta 72,237,0
Mvaa 40,44,20
Ta 74,237,2048
Zvaa 56,48,16
Ta 76,237,4096
Mvaa 56,52,20
s_waitcnt vmcnt(55) lgkmcnt(5)
Ta 78,237,6144
Zvaa 28,32,24
buffer_store_dwordx4 v[148:151], v1, s[16:19], s73 offen sc0 sc1
s_add_u32 s73, s45, 0x3020000
PK 160,160,161
PK 161,162,163
Mvaa 28,36,28
Ta 80,238,0
PK 162,168,169
Zvaa 44,40,24
Ta 82,238,2048
PK 163,170,171
Mvaa 44,44,28
buffer_load_dwordx4 v253, s[16:19], s36 offen offset:3072 sc1 lds
Zvaa 60,48,24
s_add_u32 m0, s38, 0x3800
s_add_u32 s36, s61, 0x24000
Ta 84,238,4096
Mvaa 60,52,28
s_waitcnt vmcnt(48) lgkmcnt(3)
Ta 86,238,6144
Zvaa 64,56,0
buffer_load_dwordx4 v252, s[4:7], s36 offen lds
Mvaa 64,60,4
Ta 88,239,0
Zvaa 80,64,0
s_add_u32 m0, s38, 0x6000
s_add_u32 s36, s60, 0x24000
Ta 90,239,2048
Mvaa 80,68,4
buffer_store_dwordx4 v[160:163], v1, s[16:19], s73 offen sc0 sc1
Ta 92,239,4096
Ta 94,239,6144
Zvaa 96,72,0
s_add_u32 s73, s46, 0x3020000
Ta 96,240,12288
PK 164,164,165
Mvaa 96,76,4
Ta 98,241,12288
PK 165,166,167
Zvaa 68,56,8
buffer_load_dwordx4 v248, s[4:7], s36 offen lds
Mvaa 68,60,12
ds_write_b32 v12, v10 offset:15368
Zvaa 84,64,8
Ta 100,242,12288
PK 166,172,173
Mvaa 84,68,12
buffer_load_dwordx4 v249, s[4:7], s36 offen offset:1024 lds
Zvaa 100,72,8
Ta 102,243,12288
PK 167,174,175
Mvaa 100,76,12
v_and_b32 v12, 48, v1
Zvaa 72,56,16
buffer_store_dwordx4 v[164:167], v1, s[16:19], s73 offen sc0 sc1
s_add_u32 s73, s45, 0x3040000
PK 176,176,177
PK 177,178,179
Mvaa 72,60,20
PK 178,184,185
PK 179,186,187
Zvaa 88,64,16
Mvaa 88,68,20
buffer_load_dwordx4 v250, s[4:7], s36 offen offset:2048 lds
Zvaa 104,72,16
Mvaa 104,76,20
Zvaa 76,56,24
buffer_store_dwordx4 v[176:179], v1, s[16:19], s73 offen sc0 sc1
s_add_u32 s73, s46, 0x3040000
PK 180,180,181
PK 181,182,183
Mvaa 76,60,28
s_waitcnt vmcnt(13) lgkmcnt(0)
s_barrier
Zvaa 92,64,24
ds_read_b32 v10, v12 offset:15368
PK 182,188,189
Mvaa 92,68,28
buffer_load_dwordx4 v251, s[4:7], s36 offen offset:3072 lds
Zvaa 108,72,24
s_add_u32 m0, s38, 0x7000
s_add_u32 s36, s60, 0x2d000
Ta 32,232,20480
Mvaa 108,76,28
s_waitcnt lgkmcnt(2)
Ta 34,232,22528
PK 183,190,191
Zvaa 112,80,0
buffer_store_dwordx4 v[180:183], v1, s[16:19], s73 offen sc0 sc1
Ta 36,232,32768
Ta 38,232,34816
Mvaa 112,84,4
s_add_u32 s73, s45, 0x3060000
Ta 40,233,20480
PK 192,192,193
Zvaa 128,88,0
Ta 42,233,22528
PK 193,194,195
Mvaa 128,92,4
buffer_load_dwordx4 v248, s[4:7], s36 offen lds
Zvaa 216,96,0
Ta 44,233,32768
PK 194,200,201
Mvaa 216,100,4
s_waitcnt lgkmcnt(7)
v_cmp_lt_u32 vcc, s50, v10
s_nop 0
s_cbranch_vccnz M_redo
Zvaa 116,80,8
buffer_load_dwordx4 v249, s[4:7], s36 offen offset:1024 lds
Mvaa 116,84,12
Ta 46,233,34816
PK 195,202,203
Zvaa 132,88,8
Ta 48,234,20480
Mvaa 132,92,12
buffer_store_dwordx4 v[192:195], v1, s[16:19], s73 offen sc0 sc1
Ta 50,234,22528
Ta 52,234,32768
Zvaa 220,96,8
s_add_u32 s73, s46, 0x3060000
La 224,244,16384
PK 196,196,197
Mvaa 220,100,12
Ta 54,234,34816
PK 197,198,199
Zvaa 120,80,16
buffer_load_dwordx4 v250, s[4:7], s36 offen offset:2048 lds
Mvaa 120,84,20
La 228,244,18432
PK 198,204,205
Zvaa 136,88,16
La 232,244,17408
PK 199,206,207
Mvaa 136,92,20
buffer_load_dwordx4 v251, s[4:7], s36 offen offset:3072 lds
Zvaa 224,96,16
La 236,244,19456
Mvaa 224,100,20
La 240,245,16384
Zvaa 124,80,24
buffer_store_dwordx4 v[196:199], v1, s[16:19], s73 offen sc0 sc1
s_add_u32 m0, s38, 0
s_add_u32 s36, s58, 0xc0000
La 244,245,18432
Mvaa 124,84,28
Ta 56,235,20480
Zvaa 140,88,24
Ta 58,235,22528
Mvaa 140,92,28
buffer_load_dwordx4 v1, s[16:19], s36 offen sc1 lds
Zvaa 228,96,24
Ta 60,235,32768
Mvaa 228,100,28
s_waitcnt vmcnt(63) lgkmcnt(7)
Ta 62,235,34816
Mvaa 16,32,224
buffer_load_dwordx4 v1, s[16:19], s36 offen offset:1024 sc1 lds
Mvaa 16,36,228
Ta 64,236,20480
Mvaa 32,40,224
La 248,245,17408
Mvaa 32,44,228
Ta 66,236,22528
v_and_b32 v215, 15, v15
Mvaa 48,48,224
buffer_load_dwordx4 v253, s[16:19], s36 offen offset:2048 sc1 lds
Mvaa 48,52,228
s_waitcnt lgkmcnt(9)
La 252,245,19456
v_lshlrev_b32 v214, 7, v215
Mvaa 20,32,232
s_movk_i32 s37, 0x480
Ta 68,236,32768
v_mul_u32_u24 v215, s37, v215
Mvaa 20,36,236
Ta 70,236,34816
v_lshrrev_b32 v8, 4, v15
Mvaa 36,40,232
Ta 72,237,20480
v_lshlrev_b32 v8, 3, v8
Mvaa 36,44,236
buffer_load_dwordx4 v253, s[16:19], s36 offen offset:3072 sc1 lds
Mvaa 52,48,232
Ta 74,237,22528
v_add_u32 v8, v8, v215
Mvaa 52,52,236
s_waitcnt lgkmcnt(12)
Ta 76,237,32768
v_and_b32 v7, 31, v15
Mvaa 24,32,240
Ta 78,237,34816
v_mul_u32_u24 v7, s37, v7
Mvaa 24,36,244
Ta 80,238,20480
v_and_b32 v215, 32, v15
Mvaa 40,40,240
s_add_u32 m0, s38, 0x3000
s_add_u32 s36, s61, 0x36000
Ta 82,238,22528
Mvaa 40,44,244
buffer_load_dwordx4 v252, s[4:7], s36 offen lds
Mvaa 56,48,240
Ta 84,238,32768
v_lshrrev_b32 v215, 1, v215
Mvaa 56,52,244
s_waitcnt lgkmcnt(9)
Ta 86,238,34816
v_add_u32 v7, v7, v215
Mvaa 28,32,248
Ta 88,239,20480
v_mov_b32 v0, 1
Mvaa 28,36,252
s_add_u32 m0, s38, 0x1000
s_add_u32 s36, s60, 0x36000
Ta 90,239,22528
Mvaa 44,40,248
buffer_load_dwordx4 v248, s[4:7], s36 offen lds
Mvaa 44,44,252
Ta 92,239,32768
v_mov_b32 v215, 0x10000000
Mvaa 60,48,248
Ta 94,239,34816
v_writelane_b32 v215, s78, 0
Mvaa 60,52,252
s_waitcnt vmcnt(63) lgkmcnt(8)
Ta 96,240,13312
v_writelane_b32 v215, s79, 1
Mvaa 64,56,224
buffer_load_dwordx4 v249, s[4:7], s36 offen offset:1024 lds
Mvaa 64,60,228
Ta 98,241,13312
Mvaa 80,64,224
Ta 100,242,13312
Mvaa 80,68,228
Ta 102,243,13312
Mvaa 96,72,224
Mvaa 96,76,228
buffer_load_dwordx4 v250, s[4:7], s36 offen offset:2048 lds
Mvaa 68,56,232
Mvaa 68,60,236
Mvaa 84,64,232
Mvaa 84,68,236
Mvaa 100,72,232
buffer_load_dwordx4 v251, s[4:7], s36 offen offset:3072 lds
Mvaa 100,76,236
Mvaa 72,56,240
Mvaa 72,60,244
Mvaa 88,64,240
Mvaa 88,68,244
s_add_u32 m0, s38, 0x2000
s_add_u32 s36, s60, 0x3f000
Mvaa 104,72,240
buffer_load_dwordx4 v248, s[4:7], s36 offen lds
Mvaa 104,76,244
Mvaa 76,56,248
Mvaa 76,60,252
s_waitcnt vmcnt(11) lgkmcnt(0)
s_barrier
Mvaa 92,64,248
buffer_load_dwordx4 v249, s[4:7], s36 offen offset:1024 lds
Mvaa 92,68,252
Ta 32,232,24576
Mvaa 108,72,248
Ta 34,232,26624
Mvaa 108,76,252
s_waitcnt lgkmcnt(2)
Ta 36,232,28672
Mvaa 112,80,224
Ta 38,232,30720
Mvaa 112,84,228
buffer_load_dwordx4 v250, s[4:7], s36 offen offset:2048 lds
Mvaa 128,88,224
Ta 40,233,24576
Mvaa 128,92,228
Ta 42,233,26624
Mvaa 216,96,224
Ta 44,233,28672
Mvaa 216,100,228
Ta 46,233,30720
Mvaa 116,80,232
buffer_load_dwordx4 v251, s[4:7], s36 offen offset:3072 lds
Mvaa 116,84,236
Ta 48,234,24576
Mvaa 132,88,232
Ta 50,234,26624
Mvaa 132,92,236
Ta 52,234,28672
Mvaa 220,96,232
La 0,244,36864
Mvaa 220,100,236
s_add_u32 m0, s38, 0x4000
s_add_u32 s36, s58, 0x100000
Ta 54,234,30720
Mvaa 120,80,240
buffer_load_dwordx4 v1, s[16:19], s36 offen sc1 lds
Mvaa 120,84,244
La 4,244,38912
Mvaa 136,88,240
La 8,244,37888
Mvaa 136,92,244
La 12,244,39936
Mvaa 224,96,240
buffer_load_dwordx4 v1, s[16:19], s36 offen offset:1024 sc1 lds
Mvaa 224,100,244
La 16,245,36864
Mvaa 124,80,248
La 20,245,38912
Mvaa 124,84,252
Ta 56,235,24576
Mvaa 140,88,248
Ta 58,235,26624
Mvaa 140,92,252
buffer_load_dwordx4 v253, s[16:19], s36 offen offset:2048 sc1 lds
Mvaa 228,96,248
Ta 60,235,28672
Mvaa 228,100,252
s_waitcnt vmcnt(63) lgkmcnt(7)
Ta 62,235,30720
Mvaa 16,32,0
Ta 64,236,24576
Mvaa 16,36,4
La 24,245,37888
Mvaa 32,40,0
buffer_load_dwordx4 v253, s[16:19], s36 offen offset:3072 sc1 lds
Mvaa 32,44,4
Ta 66,236,26624
Mvaa 48,48,0
La 28,245,39936
Mvaa 48,52,4
s_waitcnt vmcnt(63) lgkmcnt(10)
Ta 68,236,28672
Mvaa 20,32,8
Ta 70,236,30720
Mvaa 20,36,12
s_add_u32 m0, s38, 0x3400
s_add_u32 s36, s61, 0x48000
Ta 72,237,24576
Mvaa 36,40,8
buffer_load_dwordx4 v252, s[4:7], s36 offen lds
Mvaa 36,44,12
Ta 74,237,26624
Mvaa 52,48,8
Ta 76,237,28672
Mvaa 52,52,12
s_waitcnt vmcnt(63) lgkmcnt(13)
Ta 78,237,30720
Mvaa 24,32,16
s_add_u32 m0, s38, 0x5000
s_add_u32 s36, s60, 0x48000
Ta 80,238,24576
Mvaa 24,36,20
buffer_load_dwordx4 v248, s[4:7], s36 offen lds
Mvaa 40,40,16
Ta 82,238,26624
Mvaa 40,44,20
Ta 84,238,28672
Mvaa 56,48,16
Ta 86,238,30720
Mvaa 56,52,20
s_waitcnt vmcnt(63) lgkmcnt(10)
buffer_load_dwordx4 v249, s[4:7], s36 offen offset:1024 lds
Mvaa 28,32,24
Ta 88,239,24576
Mvaa 28,36,28
Ta 90,239,26624
Mvaa 44,40,24
Ta 92,239,28672
Mvaa 44,44,28
Ta 94,239,30720
Mvaa 60,48,24
buffer_load_dwordx4 v250, s[4:7], s36 offen offset:2048 lds
Mvaa 60,52,28
s_waitcnt vmcnt(63) lgkmcnt(8)
Ta 96,240,14336
Mvaa 64,56,0
Ta 98,241,14336
Mvaa 64,60,4
Ta 100,242,14336
Mvaa 80,64,0
Ta 102,243,14336
Mvaa 80,68,4
buffer_load_dwordx4 v251, s[4:7], s36 offen offset:3072 lds
Mvaa 96,72,0
Mvaa 96,76,4
Mvaa 68,56,8
Mvaa 68,60,12
Mvaa 84,64,8
s_add_u32 m0, s38, 0x8000
s_add_u32 s36, s60, 0x51000
Mvaa 84,68,12
buffer_load_dwordx4 v248, s[4:7], s36 offen lds
Mvaa 100,72,8
Mvaa 100,76,12
Mvaa 72,56,16
Mvaa 72,60,20
buffer_load_dwordx4 v249, s[4:7], s36 offen offset:1024 lds
Mvaa 88,64,16
Mvaa 88,68,20
Mvaa 104,72,16
Mvaa 104,76,20
Mvaa 76,56,24
buffer_load_dwordx4 v250, s[4:7], s36 offen offset:2048 lds
Mvaa 76,60,28
s_waitcnt vmcnt(12) lgkmcnt(0)
s_barrier
Mvaa 92,64,24
Ta 32,232,4096
Mvaa 92,68,28
Ta 34,232,6144
Mvaa 108,72,24
Ta 36,232,8192
Mvaa 108,76,28
s_waitcnt lgkmcnt(3)
buffer_load_dwordx4 v251, s[4:7], s36 offen offset:3072 lds
Mvaa 112,80,0
Ta 38,232,10240
Mvaa 112,84,4
Ta 40,233,4096
Mvaa 128,88,0
Ta 42,233,6144
Mvaa 128,92,4
Ta 44,233,8192
Mvaa 216,96,0
s_add_u32 m0, s38, 0x6000
s_add_u32 s36, s58, 0x140000
Ta 46,233,10240
Mvaa 216,100,4
buffer_load_dwordx4 v1, s[16:19], s36 offen sc1 lds
Mvaa 116,80,8
Ta 48,234,4096
Mvaa 116,84,12
Ta 50,234,6144
Mvaa 132,88,8
Ta 52,234,8192
Mvaa 132,92,12
buffer_load_dwordx4 v1, s[16:19], s36 offen offset:1024 sc1 lds
Mvaa 220,96,8
La 224,244,0
Mvaa 220,100,12
Ta 54,234,10240
Mvaa 120,80,16
La 228,244,2048
Mvaa 120,84,20
La 232,244,1024
Mvaa 136,88,16
buffer_load_dwordx4 v253, s[16:19], s36 offen offset:2048 sc1 lds
Mvaa 136,92,20
La 236,244,3072
Mvaa 224,96,16
La 240,245,0
Mvaa 224,100,20
La 244,245,2048
Mvaa 124,80,24
Ta 56,235,4096
Mvaa 124,84,28
buffer_load_dwordx4 v253, s[16:19], s36 offen offset:3072 sc1 lds
Mvaa 140,88,24
Ta 58,235,6144
Mvaa 140,92,28
Ta 60,235,8192
Mvaa 228,96,24
Ta 62,235,10240
Mvaa 228,100,28
s_waitcnt vmcnt(63) lgkmcnt(8)
Ta 64,236,4096
Mvaa 16,32,224
s_add_u32 m0, s38, 0x3800
s_add_u32 s36, s61, 0x5a000
La 248,245,1024
Mvaa 16,36,228
buffer_load_dwordx4 v252, s[4:7], s36 offen lds
Mvaa 32,40,224
Ta 66,236,6144
Mvaa 32,44,228
La 252,245,3072
Mvaa 48,48,224
Ta 68,236,8192
Mvaa 48,52,228
s_waitcnt lgkmcnt(11)
s_add_u32 m0, s38, 0x7000
s_add_u32 s36, s60, 0x5a000
Mvaa 20,32,232
buffer_load_dwordx4 v248, s[4:7], s36 offen lds
Mvaa 20,36,236
Ta 70,236,10240
Mvaa 36,40,232
Ta 72,237,4096
Mvaa 36,44,236
Ta 74,237,6144
Mvaa 52,48,232
buffer_load_dwordx4 v249, s[4:7], s36 offen offset:1024 lds
Mvaa 52,52,236
s_waitcnt lgkmcnt(12)
Ta 76,237,8192
Mvaa 24,32,240
Ta 78,237,10240
Mvaa 24,36,244
Ta 80,238,4096
Mvaa 40,40,240
Ta 82,238,6144
Mvaa 40,44,244
buffer_load_dwordx4 v250, s[4:7], s36 offen offset:2048 lds
Mvaa 56,48,240
Ta 84,238,8192
Mvaa 56,52,244
s_waitcnt lgkmcnt(9)
Ta 86,238,10240
Mvaa 28,32,248
Ta 88,239,4096
Mvaa 28,36,252
Ta 90,239,6144
Mvaa 44,40,248
buffer_load_dwordx4 v251, s[4:7], s36 offen offset:3072 lds
Mvaa 44,44,252
Ta 92,239,8192
Mvaa 60,48,248
Ta 94,239,10240
Mvaa 60,52,252
s_waitcnt vmcnt(63) lgkmcnt(8)
Ta 96,240,12288
Mvaa 64,56,224
Ta 98,241,12288
Mvaa 64,60,228
s_add_u32 m0, s38, 0x9000
s_add_u32 s36, s60, 0x63000
Ta 100,242,12288
Mvaa 80,64,224
buffer_load_dwordx4 v248, s[4:7], s36 offen lds
Mvaa 80,68,228
Ta 102,243,12288
Mvaa 96,72,224
Mvaa 96,76,228
Mvaa 68,56,232
buffer_load_dwordx4 v249, s[4:7], s36 offen offset:1024 lds
Mvaa 68,60,236
Mvaa 84,64,232
Mvaa 84,68,236
Mvaa 100,72,232
Mvaa 100,76,236
buffer_load_dwordx4 v250, s[4:7], s36 offen offset:2048 lds
Mvaa 72,56,240
Mvaa 72,60,244
Mvaa 88,64,240
Mvaa 88,68,244
Mvaa 104,72,240
buffer_load_dwordx4 v251, s[4:7], s36 offen offset:3072 lds
Mvaa 104,76,244
Mvaa 76,56,248
Mvaa 76,60,252
s_waitcnt vmcnt(13) lgkmcnt(0)
s_barrier
Mvaa 92,64,248
buffer_store_dword v0, v215, s[16:19], 0 offen sc0 sc1
Mvaa 92,68,252
s_add_u32 m0, s38, 0
s_add_u32 s36, s58, 0x180000
Ta 32,232,20480
Mvaa 108,72,248
Ta 34,232,22528
Mvaa 108,76,252
s_waitcnt lgkmcnt(2)
buffer_load_dwordx4 v1, s[16:19], s36 offen sc1 lds
Mvaa 112,80,224
Ta 36,232,32768
Mvaa 112,84,228
Ta 38,232,34816
Mvaa 128,88,224
buffer_load_dwordx4 v1, s[16:19], s36 offen offset:1024 sc1 lds
Mvaa 128,92,228
Ta 40,233,20480
v_and_b32 v214, 0x180, v214
Mvaa 216,96,224
Ta 42,233,22528
v_mov_b32 v215, 0x10000000
Mvaa 216,100,228
Ta 44,233,32768
v_writelane_b32 v215, s77, 0
Mvaa 116,80,232
s_and_b32 s37, s2, 1
s_lshl_b32 s37, s37, 3
Ta 46,233,34816
Mvaa 116,84,236
buffer_load_dwordx4 v253, s[16:19], s36 offen offset:2048 sc1 lds
Mvaa 132,88,232
Ta 48,234,20480
v_add_u32 v3, s37, v245
Mvaa 132,92,236
Ta 50,234,22528
v_add_u32 v4, s37, v244
Mvaa 220,96,232
Ta 52,234,32768
v_xor_b32 v246, 8, v4
Mvaa 220,100,236
La 0,244,16384
v_xor_b32 v247, 8, v3
Mvaa 120,80,240
buffer_load_dwordx4 v253, s[16:19], s36 offen offset:3072 sc1 lds
Mvaa 120,84,244
Ta 54,234,34816
Mvaa 136,88,240
La 4,244,18432
Mvaa 136,92,244
La 8,244,17408
Mvaa 224,96,240
La 12,244,19456
Mvaa 224,100,244
s_add_u32 m0, s38, 0x3000
s_add_u32 s36, s61, 0x6c000
La 16,245,16384
Mvaa 124,80,248
buffer_load_dwordx4 v252, s[4:7], s36 offen lds
Mvaa 124,84,252
La 20,245,18432
Mvaa 140,88,248
Ta 56,235,20480
Mvaa 140,92,252
Ta 58,235,22528
Mvaa 228,96,248
s_add_u32 m0, s38, 0x1000
s_add_u32 s36, s60, 0x6c000
Ta 60,235,32768
Mvaa 228,100,252
s_waitcnt vmcnt(63) lgkmcnt(7)
buffer_load_dwordx4 v248, s[4:7], s36 offen lds
Mvaa 16,32,0
Ta 62,235,34816
Mvaa 16,36,4
Ta 64,236,20480
Mvaa 32,40,0
La 24,245,17408
Mvaa 32,44,4
buffer_load_dwordx4 v249, s[4:7], s36 offen offset:1024 lds
Mvaa 48,48,0
Ta 66,236,22528
Mvaa 48,52,4
s_waitcnt vmcnt(63) lgkmcnt(9)
La 28,245,19456
Mvaa 20,32,8
Ta 68,236,32768
Mvaa 20,36,12
Ta 70,236,34816
Mvaa 36,40,8
buffer_load_dwordx4 v250, s[4:7], s36 offen offset:2048 lds
Mvaa 36,44,12
Ta 72,237,20480
Mvaa 52,48,8
Ta 74,237,22528
Mvaa 52,52,12
s_waitcnt vmcnt(63) lgkmcnt(12)
Ta 76,237,32768
Mvaa 24,32,16
Ta 78,237,34816
Mvaa 24,36,20
buffer_load_dwordx4 v251, s[4:7], s36 offen offset:3072 lds
Mvaa 40,40,16
Ta 80,238,20480
Mvaa 40,44,20
Ta 82,238,22528
Mvaa 56,48,16
Ta 84,238,32768
Mvaa 56,52,20
s_waitcnt vmcnt(63) lgkmcnt(9)
Ta 86,238,34816
Mvaa 28,32,24
s_add_u32 m0, s38, 0x2000
s_add_u32 s36, s60, 0x75000
Ta 88,239,20480
Mvaa 28,36,28
buffer_load_dwordx4 v248, s[4:7], s36 offen lds
Mvaa 44,40,24
Ta 90,239,22528
Mvaa 44,44,28
Ta 92,239,32768
Mvaa 60,48,24
Ta 94,239,34816
Mvaa 60,52,28
s_waitcnt vmcnt(63) lgkmcnt(8)
buffer_load_dwordx4 v249, s[4:7], s36 offen offset:1024 lds
Mvaa 64,56,0
Ta 96,240,13312
Mvaa 64,60,4
Ta 98,241,13312
Mvaa 80,64,0
Ta 100,242,13312
Mvaa 80,68,4
Ta 102,243,13312
Mvaa 96,72,0
buffer_load_dwordx4 v250, s[4:7], s36 offen offset:2048 lds
Mvaa 96,76,4
Mvaa 68,56,8
Mvaa 68,60,12
Mvaa 84,64,8
Mvaa 84,68,12
buffer_load_dwordx4 v251, s[4:7], s36 offen offset:3072 lds
Mvaa 100,72,8
Mvaa 100,76,12
Mvaa 72,56,16
Mvaa 72,60,20
Mvaa 88,64,16
Mvaa 88,68,20
Mvaa 104,72,16
Mvaa 104,76,20
Mvaa 76,56,24
Mvaa 76,60,28
s_waitcnt vmcnt(14) lgkmcnt(0)
s_barrier
Mvaa 92,64,24
Ta 32,232,28672
Mvaa 92,68,28
s_add_u32 m0, s38, 0x4000
s_add_u32 s36, s58, 0x1c0000
Ta 34,232,30720
Mvaa 108,72,24
buffer_load_dwordx4 v1, s[16:19], s36 offen sc1 lds
Mvaa 108,76,28
s_waitcnt lgkmcnt(2)
Ta 36,232,36864
Mvaa 112,80,0
Ta 38,232,38912
Mvaa 112,84,4
Ta 40,233,28672
Mvaa 128,88,0
buffer_load_dwordx4 v1, s[16:19], s36 offen offset:1024 sc1 lds
Mvaa 128,92,4
Ta 42,233,30720
Mvaa 216,96,0
Ta 44,233,36864
Mvaa 216,100,4
Ta 46,233,38912
Mvaa 116,80,8
Ta 48,234,28672
Mvaa 116,84,12
buffer_load_dwordx4 v253, s[16:19], s36 offen offset:2048 sc1 lds
Mvaa 132,88,8
Ta 50,234,30720
Mvaa 132,92,12
Ta 52,234,36864
Mvaa 220,96,8
La 224,244,24576
Mvaa 220,100,12
Ta 54,234,38912
Mvaa 120,80,16
buffer_load_dwordx4 v253, s[16:19], s36 offen offset:3072 sc1 lds
Mvaa 120,84,20
La 228,244,26624
Mvaa 136,88,16
La 232,244,25600
Mvaa 136,92,20
La 236,244,27648
Mvaa 224,96,16
La 240,245,24576
Mvaa 224,100,20
s_add_u32 m0, s38, 0x3400
s_add_u32 s36, s61, 0x7e000
La 244,245,26624
Mvaa 124,80,24
buffer_load_dwordx4 v252, s[4:7], s36 offen lds
Mvaa 124,84,28
Ta 56,235,28672
Mvaa 140,88,24
Ta 58,235,30720
Mvaa 140,92,28
Ta 60,235,36864
Mvaa 228,96,24
s_add_u32 m0, s38, 0x5000
s_add_u32 s36, s60, 0x7e000
Ta 62,235,38912
Mvaa 228,100,28
s_waitcnt vmcnt(63) lgkmcnt(8)
buffer_load_dwordx4 v248, s[4:7], s36 offen lds
Mvaa 16,32,224
Ta 64,236,28672
Mvaa 16,36,228
La 248,245,25600
Mvaa 32,40,224
Ta 66,236,30720
Mvaa 32,44,228
buffer_load_dwordx4 v249, s[4:7], s36 offen offset:1024 lds
Mvaa 48,48,224
La 252,245,27648
Mvaa 48,52,228
s_waitcnt lgkmcnt(10)
Ta 68,236,36864
Mvaa 20,32,232
Ta 70,236,38912
Mvaa 20,36,236
Ta 72,237,28672
Mvaa 36,40,232
buffer_load_dwordx4 v250, s[4:7], s36 offen offset:2048 lds
Mvaa 36,44,236
Ta 74,237,30720
Mvaa 52,48,232
Ta 76,237,36864
Mvaa 52,52,236
s_waitcnt lgkmcnt(13)
Ta 78,237,38912
Mvaa 24,32,240
Ta 80,238,28672
Mvaa 24,36,244
buffer_load_dwordx4 v251, s[4:7], s36 offen offset:3072 lds
Mvaa 40,40,240
Ta 82,238,30720
Mvaa 40,44,244
Ta 84,238,36864
Mvaa 56,48,240
Ta 86,238,38912
Mvaa 56,52,244
s_waitcnt lgkmcnt(10)
Ta 88,239,28672
Mvaa 28,32,248
s_add_u32 m0, s38, 0x8000
s_add_u32 s36, s60, 0x87000
Ta 90,239,30720
Mvaa 28,36,252
buffer_load_dwordx4 v248, s[4:7], s36 offen lds
Mvaa 44,40,248
Ta 92,239,36864
Mvaa 44,44,252
Ta 94,239,38912
Mvaa 60,48,248
buffer_load_dword v213, v214, s[16:19], s70 offen sc1
Mvaa 60,52,252
s_waitcnt vmcnt(63) lgkmcnt(8)
Ta 96,240,14336
Mvaa 64,56,224
Ta 98,241,14336
Mvaa 64,60,228
buffer_load_dwordx4 v249, s[4:7], s36 offen offset:1024 lds
Mvaa 80,64,224
Ta 100,242,14336
Mvaa 80,68,228
Ta 102,243,14336
Mvaa 96,72,224
buffer_load_dwordx4 v250, s[4:7], s36 offen offset:2048 lds
Mvaa 96,76,228
Mvaa 68,56,232
Mvaa 68,60,236
Mvaa 84,64,232
Mvaa 84,68,236
buffer_load_dwordx4 v251, s[4:7], s36 offen offset:3072 lds
Mvaa 100,72,232
Mvaa 100,76,236
Mvaa 72,56,240
Mvaa 72,60,244
Mvaa 88,64,240
Mvaa 88,68,244
Mvaa 104,72,240
Mvaa 104,76,244
Mvaa 76,56,248
Mvaa 76,60,252
s_waitcnt vmcnt(14) lgkmcnt(0)
s_barrier
Mvaa 92,64,248
Ta 32,232,4096
Mvaa 92,68,252
s_add_u32 m0, s38, 0x6000
s_add_u32 s36, s62, 0
Ta 34,232,6144
Mvaa 108,72,248
buffer_load_dwordx4 v248, s[8:11], s36 offen lds
Mvaa 108,76,252
s_waitcnt lgkmcnt(2)
Ta 36,232,8192
Mvaa 112,80,224
Ta 38,232,10240
Mvaa 112,84,228
buffer_load_dwordx4 v249, s[8:11], s36 offen offset:1024 lds
Mvaa 128,88,224
Ta 40,233,4096
Mvaa 128,92,228
Ta 42,233,6144
Mvaa 216,96,224
Ta 44,233,8192
Mvaa 216,100,228
buffer_load_dwordx4 v250, s[8:11], s36 offen offset:2048 lds
Mvaa 116,80,232
Ta 46,233,10240
Mvaa 116,84,236
Ta 48,234,4096
Mvaa 132,88,232
Ta 50,234,6144
Mvaa 132,92,236
buffer_load_dwordx4 v251, s[8:11], s36 offen offset:3072 lds
Mvaa 220,96,232
Ta 52,234,8192
Mvaa 220,100,236
La 0,244,0
Mvaa 120,80,240
Ta 54,234,10240
Mvaa 120,84,244
s_add_u32 m0, s38, 0x3800
s_add_u32 s36, s63, 0
La 4,244,2048
Mvaa 136,88,240
buffer_load_dwordx4 v252, s[8:11], s36 offen lds
Mvaa 136,92,244
La 8,244,1024
Mvaa 224,96,240
La 12,244,3072
Mvaa 224,100,244
s_add_u32 m0, s38, 0x7000
s_add_u32 s36, s62, 0x12000
La 16,245,0
Mvaa 124,80,248
buffer_load_dwordx4 v248, s[8:11], s36 offen lds
Mvaa 124,84,252
La 20,245,2048
Mvaa 140,88,248
Ta 56,235,4096
Mvaa 140,92,252
buffer_load_dwordx4 v249, s[8:11], s36 offen offset:1024 lds
Mvaa 228,96,248
Ta 58,235,6144
Mvaa 228,100,252
s_waitcnt vmcnt(63) lgkmcnt(6)
Ta 60,235,8192
Mvaa 16,32,0
s_waitcnt vmcnt(10)
v_cmp_ne_u32 vcc, 1, v213
s_nop 0
s_cbranch_vccnz M_sB1
M_rB1:
Mvaa 16,36,4
buffer_load_dwordx4 v250, s[8:11], s36 offen offset:2048 lds
Mvaa 32,40,0
Ta 62,235,10240
v_and_b32 v214, 7, v15
Mvaa 32,44,4
Ta 64,236,4096
v_max_u32 v214, 1, v214
Mvaa 48,48,0
La 24,245,1024
v_xor_b32 v214, s2, v214
Mvaa 48,52,4
s_waitcnt vmcnt(63) lgkmcnt(8)
buffer_load_dwordx4 v251, s[8:11], s36 offen offset:3072 lds
Mvaa 20,32,8
Ta 66,236,6144
v_and_b32 v214, 7, v214
Mvaa 20,36,12
La 28,245,3072
v_lshlrev_b32 v214, 8, v214
Mvaa 36,40,8
Ta 68,236,8192
Mvaa 36,44,12
s_add_u32 m0, s38, 0x9000
s_add_u32 s36, s59, 0
Ta 70,236,10240
Mvaa 52,48,8
buffer_load_dwordx4 v1, s[16:19], s36 offen sc1 lds
Mvaa 52,52,12
s_waitcnt vmcnt(63) lgkmcnt(10)
Ta 72,237,4096
Mvaa 24,32,16
Ta 74,237,6144
Mvaa 24,36,20
buffer_load_dwordx4 v1, s[16:19], s36 offen offset:1024 sc1 lds
Mvaa 40,40,16
Ta 76,237,8192
Mvaa 40,44,20
Ta 78,237,10240
Mvaa 56,48,16
Ta 80,238,4096
Mvaa 56,52,20
s_waitcnt vmcnt(63) lgkmcnt(7)
buffer_load_dwordx4 v253, s[16:19], s36 offen offset:2048 sc1 lds
Mvaa 28,32,24
Ta 82,238,6144
Mvaa 28,36,28
Ta 84,238,8192
Mvaa 44,40,24
Ta 86,238,10240
Mvaa 44,44,28
buffer_load_dwordx4 v253, s[16:19], s36 offen offset:3072 sc1 lds
Mvaa 60,48,24
Ta 88,239,4096
Mvaa 60,52,28
s_waitcnt vmcnt(63) lgkmcnt(5)
Ta 90,239,6144
Mvaa 64,56,0
Ta 92,239,8192
Mvaa 64,60,4
Ta 94,239,10240
Mvaa 80,64,0
Ta 96,240,12288
Mvaa 80,68,4
Ta 98,241,12288
Mvaa 96,72,0
Ta 100,242,12288
Mvaa 96,76,4
Ta 102,243,12288
Mvaa 68,56,8
Mvaa 68,60,12
Mvaa 84,64,8
Mvaa 84,68,12
Mvaa 100,72,8
Mvaa 100,76,12
Mvaa 72,56,16
Mvaa 72,60,20
Mvaa 88,64,16
Mvaa 88,68,20
Mvaa 104,72,16
Mvaa 104,76,20
Mvaa 76,56,24
Mvaa 76,60,28
s_waitcnt vmcnt(13) lgkmcnt(0)
s_barrier
Mvaa 92,64,24
Ta 32,232,20480
Mvaa 92,68,28
s_add_u32 m0, s38, 0
s_add_u32 s36, s59, 0x40000
Ta 34,232,22528
Mvaa 108,72,24
buffer_load_dwordx4 v1, s[16:19], s36 offen sc1 lds
Mvaa 108,76,28
s_waitcnt lgkmcnt(2)
Ta 36,232,32768
Mvaa 112,80,0
Ta 38,232,34816
Mvaa 112,84,4
buffer_load_dwordx4 v1, s[16:19], s36 offen offset:1024 sc1 lds
Mvaa 128,88,0
Ta 40,233,20480
Mvaa 128,92,4
Ta 42,233,22528
Mvaa 216,96,0
Ta 44,233,32768
Mvaa 216,100,4
buffer_load_dwordx4 v253, s[16:19], s36 offen offset:2048 sc1 lds
Mvaa 116,80,8
Ta 46,233,34816
Mvaa 116,84,12
Ta 48,234,20480
Mvaa 132,88,8
Ta 50,234,22528
Mvaa 132,92,12
buffer_load_dwordx4 v253, s[16:19], s36 offen offset:3072 sc1 lds
Mvaa 220,96,8
Ta 52,234,32768
Mvaa 220,100,12
ds_read2st64_b64 a[224:227], v246 offset0:32 offset1:34
Mvaa 120,80,16
Ta 54,234,34816
Mvaa 120,84,20
s_add_u32 m0, s38, 0x3000
s_add_u32 s36, s63, 0x12000
ds_read2st64_b64 a[228:231], v246 offset0:36 offset1:38
Mvaa 136,88,16
buffer_load_dwordx4 v252, s[8:11], s36 offen lds
Mvaa 136,92,20
ds_read2st64_b64 a[232:235], v247 offset0:32 offset1:34
Mvaa 224,96,16
ds_read2st64_b64 a[236:239], v247 offset0:36 offset1:38
Mvaa 224,100,20
s_add_u32 m0, s38, 0x1000
s_add_u32 s36, s59, 0x80000
ds_read2st64_b64 a[240:243], v3 offset0:32 offset1:34
Mvaa 124,80,24
buffer_load_dwordx4 v1, s[16:19], s36 offen sc1 lds
Mvaa 124,84,28
ds_read2st64_b64 a[244:247], v3 offset0:36 offset1:38
Mvaa 140,88,24
Ta 56,235,20480
Mvaa 140,92,28
buffer_load_dwordx4 v1, s[16:19], s36 offen offset:1024 sc1 lds
Mvaa 228,96,24
Ta 58,235,22528
Mvaa 228,100,28
s_waitcnt vmcnt(63) lgkmcnt(6)
Ta 60,235,32768
Mvaa 16,32,224
Ta 62,235,34816
Mvaa 16,36,228
buffer_load_dwordx4 v253, s[16:19], s36 offen offset:2048 sc1 lds
Mvaa 32,40,224
Ta 64,236,20480
Mvaa 32,44,228
ds_read2st64_b64 a[248:251], v4 offset0:32 offset1:34
Mvaa 48,48,224
Ta 66,236,22528
Mvaa 48,52,228
s_waitcnt lgkmcnt(9)
buffer_load_dwordx4 v253, s[16:19], s36 offen offset:3072 sc1 lds
Mvaa 20,32,232
ds_read2st64_b64 a[252:255], v4 offset0:36 offset1:38
Mvaa 20,36,236
Ta 68,236,32768
Mvaa 36,40,232
Ta 70,236,34816
Mvaa 36,44,236
s_add_u32 m0, s38, 0x2000
s_add_u32 s36, s62, 0x24000
Ta 72,237,20480
Mvaa 52,48,232
buffer_load_dwordx4 v248, s[8:11], s36 offen lds
Mvaa 52,52,236
s_waitcnt lgkmcnt(11)
Ta 74,237,22528
Mvaa 24,32,240
Ta 76,237,32768
Mvaa 24,36,244
buffer_load_dwordx4 v249, s[8:11], s36 offen offset:1024 lds
Mvaa 40,40,240
Ta 78,237,34816
Mvaa 40,44,244
Ta 80,238,20480
Mvaa 56,48,240
Ta 82,238,22528
Mvaa 56,52,244
s_waitcnt lgkmcnt(8)
buffer_load_dwordx4 v250, s[8:11], s36 offen offset:2048 lds
Mvaa 28,32,248
Ta 84,238,32768
Mvaa 28,36,252
Ta 86,238,34816
Mvaa 44,40,248
Ta 88,239,20480
Mvaa 44,44,252
buffer_load_dwordx4 v251, s[8:11], s36 offen offset:3072 lds
Mvaa 60,48,248
Ta 90,239,22528
Mvaa 60,52,252
s_waitcnt vmcnt(63) lgkmcnt(6)
Ta 92,239,32768
Mvaa 64,56,224
Ta 94,239,34816
Mvaa 64,60,228
Ta 96,240,13312
Mvaa 80,64,224
Ta 98,241,13312
Mvaa 80,68,228
Ta 100,242,13312
Mvaa 96,72,224
Ta 102,243,13312
Mvaa 96,76,228
Mvaa 68,56,232
Mvaa 68,60,236
Mvaa 84,64,232
Mvaa 84,68,236
Mvaa 100,72,232
Mvaa 100,76,236
Mvaa 72,56,240
Mvaa 72,60,244
Mvaa 88,64,240
Mvaa 88,68,244
Mvaa 104,72,240
Mvaa 104,76,244
Mvaa 76,56,248
Mvaa 76,60,252
s_waitcnt vmcnt(13) lgkmcnt(0)
s_barrier
Mvaa 92,64,248
Tv 144,232,24576
Mvaa 92,68,252
s_add_u32 m0, s38, 0x3400
s_add_u32 s36, s63, 0x24000
Tv 146,232,26624
Mvaa 108,72,248
buffer_load_dwordx4 v252, s[8:11], s36 offen lds
Mvaa 108,76,252
s_waitcnt lgkmcnt(2)
Tv 148,234,24576
Mvaa 112,80,224
Tv 150,234,26624
Mvaa 112,84,228
s_add_u32 m0, s38, 0x4000
s_add_u32 s36, s59, 0xc0000
Tv 152,233,24576
Mvaa 128,88,224
buffer_load_dwordx4 v1, s[16:19], s36 offen sc1 lds
Mvaa 128,92,228
Tv 154,233,26624
Mvaa 216,96,224
Tv 156,235,24576
Mvaa 216,100,228
buffer_load_dwordx4 v1, s[16:19], s36 offen offset:1024 sc1 lds
Mvaa 116,80,232
Tv 158,235,26624
Mvaa 116,84,236
Tv 160,236,24576
Mvaa 132,88,232
Tv 162,236,26624
Mvaa 132,92,236
buffer_load_dwordx4 v253, s[16:19], s36 offen offset:2048 sc1 lds
Mvaa 220,96,232
Tv 164,238,24576
Mvaa 220,100,236
La 128,244,36864
Mvaa 120,80,240
Tv 166,238,26624
Mvaa 120,84,244
buffer_load_dwordx4 v253, s[16:19], s36 offen offset:3072 sc1 lds
Mvaa 136,88,240
La 132,244,38912
Mvaa 136,92,244
La 136,244,37888
Mvaa 224,96,240
La 140,244,39936
Mvaa 224,100,244
s_add_u32 m0, s38, 0x5000
s_add_u32 s36, s62, 0x36000
Tv 168,237,24576
Mvaa 124,80,248
buffer_load_dwordx4 v248, s[8:11], s36 offen lds
Mvaa 124,84,252
La 144,245,36864
Mvaa 140,88,248
Tv 170,237,26624
Mvaa 140,92,252
buffer_load_dwordx4 v249, s[8:11], s36 offen offset:1024 lds
Mvaa 228,96,248
La 148,245,38912
Mvaa 228,100,252
s_waitcnt lgkmcnt(6)
Tv 172,239,24576
Mvva 16,144,128
Tv 174,239,26624
Mvva 16,148,132
buffer_load_dwordx4 v250, s[8:11], s36 offen offset:2048 lds
Mvva 32,152,128
Tv 176,240,14336
Mvva 32,156,132
Tv 178,241,14336
Mvva 48,160,128
Tv 180,242,14336
Mvva 48,164,132
s_waitcnt lgkmcnt(9)
buffer_load_dwordx4 v251, s[8:11], s36 offen offset:3072 lds
Mvva 20,144,136
La 152,245,37888
Mvva 20,148,140
Tv 182,243,14336
Mvva 36,152,136
La 156,245,39936
Mvva 36,156,140
Mvva 52,160,136
Mvva 52,164,140
s_waitcnt lgkmcnt(8)
Mvva 24,144,144
Mvva 24,148,148
Mvva 40,152,144
Mvva 40,156,148
Mvva 56,160,144
Mvva 56,164,148
s_waitcnt lgkmcnt(0)
s_waitcnt vmcnt(17) lgkmcnt(0)
s_barrier
Mvva 28,144,152
Tv 184,232,28672
Mvva 28,148,156
s_add_u32 m0, s38, 0x3800
s_add_u32 s36, s63, 0x36000
Tv 186,232,30720
Mvva 44,152,152
buffer_load_dwordx4 v252, s[8:11], s36 offen lds
Mvva 44,156,156
Tv 188,234,28672
Mvva 60,160,152
Tv 190,234,30720
Mvva 60,164,156
s_waitcnt lgkmcnt(5)
s_add_u32 m0, s38, 0x8000
s_add_u32 s36, s59, 0x100000
Mvva 64,168,128
buffer_load_dwordx4 v1, s[16:19], s36 offen sc1 lds
Mvva 64,172,132
Tv 192,233,28672
Mvva 216,176,128
Tv 194,233,30720
Mvva 216,180,132
buffer_load_dwordx4 v1, s[16:19], s36 offen offset:1024 sc1 lds
Mvva 68,168,136
Tv 196,235,28672
Mvva 68,172,140
Tv 198,235,30720
Mvva 220,176,136
Tv 200,236,28672
Mvva 220,180,140
Tv 202,236,30720
Mvva 72,168,144
Tv 204,238,28672
Mvva 72,172,148
La 160,244,0
Mvva 224,176,144
Tv 206,238,30720
La 164,244,2048
Mvva 224,180,148
buffer_load_dwordx4 v253, s[16:19], s36 offen offset:2048 sc1 lds
Mvva 76,168,152
La 168,244,1024
Mvva 76,172,156
La 172,244,3072
Mvva 228,176,152
buffer_load_dwordx4 v253, s[16:19], s36 offen offset:3072 sc1 lds
Mvva 228,180,156
s_waitcnt lgkmcnt(2)
s_add_u32 m0, s38, 0x6000
s_add_u32 s36, s62, 0x48000
Mvva 16,184,160
Tv 144,237,28672
Mvva 16,188,164
buffer_load_dwordx4 v248, s[8:11], s36 offen lds
Mvva 32,192,160
La 176,245,0
Mvva 32,196,164
Tv 146,237,30720
Mvva 48,200,160
buffer_load_dwordx4 v249, s[8:11], s36 offen offset:1024 lds
Mvva 48,204,164
s_waitcnt lgkmcnt(3)
La 180,245,2048
Mvva 20,184,168
Tv 148,239,28672
Mvva 20,188,172
Tv 150,239,30720
Mvva 36,192,168
Tv 152,240,12288
Mvva 36,196,172
Tv 154,241,12288
Mvva 52,200,168
Tv 156,242,12288
Mvva 52,204,172
s_waitcnt lgkmcnt(5)
La 184,245,1024
Mvva 24,184,176
Tv 158,243,12288
La 188,245,3072
Mvva 24,188,180
buffer_load_dwordx4 v250, s[8:11], s36 offen offset:2048 lds
Mvva 40,192,176
Mvva 40,196,180
Mvva 56,200,176
buffer_load_dwordx4 v251, s[8:11], s36 offen offset:3072 lds
Mvva 56,204,180
s_waitcnt lgkmcnt(0)
s_waitcnt vmcnt(17) lgkmcnt(0)
s_barrier
Mvva 28,184,184
Tv 160,232,8192
Mvva 28,188,188
s_add_u32 m0, s38, 0x3000
s_add_u32 s36, s63, 0x48000
Tv 162,232,10240
Mvva 44,192,184
buffer_load_dwordx4 v252, s[8:11], s36 offen lds
Mvva 44,196,188
Tv 164,234,8192
Mvva 60,200,184
Tv 166,234,10240
Mvva 60,204,188
s_waitcnt lgkmcnt(5)
s_add_u32 m0, s38, 0x9000
s_add_u32 s36, s59, 0x140000
Mvva 64,144,160
buffer_load_dwordx4 v1, s[16:19], s36 offen sc1 lds
Mvva 64,148,164
Tv 168,233,8192
Mvva 216,152,160
Tv 170,233,10240
Mvva 216,156,164
buffer_load_dwordx4 v1, s[16:19], s36 offen offset:1024 sc1 lds
Mvva 68,144,168
Tv 172,235,8192
Mvva 68,148,172
Tv 174,235,10240
Mvva 220,152,168
Tv 176,236,8192
Mvva 220,156,172
Tv 178,236,10240
Mvva 72,144,176
Tv 180,238,8192
Mvva 72,148,180
La 192,244,4096
Mvva 224,152,176
Tv 182,238,10240
La 196,244,6144
Mvva 224,156,180
buffer_load_dwordx4 v253, s[16:19], s36 offen offset:2048 sc1 lds
Mvva 76,144,184
La 200,244,5120
Mvva 76,148,188
La 204,244,7168
Mvva 228,152,184
buffer_load_dwordx4 v253, s[16:19], s36 offen offset:3072 sc1 lds
Mvva 228,156,188
s_waitcnt lgkmcnt(2)
s_add_u32 m0, s38, 0
s_add_u32 s36, s62, 0x5a000
Mvva 16,160,192
Tv 184,237,8192
Mvva 16,164,196
buffer_load_dwordx4 v248, s[8:11], s36 offen lds
Mvva 32,168,192
La 208,245,4096
Mvva 32,172,196
Tv 186,237,10240
Mvva 48,176,192
buffer_load_dwordx4 v249, s[8:11], s36 offen offset:1024 lds
Mvva 48,180,196
s_waitcnt lgkmcnt(3)
La 212,245,6144
Mvva 20,160,200
Tv 188,239,8192
Mvva 20,164,204
Tv 190,239,10240
Mvva 36,168,200
Tv 192,240,13312
Mvva 36,172,204
Tv 194,241,13312
Mvva 52,176,200
Tv 196,242,13312
Mvva 52,180,204
s_waitcnt lgkmcnt(5)
La 216,245,5120
Mvva 24,160,208
Tv 198,243,13312
La 220,245,7168
Mvva 24,164,212
buffer_load_dwordx4 v250, s[8:11], s36 offen offset:2048 lds
Mvva 40,168,208
Mvva 40,172,212
Mvva 56,176,208
buffer_load_dwordx4 v251, s[8:11], s36 offen offset:3072 lds
Mvva 56,180,212
s_waitcnt lgkmcnt(0)
s_waitcnt vmcnt(17) lgkmcnt(0)
s_barrier
Mvva 28,160,216
Tv 200,232,20480
Mvva 28,164,220
s_add_u32 m0, s38, 0x3400
s_add_u32 s36, s63, 0x5a000
Tv 202,232,22528
Mvva 44,168,216
buffer_load_dwordx4 v252, s[8:11], s36 offen lds
Mvva 44,172,220
Tv 204,234,20480
Mvva 60,176,216
Tv 206,234,22528
Mvva 60,180,220
s_waitcnt lgkmcnt(5)
s_add_u32 m0, s38, 0x7000
s_add_u32 s36, s59, 0x180000
Mvva 64,184,192
buffer_load_dwordx4 v1, s[16:19], s36 offen sc1 lds
Mvva 64,188,196
Tv 144,233,20480
Mvva 216,192,192
Tv 146,233,22528
Mvva 216,196,196
buffer_load_dwordx4 v1, s[16:19], s36 offen offset:1024 sc1 lds
Mvva 68,184,200
Tv 148,235,20480
Mvva 68,188,204
Tv 150,235,22528
Mvva 220,192,200
Tv 152,236,20480
Mvva 220,196,204
Tv 154,236,22528
Mvva 72,184,208
Tv 156,238,20480
Mvva 72,188,212
La 224,244,16384
Mvva 224,192,208
Tv 158,238,22528
La 228,244,18432
Mvva 224,196,212
buffer_load_dwordx4 v253, s[16:19], s36 offen offset:2048 sc1 lds
Mvva 76,184,216
La 232,244,17408
Mvva 76,188,220
La 236,244,19456
Mvva 228,192,216
buffer_load_dwordx4 v253, s[16:19], s36 offen offset:3072 sc1 lds
Mvva 228,196,220
s_waitcnt lgkmcnt(2)
s_add_u32 m0, s38, 0x1000
s_add_u32 s36, s62, 0x6c000
Mvva 16,200,224
Tv 160,237,20480
Mvva 16,204,228
buffer_load_dwordx4 v248, s[8:11], s36 offen lds
Mvva 32,144,224
La 240,245,16384
Mvva 32,148,228
Tv 162,237,22528
Mvva 48,152,224
buffer_load_dwordx4 v249, s[8:11], s36 offen offset:1024 lds
Mvva 48,156,228
s_waitcnt lgkmcnt(3)
La 244,245,18432
Mvva 20,200,232
Tv 164,239,20480
Mvva 20,204,236
Tv 166,239,22528
Mvva 36,144,232
Tv 168,240,14336
Mvva 36,148,236
Tv 170,241,14336
Mvva 52,152,232
Tv 172,242,14336
Mvva 52,156,236
s_waitcnt lgkmcnt(5)
La 248,245,17408
Mvva 24,200,240
Tv 174,243,14336
La 252,245,19456
Mvva 24,204,244
buffer_load_dwordx4 v250, s[8:11], s36 offen offset:2048 lds
Mvva 40,144,240
Mvva 40,148,244
Mvva 56,152,240
buffer_load_dwordx4 v251, s[8:11], s36 offen offset:3072 lds
Mvva 56,156,244
s_waitcnt lgkmcnt(0)
s_waitcnt vmcnt(17) lgkmcnt(0)
s_barrier
Mvva 28,200,248
Tv 176,232,24576
Mvva 28,204,252
s_add_u32 m0, s38, 0x3800
s_add_u32 s36, s63, 0x6c000
Tv 178,232,26624
Mvva 44,144,248
buffer_load_dwordx4 v252, s[8:11], s36 offen lds
Mvva 44,148,252
Tv 180,234,24576
Mvva 60,152,248
Tv 182,234,26624
Mvva 60,156,252
s_waitcnt lgkmcnt(5)
s_add_u32 m0, s38, 0x2000
s_add_u32 s36, s59, 0x1c0000
Mvva 64,160,224
buffer_load_dwordx4 v1, s[16:19], s36 offen sc1 lds
Mvva 64,164,228
Tv 184,233,24576
Mvva 216,168,224
Tv 186,233,26624
Mvva 216,172,228
buffer_load_dwordx4 v1, s[16:19], s36 offen offset:1024 sc1 lds
Mvva 68,160,232
Tv 188,235,24576
Mvva 68,164,236
Tv 190,235,26624
Mvva 220,168,232
Tv 192,236,24576
Mvva 220,172,236
Tv 194,236,26624
Mvva 72,160,240
Tv 196,238,24576
Mvva 72,164,244
La 0,244,32768
Mvva 224,168,240
Tv 198,238,26624
La 4,244,34816
Mvva 224,172,244
buffer_load_dwordx4 v253, s[16:19], s36 offen offset:2048 sc1 lds
Mvva 76,160,248
La 8,244,33792
Mvva 76,164,252
La 12,244,35840
Mvva 228,168,248
buffer_load_dwordx4 v253, s[16:19], s36 offen offset:3072 sc1 lds
Mvva 228,172,252
s_waitcnt lgkmcnt(2)
s_add_u32 m0, s38, 0x4000
s_add_u32 s36, s62, 0x7e000
Mvva 16,176,0
Tv 200,237,24576
Mvva 16,180,4
buffer_load_dwordx4 v248, s[8:11], s36 offen lds
Mvva 32,184,0
La 16,245,32768
Mvva 32,188,4
Tv 202,237,26624
Mvva 48,192,0
buffer_load_dwordx4 v249, s[8:11], s36 offen offset:1024 lds
Mvva 48,196,4
s_waitcnt lgkmcnt(3)
La 20,245,34816
Mvva 20,176,8
Tv 204,239,24576
Mvva 20,180,12
Tv 206,239,26624
Mvva 36,184,8
Tv 144,240,12288
Mvva 36,188,12
Tv 146,241,12288
Mvva 52,192,8
Tv 148,242,12288
Mvva 52,196,12
s_waitcnt lgkmcnt(5)
La 24,245,33792
Mvva 24,176,16
Tv 150,243,12288
La 28,245,35840
Mvva 24,180,20
buffer_load_dwordx4 v250, s[8:11], s36 offen offset:2048 lds
Mvva 40,184,16
Mvva 40,188,20
Mvva 56,192,16
buffer_load_dwordx4 v251, s[8:11], s36 offen offset:3072 lds
Mvva 56,196,20
s_waitcnt lgkmcnt(0)
s_waitcnt vmcnt(17) lgkmcnt(0)
s_barrier
Mvva 28,176,24
Tv 152,232,0
Mvva 28,180,28
s_add_u32 m0, s38, 0x3000
s_add_u32 s36, s63, 0x7e000
Tv 154,232,2048
Mvva 44,184,24
buffer_load_dwordx4 v252, s[8:11], s36 offen lds
Mvva 44,188,28
Tv 156,234,0
Mvva 60,192,24
Tv 158,234,2048
Mvva 60,196,28
s_waitcnt lgkmcnt(5)
s_add_u32 m0, s38, 0x5000
s_add_u32 s36, s66, 0
Mvva 64,200,0
buffer_load_dwordx4 v248, s[8:11], s36 offen lds
Mvva 64,204,4
Tv 160,233,0
Mvva 216,144,0
Tv 162,233,2048
Mvva 216,148,4
buffer_load_dwordx4 v249, s[8:11], s36 offen offset:1024 lds
Mvva 68,200,8
Tv 164,235,0
Mvva 68,204,12
Tv 166,235,2048
Mvva 220,144,8
Tv 168,236,0
Mvva 220,148,12
Tv 170,236,2048
Mvva 72,200,16
Tv 172,238,0
Mvva 72,204,20
La 32,244,36864
Mvva 224,144,16
Tv 174,238,2048
La 36,244,38912
Mvva 224,148,20
buffer_load_dwordx4 v250, s[8:11], s36 offen offset:2048 lds
Mvva 76,200,24
La 40,244,37888
Mvva 76,204,28
La 44,244,39936
Mvva 228,144,24
buffer_load_dwordx4 v251, s[8:11], s36 offen offset:3072 lds
Mvva 228,148,28
s_waitcnt lgkmcnt(2)
s_add_u32 m0, s38, 0x6000
s_add_u32 s36, s66, 0x12000
Mvva 16,152,32
Tv 176,237,0
Mvva 16,156,36
buffer_load_dwordx4 v248, s[8:11], s36 offen lds
Mvva 32,160,32
La 48,245,36864
Mvva 32,164,36
Tv 178,237,2048
Mvva 48,168,32
buffer_load_dwordx4 v249, s[8:11], s36 offen offset:1024 lds
Mvva 48,172,36
s_waitcnt lgkmcnt(3)
La 52,245,38912
Mvva 20,152,40
Tv 180,239,0
Mvva 20,156,44
Tv 182,239,2048
Mvva 36,160,40
Tv 184,240,13312
Mvva 36,164,44
Tv 186,241,13312
Mvva 52,168,40
Tv 188,242,13312
Mvva 52,172,44
s_waitcnt lgkmcnt(5)
La 56,245,37888
Mvva 24,152,48
Tv 190,243,13312
La 60,245,39936
Mvva 24,156,52
buffer_load_dwordx4 v250, s[8:11], s36 offen offset:2048 lds
Mvva 40,160,48
Mvva 40,164,52
Mvva 56,168,48
buffer_load_dwordx4 v251, s[8:11], s36 offen offset:3072 lds
Mvva 56,172,52
s_waitcnt lgkmcnt(0)
s_waitcnt vmcnt(17) lgkmcnt(0)
s_barrier
Mvva 28,152,56
s_add_u32 m0, s38, 0x8000
s_add_u32 s36, s66, 0x24000
Tv 192,232,4096
Mvva 28,156,60
buffer_load_dwordx4 v248, s[8:11], s36 offen lds
Mvva 44,160,56
s_movk_i32 s74, 0x3f80
s_mov_b32 s75, 0x3f800000
s_lshl_b32 s76, s24, 11
Mvva 44,164,60
Tv 194,232,6144
v_add_u32 v9, s67, v1
Mvva 60,168,56
buffer_load_dwordx4 v249, s[8:11], s36 offen offset:1024 lds
Mvva 60,172,60
s_waitcnt lgkmcnt(3)
s_xor_b32 s41, s2, 7
s_mul_i32 s41, s41, 0x12000
Mvva 64,176,32
s_add_u32 s41, s41, s76
s_add_u32 s41, s41, 0x6400000
Tv 196,234,4096
Mvva 64,180,36
s_xor_b32 s42, s2, 6
s_mul_i32 s42, s42, 0x12000
Tv 198,234,6144
Mvva 216,184,32
s_add_u32 s42, s42, s76
s_add_u32 s42, s42, 0x6402000
Tv 200,233,4096
Mvva 216,188,36
s_xor_b32 s43, s2, 5
s_mul_i32 s43, s43, 0x12000
Tv 202,233,6144
Mvva 68,176,40
s_add_u32 s43, s43, s76
s_add_u32 s43, s43, 0x6404000
Tv 204,235,4096
Mvva 68,180,44
s_xor_b32 s44, s2, 4
s_mul_i32 s44, s44, 0x12000
Tv 206,235,6144
Mvva 220,184,40
s_add_u32 s44, s44, s76
s_add_u32 s44, s44, 0x6406000
Tv 144,236,4096
Mvva 220,188,44
buffer_load_dwordx4 v250, s[8:11], s36 offen offset:2048 lds
Mvva 72,176,48
s_xor_b32 s45, s2, 3
s_mul_i32 s45, s45, 0x12000
Tv 146,236,6144
Mvva 72,180,52
s_add_u32 s45, s45, s76
s_add_u32 s45, s45, 0x6408000
Tv 148,238,4096
Mvva 224,184,48
s_xor_b32 s46, s2, 2
La 64,244,28672
Tv 150,238,6144
La 68,244,30720
Mvva 224,188,52
buffer_load_dwordx4 v251, s[8:11], s36 offen offset:3072 lds
Mvva 76,176,56
s_add_u32 m0, s38, 0
s_add_u32 s36, s66, 0x36000
s_mul_i32 s46, s46, 0x12000
Mvva 76,180,60
s_add_u32 s46, s46, s76
s_add_u32 s46, s46, 0x640a000
s_xor_b32 s47, s2, 1
Mvva 228,184,56
buffer_load_dwordx4 v248, s[8:11], s36 offen lds
Mvva 228,188,60
s_waitcnt lgkmcnt(0)
s_mul_i32 s47, s47, 0x12000
La 72,244,29696
Mvva 16,192,64
s_add_u32 s47, s47, s76
s_add_u32 s47, s47, 0x640c000
La 76,244,31744
Mvva 16,196,68
buffer_load_dwordx4 v249, s[8:11], s36 offen offset:1024 lds
Mvva 32,200,64
s_xor_b32 s48, s2, 0
s_mul_i32 s48, s48, 0x12000
s_add_u32 s48, s48, s76
Mvva 32,204,68
s_add_u32 s48, s48, 0x640e000
Tv 152,237,4096
Mvva 48,144,64
La 80,245,28672
Mvva 48,148,68
s_waitcnt lgkmcnt(2)
Tv 154,237,6144
Mvva 20,192,72
La 84,245,30720
Mvva 20,196,76
buffer_load_dwordx4 v250, s[8:11], s36 offen offset:2048 lds
Mvva 36,200,72
Tv 156,239,4096
Mvva 36,204,76
Tv 158,239,6144
Mvva 52,144,72
Tv 160,240,14336
Mvva 52,148,76
s_waitcnt lgkmcnt(3)
buffer_load_dwordx4 v251, s[8:11], s36 offen offset:3072 lds
Mvva 24,192,80
s_add_u32 m0, s38, 0x9000
Tv 162,241,14336
Tv 164,242,14336
La 88,245,29696
Tv 166,243,14336
La 92,245,31744
Mvva 24,196,84
s_add_u32 s36, s66, 0x48000
Mvva 40,200,80
buffer_load_dwordx4 v248, s[8:11], s36 offen lds
Mvva 40,204,84
Mvva 56,144,80
Mvva 56,148,84
s_waitcnt lgkmcnt(0)
s_waitcnt vmcnt(17) lgkmcnt(0)
s_barrier
Mvva 28,192,88
buffer_load_dwordx4 v249, s[8:11], s36 offen offset:1024 lds
Mvva 28,196,92
Tv 168,232,16384
Mvva 44,200,88
Tv 170,232,18432
Mvva 44,204,92
buffer_load_dwordx4 v250, s[8:11], s36 offen offset:2048 lds
Mvva 60,144,88
Tv 172,234,16384
Mvva 60,148,92
s_waitcnt lgkmcnt(4)
Tv 174,234,18432
Mvva 64,152,64
buffer_load_dwordx4 v251, s[8:11], s36 offen offset:3072 lds
Mvva 64,156,68
s_add_u32 m0, s38, 0x1000
s_add_u32 s36, s66, 0x5a000
Tv 176,233,16384
Mvva 216,160,64
Tv 178,233,18432
Mvva 216,164,68
buffer_load_dwordx4 v248, s[8:11], s36 offen lds
Mvva 68,152,72
Tv 180,235,16384
Mvva 68,156,76
Tv 182,235,18432
Mvva 220,160,72
Tv 184,236,16384
Mvva 220,164,76
Tv 186,236,18432
Mvva 72,152,80
Tv 188,238,16384
Mvva 72,156,84
La 96,244,8192
Mvva 224,160,80
Tv 190,238,18432
La 100,244,10240
Mvva 224,164,84
buffer_load_dwordx4 v249, s[8:11], s36 offen offset:1024 lds
Mvva 76,152,88
La 104,244,9216
Mvva 76,156,92
La 108,244,11264
Mvva 228,160,88
buffer_load_dwordx4 v250, s[8:11], s36 offen offset:2048 lds
Mvva 228,164,92
s_waitcnt lgkmcnt(2)
Tv 192,237,16384
Mvva 16,168,96
La 112,245,8192
Mvva 16,172,100
buffer_load_dwordx4 v251, s[8:11], s36 offen offset:3072 lds
Mvva 32,176,96
s_add_u32 m0, s38, 0x7000
s_add_u32 s36, s66, 0x6c000
Tv 194,237,18432
Mvva 32,180,100
La 116,245,10240
Mvva 48,184,96
buffer_load_dwordx4 v248, s[8:11], s36 offen lds
Mvva 48,188,100
s_waitcnt lgkmcnt(4)
Tv 196,239,16384
Mvva 20,168,104
Tv 198,239,18432
Mvva 20,172,108
buffer_load_dwordx4 v249, s[8:11], s36 offen offset:1024 lds
Mvva 36,176,104
Tv 200,240,12288
Mvva 36,180,108
Tv 202,241,12288
Mvva 52,184,104
Tv 204,242,12288
Mvva 52,188,108
s_waitcnt lgkmcnt(5)
s_add_u32 s73, s64, 0
La 120,245,9216
Mvva 24,168,112
Tv 206,243,12288
La 124,245,11264
Mvva 24,172,116
buffer_load_dwordx4 v250, s[8:11], s36 offen offset:2048 lds
Mvva 40,176,112
PK 16,16,17
PK 17,18,19
Mvva 40,180,116
PK 18,20,21
PK 19,22,23
Mvva 56,184,112
buffer_load_dwordx4 v251, s[8:11], s36 offen offset:3072 lds
Mvva 56,188,116
s_waitcnt lgkmcnt(0)
s_waitcnt vmcnt(16) lgkmcnt(0)
s_barrier
Mvva 28,168,120
Tv 144,232,20480
Mvva 28,172,124
buffer_store_dwordx4 v[16:19], v1, s[16:19], s73 offen sc0 sc1
s_add_u32 s73, s64, 0
PK 32,32,33
s_add_u32 m0, s38, 0x2000
Mvva 44,176,120
s_add_u32 s36, s66, 0x7e000
Tv 146,232,22528
PK 33,34,35
Mvva 44,180,124
Tv 148,234,20480
PK 34,36,37
Mvva 60,184,120
buffer_load_dwordx4 v248, s[8:11], s36 offen lds
Mvva 60,188,124
s_waitcnt lgkmcnt(4)
Tv 150,234,22528
PK 35,38,39
Mvva 64,192,96
Tv 152,233,20480
Mvva 64,196,100
buffer_store_dwordx4 v[32:35], v1, s[16:19], s73 offen offset:1024 sc0 sc1
Tv 154,233,22528
Tv 156,235,20480
Mvva 216,200,96
s_add_u32 s73, s64, 0x4000
Tv 158,235,22528
PK 48,48,49
Mvva 216,204,100
Tv 160,232,24576
PK 49,50,51
Mvva 68,192,104
buffer_load_dwordx4 v249, s[8:11], s36 offen offset:1024 lds
Mvva 68,196,108
Tv 162,232,26624
PK 50,52,53
Mvva 220,200,104
Tv 164,234,24576
PK 51,54,55
Mvva 220,204,108
buffer_load_dwordx4 v250, s[8:11], s36 offen offset:2048 lds
Mvva 72,192,112
Tv 166,234,26624
Mvva 72,196,116
Tv 168,233,24576
Mvva 224,200,112
buffer_store_dwordx4 v[48:51], v1, s[16:19], s73 offen sc0 sc1
s_add_u32 s73, s64, 0x2000
PK 24,24,25
PK 25,26,27
Mvva 224,204,116
Tv 170,233,26624
PK 26,28,29
Mvva 76,192,120
Tv 172,235,24576
PK 27,30,31
Mvva 76,196,124
buffer_load_dwordx4 v251, s[8:11], s36 offen offset:3072 lds
Mvva 228,200,120
Tv 174,235,26624
Mvva 228,204,124
s_waitcnt lgkmcnt(8)
Tv 176,232,32768
Mvva 80,144,128
buffer_store_dwordx4 v[24:27], v1, s[16:19], s73 offen sc0 sc1
s_add_u32 s73, s64, 0x2000
PK 40,40,41
PK 41,42,43
Mvva 80,148,132
Tv 178,232,34816
PK 42,44,45
Mvva 96,152,128
Tv 180,234,32768
PK 43,46,47
Mvva 96,156,132
Tv 182,234,34816
Mvva 84,144,136
Tv 184,233,32768
Mvva 84,148,140
Tv 186,233,34816
Mvva 100,152,136
Tv 188,235,32768
Mvva 100,156,140
buffer_store_dwordx4 v[40:43], v1, s[16:19], s73 offen offset:1024 sc0 sc1
Tv 190,235,34816
Mvva 88,144,144
s_add_u32 s73, s64, 0x6000
PK 56,56,57
PK 57,58,59
Mvva 88,148,148
PK 58,60,61
PK 59,62,63
Mvva 104,152,144
Mvva 104,156,148
Mvva 92,144,152
Mvva 92,148,156
Mvva 108,152,152
Mvva 108,156,156
s_waitcnt lgkmcnt(8)
Mvva 80,160,160
buffer_store_dwordx4 v[56:59], v1, s[16:19], s73 offen sc0 sc1
Mvva 80,164,164
s_add_u32 s73, s64, 0x4000
PK 64,64,65
PK 65,66,67
Mvva 96,168,160
PK 66,68,69
PK 67,70,71
Mvva 96,172,164
Mvva 84,160,168
Mvva 84,164,172
Mvva 100,168,168
Mvva 100,172,172
Mvva 88,160,176
Mvva 88,164,180
s_waitcnt vmcnt(14)
s_barrier
Mvva 104,168,176
buffer_store_dwordx4 v[64:67], v1, s[16:19], s73 offen offset:1024 sc0 sc1
Tv 192,232,0
Tv 194,232,2048
Mvva 104,172,180
s_xor_b32 s73, s65, 0
Tv 196,234,0
PK 216,216,217
Mvva 92,160,184
Tv 198,234,2048
PK 217,218,219
Mvva 92,164,188
Tv 200,233,0
PK 218,220,221
Mvva 108,168,184
Tv 202,233,2048
PK 219,222,223
Mvva 108,172,188
s_waitcnt lgkmcnt(6)
Tv 204,235,0
Mvva 80,176,192
Tv 206,235,2048
Mvva 80,180,196
Tv 144,232,36864
Mvva 96,184,192
buffer_store_dwordx4 v[216:219], v1, s[16:19], s73 offen sc0 sc1
Tv 146,232,38912
Tv 148,234,36864
Mvva 96,188,196
s_add_u32 s73, s64, 0x6000
Tv 150,234,38912
PK 72,72,73
Mvva 84,176,200
Tv 152,233,36864
PK 73,74,75
Mvva 84,180,204
Tv 154,233,38912
PK 74,76,77
Mvva 100,184,200
Tv 156,235,36864
PK 75,78,79
Mvva 100,188,204
Tv 158,235,38912
Mvva 88,176,208
Tv 160,232,4096
Mvva 88,180,212
Tv 162,232,6144
Mvva 104,184,208
Tv 164,234,4096
Mvva 104,188,212
buffer_store_dwordx4 v[72:75], v1, s[16:19], s73 offen offset:1024 sc0 sc1
Tv 166,234,6144
Tv 168,233,4096
Mvva 92,176,216
s_xor_b32 s73, s65, 0x800
Tv 170,233,6144
PK 224,224,225
Mvva 92,180,220
Tv 172,235,4096
PK 225,226,227
Mvva 108,184,216
Tv 174,235,6144
PK 226,228,229
Mvva 108,188,220
s_waitcnt lgkmcnt(15)
PK 227,230,231
Mvva 80,192,224
Mvva 80,196,228
Mvva 96,200,224
Mvva 96,204,228
Mvva 84,192,232
buffer_store_dwordx4 v[224:227], v1, s[16:19], s73 offen sc0 sc1
Mvva 84,196,236
Mvva 100,200,232
Mvva 100,204,236
Mvva 88,192,240
Mvva 88,196,244
Mvva 104,200,240
Mvva 104,204,244
Mvva 92,192,248
Mvva 92,196,252
Mvva 108,200,248
Mvva 108,204,252
s_waitcnt lgkmcnt(8)
Mvva 80,144,0
Mvva 80,148,4
Mvva 96,152,0
Mvva 96,156,4
Mvva 84,144,8
Mvva 84,148,12
Mvva 100,152,8
Mvva 100,156,12
Mvva 88,144,16
Mvva 88,148,20
s_waitcnt vmcnt(7)
s_barrier
Mvva 104,152,16
Tv 176,232,28672
Mvva 104,156,20
Tv 178,232,30720
Mvva 92,144,24
Tv 180,234,28672
Mvva 92,148,28
Tv 182,234,30720
Mvva 108,152,24
Tv 184,233,28672
Mvva 108,156,28
s_waitcnt lgkmcnt(5)
Tv 186,233,30720
Mvva 80,160,32
Tv 188,235,28672
Mvva 80,164,36
Tv 190,235,30720
Mvva 96,168,32
Tv 192,232,8192
Mvva 96,172,36
Tv 194,232,10240
Mvva 84,160,40
Tv 196,234,8192
Mvva 84,164,44
Tv 198,234,10240
Mvva 100,168,40
Tv 200,233,8192
Mvva 100,172,44
Tv 202,233,10240
Mvva 88,160,48
Tv 204,235,8192
Mvva 88,164,52
Tv 206,235,10240
Mvva 104,168,48
Tv 144,236,20480
Mvva 104,172,52
Tv 146,236,22528
Mvva 92,160,56
Tv 148,238,20480
Mvva 92,164,60
Tv 150,238,22528
Mvva 108,168,56
Tv 152,237,20480
Mvva 108,172,60
s_waitcnt lgkmcnt(13)
Tv 154,237,22528
Mvva 80,176,64
Tv 156,239,20480
Mvva 80,180,68
Tv 158,239,22528
Mvva 96,184,64
Tv 160,236,24576
Mvva 96,188,68
Tv 162,236,26624
Mvva 84,176,72
Tv 164,238,24576
Mvva 84,180,76
Tv 166,238,26624
Mvva 100,184,72
Tv 168,237,24576
Mvva 100,188,76
Tv 170,237,26624
Mvva 88,176,80
Tv 172,239,24576
Mvva 88,180,84
Tv 174,239,26624
Mvva 104,184,80
Mvva 104,188,84
Mvva 92,176,88
Mvva 92,180,92
Mvva 108,184,88
Mvva 108,188,92
s_waitcnt lgkmcnt(15)
Mvva 80,192,96
Tv 176,236,32768
Mvva 80,196,100
Tv 178,236,34816
Mvva 96,200,96
Tv 180,238,32768
Mvva 96,204,100
buffer_load_dword v213, v214, s[16:19], s71 offen sc1
Mvva 84,192,104
Tv 182,238,34816
Mvva 84,196,108
s_waitcnt vmcnt(1)
s_barrier
Mvva 100,200,104
buffer_store_dword v0, v215, s[16:19], 0 offen sc0 sc1
Mvva 100,204,108
Tv 184,237,32768
Mvva 88,192,112
Tv 186,237,34816
Mvva 88,196,116
s_add_u32 s73, s64, 0x8000
Tv 188,239,32768
PK 80,80,81
Mvva 104,200,112
Tv 190,239,34816
PK 81,82,83
Mvva 104,204,116
PK 82,84,85
PK 83,86,87
Mvva 92,192,120
buffer_store_dwordx4 v[80:83], v1, s[16:19], s73 offen sc0 sc1
s_add_u32 s73, s64, 0x8000
PK 96,96,97
PK 97,98,99
Mvva 92,196,124
PK 98,100,101
PK 99,102,103
Mvva 108,200,120
Mvva 108,204,124
s_waitcnt lgkmcnt(15)
Mvva 112,144,128
Tv 192,236,0
Mvva 112,148,132
Tv 194,236,2048
Mvva 128,152,128
buffer_store_dwordx4 v[96:99], v1, s[16:19], s73 offen offset:1024 sc0 sc1
Tv 196,238,0
Tv 198,238,2048
Mvva 128,156,132
s_add_u32 s73, s64, 0xa000
Tv 200,237,0
PK 88,88,89
Mvva 116,144,136
Tv 202,237,2048
PK 89,90,91
Mvva 116,148,140
Tv 204,239,0
PK 90,92,93
Mvva 132,152,136
Tv 206,239,2048
PK 91,94,95
Mvva 132,156,140
s_waitcnt lgkmcnt(15)
Mvva 112,160,160
Tv 144,236,36864
Mvva 112,164,164
Tv 146,236,38912
Mvva 128,168,160
Tv 148,238,36864
Mvva 128,172,164
buffer_store_dwordx4 v[88:91], v1, s[16:19], s73 offen sc0 sc1
Tv 150,238,38912
Tv 152,237,36864
Mvva 116,160,168
s_add_u32 s73, s64, 0xa000
Tv 154,237,38912
PK 104,104,105
Mvva 116,164,172
Tv 156,239,36864
PK 105,106,107
Mvva 132,168,168
Tv 158,239,38912
PK 106,108,109
Mvva 132,172,172
s_waitcnt lgkmcnt(15)
PK 107,110,111
Mvva 112,176,192
Tv 160,236,4096
Mvva 112,180,196
Tv 162,236,6144
Mvva 128,184,192
Tv 164,238,4096
Mvva 128,188,196
Tv 166,238,6144
Mvva 116,176,200
buffer_store_dwordx4 v[104:107], v1, s[16:19], s73 offen offset:1024 sc0 sc1
Tv 168,237,4096
Tv 170,237,6144
Mvva 116,180,204
Tv 172,239,4096
Mvva 132,184,200
Tv 174,239,6144
Mvva 132,188,204
s_waitcnt lgkmcnt(15)
s_waitcnt vmcnt(5)
v_cmp_ne_u32 vcc, 1, v213
s_nop 0
s_and_b32 s28, vcc_lo, 0xfe
s_cmp_lg_u32 s28, 0
s_cselect_b32 s55, 0x10000000, 0
v_or_b32 v229, s55, v1
Mvva 112,192,224
s_bitcmp1_b32 s28, 7
s_cselect_b32 s30, 0x10000000, s41
s_bitcmp1_b32 s28, 6
s_cselect_b32 s31, 0x10000000, s42
s_bitcmp1_b32 s28, 5
s_cselect_b32 s32, 0x10000000, s43
Mvva 112,196,228
s_bitcmp1_b32 s28, 4
s_cselect_b32 s33, 0x10000000, s44
Tv 176,236,28672
Mvva 128,200,224
buffer_load_dwordx4 v[16:19], v1, s[16:19], s30 offen sc1
Mvva 128,204,228
Tv 178,236,30720
Mvva 116,192,232
Tv 180,238,28672
Mvva 116,196,236
buffer_load_dwordx4 v[20:23], v1, s[16:19], s30 offen offset:1024 sc1
Mvva 132,200,232
Tv 182,238,30720
Mvva 132,204,236
s_waitcnt lgkmcnt(12)
Tv 184,237,28672
Mvva 112,144,0
buffer_load_dwordx4 v[24:27], v1, s[16:19], s31 offen sc1
Mvva 112,148,4
Tv 186,237,30720
Mvva 128,152,0
Tv 188,239,28672
Mvva 128,156,4
Tv 190,239,30720
Mvva 116,144,8
buffer_load_dwordx4 v[28:31], v1, s[16:19], s31 offen offset:1024 sc1
Mvva 116,148,12
Tv 192,236,8192
Mvva 132,152,8
Tv 194,236,10240
Mvva 132,156,12
s_waitcnt lgkmcnt(10)
Tv 196,238,8192
Mvva 112,160,32
buffer_load_dwordx4 v[32:35], v1, s[16:19], s32 offen sc1
Mvva 112,164,36
Tv 198,238,10240
Mvva 128,168,32
Tv 200,237,8192
Mvva 128,172,36
Tv 202,237,10240
Mvva 116,160,40
buffer_load_dwordx4 v[36:39], v1, s[16:19], s32 offen offset:1024 sc1
Mvva 116,164,44
Tv 204,239,8192
Mvva 132,168,40
Tv 206,239,10240
Mvva 132,172,44
s_waitcnt lgkmcnt(8)
Tv 144,236,20480
Mvva 112,176,64
buffer_load_dwordx4 v[40:43], v1, s[16:19], s33 offen sc1
Mvva 112,180,68
Tv 146,236,22528
Mvva 128,184,64
Tv 148,238,20480
Mvva 128,188,68
Tv 150,238,22528
Mvva 116,176,72
buffer_load_dwordx4 v[44:47], v1, s[16:19], s33 offen offset:1024 sc1
Mvva 116,180,76
Tv 152,237,20480
Mvva 132,184,72
Tv 154,237,22528
Mvva 132,188,76
s_waitcnt lgkmcnt(6)
Tv 156,239,20480
Mvva 112,192,96
s_bitcmp1_b32 s28, 3
s_cselect_b32 s34, 0x10000000, s45
s_bitcmp1_b32 s28, 2
s_cselect_b32 s35, 0x10000000, s46
s_bitcmp1_b32 s28, 1
s_cselect_b32 s52, 0x10000000, s47
Mvva 112,196,100
s_add_u32 s36, s30, 0xe800
Tv 158,239,22528
Mvva 128,200,96
Tv 160,236,24576
Mvva 128,204,100
Tv 162,236,26624
Mvva 116,192,104
Tv 164,238,24576
Mvva 116,196,108
Tv 166,238,26624
Mvva 132,200,104
Tv 168,237,24576
Mvva 132,204,108
s_waitcnt lgkmcnt(5)
Tv 170,237,26624
Mvva 120,144,144
buffer_load_dwordx2 v[48:49], v9, s[16:19], s36 offen sc1
Mvva 120,148,148
s_add_u32 s36, s31, 0xc800
s_add_u32 s73, s64, 0xc000
Tv 172,239,24576
Mvva 136,152,144
Tv 174,239,26624
PK 112,112,113
Mvva 136,156,148
Tv 176,236,32768
PK 113,114,115
Mvva 124,144,152
buffer_load_dwordx2 v[50:51], v9, s[16:19], s36 offen sc1
Mvva 124,148,156
s_add_u32 s36, s32, 0xa800
Tv 178,236,34816
PK 114,116,117
Mvva 140,152,152
Tv 180,238,32768
PK 115,118,119
Mvva 140,156,156
s_waitcnt lgkmcnt(3)
Tv 182,238,34816
Mvva 120,160,176
buffer_load_dwordx2 v[52:53], v9, s[16:19], s36 offen sc1
Mvva 120,164,180
buffer_store_dwordx4 v[112:115], v1, s[16:19], s73 offen sc0 sc1
Tv 184,237,32768
Tv 186,237,34816
Mvva 136,168,176
s_add_u32 s73, s64, 0xc000
Tv 188,239,32768
Tv 190,239,34816
Mvva 136,172,180
PK 128,128,129
PK 129,130,131
PK 130,132,133
PK 131,134,135
buffer_store_dwordx4 v[128:131], v1, s[16:19], s73 offen offset:1024 sc0 sc1
Tv 192,236,0
s_add_u32 s36, s33, 0x8800
Mvva 124,160,184
buffer_load_dwordx2 v[54:55], v9, s[16:19], s36 offen sc1
Mvva 124,164,188
s_add_u32 s36, s34, 0x6800
Tv 194,236,2048
Mvva 140,168,184
Tv 196,238,0
Mvva 140,172,188
s_waitcnt lgkmcnt(3)
Tv 198,238,2048
Mvva 120,176,208
buffer_load_dwordx2 v[56:57], v9, s[16:19], s36 offen sc1
Mvva 120,180,212
s_add_u32 s36, s35, 0x4800
Tv 200,237,0
Mvva 136,184,208
Tv 202,237,2048
Tv 204,239,0
Tv 206,239,2048
Mvva 136,188,212
Tv 144,236,36864
Mvva 124,176,216
buffer_load_dwordx2 v[58:59], v9, s[16:19], s36 offen sc1
Mvva 124,180,220
s_add_u32 s36, s52, 0x2800
Tv 146,236,38912
Mvva 140,184,216
Tv 148,238,36864
Mvva 140,188,220
s_waitcnt lgkmcnt(3)
buffer_load_dword v213, v214, s[16:19], s71 offen sc1
Mvva 120,192,240
buffer_load_dwordx2 v[60:61], v9, s[16:19], s36 offen sc1
Mvva 120,196,244
s_add_u32 s36, s48, 0x800
Tv 150,238,38912
Mvva 136,200,240
Tv 152,237,36864
Tv 154,237,38912
Tv 156,239,36864
Tv 158,239,38912
Mvva 136,204,244
Tv 160,236,4096
Mvva 124,192,248
buffer_load_dwordx2 v[62:63], v9, s[16:19], s36 offen sc1
Mvva 124,196,252
Tv 162,236,6144
Mvva 140,200,248
Tv 164,238,4096
Mvva 140,204,252
s_waitcnt lgkmcnt(3)
Tv 166,238,6144
Mvva 120,144,16
buffer_load_dwordx4 v[84:87], v229, s[16:19], s45 offen sc1
Mvva 120,148,20
Tv 168,237,4096
Mvva 136,152,16
Tv 170,237,6144
Tv 172,239,4096
Tv 174,239,6144
Mvva 136,156,20
Tv 176,236,28672
Mvva 124,144,24
buffer_load_dwordx4 v[92:95], v229, s[16:19], s45 offen offset:1024 sc1
Mvva 124,148,28
Tv 178,236,30720
Mvva 140,152,24
Tv 180,238,28672
Mvva 140,156,28
s_waitcnt lgkmcnt(3)
Tv 182,238,30720
Mvva 120,160,48
buffer_load_dwordx4 v[100:103], v229, s[16:19], s46 offen sc1
Mvva 120,164,52
Tv 184,237,28672
Mvva 136,168,48
Tv 186,237,30720
Tv 188,239,28672
Tv 190,239,30720
Mvva 136,172,52
Tv 192,236,8192
Mvva 124,160,56
buffer_load_dwordx4 v[108:111], v229, s[16:19], s46 offen offset:1024 sc1
Mvva 124,164,60
Tv 194,236,10240
Mvva 140,168,56
Tv 196,238,8192
Mvva 140,172,60
s_waitcnt lgkmcnt(3)
Tv 198,238,10240
Mvva 120,176,80
Tv 200,237,8192
Mvva 120,180,84
Tv 202,237,10240
Mvva 136,184,80
Tv 204,239,8192
Tv 206,239,10240
Mvva 136,188,84
buffer_load_dwordx4 v[220:223], v229, s[16:19], s47 offen sc1
Mvva 124,176,88
Mvva 124,180,92
Mvva 140,184,88
buffer_load_dwordx4 v[224:227], v229, s[16:19], s47 offen offset:1024 sc1
Mvva 140,188,92
s_waitcnt lgkmcnt(0)
Mvva 120,192,112
Mvva 120,196,116
Mvva 136,200,112
Mvva 136,204,116
Mvva 124,192,120
Mvva 124,196,124
Mvva 140,200,120
Mvva 140,204,124
M_T:
s_cmp_lg_u32 s28, 0
s_cbranch_scc1 M_lt
s_waitcnt vmcnt(24)
v_lshlrev_b32 v64, 16, v16
v_and_b32 v65, 0xffff0000, v16
v_lshlrev_b32 v66, 16, v17
v_and_b32 v67, 0xffff0000, v17
v_lshlrev_b32 v68, 16, v18
v_and_b32 v69, 0xffff0000, v18
v_lshlrev_b32 v70, 16, v19
v_and_b32 v71, 0xffff0000, v19
s_waitcnt vmcnt(23)
v_lshlrev_b32 v72, 16, v20
v_and_b32 v73, 0xffff0000, v20
v_lshlrev_b32 v74, 16, v21
v_and_b32 v75, 0xffff0000, v21
v_lshlrev_b32 v76, 16, v22
v_and_b32 v77, 0xffff0000, v22
v_lshlrev_b32 v78, 16, v23
v_and_b32 v79, 0xffff0000, v23
s_waitcnt vmcnt(22)
v_dot2c_f32_bf16 v64, s74, v24
v_dot2c_f32_bf16 v65, s75, v24
v_dot2c_f32_bf16 v66, s74, v25
v_dot2c_f32_bf16 v67, s75, v25
v_dot2c_f32_bf16 v68, s74, v26
v_dot2c_f32_bf16 v69, s75, v26
v_dot2c_f32_bf16 v70, s74, v27
v_dot2c_f32_bf16 v71, s75, v27
s_waitcnt vmcnt(21)
v_dot2c_f32_bf16 v72, s74, v28
v_dot2c_f32_bf16 v73, s75, v28
v_dot2c_f32_bf16 v74, s74, v29
v_dot2c_f32_bf16 v75, s75, v29
v_dot2c_f32_bf16 v76, s74, v30
v_dot2c_f32_bf16 v77, s75, v30
v_dot2c_f32_bf16 v78, s74, v31
v_dot2c_f32_bf16 v79, s75, v31
s_waitcnt vmcnt(20)
v_dot2c_f32_bf16 v64, s74, v32
v_dot2c_f32_bf16 v65, s75, v32
v_dot2c_f32_bf16 v66, s74, v33
v_dot2c_f32_bf16 v67, s75, v33
v_dot2c_f32_bf16 v68, s74, v34
v_dot2c_f32_bf16 v69, s75, v34
v_dot2c_f32_bf16 v70, s74, v35
v_dot2c_f32_bf16 v71, s75, v35
s_waitcnt vmcnt(19)
v_dot2c_f32_bf16 v72, s74, v36
v_dot2c_f32_bf16 v73, s75, v36
v_dot2c_f32_bf16 v74, s74, v37
v_dot2c_f32_bf16 v75, s75, v37
v_dot2c_f32_bf16 v76, s74, v38
v_dot2c_f32_bf16 v77, s75, v38
v_dot2c_f32_bf16 v78, s74, v39
v_dot2c_f32_bf16 v79, s75, v39
s_waitcnt vmcnt(18)
v_dot2c_f32_bf16 v64, s74, v40
v_dot2c_f32_bf16 v65, s75, v40
v_dot2c_f32_bf16 v66, s74, v41
v_dot2c_f32_bf16 v67, s75, v41
v_dot2c_f32_bf16 v68, s74, v42
v_dot2c_f32_bf16 v69, s75, v42
v_dot2c_f32_bf16 v70, s74, v43
v_dot2c_f32_bf16 v71, s75, v43
s_waitcnt vmcnt(17)
v_dot2c_f32_bf16 v72, s74, v44
v_dot2c_f32_bf16 v73, s75, v44
v_dot2c_f32_bf16 v74, s74, v45
v_dot2c_f32_bf16 v75, s75, v45
v_dot2c_f32_bf16 v76, s74, v46
v_dot2c_f32_bf16 v77, s75, v46
v_dot2c_f32_bf16 v78, s74, v47
v_dot2c_f32_bf16 v79, s75, v47
s_waitcnt vmcnt(6)
v_lshlrev_b32 v216, 16, v48
v_and_b32 v217, 0xffff0000, v48
v_lshlrev_b32 v218, 16, v49
v_and_b32 v219, 0xffff0000, v49
v_dot2c_f32_bf16 v216, s74, v50
v_dot2c_f32_bf16 v217, s75, v50
v_dot2c_f32_bf16 v218, s74, v51
v_dot2c_f32_bf16 v219, s75, v51
v_dot2c_f32_bf16 v216, s74, v52
v_dot2c_f32_bf16 v217, s75, v52
v_dot2c_f32_bf16 v218, s74, v53
v_dot2c_f32_bf16 v219, s75, v53
v_dot2c_f32_bf16 v216, s74, v54
v_dot2c_f32_bf16 v217, s75, v54
v_dot2c_f32_bf16 v218, s74, v55
v_dot2c_f32_bf16 v219, s75, v55
v_dot2c_f32_bf16 v216, s74, v56
v_dot2c_f32_bf16 v217, s75, v56
v_dot2c_f32_bf16 v218, s74, v57
v_dot2c_f32_bf16 v219, s75, v57
v_dot2c_f32_bf16 v216, s74, v58
v_dot2c_f32_bf16 v217, s75, v58
v_dot2c_f32_bf16 v218, s74, v59
v_dot2c_f32_bf16 v219, s75, v59
v_dot2c_f32_bf16 v216, s74, v60
v_dot2c_f32_bf16 v217, s75, v60
v_dot2c_f32_bf16 v218, s74, v61
v_dot2c_f32_bf16 v219, s75, v61
v_dot2c_f32_bf16 v216, s74, v62
v_dot2c_f32_bf16 v217, s75, v62
v_dot2c_f32_bf16 v218, s74, v63
v_dot2c_f32_bf16 v219, s75, v63
M_nl:
s_waitcnt vmcnt(5)
v_max3_u32 v228, v84, v85, v85
v_max3_u32 v228, v86, v87, v228
s_waitcnt vmcnt(4)
v_max3_u32 v228, v92, v93, v228
v_max3_u32 v228, v94, v95, v228
s_waitcnt vmcnt(3)
v_max3_u32 v228, v100, v101, v228
v_max3_u32 v228, v102, v103, v228
s_waitcnt vmcnt(2)
v_max3_u32 v228, v108, v109, v228
v_max3_u32 v228, v110, v111, v228
v_cmp_eq_u32 vcc, -1, v228
s_nop 0
s_cbranch_vccnz M_sG
M_rG:
PK 216,216,217
PK 217,218,219
v_dot2c_f32_bf16 v64, s74, v84
v_dot2c_f32_bf16 v65, s75, v84
v_dot2c_f32_bf16 v66, s74, v85
v_dot2c_f32_bf16 v67, s75, v85
v_dot2c_f32_bf16 v68, s74, v86
v_dot2c_f32_bf16 v69, s75, v86
v_dot2c_f32_bf16 v70, s74, v87
v_dot2c_f32_bf16 v71, s75, v87
v_dot2c_f32_bf16 v72, s74, v92
v_dot2c_f32_bf16 v73, s75, v92
v_dot2c_f32_bf16 v74, s74, v93
v_dot2c_f32_bf16 v75, s75, v93
v_dot2c_f32_bf16 v76, s74, v94
v_dot2c_f32_bf16 v77, s75, v94
v_dot2c_f32_bf16 v78, s74, v95
v_dot2c_f32_bf16 v79, s75, v95
v_dot2c_f32_bf16 v64, s74, v100
v_dot2c_f32_bf16 v65, s75, v100
v_dot2c_f32_bf16 v66, s74, v101
v_dot2c_f32_bf16 v67, s75, v101
v_dot2c_f32_bf16 v68, s74, v102
v_dot2c_f32_bf16 v69, s75, v102
v_dot2c_f32_bf16 v70, s74, v103
v_dot2c_f32_bf16 v71, s75, v103
v_dot2c_f32_bf16 v72, s74, v108
v_dot2c_f32_bf16 v73, s75, v108
v_dot2c_f32_bf16 v74, s74, v109
v_dot2c_f32_bf16 v75, s75, v109
v_dot2c_f32_bf16 v76, s74, v110
v_dot2c_f32_bf16 v77, s75, v110
v_dot2c_f32_bf16 v78, s74, v111
v_dot2c_f32_bf16 v79, s75, v111
s_nop 2
v_pk_add_f32 v[64:65], v[64:65], v[120:121]
v_pk_add_f32 v[66:67], v[66:67], v[122:123]
v_pk_add_f32 v[68:69], v[68:69], v[124:125]
v_pk_add_f32 v[70:71], v[70:71], v[126:127]
v_pk_add_f32 v[72:73], v[72:73], v[136:137]
v_pk_add_f32 v[74:75], v[74:75], v[138:139]
v_pk_add_f32 v[76:77], v[76:77], v[140:141]
v_pk_add_f32 v[78:79], v[78:79], v[142:143]
s_waitcnt vmcnt(1)
v_max3_u32 v228, v220, v221, v221
v_max3_u32 v228, v222, v223, v228
s_waitcnt vmcnt(0)
v_max3_u32 v228, v224, v225, v228
v_max3_u32 v228, v226, v227, v228
v_cmp_eq_u32 vcc, -1, v228
s_nop 0
s_cbranch_vccnz M_sL
M_rL:
v_dot2c_f32_bf16 v64, s74, v220
v_dot2c_f32_bf16 v65, s75, v220
v_dot2c_f32_bf16 v66, s74, v221
v_dot2c_f32_bf16 v67, s75, v221
v_dot2c_f32_bf16 v68, s74, v222
v_dot2c_f32_bf16 v69, s75, v222
v_dot2c_f32_bf16 v70, s74, v223
v_dot2c_f32_bf16 v71, s75, v223
v_dot2c_f32_bf16 v72, s74, v224
v_dot2c_f32_bf16 v73, s75, v224
v_dot2c_f32_bf16 v74, s74, v225
v_dot2c_f32_bf16 v75, s75, v225
v_dot2c_f32_bf16 v76, s74, v226
v_dot2c_f32_bf16 v77, s75, v226
v_dot2c_f32_bf16 v78, s74, v227
v_dot2c_f32_bf16 v79, s75, v227
PK 64,64,65
PK 65,66,67
PK 66,68,69
PK 67,70,71
s_nop 0
v_permlane16_swap_b32 v64, v66
v_permlane16_swap_b32 v65, v67
buffer_store_dwordx4 v[64:67], v7, s[12:15], s68 offen
PK 72,72,73
PK 73,74,75
PK 74,76,77
PK 75,78,79
s_nop 0
v_permlane16_swap_b32 v72, v74
v_permlane16_swap_b32 v73, v75
buffer_store_dwordx4 v[72:75], v7, s[12:15], s68 offen offset:32
buffer_store_dwordx2 v[216:217], v8, s[12:15], s69 offen
s_endpgm
M_lt:
s_xor_b32 s53, s28, 0xff
v_mov_b32 v64, 0
v_mov_b32 v65, 0
v_mov_b32 v66, 0
v_mov_b32 v67, 0
v_mov_b32 v68, 0
v_mov_b32 v69, 0
v_mov_b32 v70, 0
v_mov_b32 v71, 0
v_mov_b32 v72, 0
v_mov_b32 v73, 0
v_mov_b32 v74, 0
v_mov_b32 v75, 0
v_mov_b32 v76, 0
v_mov_b32 v77, 0
v_mov_b32 v78, 0
v_mov_b32 v79, 0
v_mov_b32 v216, 0
v_mov_b32 v217, 0
v_mov_b32 v218, 0
v_mov_b32 v219, 0
M_l1:
s_add_u32 s88, s88, 1
s_waitcnt vmcnt(0)
v_cmp_ne_u32 vcc, 1, v213
s_nop 0
s_and_b32 s29, vcc_lo, s28
s_cmp_gt_u32 s88, 0x40000
s_cselect_b32 s29, 0, s29
s_xor_b32 s29, s29, s28
s_cmp_eq_u32 s29, 0
s_cbranch_scc1 M_l2
s_xor_b32 s28, s28, s29
s_add_u32 s36, s41, 0xe800
s_bitcmp0_b32 s29, 7
s_cbranch_scc1 M_la0
buffer_load_dwordx4 v[16:19], v1, s[16:19], s41 offen sc1
buffer_load_dwordx4 v[20:23], v1, s[16:19], s41 offen offset:1024 sc1
buffer_load_dwordx2 v[48:49], v9, s[16:19], s36 offen sc1
M_la0:
s_add_u32 s36, s42, 0xc800
s_bitcmp0_b32 s29, 6
s_cbranch_scc1 M_la1
buffer_load_dwordx4 v[24:27], v1, s[16:19], s42 offen sc1
buffer_load_dwordx4 v[28:31], v1, s[16:19], s42 offen offset:1024 sc1
buffer_load_dwordx2 v[50:51], v9, s[16:19], s36 offen sc1
M_la1:
s_add_u32 s36, s43, 0xa800
s_bitcmp0_b32 s29, 5
s_cbranch_scc1 M_la2
buffer_load_dwordx4 v[32:35], v1, s[16:19], s43 offen sc1
buffer_load_dwordx4 v[36:39], v1, s[16:19], s43 offen offset:1024 sc1
buffer_load_dwordx2 v[52:53], v9, s[16:19], s36 offen sc1
M_la2:
s_add_u32 s36, s44, 0x8800
s_bitcmp0_b32 s29, 4
s_cbranch_scc1 M_la3
buffer_load_dwordx4 v[40:43], v1, s[16:19], s44 offen sc1
buffer_load_dwordx4 v[44:47], v1, s[16:19], s44 offen offset:1024 sc1
buffer_load_dwordx2 v[54:55], v9, s[16:19], s36 offen sc1
M_la3:
s_add_u32 s36, s45, 0x6800
s_bitcmp0_b32 s29, 3
s_cbranch_scc1 M_la4
buffer_load_dwordx2 v[56:57], v9, s[16:19], s36 offen sc1
M_la4:
s_add_u32 s36, s46, 0x4800
s_bitcmp0_b32 s29, 2
s_cbranch_scc1 M_la5
buffer_load_dwordx2 v[58:59], v9, s[16:19], s36 offen sc1
M_la5:
s_add_u32 s36, s47, 0x2800
s_bitcmp0_b32 s29, 1
s_cbranch_scc1 M_la6
buffer_load_dwordx2 v[60:61], v9, s[16:19], s36 offen sc1
M_la6:
s_cmp_lg_u32 s28, 0
s_cbranch_scc1 M_l3
buffer_load_dwordx4 v[84:87], v1, s[16:19], s45 offen sc1
buffer_load_dwordx4 v[92:95], v1, s[16:19], s45 offen offset:1024 sc1
buffer_load_dwordx4 v[100:103], v1, s[16:19], s46 offen sc1
buffer_load_dwordx4 v[108:111], v1, s[16:19], s46 offen offset:1024 sc1
buffer_load_dwordx4 v[220:223], v1, s[16:19], s47 offen sc1
buffer_load_dwordx4 v[224:227], v1, s[16:19], s47 offen offset:1024 sc1
M_l2:
s_cmp_eq_u32 s28, 0
s_cbranch_scc1 M_l4
M_l3:
buffer_load_dword v213, v214, s[16:19], s71 offen sc1
M_l4:
s_cmp_eq_u32 s53, 0
s_cbranch_scc1 M_lb7
s_bitcmp0_b32 s53, 7
s_cbranch_scc1 M_lb0
v_dot2c_f32_bf16 v64, s74, v16
v_dot2c_f32_bf16 v65, s75, v16
v_dot2c_f32_bf16 v66, s74, v17
v_dot2c_f32_bf16 v67, s75, v17
v_dot2c_f32_bf16 v68, s74, v18
v_dot2c_f32_bf16 v69, s75, v18
v_dot2c_f32_bf16 v70, s74, v19
v_dot2c_f32_bf16 v71, s75, v19
v_dot2c_f32_bf16 v72, s74, v20
v_dot2c_f32_bf16 v73, s75, v20
v_dot2c_f32_bf16 v74, s74, v21
v_dot2c_f32_bf16 v75, s75, v21
v_dot2c_f32_bf16 v76, s74, v22
v_dot2c_f32_bf16 v77, s75, v22
v_dot2c_f32_bf16 v78, s74, v23
v_dot2c_f32_bf16 v79, s75, v23
v_dot2c_f32_bf16 v216, s74, v48
v_dot2c_f32_bf16 v217, s75, v48
v_dot2c_f32_bf16 v218, s74, v49
v_dot2c_f32_bf16 v219, s75, v49
M_lb0:
s_bitcmp0_b32 s53, 6
s_cbranch_scc1 M_lb1
v_dot2c_f32_bf16 v64, s74, v24
v_dot2c_f32_bf16 v65, s75, v24
v_dot2c_f32_bf16 v66, s74, v25
v_dot2c_f32_bf16 v67, s75, v25
v_dot2c_f32_bf16 v68, s74, v26
v_dot2c_f32_bf16 v69, s75, v26
v_dot2c_f32_bf16 v70, s74, v27
v_dot2c_f32_bf16 v71, s75, v27
v_dot2c_f32_bf16 v72, s74, v28
v_dot2c_f32_bf16 v73, s75, v28
v_dot2c_f32_bf16 v74, s74, v29
v_dot2c_f32_bf16 v75, s75, v29
v_dot2c_f32_bf16 v76, s74, v30
v_dot2c_f32_bf16 v77, s75, v30
v_dot2c_f32_bf16 v78, s74, v31
v_dot2c_f32_bf16 v79, s75, v31
v_dot2c_f32_bf16 v216, s74, v50
v_dot2c_f32_bf16 v217, s75, v50
v_dot2c_f32_bf16 v218, s74, v51
v_dot2c_f32_bf16 v219, s75, v51
M_lb1:
s_bitcmp0_b32 s53, 5
s_cbranch_scc1 M_lb2
v_dot2c_f32_bf16 v64, s74, v32
v_dot2c_f32_bf16 v65, s75, v32
v_dot2c_f32_bf16 v66, s74, v33
v_dot2c_f32_bf16 v67, s75, v33
v_dot2c_f32_bf16 v68, s74, v34
v_dot2c_f32_bf16 v69, s75, v34
v_dot2c_f32_bf16 v70, s74, v35
v_dot2c_f32_bf16 v71, s75, v35
v_dot2c_f32_bf16 v72, s74, v36
v_dot2c_f32_bf16 v73, s75, v36
v_dot2c_f32_bf16 v74, s74, v37
v_dot2c_f32_bf16 v75, s75, v37
v_dot2c_f32_bf16 v76, s74, v38
v_dot2c_f32_bf16 v77, s75, v38
v_dot2c_f32_bf16 v78, s74, v39
v_dot2c_f32_bf16 v79, s75, v39
v_dot2c_f32_bf16 v216, s74, v52
v_dot2c_f32_bf16 v217, s75, v52
v_dot2c_f32_bf16 v218, s74, v53
v_dot2c_f32_bf16 v219, s75, v53
M_lb2:
s_bitcmp0_b32 s53, 4
s_cbranch_scc1 M_lb3
v_dot2c_f32_bf16 v64, s74, v40
v_dot2c_f32_bf16 v65, s75, v40
v_dot2c_f32_bf16 v66, s74, v41
v_dot2c_f32_bf16 v67, s75, v41
v_dot2c_f32_bf16 v68, s74, v42
v_dot2c_f32_bf16 v69, s75, v42
v_dot2c_f32_bf16 v70, s74, v43
v_dot2c_f32_bf16 v71, s75, v43
v_dot2c_f32_bf16 v72, s74, v44
v_dot2c_f32_bf16 v73, s75, v44
v_dot2c_f32_bf16 v74, s74, v45
v_dot2c_f32_bf16 v75, s75, v45
v_dot2c_f32_bf16 v76, s74, v46
v_dot2c_f32_bf16 v77, s75, v46
v_dot2c_f32_bf16 v78, s74, v47
v_dot2c_f32_bf16 v79, s75, v47
v_dot2c_f32_bf16 v216, s74, v54
v_dot2c_f32_bf16 v217, s75, v54
v_dot2c_f32_bf16 v218, s74, v55
v_dot2c_f32_bf16 v219, s75, v55
M_lb3:
s_bitcmp0_b32 s53, 3
s_cbranch_scc1 M_lb4
v_dot2c_f32_bf16 v216, s74, v56
v_dot2c_f32_bf16 v217, s75, v56
v_dot2c_f32_bf16 v218, s74, v57
v_dot2c_f32_bf16 v219, s75, v57
M_lb4:
s_bitcmp0_b32 s53, 2
s_cbranch_scc1 M_lb5
v_dot2c_f32_bf16 v216, s74, v58
v_dot2c_f32_bf16 v217, s75, v58
v_dot2c_f32_bf16 v218, s74, v59
v_dot2c_f32_bf16 v219, s75, v59
M_lb5:
s_bitcmp0_b32 s53, 1
s_cbranch_scc1 M_lb6
v_dot2c_f32_bf16 v216, s74, v60
v_dot2c_f32_bf16 v217, s75, v60
v_dot2c_f32_bf16 v218, s74, v61
v_dot2c_f32_bf16 v219, s75, v61
M_lb6:
s_bitcmp0_b32 s53, 0
s_cbranch_scc1 M_lb7
v_dot2c_f32_bf16 v216, s74, v62
v_dot2c_f32_bf16 v217, s75, v62
v_dot2c_f32_bf16 v218, s74, v63
v_dot2c_f32_bf16 v219, s75, v63
M_lb7:
s_mov_b32 s53, s29
s_or_b32 s29, s29, s28
s_cmp_lg_u32 s29, 0
s_cbranch_scc1 M_l1
s_branch M_nl
s_waitcnt vmcnt(0)
M_sG:
s_mov_b64 s[86:87], 0
s_add_u32 s88, s88, 1
s_mov_b64 exec, -1
s_waitcnt vmcnt(3)
v_max3_u32 v228, v84, v85, v86
v_max_u32 v228, v87, v228
v_cmp_eq_u32 vcc, -1, v228
s_nop 0
s_mov_b64 exec, vcc
s_or_b64 s[86:87], s[86:87], vcc
buffer_load_dwordx4 v[84:87], v1, s[16:19], s45 offen sc1
s_mov_b64 exec, -1
s_waitcnt vmcnt(3)
v_max3_u32 v228, v92, v93, v94
v_max_u32 v228, v95, v228
v_cmp_eq_u32 vcc, -1, v228
s_nop 0
s_mov_b64 exec, vcc
s_or_b64 s[86:87], s[86:87], vcc
buffer_load_dwordx4 v[92:95], v1, s[16:19], s45 offen offset:1024 sc1
s_mov_b64 exec, -1
s_waitcnt vmcnt(3)
v_max3_u32 v228, v100, v101, v102
v_max_u32 v228, v103, v228
v_cmp_eq_u32 vcc, -1, v228
s_nop 0
s_mov_b64 exec, vcc
s_or_b64 s[86:87], s[86:87], vcc
buffer_load_dwordx4 v[100:103], v1, s[16:19], s46 offen sc1
s_mov_b64 exec, -1
s_waitcnt vmcnt(3)
v_max3_u32 v228, v108, v109, v110
v_max_u32 v228, v111, v228
v_cmp_eq_u32 vcc, -1, v228
s_nop 0
s_mov_b64 exec, vcc
s_or_b64 s[86:87], s[86:87], vcc
buffer_load_dwordx4 v[108:111], v1, s[16:19], s46 offen offset:1024 sc1
s_mov_b64 exec, -1
s_cmp_gt_u32 s88, 0x40000
s_cbranch_scc1 M_xG
s_cmp_lg_u64 s[86:87], 0
s_cbranch_scc1 M_sG
M_xG:
s_waitcnt vmcnt(0)
s_branch M_rG
M_sL:
s_mov_b64 s[86:87], 0
s_add_u32 s88, s88, 1
s_mov_b64 exec, -1
s_waitcnt vmcnt(1)
v_max3_u32 v228, v220, v221, v222
v_max_u32 v228, v223, v228
v_cmp_eq_u32 vcc, -1, v228
s_nop 0
s_mov_b64 exec, vcc
s_or_b64 s[86:87], s[86:87], vcc
buffer_load_dwordx4 v[220:223], v1, s[16:19], s47 offen sc1
s_mov_b64 exec, -1
s_waitcnt vmcnt(1)
v_max3_u32 v228, v224, v225, v226
v_max_u32 v228, v227, v228
v_cmp_eq_u32 vcc, -1, v228
s_nop 0
s_mov_b64 exec, vcc
s_or_b64 s[86:87], s[86:87], vcc
buffer_load_dwordx4 v[224:227], v1, s[16:19], s47 offen offset:1024 sc1
s_mov_b64 exec, -1
s_cmp_gt_u32 s88, 0x40000
s_cbranch_scc1 M_xL
s_cmp_lg_u64 s[86:87], 0
s_cbranch_scc1 M_sL
M_xL:
s_waitcnt vmcnt(0)
s_branch M_rL
M_end:
.section .rodata,"a"
.p2align 6
.amdhsa_kernel gated_mix__compressed_kv_cla__dense_activation_silu__prompt_kernel
  .amdhsa_next_free_vgpr 512
  .amdhsa_next_free_sgpr 102
  .amdhsa_accum_offset 256
  .amdhsa_group_segment_fixed_size 0
  .amdhsa_kernarg_size 104
  .amdhsa_user_sgpr_count 2
  .amdhsa_user_sgpr_kernarg_segment_ptr 1
  .amdhsa_system_sgpr_workgroup_id_x 1
.end_amdhsa_kernel
```
